```python
import torch

def _softmax(x, axis=-1):
    return torch.softmax(x, dim=axis)

def _gelu(x):
    return torch.nn.functional.gelu(x, approximate='tanh')

def _silu(x):
    return torch.nn.functional.silu(x)

def _sigmoid(x):
    return torch.sigmoid(x)

def _layernorm(x, axis=-1, eps=1e-05):
    m = x.mean(dim=axis, keepdim=True)
    v = x.var(dim=axis, keepdim=True, unbiased=False)
    return (x - m) / torch.sqrt(v + eps)

def _scatter_add(tgt, idx, src, axis=0):
    return tgt.clone().index_add_(axis, idx, src)

def _segment_sum(src, seg, n):
    out = torch.zeros((n,) + src.shape[1:], dtype=src.dtype)
    return out.index_add_(0, seg, src)

def _pad(x, pw):
    flat = tuple((v for pair in reversed(pw) for v in pair))
    return torch.nn.functional.pad(x, flat)
kernel_name = 'parallel_sum__spectral_fnet__mixer_gmlp__prompt'

def setup_inputs():

    _w = lambda a: (lambda t: t.to(torch.bfloat16) if t.is_floating_point() else t)(torch.as_tensor(a))

    def _A_setup():
        B, S, D = (1, 2048, 512)
        ns = torch.arange(S)[:, None] * torch.arange(S)[None, :]
        nd = torch.arange(D)[:, None] * torch.arange(D)[None, :]
        Ws_re = torch.cos(-2.0 * torch.pi * ns / S).to(float)
        Ws_im = torch.sin(-2.0 * torch.pi * ns / S).to(float)
        Wd_re = torch.cos(-2.0 * torch.pi * nd / D).to(float)
        Wd_im = torch.sin(-2.0 * torch.pi * nd / D).to(float)
        return {'x': _w((lambda *s: torch.randn(*s, dtype=torch.bfloat16) * 0.05)(B, S, D)), 'dft_seq_re': _w(Ws_re), 'dft_seq_im': _w(Ws_im), 'dft_hid_re': _w(Wd_re), 'dft_hid_im': _w(Wd_im)}
    _A_in = _A_setup()

    def _B_setup():
        B, S, D, F = (1, 2048, 512, 1792)
        Fh = F // 2
        return {'x': _w((lambda *s: torch.randn(*s, dtype=torch.bfloat16) * 0.05)(B, S, D)), 'w_in': _w((lambda *s: torch.randn(*s, dtype=torch.bfloat16) * 0.8)(D, 2 * Fh)), 'w_sp': _w(0.01 * (lambda *s: torch.randn(*s, dtype=torch.bfloat16) * 0.8)(S, S)), 'b_sp': _w(1.0 + 0.01 * (lambda *s: torch.randn(*s, dtype=torch.bfloat16) * 0.8)(S)), 'w_out': _w((lambda *s: torch.randn(*s, dtype=torch.bfloat16) * 0.8)(Fh, D))}
    _B_in = _B_setup()
    return {'A_x': _A_in['x'], 'A_dft_seq_re': _A_in['dft_seq_re'], 'A_dft_seq_im': _A_in['dft_seq_im'], 'A_dft_hid_re': _A_in['dft_hid_re'], 'A_dft_hid_im': _A_in['dft_hid_im'], 'B_x': _B_in['x'], 'B_w_in': _B_in['w_in'], 'B_w_sp': _B_in['w_sp'], 'B_b_sp': _B_in['b_sp'], 'B_w_out': _B_in['w_out']}

def reference(A_x, A_dft_seq_re, A_dft_seq_im, A_dft_hid_re, A_dft_hid_im, B_x, B_w_in, B_w_sp, B_b_sp, B_w_out):

    def _A_ref(x, dft_seq_re, dft_seq_im, dft_hid_re, dft_hid_im):
        a = torch.einsum('bsd,ed->bse', x, dft_hid_re)
        b = torch.einsum('bsd,ed->bse', x, dft_hid_im)
        y = torch.einsum('ts,bse->bte', dft_seq_re, a) - torch.einsum('ts,bse->bte', dft_seq_im, b)
        return y

    def _B_ref(x, w_in, w_sp, b_sp, w_out):
        B, S, D = x.shape
        F = w_in.shape[-1]
        Fh = F // 2
        z = _gelu(torch.einsum('bsd,df->bsf', x, w_in))
        z1 = z[..., :Fh].clone()
        z2 = _layernorm(z[..., Fh:], axis=-1)
        g = torch.einsum('ts,bsf->btf', w_sp, z2) + b_sp[None, :, None]
        return torch.einsum('bsf,fd->bsd', z1 * g, w_out)
    x = A_x
    xn = _layernorm(x, axis=-1)
    return x + _A_ref(xn, A_dft_seq_re, A_dft_seq_im, A_dft_hid_re, A_dft_hid_im) + _B_ref(xn, B_w_in, B_w_sp, B_b_sp, B_w_out)
```

```asm
; @launch kernel=gz_kernel grid=(256,1,1) block=(512,1,1) lds=163840
.amdgcn_target "amdgcn-amd-amdhsa--gfx950"
.text
.globl gz_kernel
.p2align 8
.type gz_kernel,@function
gz_kernel:
  s_cmp_ge_u32 s2, 256
  s_cbranch_scc1 .Lexit
  s_load_dwordx16 s[44:59], s[0:1], 0
  s_load_dwordx8 s[60:67], s[0:1], 64
  s_load_dwordx2 s[68:69], s[0:1], 96
  v_lshrrev_b32 v1, 6, v0
  s_and_b32 s71, s2, 3
  s_lshl_b32 s71, s71, 2
  v_readfirstlane_b32 s70, v1
  v_and_b32 v0, 63, v0
  s_lshr_b32 s3, s2, 6
  s_add_u32 s71, s71, s3
  s_bfe_u32 s72, s2, 196611
  s_and_b32 s75, s70, 3
  s_mov_b32 s74, 262144
  s_mov_b32 s6, 2097152
  s_mov_b32 s7, 0x20000
  s_mov_b32 s10, 1835008
  s_mov_b32 s11, 0x20000
  s_mov_b32 s14, 524288
  s_mov_b32 s15, 0x20000
  s_mov_b32 s18, 22020096
  s_mov_b32 s19, 0x20000
  s_mov_b32 s22, 256
  s_mov_b32 s23, 0x20000
  s_mov_b32 s26, 8388608
  s_mov_b32 s27, 0x20000
  s_mov_b32 s30, 917504
  s_mov_b32 s31, 0x20000
  s_mov_b32 s34, 2097152
  s_mov_b32 s35, 0x20000
  s_mov_b32 s38, 4096
  s_mov_b32 s39, 0x20000
  s_mov_b32 s43, 0x20000
.Lside_y:
  s_cmp_lt_u32 s70, 4
  s_cbranch_scc1 .Lcompute_y
  v_lshrrev_b32 v1, 4, v0
  v_xor_b32 v44, v1, v0
  v_and_b32 v44, 7, v44
  v_lshlrev_b32 v44, 4, v44
  v_lshrrev_b32 v1, 5, v0
  v_lshl_add_u32 v44, v1, 13, v44
  v_bfe_u32 v1, v0, 3, 2
  v_lshl_add_u32 v44, v1, 10, v44
  v_xor_b32 v45, 64, v44
  v_add_u32 v46, 2048, v44
  v_add_u32 v47, 17408, v45
  v_add_u32 v45, 15360, v45
  v_lshrrev_b32 v1, 3, v0
  v_and_b32 v2, 7, v0
  v_bfe_u32 v3, v0, 4, 1
  v_lshlrev_b32 v3, 2, v3
  v_xor_b32 v3, v2, v3
  v_lshlrev_b32 v3, 4, v3
  v_mul_u32_u24 v8, 3584, v1
  v_xor_b32 v9, 32, v3
  v_add_u32 v9, v8, v9
  v_add_u32 v9, 27648, v9
  v_add_u32 v8, v8, v3
  s_min_u32 s78, s72, 6
  s_mul_i32 s77, s75, 57344
  v_and_b32 v3, 3, v0
  v_mul_u32_u24 v3, 260, v3
  v_add_u32 v10, 147456, v3
  s_lshl_b32 s3, s75, 8
  s_add_u32 s3, s3, 147456
  v_lshl_add_u32 v11, v0, 2, s3
  v_mov_b32 v13, 0
  ds_write_b32 v11, v13
  ds_write_b32 v11, v13 offset:2048
  s_mov_b32 s76, 0
  s_lshl_b32 s79, s78, 7
  s_add_u32 s79, s79, s77
  s_lshl2_add_u32 s77, s71, s75
  s_waitcnt lgkmcnt(0)
  s_mov_b32 s4, s44
  s_mov_b32 s5, s45
  s_mov_b32 s8, s56
  s_mov_b32 s9, s57
  s_mov_b32 s16, s68
  s_mov_b32 s17, s69
  s_mov_b32 s20, s66
  s_mov_b32 s21, s67
  s_lshr_b32 s3, s2, 1
  s_xor_b32 s3, s3, s2
  s_cmp_eq_u32 s72, 7
  s_cselect_b32 s3, 2, s3
  s_bitcmp1_b32 s3, 1
  s_cselect_b32 s12, s50, s52
  s_cselect_b32 s13, s51, s53
  s_bitcmp0_b32 s2, 1
  s_cselect_b32 s40, s46, s48
  s_cselect_b32 s41, s47, s49
  s_mov_b32 s42, 8388608
  s_bitcmp0_b32 s2, 2
  s_cselect_b32 s24, s40, s58
  s_cselect_b32 s25, s41, s59
  s_cselect_b32 s40, s52, s40
  s_cselect_b32 s41, s53, s41
  s_cselect_b32 s42, 524288, s42
  s_mov_b32 s28, s62
  s_mov_b32 s29, s63
  s_mov_b32 s32, s64
  s_mov_b32 s33, s65
  s_mov_b32 s36, s60
  s_mov_b32 s37, s61
  s_cselect_b32 s44, 0, 896
  s_add_u32 s44, s79, s44
  s_add_u32 s46, s44, 1792
  s_lshl_b32 s45, s77, 15
  s_lshl_b32 s48, s75, 11
  s_lshl_b32 s49, s75, 12
.Lh_srd_y:
  s_and_b32 s3, s2, 0x3C
  s_cmp_eq_u32 s3, 0x3C
  s_cbranch_scc1 .Lh_issued_y
  s_add_u32 s47, s76, 0
  s_and_b32 s47, s47, 7
  s_lshl_b32 s3, s47, 7
  s_add_u32 m0, s49, 98304
  s_add_u32 s3, s3, s45
  buffer_load_dwordx4 v44, s[4:7], s3 offen lds
  buffer_load_dwordx4 v45, s[4:7], s3 offen offset:1024 lds
  buffer_load_dwordx4 v46, s[4:7], s3 offen offset:2048 lds
  buffer_load_dwordx4 v47, s[4:7], s3 offen offset:3072 lds
  s_add_u32 s47, s76, 0
  s_and_b32 s47, s47, 7
  s_mul_i32 s3, s47, 229376
  s_add_u32 m0, s48, 0
  s_add_u32 s3, s3, s46
  buffer_load_dwordx4 v8, s[8:11], s3 offen lds
  buffer_load_dwordx4 v9, s[8:11], s3 offen offset:1024 lds
  s_add_u32 s47, s76, 1
  s_and_b32 s47, s47, 7
  s_lshl_b32 s3, s47, 7
  s_add_u32 m0, s49, 114688
  s_add_u32 s3, s3, s45
  buffer_load_dwordx4 v44, s[4:7], s3 offen lds
  buffer_load_dwordx4 v45, s[4:7], s3 offen offset:1024 lds
  buffer_load_dwordx4 v46, s[4:7], s3 offen offset:2048 lds
  buffer_load_dwordx4 v47, s[4:7], s3 offen offset:3072 lds
  s_add_u32 s47, s76, 1
  s_and_b32 s47, s47, 7
  s_mul_i32 s3, s47, 229376
  s_add_u32 m0, s48, 8192
  s_add_u32 s3, s3, s46
  buffer_load_dwordx4 v8, s[8:11], s3 offen lds
  buffer_load_dwordx4 v9, s[8:11], s3 offen offset:1024 lds
.Lh_issued_y:
  v_lshrrev_b32 v3, 4, v0
  v_xor_b32 v3, v2, v3
  v_lshlrev_b32 v3, 4, v3
  v_lshl_add_u32 v4, v1, 10, v3
  v_xor_b32 v5, 64, v4
  v_add_u32 v5, 7168, v5
  s_lshl2_add_u32 s77, s72, s75
  s_lshl_b32 s77, s77, 14
  s_lshl_b32 s3, s75, 13
  s_add_u32 s3, s3, 98304
  v_lshl_add_u32 v57, v0, 4, s3
  v_and_b32 v1, 15, v0
  v_lshrrev_b32 v2, 4, v0
  v_lshrrev_b32 v3, 5, v0
  v_lshl_add_u32 v3, v3, 4, v1
  v_lshlrev_b32 v58, 4, v3
  v_and_b32 v3, 1, v2
  v_lshl_add_u32 v58, v3, 3, v58
  v_and_b32 v63, 12, v0
  v_add_u32 v63, v63, v1
  v_lshrrev_b32 v59, 1, v63
  v_lshrrev_b32 v60, 5, v0
  v_xor_b32 v59, v59, v60
  v_and_b32 v59, 7, v59
  v_lshlrev_b32 v59, 4, v59
  v_lshl_add_u32 v59, v3, 3, v59
  v_lshl_add_u32 v59, v63, 7, v59
  s_lshl_b32 s79, s75, 5
  s_add_u32 s79, s79, s3
  v_xor_b32 v59, s79, v59
  s_lshl_b32 s79, s75, 7
  s_add_u32 s79, s79, 156672
  v_lshl_add_u32 v63, v63, 2, s79
  s_lshl_b32 s79, s75, 6
  s_xor_b32 s79, s79, 150656
  v_lshl_add_u32 v62, v2, 4, s79
  v_bfe_u32 v3, v0, 2, 2
  v_lshl_add_u32 v1, v2, 3, v3
  v_bfe_u32 v3, v1, 1, 3
  v_bfe_u32 v60, v0, 1, 1
  v_xor_b32 v3, v3, v60
  v_lshlrev_b32 v3, 4, v3
  v_lshl_add_u32 v3, v1, 7, v3
  v_and_b32 v1, 1, v0
  v_lshl_add_u32 v3, v1, 3, v3
  v_add_u32 v60, s3, v3
  v_mul_u32_u24 v1, 30720, v2
  v_and_b32 v2, 3, v0
  v_bfe_u32 v3, v0, 2, 1
  v_lshl_or_b32 v2, v3, 4, v2
  v_bfe_u32 v3, v0, 3, 1
  v_lshl_or_b32 v2, v3, 2, v2
  v_lshl_add_u32 v61, v2, 4, v1
  s_lshl_b32 s61, s71, 2
  s_add_u32 s61, s61, s75
  s_lshl_b32 s58, s61, 13
  s_add_u32 s58, s58, 16777216
  s_add_u32 s59, s58, 4096
  s_bitcmp1_b32 s2, 2
  s_cselect_b32 s3, 7, 0
  s_add_u32 s78, s78, s3
  s_lshl_b32 s60, s78, 9
  s_add_u32 s60, s60, s58
  s_lshl_b32 s62, s61, 2
  s_lshl_b32 s3, s78, 8
  s_add_u32 s62, s62, s3
  s_add_u32 s62, s62, 17305600
  s_mul_i32 s61, s61, 122880
  s_lshl_b32 s3, s78, 10
  s_add_u32 s61, s61, s3
  s_add_u32 s61, s61, 16384
  v_mov_b32 v54, 0
  v_mov_b32 v56, 0
  v_mov_b32 v50, 0
  v_mov_b32 v51, 0
  v_add_u32 v100, 4294962176, v63
  v_xor_b32 v101, 64, v62
  s_and_b32 s50, s2, 1
  s_lshl_b32 s50, s50, 3
  s_lshr_b32 s3, s2, 5
  s_add_u32 s50, s50, s3
  s_bitcmp1_b32 s2, 2
  s_cselect_b32 s50, s71, s50
  s_mov_b32 s51, 0
  s_lshl2_add_u32 s50, s50, s75
  s_lshl_b32 s50, s50, 17
  s_lshl_b32 s51, s51, 7
  v_lshrrev_b32 v1, 3, v0
  v_and_b32 v2, 7, v0
  v_lshrrev_b32 v3, 4, v0
  v_xor_b32 v3, v2, v3
  v_lshlrev_b32 v3, 4, v3
  v_lshl_add_u32 v200, v1, 12, v3
  v_xor_b32 v201, 64, v200
  v_add_u32 v202, 63488, v200
  v_add_u32 v203, 95232, v201
  v_add_u32 v201, 31744, v201
  v_bfe_u32 v3, v0, 4, 1
  v_lshlrev_b32 v3, 2, v3
  v_xor_b32 v2, v2, v3
  v_lshlrev_b32 v2, 4, v2
  v_lshl_add_u32 v204, v1, 10, v2
  v_add_u32 v205, 7168, v204
  s_lshl_b32 s69, s75, 14
  s_xor_b32 s3, s72, 4
  s_lshl_b32 s3, s3, 7
  s_add_u32 s69, s69, s3
  v_lshlrev_b32 v206, 7, v0
  s_barrier
  s_cmp_eq_u32 s72, 7
  s_cbranch_scc1 .Lh_j7
  s_add_u32 s47, s76, 2
  s_and_b32 s47, s47, 7
  s_lshl_b32 s3, s47, 7
  s_add_u32 m0, s49, 65536
  s_add_u32 s3, s3, s45
  s_waitcnt vmcnt(10)
  buffer_load_dwordx4 v44, s[4:7], s3 offen lds
  buffer_load_dwordx4 v45, s[4:7], s3 offen offset:1024 lds
  s_waitcnt vmcnt(10)
  buffer_load_dwordx4 v46, s[4:7], s3 offen offset:2048 lds
  buffer_load_dwordx4 v47, s[4:7], s3 offen offset:3072 lds
  s_add_u32 s47, s76, 2
  s_and_b32 s47, s47, 7
  s_mul_i32 s3, s47, 229376
  s_add_u32 m0, s48, 16384
  s_add_u32 s3, s3, s46
  s_waitcnt vmcnt(10)
  s_getreg_b32 s64, hwreg(HW_REG_IB_STS)
  s_bfe_u32 s65, s64, 131094
  s_and_b32 s64, s64, 15
  s_lshl4_add_u32 s64, s65, s64
  s_sub_u32 s64, 16, s64
  v_mov_b32 v13, s64
  ds_write_b32 v11, v13
.Lh_s0_y:
  buffer_load_dwordx4 v8, s[8:11], s3 offen lds
  buffer_load_dwordx4 v9, s[8:11], s3 offen offset:1024 lds
  s_add_u32 s47, s76, 3
  s_and_b32 s47, s47, 7
  s_lshl_b32 s3, s47, 7
  s_add_u32 m0, s49, 81920
  s_add_u32 s3, s3, s45
  s_waitcnt vmcnt(10)
  buffer_load_dwordx4 v44, s[4:7], s3 offen lds
  buffer_load_dwordx4 v45, s[4:7], s3 offen offset:1024 lds
  s_waitcnt vmcnt(10)
  buffer_load_dwordx4 v46, s[4:7], s3 offen offset:2048 lds
  buffer_load_dwordx4 v47, s[4:7], s3 offen offset:3072 lds
  s_add_u32 s47, s76, 3
  s_and_b32 s47, s47, 7
  s_mul_i32 s3, s47, 229376
  s_add_u32 m0, s48, 24576
  s_add_u32 s3, s3, s46
  s_waitcnt vmcnt(10)
  s_getreg_b32 s64, hwreg(HW_REG_IB_STS)
  s_bfe_u32 s65, s64, 131094
  s_and_b32 s64, s64, 15
  s_lshl4_add_u32 s64, s65, s64
  s_sub_u32 s64, 22, s64
  v_mov_b32 v13, s64
  ds_write_b32 v11, v13
.Lh_s1_y:
  buffer_load_dwordx4 v8, s[8:11], s3 offen lds
  buffer_load_dwordx4 v9, s[8:11], s3 offen offset:1024 lds
  s_add_u32 s47, s76, 4
  s_and_b32 s47, s47, 7
  s_mul_i32 s3, s47, 229376
  s_add_u32 m0, s48, 32768
  s_add_u32 s3, s3, s46
  s_waitcnt vmcnt(10)
  buffer_load_dwordx4 v8, s[8:11], s3 offen lds
  buffer_load_dwordx4 v9, s[8:11], s3 offen offset:1024 lds
  ds_read_b32 v12, v11 offset:11264
  s_waitcnt lgkmcnt(0)
  v_cmp_gt_u32 vcc, 1, v12
  s_cbranch_vccnz .Lsp_17
.Lrt_18:
  s_add_u32 s47, s76, 4
  s_and_b32 s47, s47, 7
  s_lshl_b32 s3, s47, 7
  s_add_u32 m0, s49, 98304
  s_add_u32 s3, s3, s45
  s_waitcnt vmcnt(10)
  buffer_load_dwordx4 v44, s[4:7], s3 offen lds
  buffer_load_dwordx4 v45, s[4:7], s3 offen offset:1024 lds
  s_waitcnt vmcnt(10)
  s_getreg_b32 s64, hwreg(HW_REG_IB_STS)
  s_bfe_u32 s65, s64, 131094
  s_and_b32 s64, s64, 15
  s_lshl4_add_u32 s64, s65, s64
  s_sub_u32 s64, 28, s64
  v_mov_b32 v13, s64
  ds_write_b32 v11, v13
.Lh_s2_y:
  buffer_load_dwordx4 v46, s[4:7], s3 offen offset:2048 lds
  buffer_load_dwordx4 v47, s[4:7], s3 offen offset:3072 lds
  s_add_u32 s47, s76, 5
  s_and_b32 s47, s47, 7
  s_mul_i32 s3, s47, 229376
  s_add_u32 m0, s48, 40960
  s_add_u32 s3, s3, s46
  s_waitcnt vmcnt(10)
  buffer_load_dwordx4 v8, s[8:11], s3 offen lds
  buffer_load_dwordx4 v9, s[8:11], s3 offen offset:1024 lds
  ds_read_b32 v12, v11 offset:11264
  s_waitcnt lgkmcnt(0)
  v_cmp_gt_u32 vcc, 2, v12
  s_cbranch_vccnz .Lsp_19
.Lrt_20:
  s_add_u32 s47, s76, 5
  s_and_b32 s47, s47, 7
  s_lshl_b32 s3, s47, 7
  s_add_u32 m0, s49, 114688
  s_add_u32 s3, s3, s45
  s_waitcnt vmcnt(10)
  buffer_load_dwordx4 v44, s[4:7], s3 offen lds
  buffer_load_dwordx4 v45, s[4:7], s3 offen offset:1024 lds
  s_waitcnt vmcnt(10)
  s_getreg_b32 s64, hwreg(HW_REG_IB_STS)
  s_bfe_u32 s65, s64, 131094
  s_and_b32 s64, s64, 15
  s_lshl4_add_u32 s64, s65, s64
  s_sub_u32 s64, 34, s64
  v_mov_b32 v13, s64
  ds_write_b32 v11, v13
.Lh_s3_y:
  buffer_load_dwordx4 v46, s[4:7], s3 offen offset:2048 lds
  buffer_load_dwordx4 v47, s[4:7], s3 offen offset:3072 lds
  s_add_u32 s47, s76, 6
  s_and_b32 s47, s47, 7
  s_mul_i32 s3, s47, 229376
  s_add_u32 m0, s48, 49152
  s_add_u32 s3, s3, s46
  s_waitcnt vmcnt(10)
  buffer_load_dwordx4 v8, s[8:11], s3 offen lds
  buffer_load_dwordx4 v9, s[8:11], s3 offen offset:1024 lds
  ds_read_b32 v12, v11 offset:11264
  s_waitcnt lgkmcnt(0)
  v_cmp_gt_u32 vcc, 3, v12
  s_cbranch_vccnz .Lsp_21
.Lrt_22:
  s_add_u32 s47, s76, 6
  s_and_b32 s47, s47, 7
  s_lshl_b32 s3, s47, 7
  s_add_u32 m0, s49, 65536
  s_add_u32 s3, s3, s45
  s_waitcnt vmcnt(10)
  buffer_load_dwordx4 v44, s[4:7], s3 offen lds
  buffer_load_dwordx4 v45, s[4:7], s3 offen offset:1024 lds
  s_waitcnt vmcnt(10)
  s_getreg_b32 s64, hwreg(HW_REG_IB_STS)
  s_bfe_u32 s65, s64, 131094
  s_and_b32 s64, s64, 15
  s_lshl4_add_u32 s64, s65, s64
  s_sub_u32 s64, 40, s64
  v_mov_b32 v13, s64
  ds_write_b32 v11, v13
.Lh_s4_y:
  buffer_load_dwordx4 v46, s[4:7], s3 offen offset:2048 lds
  buffer_load_dwordx4 v47, s[4:7], s3 offen offset:3072 lds
  s_add_u32 s47, s76, 7
  s_and_b32 s47, s47, 7
  s_mul_i32 s3, s47, 229376
  s_add_u32 m0, s48, 57344
  s_add_u32 s3, s3, s46
  s_waitcnt vmcnt(10)
  buffer_load_dwordx4 v8, s[8:11], s3 offen lds
  buffer_load_dwordx4 v9, s[8:11], s3 offen offset:1024 lds
  ds_read_b32 v12, v11 offset:11264
  s_waitcnt lgkmcnt(0)
  v_cmp_gt_u32 vcc, 4, v12
  s_cbranch_vccnz .Lsp_23
.Lrt_24:
  s_add_u32 s47, s76, 7
  s_and_b32 s47, s47, 7
  s_lshl_b32 s3, s47, 7
  s_add_u32 m0, s49, 81920
  s_add_u32 s3, s3, s45
  s_waitcnt vmcnt(10)
  buffer_load_dwordx4 v44, s[4:7], s3 offen lds
  buffer_load_dwordx4 v45, s[4:7], s3 offen offset:1024 lds
  s_waitcnt vmcnt(10)
  s_getreg_b32 s64, hwreg(HW_REG_IB_STS)
  s_bfe_u32 s65, s64, 131094
  s_and_b32 s64, s64, 15
  s_lshl4_add_u32 s64, s65, s64
  s_sub_u32 s64, 46, s64
  v_mov_b32 v13, s64
  ds_write_b32 v11, v13
.Lh_s5_y:
  buffer_load_dwordx4 v46, s[4:7], s3 offen offset:2048 lds
  buffer_load_dwordx4 v47, s[4:7], s3 offen offset:3072 lds
  s_add_u32 s47, s76, 0
  s_and_b32 s47, s47, 7
  s_mul_i32 s3, s47, 128
  s_add_u32 m0, s48, 131072
  s_add_u32 s3, s3, s77
  s_waitcnt vmcnt(10)
  buffer_load_dwordx4 v4, s[12:15], s3 offen lds
  buffer_load_dwordx4 v5, s[12:15], s3 offen offset:1024 lds
  s_add_u32 s47, s76, 1
  s_and_b32 s47, s47, 7
  s_mul_i32 s3, s47, 128
  s_add_u32 m0, s48, 139264
  s_add_u32 s3, s3, s77
  s_waitcnt vmcnt(10)
  buffer_load_dwordx4 v4, s[12:15], s3 offen lds
  buffer_load_dwordx4 v5, s[12:15], s3 offen offset:1024 lds
  buffer_load_dword v52, off, s[20:23], 0 sc1
  ds_read_b32 v12, v10 offset:1024
  s_waitcnt lgkmcnt(0)
  v_cmp_gt_u32 vcc, 2, v12
  s_cbranch_vccnz .Lsp_25
.Lrt_26:
  s_add_u32 s47, s76, 2
  s_and_b32 s47, s47, 7
  s_mul_i32 s3, s47, 128
  s_add_u32 m0, s48, 0
  s_add_u32 s3, s3, s77
  s_waitcnt vmcnt(10)
  s_getreg_b32 s64, hwreg(HW_REG_IB_STS)
  s_bfe_u32 s65, s64, 131094
  s_and_b32 s64, s64, 15
  s_lshl4_add_u32 s64, s65, s64
  s_sub_u32 s64, 53, s64
  v_mov_b32 v13, s64
  ds_write_b32 v11, v13
.Lh_s6_y:
  buffer_load_dwordx4 v4, s[12:15], s3 offen lds
  buffer_load_dwordx4 v5, s[12:15], s3 offen offset:1024 lds
  s_add_u32 s47, s76, 3
  s_and_b32 s47, s47, 7
  s_mul_i32 s3, s47, 128
  s_add_u32 m0, s48, 8192
  s_add_u32 s3, s3, s77
  s_waitcnt vmcnt(10)
  buffer_load_dwordx4 v4, s[12:15], s3 offen lds
  buffer_load_dwordx4 v5, s[12:15], s3 offen offset:1024 lds
  ds_read_b32 v12, v10 offset:1024
  s_waitcnt lgkmcnt(0)
  v_cmp_gt_u32 vcc, 4, v12
  s_cbranch_vccnz .Lsp_27
.Lrt_28:
  s_add_u32 s47, s76, 4
  s_and_b32 s47, s47, 7
  s_mul_i32 s3, s47, 128
  s_add_u32 m0, s48, 16384
  s_add_u32 s3, s3, s77
  s_waitcnt vmcnt(10)
  buffer_load_dwordx4 v4, s[12:15], s3 offen lds
  buffer_load_dwordx4 v5, s[12:15], s3 offen offset:1024 lds
  s_add_u32 s47, s76, 5
  s_and_b32 s47, s47, 7
  s_mul_i32 s3, s47, 128
  s_add_u32 m0, s48, 24576
  s_add_u32 s3, s3, s77
  s_waitcnt vmcnt(10)
  s_getreg_b32 s64, hwreg(HW_REG_IB_STS)
  s_bfe_u32 s65, s64, 131094
  s_and_b32 s64, s64, 15
  s_lshl4_add_u32 s64, s65, s64
  s_sub_u32 s64, 59, s64
  v_mov_b32 v13, s64
  ds_write_b32 v11, v13
.Lh_s7_y:
  buffer_load_dwordx4 v4, s[12:15], s3 offen lds
  buffer_load_dwordx4 v5, s[12:15], s3 offen offset:1024 lds
  ds_read_b32 v12, v10 offset:1024
  s_waitcnt lgkmcnt(0)
  v_cmp_gt_u32 vcc, 6, v12
  s_cbranch_vccnz .Lsp_29
.Lrt_30:
  s_add_u32 s47, s76, 6
  s_and_b32 s47, s47, 7
  s_mul_i32 s3, s47, 128
  s_add_u32 m0, s48, 32768
  s_add_u32 s3, s3, s77
  s_waitcnt vmcnt(10)
  buffer_load_dwordx4 v4, s[12:15], s3 offen lds
  buffer_load_dwordx4 v5, s[12:15], s3 offen offset:1024 lds
  s_add_u32 s47, s76, 7
  s_and_b32 s47, s47, 7
  s_mul_i32 s3, s47, 128
  s_add_u32 m0, s48, 40960
  s_add_u32 s3, s3, s77
  s_waitcnt vmcnt(10)
  s_getreg_b32 s64, hwreg(HW_REG_IB_STS)
  s_bfe_u32 s65, s64, 131094
  s_and_b32 s64, s64, 15
  s_lshl4_add_u32 s64, s65, s64
  s_sub_u32 s64, 63, s64
  v_mov_b32 v13, s64
  ds_write_b32 v11, v13
  buffer_load_dwordx4 v4, s[12:15], s3 offen lds
  buffer_load_dwordx4 v5, s[12:15], s3 offen offset:1024 lds
  ds_read_b32 v12, v10 offset:1024
  s_waitcnt lgkmcnt(0)
  v_cmp_gt_u32 vcc, 7, v12
  s_cbranch_vccnz .Lsp_31
.Lrt_32:
  s_add_u32 s47, s76, 0
  s_and_b32 s47, s47, 7
  s_mul_i32 s3, s47, 229376
  s_add_u32 m0, s48, 49152
  s_add_u32 s3, s3, s44
  s_waitcnt vmcnt(10)
  buffer_load_dwordx4 v8, s[8:11], s3 offen lds
  buffer_load_dwordx4 v9, s[8:11], s3 offen offset:1024 lds
  s_add_u32 s47, s76, 2
  s_and_b32 s47, s47, 7
  s_mul_i32 s3, s47, 229376
  s_add_u32 m0, s48, 65536
  s_add_u32 s3, s3, s44
  s_waitcnt vmcnt(10)
  buffer_load_dwordx4 v8, s[8:11], s3 offen lds
  buffer_load_dwordx4 v9, s[8:11], s3 offen offset:1024 lds
  s_add_u32 s47, s76, 3
  s_and_b32 s47, s47, 7
  s_mul_i32 s3, s47, 229376
  s_add_u32 m0, s48, 73728
  s_add_u32 s3, s3, s44
  s_waitcnt vmcnt(10)
  s_getreg_b32 s64, hwreg(HW_REG_IB_STS)
  s_bfe_u32 s65, s64, 131094
  s_and_b32 s64, s64, 15
  s_lshl4_add_u32 s64, s65, s64
  s_sub_u32 s64, 69, s64
  v_mov_b32 v13, s64
  ds_write_b32 v11, v13
  buffer_load_dwordx4 v8, s[8:11], s3 offen lds
  buffer_load_dwordx4 v9, s[8:11], s3 offen offset:1024 lds
  ds_read_b32 v12, v10 offset:1024
  s_waitcnt lgkmcnt(0)
  v_cmp_gt_u32 vcc, 8, v12
  s_cbranch_vccnz .Lsp_33
.Lrt_34:
  s_add_u32 s47, s76, 1
  s_and_b32 s47, s47, 7
  s_mul_i32 s3, s47, 229376
  s_add_u32 m0, s48, 57344
  s_add_u32 s3, s3, s44
  s_waitcnt vmcnt(10)
  buffer_load_dwordx4 v8, s[8:11], s3 offen lds
  buffer_load_dwordx4 v9, s[8:11], s3 offen offset:1024 lds
  s_add_u32 s47, s76, 4
  s_and_b32 s47, s47, 7
  s_mul_i32 s3, s47, 229376
  s_add_u32 m0, s48, 81920
  s_add_u32 s3, s3, s44
  s_waitcnt vmcnt(10)
  buffer_load_dwordx4 v8, s[8:11], s3 offen lds
  buffer_load_dwordx4 v9, s[8:11], s3 offen offset:1024 lds
  s_add_u32 s47, s76, 5
  s_and_b32 s47, s47, 7
  s_mul_i32 s3, s47, 229376
  s_add_u32 m0, s48, 90112
  s_add_u32 s3, s3, s44
  s_waitcnt vmcnt(10)
  s_getreg_b32 s64, hwreg(HW_REG_IB_STS)
  s_bfe_u32 s65, s64, 131094
  s_and_b32 s64, s64, 15
  s_lshl4_add_u32 s64, s65, s64
  s_sub_u32 s64, 75, s64
  v_mov_b32 v13, s64
  ds_write_b32 v11, v13
  buffer_load_dwordx4 v8, s[8:11], s3 offen lds
  buffer_load_dwordx4 v9, s[8:11], s3 offen offset:1024 lds
  s_getreg_b32 s3, hwreg(HW_REG_IB_STS)
  s_bfe_u32 s79, s3, 131094
  s_and_b32 s3, s3, 15
  s_lshl4_add_u32 s3, s79, s3
  s_sub_u32 s3, 77, s3
  v_mov_b32 v13, s3
  ds_write_b32 v11, v13
  s_bitcmp1_b32 s2, 2
  s_cbranch_scc1 .Lh_tail_g
  s_branch .Lh_tail_y
.Lh_j7:
  s_bitcmp1_b32 s2, 2
  s_cbranch_scc1 .Lh_tch_g
  s_branch .Lh_v7
.Lsp_17:
  s_getreg_b32 s3, hwreg(HW_REG_IB_STS)
  s_bfe_u32 s79, s3, 131094
  s_and_b32 s3, s3, 15
  s_lshl4_add_u32 s3, s79, s3
  s_sub_u32 s3, 26, s3
  v_mov_b32 v13, s3
  ds_write_b32 v11, v13
  ds_read_b32 v12, v11 offset:11264
  s_cmp_eq_u32 s74, 0
  s_waitcnt lgkmcnt(0)
  s_cbranch_scc1 .Lrt_18
  s_sub_u32 s74, s74, 1
  v_cmp_gt_u32 vcc, 1, v12
  s_cbranch_vccnz .Lsp_17
  s_branch .Lrt_18
.Lsp_19:
  s_getreg_b32 s3, hwreg(HW_REG_IB_STS)
  s_bfe_u32 s79, s3, 131094
  s_and_b32 s3, s3, 15
  s_lshl4_add_u32 s3, s79, s3
  s_sub_u32 s3, 32, s3
  v_mov_b32 v13, s3
  ds_write_b32 v11, v13
  ds_read_b32 v12, v11 offset:11264
  s_cmp_eq_u32 s74, 0
  s_waitcnt lgkmcnt(0)
  s_cbranch_scc1 .Lrt_20
  s_sub_u32 s74, s74, 1
  v_cmp_gt_u32 vcc, 2, v12
  s_cbranch_vccnz .Lsp_19
  s_branch .Lrt_20
.Lsp_21:
  s_getreg_b32 s3, hwreg(HW_REG_IB_STS)
  s_bfe_u32 s79, s3, 131094
  s_and_b32 s3, s3, 15
  s_lshl4_add_u32 s3, s79, s3
  s_sub_u32 s3, 38, s3
  v_mov_b32 v13, s3
  ds_write_b32 v11, v13
  ds_read_b32 v12, v11 offset:11264
  s_cmp_eq_u32 s74, 0
  s_waitcnt lgkmcnt(0)
  s_cbranch_scc1 .Lrt_22
  s_sub_u32 s74, s74, 1
  v_cmp_gt_u32 vcc, 3, v12
  s_cbranch_vccnz .Lsp_21
  s_branch .Lrt_22
.Lsp_23:
  s_getreg_b32 s3, hwreg(HW_REG_IB_STS)
  s_bfe_u32 s79, s3, 131094
  s_and_b32 s3, s3, 15
  s_lshl4_add_u32 s3, s79, s3
  s_sub_u32 s3, 44, s3
  v_mov_b32 v13, s3
  ds_write_b32 v11, v13
  ds_read_b32 v12, v11 offset:11264
  s_cmp_eq_u32 s74, 0
  s_waitcnt lgkmcnt(0)
  s_cbranch_scc1 .Lrt_24
  s_sub_u32 s74, s74, 1
  v_cmp_gt_u32 vcc, 4, v12
  s_cbranch_vccnz .Lsp_23
  s_branch .Lrt_24
.Lsp_25:
  s_getreg_b32 s3, hwreg(HW_REG_IB_STS)
  s_bfe_u32 s79, s3, 131094
  s_and_b32 s3, s3, 15
  s_lshl4_add_u32 s3, s79, s3
  s_sub_u32 s3, 53, s3
  v_mov_b32 v13, s3
  ds_write_b32 v11, v13
  ds_read_b32 v12, v10 offset:1024
  s_cmp_eq_u32 s74, 0
  s_waitcnt lgkmcnt(0)
  s_cbranch_scc1 .Lrt_26
  s_sub_u32 s74, s74, 1
  v_cmp_gt_u32 vcc, 2, v12
  s_cbranch_vccnz .Lsp_25
  s_branch .Lrt_26
.Lsp_27:
  s_getreg_b32 s3, hwreg(HW_REG_IB_STS)
  s_bfe_u32 s79, s3, 131094
  s_and_b32 s3, s3, 15
  s_lshl4_add_u32 s3, s79, s3
  s_sub_u32 s3, 57, s3
  v_mov_b32 v13, s3
  ds_write_b32 v11, v13
  ds_read_b32 v12, v10 offset:1024
  s_cmp_eq_u32 s74, 0
  s_waitcnt lgkmcnt(0)
  s_cbranch_scc1 .Lrt_28
  s_sub_u32 s74, s74, 1
  v_cmp_gt_u32 vcc, 4, v12
  s_cbranch_vccnz .Lsp_27
  s_branch .Lrt_28
.Lsp_29:
  s_getreg_b32 s3, hwreg(HW_REG_IB_STS)
  s_bfe_u32 s79, s3, 131094
  s_and_b32 s3, s3, 15
  s_lshl4_add_u32 s3, s79, s3
  s_sub_u32 s3, 61, s3
  v_mov_b32 v13, s3
  ds_write_b32 v11, v13
  ds_read_b32 v12, v10 offset:1024
  s_cmp_eq_u32 s74, 0
  s_waitcnt lgkmcnt(0)
  s_cbranch_scc1 .Lrt_30
  s_sub_u32 s74, s74, 1
  v_cmp_gt_u32 vcc, 6, v12
  s_cbranch_vccnz .Lsp_29
  s_branch .Lrt_30
.Lsp_31:
  s_getreg_b32 s3, hwreg(HW_REG_IB_STS)
  s_bfe_u32 s79, s3, 131094
  s_and_b32 s3, s3, 15
  s_lshl4_add_u32 s3, s79, s3
  s_sub_u32 s3, 65, s3
  v_mov_b32 v13, s3
  ds_write_b32 v11, v13
  ds_read_b32 v12, v10 offset:1024
  s_cmp_eq_u32 s74, 0
  s_waitcnt lgkmcnt(0)
  s_cbranch_scc1 .Lrt_32
  s_sub_u32 s74, s74, 1
  v_cmp_gt_u32 vcc, 7, v12
  s_cbranch_vccnz .Lsp_31
  s_branch .Lrt_32
.Lsp_33:
  s_getreg_b32 s3, hwreg(HW_REG_IB_STS)
  s_bfe_u32 s79, s3, 131094
  s_and_b32 s3, s3, 15
  s_lshl4_add_u32 s3, s79, s3
  s_sub_u32 s3, 71, s3
  v_mov_b32 v13, s3
  ds_write_b32 v11, v13
  ds_read_b32 v12, v10 offset:1024
  s_cmp_eq_u32 s74, 0
  s_waitcnt lgkmcnt(0)
  s_cbranch_scc1 .Lrt_34
  s_sub_u32 s74, s74, 1
  v_cmp_gt_u32 vcc, 8, v12
  s_cbranch_vccnz .Lsp_33
  s_branch .Lrt_34
.Lsp_71:
  ds_read_b32 v13, v10 offset:0
  s_cmp_eq_u32 s74, 0
  s_waitcnt lgkmcnt(0)
  s_cbranch_scc1 .Lrt_72
  s_sub_u32 s74, s74, 1
  v_cmp_gt_u32 vcc, 6, v13
  s_cbranch_vccnz .Lsp_71
  s_branch .Lrt_72
.Lsp_73:
  ds_read_b32 v13, v10 offset:0
  s_cmp_eq_u32 s74, 0
  s_waitcnt lgkmcnt(0)
  s_cbranch_scc1 .Lrt_74
  s_sub_u32 s74, s74, 1
  v_cmp_gt_u32 vcc, 12, v13
  s_cbranch_vccnz .Lsp_73
  s_branch .Lrt_74
.Lsp_75:
  ds_read_b32 v13, v10 offset:0
  s_cmp_eq_u32 s74, 0
  s_waitcnt lgkmcnt(0)
  s_cbranch_scc1 .Lrt_76
  s_sub_u32 s74, s74, 1
  v_cmp_gt_u32 vcc, 18, v13
  s_cbranch_vccnz .Lsp_75
  s_branch .Lrt_76
.Lsp_77:
  ds_read_b32 v13, v10 offset:0
  s_cmp_eq_u32 s74, 0
  s_waitcnt lgkmcnt(0)
  s_cbranch_scc1 .Lrt_78
  s_sub_u32 s74, s74, 1
  v_cmp_gt_u32 vcc, 24, v13
  s_cbranch_vccnz .Lsp_77
  s_branch .Lrt_78
.Lsp_79:
  ds_read_b32 v13, v10 offset:0
  s_cmp_eq_u32 s74, 0
  s_waitcnt lgkmcnt(0)
  s_cbranch_scc1 .Lrt_80
  s_sub_u32 s74, s74, 1
  v_cmp_gt_u32 vcc, 30, v13
  s_cbranch_vccnz .Lsp_79
  s_branch .Lrt_80
.Lsp_81:
  ds_read_b32 v13, v10 offset:0
  s_cmp_eq_u32 s74, 0
  s_waitcnt lgkmcnt(0)
  s_cbranch_scc1 .Lrt_82
  s_sub_u32 s74, s74, 1
  v_cmp_gt_u32 vcc, 36, v13
  s_cbranch_vccnz .Lsp_81
  s_branch .Lrt_82
.Lsp_83:
  ds_read_b32 v13, v10 offset:0
  s_cmp_eq_u32 s74, 0
  s_waitcnt lgkmcnt(0)
  s_cbranch_scc1 .Lrt_84
  s_sub_u32 s74, s74, 1
  v_cmp_gt_u32 vcc, 42, v13
  s_cbranch_vccnz .Lsp_83
  s_branch .Lrt_84
.Lsp_85:
  ds_read_b32 v13, v10 offset:0
  s_cmp_eq_u32 s74, 0
  s_waitcnt lgkmcnt(0)
  s_cbranch_scc1 .Lrt_86
  s_sub_u32 s74, s74, 1
  v_cmp_gt_u32 vcc, 48, v13
  s_cbranch_vccnz .Lsp_85
  s_branch .Lrt_86
.Lsp_87:
  ds_read_b32 v13, v10 offset:1024
  s_cmp_eq_u32 s74, 0
  s_waitcnt lgkmcnt(0)
  s_cbranch_scc1 .Lrt_88
  s_sub_u32 s74, s74, 1
  v_cmp_gt_u32 vcc, 6, v13
  s_cbranch_vccnz .Lsp_87
  s_branch .Lrt_88
.Lsp_89:
  ds_read_b32 v13, v10 offset:0
  s_cmp_eq_u32 s74, 0
  s_waitcnt lgkmcnt(0)
  s_cbranch_scc1 .Lrt_90
  s_sub_u32 s74, s74, 1
  v_cmp_gt_u32 vcc, 52, v13
  s_cbranch_vccnz .Lsp_89
  s_branch .Lrt_90
.Lsp_91:
  ds_read_b32 v64, v10 offset:10240
  s_cmp_eq_u32 s74, 0
  s_waitcnt lgkmcnt(0)
  s_cbranch_scc1 .Lrt_92
  s_sub_u32 s74, s74, 1
  v_cmp_gt_u32 vcc, 1, v64
  s_cbranch_vccnz .Lsp_91
  s_branch .Lrt_92
.Lsp_93:
  ds_read_b32 v13, v10 offset:0
  s_cmp_eq_u32 s74, 0
  s_waitcnt lgkmcnt(0)
  s_cbranch_scc1 .Lrt_94
  s_sub_u32 s74, s74, 1
  v_cmp_gt_u32 vcc, 59, v13
  s_cbranch_vccnz .Lsp_93
  s_branch .Lrt_94
.Lsp_95:
  ds_read_b32 v13, v10 offset:0
  s_cmp_eq_u32 s74, 0
  s_waitcnt lgkmcnt(0)
  s_cbranch_scc1 .Lrt_96
  s_sub_u32 s74, s74, 1
  v_cmp_gt_u32 vcc, 65, v13
  s_cbranch_vccnz .Lsp_95
  s_branch .Lrt_96
.Lsp_97:
  ds_read_b32 v13, v10 offset:0
  s_cmp_eq_u32 s74, 0
  s_waitcnt lgkmcnt(0)
  s_cbranch_scc1 .Lrt_98
  s_sub_u32 s74, s74, 1
  v_cmp_gt_u32 vcc, 73, v13
  s_cbranch_vccnz .Lsp_97
  s_branch .Lrt_98
.Lsp_99:
  ds_read_b32 v13, v10 offset:1024
  s_cmp_eq_u32 s74, 0
  s_waitcnt lgkmcnt(0)
  s_cbranch_scc1 .Lrt_100
  s_sub_u32 s74, s74, 1
  v_cmp_gt_u32 vcc, 12, v13
  s_cbranch_vccnz .Lsp_99
  s_branch .Lrt_100
.Lno_101:
  buffer_load_dword v12, off, s[20:23], 0 sc1
  s_cmp_eq_u32 s74, 0
  s_waitcnt vmcnt(0)
  s_cbranch_scc1 .Lnk_102
  s_sub_u32 s74, s74, 1
  v_readfirstlane_b32 s73, v12
  s_cmp_lg_u32 s73, 0
  s_cbranch_scc0 .Lno_101
  s_branch .Lnk_102
.Lsp_103:
  ds_read_b32 v13, v10 offset:0
  s_cmp_eq_u32 s74, 0
  s_waitcnt lgkmcnt(0)
  s_cbranch_scc1 .Lrt_104
  s_sub_u32 s74, s74, 1
  v_cmp_gt_u32 vcc, 77, v13
  s_cbranch_vccnz .Lsp_103
  s_branch .Lrt_104
.Lsp_105:
  ds_read_b32 v13, v10 offset:0
  s_cmp_eq_u32 s74, 0
  s_waitcnt lgkmcnt(0)
  s_cbranch_scc1 .Lrt_106
  s_sub_u32 s74, s74, 1
  v_cmp_gt_u32 vcc, 83, v13
  s_cbranch_vccnz .Lsp_105
  s_branch .Lrt_106
.Lcompute_y:
  v_and_b32 v1, 15, v0
  v_lshrrev_b32 v2, 4, v0
  v_and_b32 v3, 12, v0
  v_add_u32 v3, v3, v1
  v_and_b32 v14, 3, v0
  v_mul_u32_u24 v14, 260, v14
  v_add_u32 v10, 147456, v14
  s_lshl_b32 s3, s75, 8
  s_add_u32 s3, s3, 148480
  v_lshl_add_u32 v11, v0, 2, s3
  v_mov_b32 v15, 0
  ds_write_b32 v11, v15
  ds_write_b32 v11, v15 offset:9216
  ds_write_b32 v11, v15 offset:10240
  s_waitcnt lgkmcnt(0)
  s_mov_b32 s4, s44
  s_mov_b32 s5, s45
  s_mov_b32 s8, s56
  s_mov_b32 s9, s57
  s_mov_b32 s16, s68
  s_mov_b32 s17, s69
  s_mov_b32 s20, s66
  s_mov_b32 s21, s67
  s_lshr_b32 s3, s2, 1
  s_xor_b32 s3, s3, s2
  s_cmp_eq_u32 s72, 7
  s_cselect_b32 s3, 2, s3
  s_bitcmp1_b32 s3, 1
  s_cselect_b32 s12, s50, s52
  s_cselect_b32 s13, s51, s53
  s_bitcmp0_b32 s2, 1
  s_cselect_b32 s40, s46, s48
  s_cselect_b32 s41, s47, s49
  s_mov_b32 s42, 8388608
  s_bitcmp0_b32 s2, 2
  s_cselect_b32 s24, s40, s58
  s_cselect_b32 s25, s41, s59
  s_mov_b32 s28, s62
  s_mov_b32 s29, s63
  s_mov_b32 s32, s64
  s_mov_b32 s33, s65
  s_mov_b32 s36, s60
  s_mov_b32 s37, s61
  s_barrier
.Lc_srd_y:
  s_and_b32 s3, s2, 0x3C
  s_cmp_eq_u32 s3, 0x3C
  s_cbranch_scc1 .Lc2_skip
  v_bfe_u32 v17, v0, 2, 2
  v_lshrrev_b32 v16, 4, v0
  v_lshl_add_u32 v17, v16, 3, v17
  v_lshlrev_b32 v17, 7, v17
  v_bfe_u32 v16, v0, 3, 1
  v_lshl_or_b32 v17, v16, 6, v17
  v_bfe_u32 v16, v0, 4, 1
  v_lshl_or_b32 v17, v16, 5, v17
  v_and_b32 v16, 3, v0
  v_lshl_or_b32 v17, v16, 3, v17
  s_lshl_b32 s3, s75, 5
  s_add_u32 s3, s3, 0
  v_xor_b32 v16, s3, v17
  v_xor_b32 v17, 32, v16
  v_xor_b32 v18, 64, v16
  v_xor_b32 v19, 96, v16
  v_lshrrev_b32 v14, 1, v1
  v_xor_b32 v14, v14, v2
  v_lshlrev_b32 v14, 4, v14
  v_lshl_add_u32 v14, v1, 7, v14
  s_lshl_b32 s3, s75, 12
  s_add_u32 s3, s3, 65536
  v_add_u32 v20, s3, v14
  v_xor_b32 v21, 64, v20
  v_mov_b32 v24, 0x3f803f80
  v_mov_b32 v25, 0x3f803f80
  v_mov_b32 v26, 0x3f803f80
  v_mov_b32 v27, 0x3f803f80
  s_lshl_b32 s3, s75, 13
  s_add_u32 s3, s3, 98304
  v_lshl_add_u32 v12, v0, 4, s3
  s_lshl_b32 s3, s75, 6
  s_add_u32 s3, s3, 150528
  v_lshl_add_u32 v8, v2, 4, s3
  v_lshl_add_u32 v9, v1, 2, s3
  v_lshrrev_b32 v14, 5, v0
  v_lshl_add_u32 v14, v14, 2, v3
  s_lshl_b32 s3, s75, 7
  s_add_u32 s52, s3, 156672
  v_lshl_add_u32 v7, v14, 2, s52
  s_mov_b32 s44, 0xAAAAAAAA
  s_mov_b32 s45, 0xAAAAAAAA
  s_mov_b32 s46, 0xCCCCCCCC
  s_mov_b32 s47, 0xCCCCCCCC
  s_mov_b32 s62, 0x00F0000F
  s_mov_b32 s63, 0xF0000F00
  s_mov_b32 s64, 0
  s_mov_b32 s65, -1
  s_lshl2_add_u32 s54, s71, s75
  v_mul_u32_u24 v6, 30720, v2
  v_and_b32 v14, 3, v0
  v_lshl_add_u32 v6, v14, 4, v6
  v_bfe_u32 v14, v0, 2, 1
  v_lshl_add_u32 v6, v14, 8, v6
  v_bfe_u32 v14, v0, 3, 1
  v_lshl_add_u32 v6, v14, 6, v6
  s_lshl_b32 s57, s54, 2
  s_lshl_b32 s3, s72, 8
  s_add_u32 s3, s57, s3
  s_add_u32 s56, s3, 17301504
  s_min_u32 s53, s72, 6
  s_cmp_eq_u32 s72, 7
  s_cselect_b32 s53, 14, s53
  s_bitcmp1_b32 s2, 2
  s_cselect_b32 s3, 7, 0
  s_add_u32 s53, s53, s3
  s_lshl_b32 s3, s53, 8
  s_add_u32 s57, s57, s3
  s_add_u32 s57, s57, 17309184
  s_lshl_b32 s53, s53, 18
  s_lshl_b32 s3, s54, 9
  s_add_u32 s53, s53, s3
  s_add_u32 s53, s53, 17825792
  s_lshl_b32 s3, s75, 16
  s_xor_b32 s66, s3, 0
  s_add_u32 s66, s66, s53
  s_xor_b32 s67, s3, 65536
  s_add_u32 s67, s67, s53
  s_xor_b32 s68, s3, 131072
  s_add_u32 s68, s68, s53
  s_xor_b32 s69, s3, 196608
  s_add_u32 s69, s69, s53
  s_mul_i32 s54, s54, 122880
  s_lshl_b32 s3, s72, 10
  s_add_u32 s54, s54, s3
  s_add_u32 s54, s54, 0
  s_lshr_b32 s3, s2, 1
  s_xor_b32 s3, s3, s2
  s_cmp_eq_u32 s72, 7
  s_cselect_b32 s3, 2, s3
  s_bitcmp1_b32 s3, 1
  s_cselect_b32 s3, 0, 2048
  s_add_u32 s56, s56, s3
  s_lshl2_add_u32 s54, s3, s54
  s_and_b32 s3, s75, 1
  s_lshl_b32 s3, s3, 7
  s_and_b32 s55, s75, 2
  s_lshl_b32 s55, s55, 8
  s_or_b32 s3, s3, s55
  s_xor_b32 s48, s3, 0
  s_add_u32 s48, s48, s54
  s_xor_b32 s49, s3, 128
  s_add_u32 s49, s49, s54
  s_xor_b32 s50, s3, 512
  s_add_u32 s50, s50, s54
  s_xor_b32 s51, s3, 640
  s_add_u32 s51, s51, s54
  v_lshlrev_b32 v1, 7, v0
  s_getpc_b64 s[78:79]
.Lpc_y:
  s_sub_u32 s78, s78, .Lpc_y-.Lside_y
  s_subb_u32 s79, s79, 0
  s_lshr_b32 s3, s2, 6
  s_bitcmp1_b32 s2, 2
  s_cselect_b32 s77, 7, 8
  s_cselect_b32 s76, .Lshe-.Lside_y, -1
  s_mul_i32 s3, s3, s77
  s_add_u32 s3, s3, s72
  s_lshl2_add_u32 s3, s3, s75
  s_mul_i32 s3, s3, 384
  s_cmp_ge_u32 s3, s76
  s_cselect_b32 s76, .Lside_g-.Lshe-384, 0
  s_add_u32 s3, s3, s76
  v_and_b32 v2, 3, v0
  v_min_u32 v2, 2, v2
  v_lshl_add_u32 v2, v2, 7, s3
  v_min_u32 v2, .Lend_g-.Lside_y-4, v2
  global_load_dword v5, v2, s[78:79]
  s_or_b32 s3, s2, s75
  s_cmp_lg_u32 s3, 0
  s_cbranch_scc1 .Lc_nononce
  s_memrealtime s[60:61]
  s_waitcnt lgkmcnt(0)
  s_or_b32 s60, s60, 1
  v_mov_b32 v1, s60
  buffer_store_dword v1, off, s[20:23], 0 sc1
.Lc_nononce:
  s_cmp_eq_u32 s72, 7
  s_cbranch_scc1 .Lc_v7
  ds_read_b32 v13, v10 offset:0
  s_waitcnt lgkmcnt(0)
  v_cmp_gt_u32 vcc, 6, v13
  s_cbranch_vccnz .Lsp_71
.Lrt_72:
.Lc_K0_y:
  ds_read_b128 v[128:131], v20 offset:32768
  ds_read_b128 v[132:135], v20 offset:34816
  ds_read_b128 v[136:139], v21 offset:32768
  ds_read_b128 v[140:143], v21 offset:34816
  v_mov_b32 v15, 1
  ds_write_b32 v11, v15 offset:10240
  ds_read_b64_tr_b16 v[32:33], v16 offset:0
  ds_read_b64_tr_b16 v[34:35], v16 offset:512
  ds_read_b64_tr_b16 v[36:37], v17 offset:0
  ds_read_b64_tr_b16 v[38:39], v17 offset:512
  ds_read_b64_tr_b16 v[40:41], v18 offset:0
  ds_read_b64_tr_b16 v[42:43], v18 offset:512
  ds_read_b64_tr_b16 v[44:45], v19 offset:0
  ds_read_b64_tr_b16 v[46:47], v19 offset:512
  ds_read_b64_tr_b16 v[48:49], v16 offset:4096
  ds_read_b64_tr_b16 v[50:51], v16 offset:4608
  ds_read_b64_tr_b16 v[52:53], v17 offset:4096
  ds_read_b64_tr_b16 v[54:55], v17 offset:4608
  ds_read_b64_tr_b16 v[56:57], v18 offset:4096
  ds_read_b64_tr_b16 v[58:59], v18 offset:4608
  ds_read_b32 v13, v10 offset:0
  ds_read_b64_tr_b16 v[60:61], v19 offset:4096
  ds_read_b64_tr_b16 v[62:63], v19 offset:4608
  s_waitcnt lgkmcnt(15)
  v_mfma_f32_16x16x32_bf16 v[80:83], v[128:131], v[128:131], 0
  v_mov_b32 v15, 1
  ds_write_b32 v11, v15
  v_mfma_f32_16x16x32_bf16 v[88:91], v[24:27], v[128:131], 0
  v_mfma_f32_16x16x32_bf16 v[84:87], v[132:135], v[132:135], 0
  v_mfma_f32_16x16x32_bf16 v[92:95], v[24:27], v[132:135], 0
  v_mfma_f32_16x16x32_bf16 v[28:31], v[32:35], v[24:27], 0
  s_waitcnt lgkmcnt(3)
  v_cmp_gt_u32 vcc, 12, v13
  s_cbranch_vccnz .Lsp_73
.Lrt_74:
.Lc_K1_y:
  ds_read_b128 v[144:147], v20 offset:49152
  ds_read_b128 v[148:151], v20 offset:51200
  v_mfma_f32_16x16x32_bf16 v[96:99], v[32:35], v[128:131], 0
  ds_read_b128 v[152:155], v21 offset:49152
  ds_read_b128 v[156:159], v21 offset:51200
  v_mfma_f32_16x16x32_bf16 v[100:103], v[32:35], v[132:135], 0
  v_mov_b32 v15, 2
  ds_write_b32 v11, v15 offset:10240
  ds_read_b64_tr_b16 v[32:33], v16 offset:8192
  ds_read_b64_tr_b16 v[34:35], v16 offset:8704
  v_mfma_f32_16x16x32_bf16 v[104:107], v[36:39], v[128:131], 0
  v_mfma_f32_16x16x32_bf16 v[108:111], v[36:39], v[132:135], 0
  ds_read_b64_tr_b16 v[36:37], v17 offset:8192
  ds_read_b64_tr_b16 v[38:39], v17 offset:8704
  v_mfma_f32_16x16x32_bf16 v[112:115], v[40:43], v[128:131], 0
  v_mfma_f32_16x16x32_bf16 v[116:119], v[40:43], v[132:135], 0
  ds_read_b64_tr_b16 v[40:41], v18 offset:8192
  ds_read_b64_tr_b16 v[42:43], v18 offset:8704
  v_mfma_f32_16x16x32_bf16 v[120:123], v[44:47], v[128:131], 0
  v_mfma_f32_16x16x32_bf16 v[124:127], v[44:47], v[132:135], 0
  ds_read_b64_tr_b16 v[44:45], v19 offset:8192
  ds_read_b64_tr_b16 v[46:47], v19 offset:8704
  v_mfma_f32_16x16x32_bf16 v[80:83], v[136:139], v[136:139], v[80:83]
  v_mfma_f32_16x16x32_bf16 v[88:91], v[24:27], v[136:139], v[88:91]
  v_mfma_f32_16x16x32_bf16 v[84:87], v[140:143], v[140:143], v[84:87]
  v_mfma_f32_16x16x32_bf16 v[92:95], v[24:27], v[140:143], v[92:95]
  v_mfma_f32_16x16x32_bf16 v[28:31], v[48:51], v[24:27], v[28:31]
  v_mfma_f32_16x16x32_bf16 v[96:99], v[48:51], v[136:139], v[96:99]
  v_mfma_f32_16x16x32_bf16 v[100:103], v[48:51], v[140:143], v[100:103]
  ds_read_b64_tr_b16 v[48:49], v16 offset:12288
  ds_read_b64_tr_b16 v[50:51], v16 offset:12800
  v_mfma_f32_16x16x32_bf16 v[104:107], v[52:55], v[136:139], v[104:107]
  v_mfma_f32_16x16x32_bf16 v[108:111], v[52:55], v[140:143], v[108:111]
  ds_read_b64_tr_b16 v[52:53], v17 offset:12288
  ds_read_b64_tr_b16 v[54:55], v17 offset:12800
  v_mfma_f32_16x16x32_bf16 v[112:115], v[56:59], v[136:139], v[112:115]
  v_mfma_f32_16x16x32_bf16 v[116:119], v[56:59], v[140:143], v[116:119]
  ds_read_b64_tr_b16 v[56:57], v18 offset:12288
  ds_read_b64_tr_b16 v[58:59], v18 offset:12800
  s_waitcnt lgkmcnt(15)
  v_mfma_f32_16x16x32_bf16 v[120:123], v[60:63], v[136:139], v[120:123]
  ds_read_b32 v13, v10 offset:0
  v_mfma_f32_16x16x32_bf16 v[124:127], v[60:63], v[140:143], v[124:127]
  ds_read_b64_tr_b16 v[60:61], v19 offset:12288
  ds_read_b64_tr_b16 v[62:63], v19 offset:12800
  v_mfma_f32_16x16x32_bf16 v[80:83], v[144:147], v[144:147], v[80:83]
  v_mov_b32 v15, 2
  ds_write_b32 v11, v15
  v_mfma_f32_16x16x32_bf16 v[88:91], v[24:27], v[144:147], v[88:91]
  v_mfma_f32_16x16x32_bf16 v[84:87], v[148:151], v[148:151], v[84:87]
  v_mfma_f32_16x16x32_bf16 v[92:95], v[24:27], v[148:151], v[92:95]
  s_waitcnt lgkmcnt(15)
  v_mfma_f32_16x16x32_bf16 v[28:31], v[32:35], v[24:27], v[28:31]
  s_waitcnt lgkmcnt(3)
  v_cmp_gt_u32 vcc, 18, v13
  s_cbranch_vccnz .Lsp_75
.Lrt_76:
.Lc_K2_y:
  ds_read_b128 v[160:163], v20 offset:0
  ds_read_b128 v[164:167], v20 offset:2048
  v_mfma_f32_16x16x32_bf16 v[96:99], v[32:35], v[144:147], v[96:99]
  ds_read_b128 v[168:171], v21 offset:0
  ds_read_b128 v[172:175], v21 offset:2048
  v_mfma_f32_16x16x32_bf16 v[100:103], v[32:35], v[148:151], v[100:103]
  v_mov_b32 v15, 3
  ds_write_b32 v11, v15 offset:10240
  ds_read_b64_tr_b16 v[32:33], v16 offset:16384
  ds_read_b64_tr_b16 v[34:35], v16 offset:16896
  v_mfma_f32_16x16x32_bf16 v[104:107], v[36:39], v[144:147], v[104:107]
  v_mfma_f32_16x16x32_bf16 v[108:111], v[36:39], v[148:151], v[108:111]
  ds_read_b64_tr_b16 v[36:37], v17 offset:16384
  ds_read_b64_tr_b16 v[38:39], v17 offset:16896
  v_mfma_f32_16x16x32_bf16 v[112:115], v[40:43], v[144:147], v[112:115]
  v_mfma_f32_16x16x32_bf16 v[116:119], v[40:43], v[148:151], v[116:119]
  ds_read_b64_tr_b16 v[40:41], v18 offset:16384
  ds_read_b64_tr_b16 v[42:43], v18 offset:16896
  v_mfma_f32_16x16x32_bf16 v[120:123], v[44:47], v[144:147], v[120:123]
  v_mfma_f32_16x16x32_bf16 v[124:127], v[44:47], v[148:151], v[124:127]
  ds_read_b64_tr_b16 v[44:45], v19 offset:16384
  ds_read_b64_tr_b16 v[46:47], v19 offset:16896
  v_mfma_f32_16x16x32_bf16 v[80:83], v[152:155], v[152:155], v[80:83]
  v_mfma_f32_16x16x32_bf16 v[88:91], v[24:27], v[152:155], v[88:91]
  v_mfma_f32_16x16x32_bf16 v[84:87], v[156:159], v[156:159], v[84:87]
  v_mfma_f32_16x16x32_bf16 v[92:95], v[24:27], v[156:159], v[92:95]
  v_mfma_f32_16x16x32_bf16 v[28:31], v[48:51], v[24:27], v[28:31]
  v_mfma_f32_16x16x32_bf16 v[96:99], v[48:51], v[152:155], v[96:99]
  v_mfma_f32_16x16x32_bf16 v[100:103], v[48:51], v[156:159], v[100:103]
  ds_read_b64_tr_b16 v[48:49], v16 offset:20480
  ds_read_b64_tr_b16 v[50:51], v16 offset:20992
  v_mfma_f32_16x16x32_bf16 v[104:107], v[52:55], v[152:155], v[104:107]
  v_mfma_f32_16x16x32_bf16 v[108:111], v[52:55], v[156:159], v[108:111]
  ds_read_b64_tr_b16 v[52:53], v17 offset:20480
  ds_read_b64_tr_b16 v[54:55], v17 offset:20992
  v_mfma_f32_16x16x32_bf16 v[112:115], v[56:59], v[152:155], v[112:115]
  v_mfma_f32_16x16x32_bf16 v[116:119], v[56:59], v[156:159], v[116:119]
  ds_read_b64_tr_b16 v[56:57], v18 offset:20480
  ds_read_b64_tr_b16 v[58:59], v18 offset:20992
  s_waitcnt lgkmcnt(15)
  v_mfma_f32_16x16x32_bf16 v[120:123], v[60:63], v[152:155], v[120:123]
  ds_read_b32 v13, v10 offset:0
  v_mfma_f32_16x16x32_bf16 v[124:127], v[60:63], v[156:159], v[124:127]
  ds_read_b64_tr_b16 v[60:61], v19 offset:20480
  ds_read_b64_tr_b16 v[62:63], v19 offset:20992
  v_mfma_f32_16x16x32_bf16 v[80:83], v[160:163], v[160:163], v[80:83]
  v_mov_b32 v15, 3
  ds_write_b32 v11, v15
  v_mfma_f32_16x16x32_bf16 v[88:91], v[24:27], v[160:163], v[88:91]
  v_mfma_f32_16x16x32_bf16 v[84:87], v[164:167], v[164:167], v[84:87]
  v_mfma_f32_16x16x32_bf16 v[92:95], v[24:27], v[164:167], v[92:95]
  s_waitcnt lgkmcnt(15)
  v_mfma_f32_16x16x32_bf16 v[28:31], v[32:35], v[24:27], v[28:31]
  s_waitcnt lgkmcnt(3)
  v_cmp_gt_u32 vcc, 24, v13
  s_cbranch_vccnz .Lsp_77
.Lrt_78:
.Lc_K3_y:
  ds_read_b128 v[176:179], v20 offset:16384
  ds_read_b128 v[180:183], v20 offset:18432
  v_mfma_f32_16x16x32_bf16 v[96:99], v[32:35], v[160:163], v[96:99]
  ds_read_b128 v[184:187], v21 offset:16384
  ds_read_b128 v[188:191], v21 offset:18432
  v_mfma_f32_16x16x32_bf16 v[100:103], v[32:35], v[164:167], v[100:103]
  v_mov_b32 v15, 4
  ds_write_b32 v11, v15 offset:10240
  ds_read_b64_tr_b16 v[32:33], v16 offset:24576
  ds_read_b64_tr_b16 v[34:35], v16 offset:25088
  v_mfma_f32_16x16x32_bf16 v[104:107], v[36:39], v[160:163], v[104:107]
  v_mfma_f32_16x16x32_bf16 v[108:111], v[36:39], v[164:167], v[108:111]
  ds_read_b64_tr_b16 v[36:37], v17 offset:24576
  ds_read_b64_tr_b16 v[38:39], v17 offset:25088
  v_mfma_f32_16x16x32_bf16 v[112:115], v[40:43], v[160:163], v[112:115]
  v_mfma_f32_16x16x32_bf16 v[116:119], v[40:43], v[164:167], v[116:119]
  ds_read_b64_tr_b16 v[40:41], v18 offset:24576
  ds_read_b64_tr_b16 v[42:43], v18 offset:25088
  v_mfma_f32_16x16x32_bf16 v[120:123], v[44:47], v[160:163], v[120:123]
  v_mfma_f32_16x16x32_bf16 v[124:127], v[44:47], v[164:167], v[124:127]
  ds_read_b64_tr_b16 v[44:45], v19 offset:24576
  ds_read_b64_tr_b16 v[46:47], v19 offset:25088
  v_mfma_f32_16x16x32_bf16 v[80:83], v[168:171], v[168:171], v[80:83]
  v_mfma_f32_16x16x32_bf16 v[88:91], v[24:27], v[168:171], v[88:91]
  v_mfma_f32_16x16x32_bf16 v[84:87], v[172:175], v[172:175], v[84:87]
  v_mfma_f32_16x16x32_bf16 v[92:95], v[24:27], v[172:175], v[92:95]
  v_mfma_f32_16x16x32_bf16 v[28:31], v[48:51], v[24:27], v[28:31]
  v_mfma_f32_16x16x32_bf16 v[96:99], v[48:51], v[168:171], v[96:99]
  v_mfma_f32_16x16x32_bf16 v[100:103], v[48:51], v[172:175], v[100:103]
  ds_read_b64_tr_b16 v[48:49], v16 offset:28672
  ds_read_b64_tr_b16 v[50:51], v16 offset:29184
  v_mfma_f32_16x16x32_bf16 v[104:107], v[52:55], v[168:171], v[104:107]
  v_mfma_f32_16x16x32_bf16 v[108:111], v[52:55], v[172:175], v[108:111]
  ds_read_b64_tr_b16 v[52:53], v17 offset:28672
  ds_read_b64_tr_b16 v[54:55], v17 offset:29184
  v_mfma_f32_16x16x32_bf16 v[112:115], v[56:59], v[168:171], v[112:115]
  v_mfma_f32_16x16x32_bf16 v[116:119], v[56:59], v[172:175], v[116:119]
  ds_read_b64_tr_b16 v[56:57], v18 offset:28672
  ds_read_b64_tr_b16 v[58:59], v18 offset:29184
  s_waitcnt lgkmcnt(15)
  v_mfma_f32_16x16x32_bf16 v[120:123], v[60:63], v[168:171], v[120:123]
  ds_read_b32 v13, v10 offset:0
  v_mfma_f32_16x16x32_bf16 v[124:127], v[60:63], v[172:175], v[124:127]
  ds_read_b64_tr_b16 v[60:61], v19 offset:28672
  ds_read_b64_tr_b16 v[62:63], v19 offset:29184
  v_mfma_f32_16x16x32_bf16 v[80:83], v[176:179], v[176:179], v[80:83]
  v_mov_b32 v15, 4
  ds_write_b32 v11, v15
  v_mfma_f32_16x16x32_bf16 v[88:91], v[24:27], v[176:179], v[88:91]
  v_mfma_f32_16x16x32_bf16 v[84:87], v[180:183], v[180:183], v[84:87]
  v_mfma_f32_16x16x32_bf16 v[92:95], v[24:27], v[180:183], v[92:95]
  s_waitcnt lgkmcnt(15)
  v_mfma_f32_16x16x32_bf16 v[28:31], v[32:35], v[24:27], v[28:31]
  s_waitcnt lgkmcnt(3)
  v_cmp_gt_u32 vcc, 30, v13
  s_cbranch_vccnz .Lsp_79
.Lrt_80:
.Lc_K4_y:
  ds_read_b128 v[192:195], v20 offset:32768
  ds_read_b128 v[196:199], v20 offset:34816
  v_mfma_f32_16x16x32_bf16 v[96:99], v[32:35], v[176:179], v[96:99]
  ds_read_b128 v[200:203], v21 offset:32768
  ds_read_b128 v[204:207], v21 offset:34816
  v_mfma_f32_16x16x32_bf16 v[100:103], v[32:35], v[180:183], v[100:103]
  ds_read_b64_tr_b16 v[32:33], v16 offset:32768
  ds_read_b64_tr_b16 v[34:35], v16 offset:33280
  v_mfma_f32_16x16x32_bf16 v[104:107], v[36:39], v[176:179], v[104:107]
  v_mfma_f32_16x16x32_bf16 v[108:111], v[36:39], v[180:183], v[108:111]
  ds_read_b64_tr_b16 v[36:37], v17 offset:32768
  ds_read_b64_tr_b16 v[38:39], v17 offset:33280
  v_mfma_f32_16x16x32_bf16 v[112:115], v[40:43], v[176:179], v[112:115]
  v_mfma_f32_16x16x32_bf16 v[116:119], v[40:43], v[180:183], v[116:119]
  ds_read_b64_tr_b16 v[40:41], v18 offset:32768
  ds_read_b64_tr_b16 v[42:43], v18 offset:33280
  v_mfma_f32_16x16x32_bf16 v[120:123], v[44:47], v[176:179], v[120:123]
  v_mfma_f32_16x16x32_bf16 v[124:127], v[44:47], v[180:183], v[124:127]
  ds_read_b64_tr_b16 v[44:45], v19 offset:32768
  ds_read_b64_tr_b16 v[46:47], v19 offset:33280
  v_mfma_f32_16x16x32_bf16 v[80:83], v[184:187], v[184:187], v[80:83]
  v_mfma_f32_16x16x32_bf16 v[88:91], v[24:27], v[184:187], v[88:91]
  v_mfma_f32_16x16x32_bf16 v[84:87], v[188:191], v[188:191], v[84:87]
  v_mfma_f32_16x16x32_bf16 v[92:95], v[24:27], v[188:191], v[92:95]
  v_mfma_f32_16x16x32_bf16 v[28:31], v[48:51], v[24:27], v[28:31]
  v_mfma_f32_16x16x32_bf16 v[96:99], v[48:51], v[184:187], v[96:99]
  v_mfma_f32_16x16x32_bf16 v[100:103], v[48:51], v[188:191], v[100:103]
  ds_read_b64_tr_b16 v[48:49], v16 offset:36864
  ds_read_b64_tr_b16 v[50:51], v16 offset:37376
  v_mfma_f32_16x16x32_bf16 v[104:107], v[52:55], v[184:187], v[104:107]
  v_mfma_f32_16x16x32_bf16 v[108:111], v[52:55], v[188:191], v[108:111]
  ds_read_b64_tr_b16 v[52:53], v17 offset:36864
  ds_read_b64_tr_b16 v[54:55], v17 offset:37376
  v_mfma_f32_16x16x32_bf16 v[112:115], v[56:59], v[184:187], v[112:115]
  v_mfma_f32_16x16x32_bf16 v[116:119], v[56:59], v[188:191], v[116:119]
  ds_read_b64_tr_b16 v[56:57], v18 offset:36864
  ds_read_b64_tr_b16 v[58:59], v18 offset:37376
  s_waitcnt lgkmcnt(15)
  v_mfma_f32_16x16x32_bf16 v[120:123], v[60:63], v[184:187], v[120:123]
  ds_read_b32 v13, v10 offset:0
  v_mfma_f32_16x16x32_bf16 v[124:127], v[60:63], v[188:191], v[124:127]
  ds_read_b64_tr_b16 v[60:61], v19 offset:36864
  ds_read_b64_tr_b16 v[62:63], v19 offset:37376
  v_mfma_f32_16x16x32_bf16 v[80:83], v[192:195], v[192:195], v[80:83]
  v_mov_b32 v15, 5
  ds_write_b32 v11, v15
  v_mfma_f32_16x16x32_bf16 v[88:91], v[24:27], v[192:195], v[88:91]
  v_mfma_f32_16x16x32_bf16 v[84:87], v[196:199], v[196:199], v[84:87]
  v_mfma_f32_16x16x32_bf16 v[92:95], v[24:27], v[196:199], v[92:95]
  s_waitcnt lgkmcnt(15)
  v_mfma_f32_16x16x32_bf16 v[28:31], v[32:35], v[24:27], v[28:31]
  s_waitcnt lgkmcnt(3)
  v_cmp_gt_u32 vcc, 36, v13
  s_cbranch_vccnz .Lsp_81
.Lrt_82:
.Lc_K5_y:
  ds_read_b128 v[208:211], v20 offset:49152
  ds_read_b128 v[212:215], v20 offset:51200
  v_mfma_f32_16x16x32_bf16 v[96:99], v[32:35], v[192:195], v[96:99]
  ds_read_b128 v[216:219], v21 offset:49152
  ds_read_b128 v[220:223], v21 offset:51200
  v_mfma_f32_16x16x32_bf16 v[100:103], v[32:35], v[196:199], v[100:103]
  ds_read_b64_tr_b16 v[32:33], v16 offset:40960
  ds_read_b64_tr_b16 v[34:35], v16 offset:41472
  v_mfma_f32_16x16x32_bf16 v[104:107], v[36:39], v[192:195], v[104:107]
  v_mfma_f32_16x16x32_bf16 v[108:111], v[36:39], v[196:199], v[108:111]
  ds_read_b64_tr_b16 v[36:37], v17 offset:40960
  ds_read_b64_tr_b16 v[38:39], v17 offset:41472
  v_mfma_f32_16x16x32_bf16 v[112:115], v[40:43], v[192:195], v[112:115]
  v_mfma_f32_16x16x32_bf16 v[116:119], v[40:43], v[196:199], v[116:119]
  ds_read_b64_tr_b16 v[40:41], v18 offset:40960
  ds_read_b64_tr_b16 v[42:43], v18 offset:41472
  v_mfma_f32_16x16x32_bf16 v[120:123], v[44:47], v[192:195], v[120:123]
  v_mfma_f32_16x16x32_bf16 v[124:127], v[44:47], v[196:199], v[124:127]
  ds_read_b64_tr_b16 v[44:45], v19 offset:40960
  ds_read_b64_tr_b16 v[46:47], v19 offset:41472
  v_mfma_f32_16x16x32_bf16 v[80:83], v[200:203], v[200:203], v[80:83]
  v_mfma_f32_16x16x32_bf16 v[88:91], v[24:27], v[200:203], v[88:91]
  v_mfma_f32_16x16x32_bf16 v[84:87], v[204:207], v[204:207], v[84:87]
  v_mfma_f32_16x16x32_bf16 v[92:95], v[24:27], v[204:207], v[92:95]
  v_mfma_f32_16x16x32_bf16 v[28:31], v[48:51], v[24:27], v[28:31]
  v_mfma_f32_16x16x32_bf16 v[96:99], v[48:51], v[200:203], v[96:99]
  v_mfma_f32_16x16x32_bf16 v[100:103], v[48:51], v[204:207], v[100:103]
  ds_read_b64_tr_b16 v[48:49], v16 offset:45056
  ds_read_b64_tr_b16 v[50:51], v16 offset:45568
  v_mfma_f32_16x16x32_bf16 v[104:107], v[52:55], v[200:203], v[104:107]
  v_mfma_f32_16x16x32_bf16 v[108:111], v[52:55], v[204:207], v[108:111]
  ds_read_b64_tr_b16 v[52:53], v17 offset:45056
  ds_read_b64_tr_b16 v[54:55], v17 offset:45568
  v_mfma_f32_16x16x32_bf16 v[112:115], v[56:59], v[200:203], v[112:115]
  v_mfma_f32_16x16x32_bf16 v[116:119], v[56:59], v[204:207], v[116:119]
  ds_read_b64_tr_b16 v[56:57], v18 offset:45056
  ds_read_b64_tr_b16 v[58:59], v18 offset:45568
  s_waitcnt lgkmcnt(15)
  v_mfma_f32_16x16x32_bf16 v[120:123], v[60:63], v[200:203], v[120:123]
  ds_read_b32 v13, v10 offset:0
  v_mfma_f32_16x16x32_bf16 v[124:127], v[60:63], v[204:207], v[124:127]
  ds_read_b64_tr_b16 v[60:61], v19 offset:45056
  ds_read_b64_tr_b16 v[62:63], v19 offset:45568
  v_mfma_f32_16x16x32_bf16 v[80:83], v[208:211], v[208:211], v[80:83]
  v_mov_b32 v15, 6
  ds_write_b32 v11, v15
  v_mfma_f32_16x16x32_bf16 v[88:91], v[24:27], v[208:211], v[88:91]
  v_mfma_f32_16x16x32_bf16 v[84:87], v[212:215], v[212:215], v[84:87]
  v_mfma_f32_16x16x32_bf16 v[92:95], v[24:27], v[212:215], v[92:95]
  s_waitcnt lgkmcnt(15)
  v_mfma_f32_16x16x32_bf16 v[28:31], v[32:35], v[24:27], v[28:31]
  s_waitcnt lgkmcnt(3)
  v_cmp_gt_u32 vcc, 42, v13
  s_cbranch_vccnz .Lsp_83
.Lrt_84:
.Lc_K6_y:
  ds_read_b128 v[224:227], v20 offset:0
  ds_read_b128 v[228:231], v20 offset:2048
  v_mfma_f32_16x16x32_bf16 v[96:99], v[32:35], v[208:211], v[96:99]
  ds_read_b128 v[232:235], v21 offset:0
  ds_read_b128 v[236:239], v21 offset:2048
  v_mfma_f32_16x16x32_bf16 v[100:103], v[32:35], v[212:215], v[100:103]
  ds_read_b64_tr_b16 v[32:33], v16 offset:49152
  ds_read_b64_tr_b16 v[34:35], v16 offset:49664
  v_mfma_f32_16x16x32_bf16 v[104:107], v[36:39], v[208:211], v[104:107]
  v_mfma_f32_16x16x32_bf16 v[108:111], v[36:39], v[212:215], v[108:111]
  ds_read_b64_tr_b16 v[36:37], v17 offset:49152
  ds_read_b64_tr_b16 v[38:39], v17 offset:49664
  v_mfma_f32_16x16x32_bf16 v[112:115], v[40:43], v[208:211], v[112:115]
  v_mfma_f32_16x16x32_bf16 v[116:119], v[40:43], v[212:215], v[116:119]
  ds_read_b64_tr_b16 v[40:41], v18 offset:49152
  ds_read_b64_tr_b16 v[42:43], v18 offset:49664
  v_mfma_f32_16x16x32_bf16 v[120:123], v[44:47], v[208:211], v[120:123]
  v_mfma_f32_16x16x32_bf16 v[124:127], v[44:47], v[212:215], v[124:127]
  ds_read_b64_tr_b16 v[44:45], v19 offset:49152
  ds_read_b64_tr_b16 v[46:47], v19 offset:49664
  v_mfma_f32_16x16x32_bf16 v[80:83], v[216:219], v[216:219], v[80:83]
  v_mfma_f32_16x16x32_bf16 v[88:91], v[24:27], v[216:219], v[88:91]
  v_mfma_f32_16x16x32_bf16 v[84:87], v[220:223], v[220:223], v[84:87]
  v_mfma_f32_16x16x32_bf16 v[92:95], v[24:27], v[220:223], v[92:95]
  v_mfma_f32_16x16x32_bf16 v[28:31], v[48:51], v[24:27], v[28:31]
  v_mfma_f32_16x16x32_bf16 v[96:99], v[48:51], v[216:219], v[96:99]
  v_mfma_f32_16x16x32_bf16 v[100:103], v[48:51], v[220:223], v[100:103]
  ds_read_b64_tr_b16 v[48:49], v16 offset:53248
  ds_read_b64_tr_b16 v[50:51], v16 offset:53760
  v_mfma_f32_16x16x32_bf16 v[104:107], v[52:55], v[216:219], v[104:107]
  v_mfma_f32_16x16x32_bf16 v[108:111], v[52:55], v[220:223], v[108:111]
  ds_read_b64_tr_b16 v[52:53], v17 offset:53248
  ds_read_b64_tr_b16 v[54:55], v17 offset:53760
  v_mfma_f32_16x16x32_bf16 v[112:115], v[56:59], v[216:219], v[112:115]
  v_mfma_f32_16x16x32_bf16 v[116:119], v[56:59], v[220:223], v[116:119]
  ds_read_b64_tr_b16 v[56:57], v18 offset:53248
  ds_read_b64_tr_b16 v[58:59], v18 offset:53760
  s_waitcnt lgkmcnt(15)
  v_mfma_f32_16x16x32_bf16 v[120:123], v[60:63], v[216:219], v[120:123]
  ds_read_b32 v13, v10 offset:0
  v_mfma_f32_16x16x32_bf16 v[124:127], v[60:63], v[220:223], v[124:127]
  ds_read_b64_tr_b16 v[60:61], v19 offset:53248
  ds_read_b64_tr_b16 v[62:63], v19 offset:53760
  v_mfma_f32_16x16x32_bf16 v[80:83], v[224:227], v[224:227], v[80:83]
  v_mov_b32 v15, 7
  ds_write_b32 v11, v15
  v_mfma_f32_16x16x32_bf16 v[88:91], v[24:27], v[224:227], v[88:91]
  v_mfma_f32_16x16x32_bf16 v[84:87], v[228:231], v[228:231], v[84:87]
  v_mfma_f32_16x16x32_bf16 v[92:95], v[24:27], v[228:231], v[92:95]
  s_waitcnt lgkmcnt(15)
  v_mfma_f32_16x16x32_bf16 v[28:31], v[32:35], v[24:27], v[28:31]
  s_waitcnt lgkmcnt(3)
  v_cmp_gt_u32 vcc, 48, v13
  s_cbranch_vccnz .Lsp_85
.Lrt_86:
.Lc_K7_y:
  ds_read_b128 v[240:243], v20 offset:16384
  ds_read_b128 v[244:247], v20 offset:18432
  v_mfma_f32_16x16x32_bf16 v[96:99], v[32:35], v[224:227], v[96:99]
  ds_read_b128 v[248:251], v21 offset:16384
  ds_read_b128 v[252:255], v21 offset:18432
  v_mfma_f32_16x16x32_bf16 v[100:103], v[32:35], v[228:231], v[100:103]
  ds_read_b64_tr_b16 v[32:33], v16 offset:57344
  ds_read_b64_tr_b16 v[34:35], v16 offset:57856
  v_mfma_f32_16x16x32_bf16 v[104:107], v[36:39], v[224:227], v[104:107]
  v_mfma_f32_16x16x32_bf16 v[108:111], v[36:39], v[228:231], v[108:111]
  ds_read_b64_tr_b16 v[36:37], v16 offset:61440
  ds_read_b64_tr_b16 v[38:39], v16 offset:61952
  v_mfma_f32_16x16x32_bf16 v[112:115], v[40:43], v[224:227], v[112:115]
  v_mfma_f32_16x16x32_bf16 v[116:119], v[40:43], v[228:231], v[116:119]
  ds_read_b64_tr_b16 v[40:41], v18 offset:57344
  ds_read_b64_tr_b16 v[42:43], v18 offset:57856
  v_mfma_f32_16x16x32_bf16 v[120:123], v[44:47], v[224:227], v[120:123]
  v_mfma_f32_16x16x32_bf16 v[124:127], v[44:47], v[228:231], v[124:127]
  ds_read_b64_tr_b16 v[44:45], v18 offset:61440
  ds_read_b64_tr_b16 v[46:47], v18 offset:61952
  v_mfma_f32_16x16x32_bf16 v[80:83], v[232:235], v[232:235], v[80:83]
  v_mfma_f32_16x16x32_bf16 v[88:91], v[24:27], v[232:235], v[88:91]
  v_mfma_f32_16x16x32_bf16 v[84:87], v[236:239], v[236:239], v[84:87]
  v_mfma_f32_16x16x32_bf16 v[92:95], v[24:27], v[236:239], v[92:95]
  v_mfma_f32_16x16x32_bf16 v[28:31], v[48:51], v[24:27], v[28:31]
  v_mfma_f32_16x16x32_bf16 v[96:99], v[48:51], v[232:235], v[96:99]
  v_mfma_f32_16x16x32_bf16 v[100:103], v[48:51], v[236:239], v[100:103]
  ds_read_b64_tr_b16 v[48:49], v19 offset:57344
  ds_read_b64_tr_b16 v[50:51], v19 offset:57856
  v_mfma_f32_16x16x32_bf16 v[104:107], v[52:55], v[232:235], v[104:107]
  v_mfma_f32_16x16x32_bf16 v[108:111], v[52:55], v[236:239], v[108:111]
  ds_read_b64_tr_b16 v[52:53], v19 offset:61440
  ds_read_b64_tr_b16 v[54:55], v19 offset:61952
  v_mfma_f32_16x16x32_bf16 v[112:115], v[56:59], v[232:235], v[112:115]
  v_mfma_f32_16x16x32_bf16 v[116:119], v[56:59], v[236:239], v[116:119]
  ds_read_b64_tr_b16 v[56:57], v17 offset:57344
  ds_read_b64_tr_b16 v[58:59], v17 offset:57856
  ds_read_b32 v13, v10 offset:1024
  s_waitcnt lgkmcnt(15)
  v_mfma_f32_16x16x32_bf16 v[120:123], v[60:63], v[232:235], v[120:123]
  v_mfma_f32_16x16x32_bf16 v[124:127], v[60:63], v[236:239], v[124:127]
  ds_read_b64_tr_b16 v[60:61], v17 offset:61440
  ds_read_b64_tr_b16 v[62:63], v17 offset:61952
  v_mfma_f32_16x16x32_bf16 v[80:83], v[240:243], v[240:243], v[80:83]
  v_mov_b32 v15, 8
  ds_write_b32 v11, v15
  v_mfma_f32_16x16x32_bf16 v[88:91], v[24:27], v[240:243], v[88:91]
  v_mfma_f32_16x16x32_bf16 v[84:87], v[244:247], v[244:247], v[84:87]
  v_mfma_f32_16x16x32_bf16 v[92:95], v[24:27], v[244:247], v[92:95]
  s_waitcnt lgkmcnt(3)
  v_cmp_gt_u32 vcc, 6, v13
  s_cbranch_vccnz .Lsp_87
.Lrt_88:
.Lc_KD_y:
  v_mfma_f32_16x16x32_bf16 v[80:83], v[248:251], v[248:251], v[80:83]
  v_mfma_f32_16x16x32_bf16 v[88:91], v[24:27], v[248:251], v[88:91]
  v_mfma_f32_16x16x32_bf16 v[84:87], v[252:255], v[252:255], v[84:87]
  v_mfma_f32_16x16x32_bf16 v[92:95], v[24:27], v[252:255], v[92:95]
  v_mfma_f32_16x16x32_bf16 v[28:31], v[32:35], v[24:27], v[28:31]
  v_mfma_f32_16x16x32_bf16 v[96:99], v[32:35], v[240:243], v[96:99]
  s_nop 2
  v_cndmask_b32_e64 v1, v80, v81, s[44:45]
  v_cndmask_b32_e64 v2, v82, v83, s[44:45]
  v_cndmask_b32_e64 v3, v84, v85, s[44:45]
  v_mfma_f32_16x16x32_bf16 v[100:103], v[32:35], v[244:247], v[100:103]
  v_cndmask_b32_e64 v1, v1, v2, s[46:47]
  v_cndmask_b32_e64 v2, v86, v87, s[44:45]
  v_cndmask_b32_e64 v14, v88, v92, s[64:65]
  v_mfma_f32_16x16x32_bf16 v[28:31], v[36:39], v[24:27], v[28:31]
  v_cndmask_b32_e64 v3, v3, v2, s[46:47]
  v_cndmask_b32_e64 v1, 0, v1, s[62:63]
  v_cndmask_b32_e64 v3, 0, v3, s[62:63]
  v_mfma_f32_16x16x32_bf16 v[96:99], v[36:39], v[248:251], v[96:99]
  v_mul_f32 v14, 989855744, v14
  v_permlane32_swap_b32 v1, v3
  v_add_f32 v1, v1, v3
  v_mfma_f32_16x16x32_bf16 v[100:103], v[36:39], v[252:255], v[100:103]
  ds_write_b128 v8, v[28:31]
  v_mov_b32 v15, 1
  ds_write_b32 v11, v15 offset:9216
  v_mfma_f32_16x16x32_bf16 v[112:115], v[40:43], v[240:243], v[112:115]
  v_mov_b32 v2, v1
  v_cvt_pk_bf16_f32 v3, v14, v14
  s_nop 0
  v_permlane16_swap_b32 v1, v2
  v_mfma_f32_16x16x32_bf16 v[116:119], v[40:43], v[244:247], v[116:119]
  v_add_f32 v1, v1, v2
  v_mul_f32 v1, 989855744, v1
  v_fma_f32 v1, -v14, v14, v1
  v_mfma_f32_16x16x32_bf16 v[112:115], v[44:47], v[248:251], v[112:115]
  v_cvt_pk_bf16_f32 v1, v1, v1
  v_lshlrev_b32 v1, 16, v1
  v_add_f32 v1, 925353388, v1
  v_mfma_f32_16x16x32_bf16 v[116:119], v[44:47], v[252:255], v[116:119]
  v_cvt_pk_bf16_f32 v1, v1, v1
  v_lshlrev_b32 v1, 16, v1
  ds_read_b32 v13, v10 offset:0
  v_mfma_f32_16x16x32_bf16 v[120:123], v[48:51], v[240:243], v[120:123]
  v_sqrt_f32 v1, v1
  v_lshlrev_b32 v3, 16, v3
  v_mfma_f32_16x16x32_bf16 v[124:127], v[48:51], v[244:247], v[124:127]
  v_cvt_pk_bf16_f32 v1, v1, v1
  v_lshlrev_b32 v72, 16, v1
  v_mfma_f32_16x16x32_bf16 v[120:123], v[52:55], v[248:251], v[120:123]
  v_rcp_f32 v70, v72
  v_xor_b32 v68, 0x80000000, v3
  v_mfma_f32_16x16x32_bf16 v[124:127], v[52:55], v[252:255], v[124:127]
  v_add_u32 v14, 4294962176, v7
  ds_write_b32 v14, v72
  ds_write_b32 v7, v68
  v_mfma_f32_16x16x32_bf16 v[104:107], v[56:59], v[240:243], v[104:107]
  ds_write_b32 v7, v70 offset:512
  ds_write_b128 v12, v[112:115] offset:0
  ds_write_b128 v12, v[116:119] offset:1024
  v_mfma_f32_16x16x32_bf16 v[108:111], v[56:59], v[244:247], v[108:111]
  ds_write_b128 v12, v[120:123] offset:2048
  ds_write_b128 v12, v[124:127] offset:3072
  s_waitcnt lgkmcnt(7)
  v_cmp_gt_u32 vcc, 52, v13
  s_cbranch_vccnz .Lsp_89
.Lrt_90:
.Lc_KA0_y:
  v_and_b32 v18, 15, v0
  v_lshrrev_b32 v16, 1, v18
  v_lshrrev_b32 v17, 4, v0
  v_xor_b32 v16, v16, v17
  v_lshlrev_b32 v16, 4, v16
  v_lshl_add_u32 v16, v18, 7, v16
  s_lshl_b32 s3, s75, 11
  s_add_u32 s3, s3, 131072
  v_add_u32 v16, s3, v16
  v_xor_b32 v17, 2048, v16
  v_xor_b32 v18, 4096, v16
  v_xor_b32 v19, 6144, v16
  v_xor_b32 v20, 64, v16
  v_xor_b32 v21, 2112, v16
  v_xor_b32 v22, 4160, v16
  v_xor_b32 v23, 6208, v16
  ds_read_b128 v[32:35], v16 offset:0
  ds_read_b128 v[36:39], v17 offset:0
  v_mfma_f32_16x16x32_bf16 v[104:107], v[60:63], v[248:251], v[104:107]
  ds_read_b128 v[40:43], v18 offset:0
  ds_read_b128 v[44:47], v19 offset:0
  v_mfma_f32_16x16x32_bf16 v[108:111], v[60:63], v[252:255], v[108:111]
  ds_read_b128 v[48:51], v20 offset:0
  ds_read_b128 v[52:55], v21 offset:0
.Lc_U1E_y:
  ds_read_b128 v[56:59], v22 offset:0
  ds_read_b128 v[60:63], v23 offset:0
  v_mov_b32 v15, 2
  ds_write_b32 v11, v15 offset:9216
  ds_read_b32 v64, v10 offset:10240
  v_xor_b32 v2, 64, v8
  v_mov_b32 v71, v70
  v_mov_b32 v69, v68
  v_mov_b32 v73, v72
  v_permlane32_swap_b32 v70, v71
  v_permlane32_swap_b32 v68, v69
  v_permlane32_swap_b32 v72, v73
  v_mul_f32 v1, v70, v70
  v_mul_f32 v1, v1, v70
  v_mul_f32 v70, 3222493025, v70
  v_mul_f32 v74, 3184710632, v1
  v_mul_f32 v1, v71, v71
  v_mul_f32 v1, v1, v71
  v_mul_f32 v71, 3222493025, v71
  v_mul_f32 v75, 3184710632, v1
  v_fma_f32 v96, v68, v28, v96
  v_fma_f32 v97, v68, v29, v97
  v_fma_f32 v98, v68, v30, v98
  v_fma_f32 v99, v68, v31, v99
  v_mul_f32 v80, v96, v96
  v_mul_f32 v81, v97, v97
  v_mul_f32 v82, v98, v98
  v_mul_f32 v83, v99, v99
  v_fma_f32 v80, v74, v80, v70
  v_fma_f32 v81, v74, v81, v70
  v_fma_f32 v82, v74, v82, v70
  v_fma_f32 v83, v74, v83, v70
  v_mul_f32 v80, v96, v80
  v_mul_f32 v81, v97, v81
  v_mul_f32 v82, v98, v82
  v_mul_f32 v83, v99, v83
  v_exp_f32 v80, v80
  v_exp_f32 v81, v81
  v_exp_f32 v82, v82
  v_exp_f32 v83, v83
  v_fma_f32 v80, v80, v72, v72
  v_fma_f32 v81, v81, v72, v72
  v_fma_f32 v82, v82, v72, v72
  v_fma_f32 v83, v83, v72, v72
  v_rcp_f32 v80, v80
  v_rcp_f32 v81, v81
  v_rcp_f32 v82, v82
  v_rcp_f32 v83, v83
  v_mul_f32 v96, v96, v80
  v_mul_f32 v97, v97, v81
  v_mul_f32 v98, v98, v82
  v_mul_f32 v99, v99, v83
  v_add_f32 v76, v96, v97
  v_mul_f32 v77, v96, v96
  v_fma_f32 v77, v97, v97, v77
  v_add_f32 v76, v76, v98
  v_fma_f32 v77, v98, v98, v77
  v_add_f32 v76, v76, v99
  v_fma_f32 v77, v99, v99, v77
  v_cvt_pk_bf16_f32 v112, v96, v97
  v_cvt_pk_bf16_f32 v113, v98, v99
  s_waitcnt lgkmcnt(0)
  v_cmp_gt_u32 vcc, 1, v64
  s_cbranch_vccnz .Lsp_91
.Lrt_92:
  ds_read_b128 v[64:67], v2
  v_fma_f32 v100, v69, v28, v100
  v_fma_f32 v101, v69, v29, v101
  v_fma_f32 v102, v69, v30, v102
  v_fma_f32 v103, v69, v31, v103
  v_mul_f32 v84, v100, v100
  v_mul_f32 v85, v101, v101
  v_mul_f32 v86, v102, v102
  v_mul_f32 v87, v103, v103
  v_fma_f32 v84, v75, v84, v71
  v_fma_f32 v85, v75, v85, v71
  v_fma_f32 v86, v75, v86, v71
  v_fma_f32 v87, v75, v87, v71
  v_mul_f32 v84, v100, v84
  v_mul_f32 v85, v101, v85
  v_mul_f32 v86, v102, v86
  v_mul_f32 v87, v103, v87
  v_exp_f32 v84, v84
  v_exp_f32 v85, v85
  v_exp_f32 v86, v86
  v_exp_f32 v87, v87
  v_fma_f32 v84, v84, v73, v73
  v_fma_f32 v85, v85, v73, v73
  v_fma_f32 v86, v86, v73, v73
  v_fma_f32 v87, v87, v73, v73
  v_rcp_f32 v84, v84
  v_rcp_f32 v85, v85
  v_rcp_f32 v86, v86
  v_rcp_f32 v87, v87
  v_mul_f32 v100, v100, v84
  v_mul_f32 v101, v101, v85
  v_mul_f32 v102, v102, v86
  v_mul_f32 v103, v103, v87
  v_add_f32 v78, v100, v101
  v_mul_f32 v79, v100, v100
  v_fma_f32 v79, v101, v101, v79
  v_add_f32 v78, v78, v102
  v_fma_f32 v79, v102, v102, v79
  v_add_f32 v78, v78, v103
  v_fma_f32 v79, v103, v103, v79
  v_cvt_pk_bf16_f32 v114, v100, v101
  v_cvt_pk_bf16_f32 v115, v102, v103
  ds_write_b128 v12, v[112:115] offset:4096
  s_waitcnt lgkmcnt(1)
  v_fma_f32 v104, v68, v64, v104
  v_fma_f32 v105, v68, v65, v105
  v_fma_f32 v106, v68, v66, v106
  v_fma_f32 v107, v68, v67, v107
  v_mul_f32 v80, v104, v104
  v_mul_f32 v81, v105, v105
  v_mul_f32 v82, v106, v106
  v_mul_f32 v83, v107, v107
  v_fma_f32 v80, v74, v80, v70
  v_fma_f32 v81, v74, v81, v70
  v_fma_f32 v82, v74, v82, v70
  v_fma_f32 v83, v74, v83, v70
  v_mul_f32 v80, v104, v80
  v_mul_f32 v81, v105, v81
  v_mul_f32 v82, v106, v82
  v_mul_f32 v83, v107, v83
  v_exp_f32 v80, v80
  v_exp_f32 v81, v81
  v_exp_f32 v82, v82
  v_exp_f32 v83, v83
  v_fma_f32 v80, v80, v72, v72
  v_fma_f32 v81, v81, v72, v72
  v_fma_f32 v82, v82, v72, v72
  v_fma_f32 v83, v83, v72, v72
  v_rcp_f32 v80, v80
  v_rcp_f32 v81, v81
  v_rcp_f32 v82, v82
  v_rcp_f32 v83, v83
  v_mul_f32 v104, v104, v80
  v_mul_f32 v105, v105, v81
  v_mul_f32 v106, v106, v82
  v_mul_f32 v107, v107, v83
  v_add_f32 v76, v76, v104
  v_fma_f32 v77, v104, v104, v77
  v_add_f32 v76, v76, v105
  v_fma_f32 v77, v105, v105, v77
  v_add_f32 v76, v76, v106
  v_fma_f32 v77, v106, v106, v77
  v_add_f32 v76, v76, v107
  v_fma_f32 v77, v107, v107, v77
  v_cvt_pk_bf16_f32 v116, v104, v105
  v_cvt_pk_bf16_f32 v117, v106, v107
  v_fma_f32 v108, v69, v64, v108
  v_fma_f32 v109, v69, v65, v109
  v_fma_f32 v110, v69, v66, v110
  v_fma_f32 v111, v69, v67, v111
  v_mul_f32 v84, v108, v108
  v_mul_f32 v85, v109, v109
  v_mul_f32 v86, v110, v110
  v_mul_f32 v87, v111, v111
  v_fma_f32 v84, v75, v84, v71
  v_fma_f32 v85, v75, v85, v71
  v_fma_f32 v86, v75, v86, v71
  v_fma_f32 v87, v75, v87, v71
  v_mul_f32 v84, v108, v84
  v_mul_f32 v85, v109, v85
  v_mul_f32 v86, v110, v86
  v_mul_f32 v87, v111, v87
  v_exp_f32 v84, v84
  v_exp_f32 v85, v85
  v_exp_f32 v86, v86
  v_exp_f32 v87, v87
  v_fma_f32 v84, v84, v73, v73
  v_fma_f32 v85, v85, v73, v73
  v_fma_f32 v86, v86, v73, v73
  v_fma_f32 v87, v87, v73, v73
  v_rcp_f32 v84, v84
  v_rcp_f32 v85, v85
  v_rcp_f32 v86, v86
  v_rcp_f32 v87, v87
  v_mul_f32 v108, v108, v84
  v_mul_f32 v109, v109, v85
  v_mul_f32 v110, v110, v86
  v_mul_f32 v111, v111, v87
  v_add_f32 v78, v78, v108
  v_fma_f32 v79, v108, v108, v79
  v_add_f32 v78, v78, v109
  v_fma_f32 v79, v109, v109, v79
  v_add_f32 v78, v78, v110
  v_fma_f32 v79, v110, v110, v79
  v_add_f32 v78, v78, v111
  v_fma_f32 v79, v111, v111, v79
  ds_write_b128 v12, v[76:79] offset:6144
  v_cvt_pk_bf16_f32 v118, v108, v109
  v_cvt_pk_bf16_f32 v119, v110, v111
  ds_write_b128 v12, v[116:119] offset:5120
  v_mov_b32 v15, 3
  ds_write_b32 v11, v15 offset:9216
.Lc_G1E_y:
.Lc_s10_y:
  v_mfma_f32_16x16x32_bf16 v[28:31], v[24:27], v[32:35], 0
  buffer_load_dword v12, off, s[20:23], 0 sc1
  v_mfma_f32_16x16x32_bf16 v[64:67], v[128:131], v[32:35], 0
  v_mfma_f32_16x16x32_bf16 v[68:71], v[132:135], v[32:35], 0
  ds_read_b128 v[32:35], v16 offset:8192
  v_mfma_f32_16x16x32_bf16 v[72:75], v[128:131], v[36:39], 0
  v_mfma_f32_16x16x32_bf16 v[76:79], v[132:135], v[36:39], 0
  ds_read_b128 v[36:39], v17 offset:8192
  v_mfma_f32_16x16x32_bf16 v[80:83], v[128:131], v[40:43], 0
  v_mfma_f32_16x16x32_bf16 v[84:87], v[132:135], v[40:43], 0
  ds_read_b128 v[40:43], v18 offset:8192
  v_mfma_f32_16x16x32_bf16 v[88:91], v[128:131], v[44:47], 0
  v_mfma_f32_16x16x32_bf16 v[92:95], v[132:135], v[44:47], 0
  ds_read_b128 v[44:47], v19 offset:8192
  v_mfma_f32_16x16x32_bf16 v[28:31], v[24:27], v[48:51], v[28:31]
  v_mfma_f32_16x16x32_bf16 v[64:67], v[136:139], v[48:51], v[64:67]
  v_mfma_f32_16x16x32_bf16 v[68:71], v[140:143], v[48:51], v[68:71]
  ds_read_b128 v[48:51], v20 offset:8192
  v_mfma_f32_16x16x32_bf16 v[72:75], v[136:139], v[52:55], v[72:75]
  v_mfma_f32_16x16x32_bf16 v[76:79], v[140:143], v[52:55], v[76:79]
  ds_read_b128 v[52:55], v21 offset:8192
  v_mfma_f32_16x16x32_bf16 v[80:83], v[136:139], v[56:59], v[80:83]
  v_mfma_f32_16x16x32_bf16 v[84:87], v[140:143], v[56:59], v[84:87]
  ds_read_b128 v[56:59], v22 offset:8192
  v_mfma_f32_16x16x32_bf16 v[88:91], v[136:139], v[60:63], v[88:91]
  v_mfma_f32_16x16x32_bf16 v[92:95], v[140:143], v[60:63], v[92:95]
  ds_read_b128 v[60:63], v23 offset:8192
  v_mov_b32 v15, 9
  ds_write_b32 v11, v15
  s_waitcnt lgkmcnt(8)
.Lc_s11_y:
  v_mfma_f32_16x16x32_bf16 v[28:31], v[24:27], v[32:35], v[28:31]
  v_mfma_f32_16x16x32_bf16 v[64:67], v[144:147], v[32:35], v[64:67]
  v_mfma_f32_16x16x32_bf16 v[68:71], v[148:151], v[32:35], v[68:71]
  ds_read_b32 v13, v10 offset:0
  s_waitcnt lgkmcnt(8)
  v_mfma_f32_16x16x32_bf16 v[72:75], v[144:147], v[36:39], v[72:75]
  v_mfma_f32_16x16x32_bf16 v[76:79], v[148:151], v[36:39], v[76:79]
  s_waitcnt lgkmcnt(7)
  v_mfma_f32_16x16x32_bf16 v[80:83], v[144:147], v[40:43], v[80:83]
  v_mfma_f32_16x16x32_bf16 v[84:87], v[148:151], v[40:43], v[84:87]
  s_waitcnt lgkmcnt(6)
  v_mfma_f32_16x16x32_bf16 v[88:91], v[144:147], v[44:47], v[88:91]
  v_mfma_f32_16x16x32_bf16 v[92:95], v[148:151], v[44:47], v[92:95]
  s_waitcnt lgkmcnt(0)
  v_cmp_gt_u32 vcc, 59, v13
  s_cbranch_vccnz .Lsp_93
.Lrt_94:
.Lc_KA1_y:
  v_add_u32 v16, 4294836224, v16
  ds_read_b128 v[32:35], v16 offset:0
  v_add_u32 v17, 4294836224, v17
  ds_read_b128 v[36:39], v17 offset:0
  v_mfma_f32_16x16x32_bf16 v[28:31], v[24:27], v[48:51], v[28:31]
  v_add_u32 v18, 4294836224, v18
  ds_read_b128 v[40:43], v18 offset:0
  v_add_u32 v19, 4294836224, v19
  ds_read_b128 v[44:47], v19 offset:0
  v_mfma_f32_16x16x32_bf16 v[64:67], v[152:155], v[48:51], v[64:67]
  v_mfma_f32_16x16x32_bf16 v[68:71], v[156:159], v[48:51], v[68:71]
  v_add_u32 v20, 4294836224, v20
  ds_read_b128 v[48:51], v20 offset:0
  v_mfma_f32_16x16x32_bf16 v[72:75], v[152:155], v[52:55], v[72:75]
  v_mfma_f32_16x16x32_bf16 v[76:79], v[156:159], v[52:55], v[76:79]
  v_add_u32 v21, 4294836224, v21
  ds_read_b128 v[52:55], v21 offset:0
  v_mfma_f32_16x16x32_bf16 v[80:83], v[152:155], v[56:59], v[80:83]
  v_mfma_f32_16x16x32_bf16 v[84:87], v[156:159], v[56:59], v[84:87]
  v_add_u32 v22, 4294836224, v22
  ds_read_b128 v[56:59], v22 offset:0
  v_mfma_f32_16x16x32_bf16 v[88:91], v[152:155], v[60:63], v[88:91]
  v_mfma_f32_16x16x32_bf16 v[92:95], v[156:159], v[60:63], v[92:95]
  v_add_u32 v23, 4294836224, v23
  ds_read_b128 v[60:63], v23 offset:0
  s_waitcnt lgkmcnt(7)
.Lc_s12_y:
  v_mfma_f32_16x16x32_bf16 v[28:31], v[24:27], v[32:35], v[28:31]
  v_mfma_f32_16x16x32_bf16 v[64:67], v[160:163], v[32:35], v[64:67]
  v_mfma_f32_16x16x32_bf16 v[68:71], v[164:167], v[32:35], v[68:71]
  ds_read_b128 v[32:35], v16 offset:8192
  s_waitcnt lgkmcnt(7)
  v_mfma_f32_16x16x32_bf16 v[72:75], v[160:163], v[36:39], v[72:75]
  v_mfma_f32_16x16x32_bf16 v[76:79], v[164:167], v[36:39], v[76:79]
  ds_read_b128 v[36:39], v17 offset:8192
  s_waitcnt lgkmcnt(7)
  v_mfma_f32_16x16x32_bf16 v[80:83], v[160:163], v[40:43], v[80:83]
  v_mfma_f32_16x16x32_bf16 v[84:87], v[164:167], v[40:43], v[84:87]
  ds_read_b128 v[40:43], v18 offset:8192
  s_waitcnt lgkmcnt(7)
  v_mfma_f32_16x16x32_bf16 v[88:91], v[160:163], v[44:47], v[88:91]
  v_mfma_f32_16x16x32_bf16 v[92:95], v[164:167], v[44:47], v[92:95]
  ds_read_b128 v[44:47], v19 offset:8192
  s_waitcnt lgkmcnt(7)
  v_mfma_f32_16x16x32_bf16 v[28:31], v[24:27], v[48:51], v[28:31]
  v_mfma_f32_16x16x32_bf16 v[64:67], v[168:171], v[48:51], v[64:67]
  v_mfma_f32_16x16x32_bf16 v[68:71], v[172:175], v[48:51], v[68:71]
  ds_read_b128 v[48:51], v20 offset:8192
  s_waitcnt lgkmcnt(7)
  v_mfma_f32_16x16x32_bf16 v[72:75], v[168:171], v[52:55], v[72:75]
  v_mfma_f32_16x16x32_bf16 v[76:79], v[172:175], v[52:55], v[76:79]
  ds_read_b128 v[52:55], v21 offset:8192
  s_waitcnt lgkmcnt(7)
  v_mfma_f32_16x16x32_bf16 v[80:83], v[168:171], v[56:59], v[80:83]
  v_mfma_f32_16x16x32_bf16 v[84:87], v[172:175], v[56:59], v[84:87]
  ds_read_b128 v[56:59], v22 offset:8192
  s_waitcnt lgkmcnt(7)
  v_mfma_f32_16x16x32_bf16 v[88:91], v[168:171], v[60:63], v[88:91]
  v_mfma_f32_16x16x32_bf16 v[92:95], v[172:175], v[60:63], v[92:95]
  ds_read_b128 v[60:63], v23 offset:8192
  v_mov_b32 v15, 10
  ds_write_b32 v11, v15
  s_waitcnt lgkmcnt(8)
.Lc_s13_y:
  v_mfma_f32_16x16x32_bf16 v[28:31], v[24:27], v[32:35], v[28:31]
  v_mfma_f32_16x16x32_bf16 v[64:67], v[176:179], v[32:35], v[64:67]
  v_mfma_f32_16x16x32_bf16 v[68:71], v[180:183], v[32:35], v[68:71]
  ds_read_b128 v[32:35], v16 offset:16384
  s_waitcnt lgkmcnt(8)
  v_mfma_f32_16x16x32_bf16 v[72:75], v[176:179], v[36:39], v[72:75]
  v_mfma_f32_16x16x32_bf16 v[76:79], v[180:183], v[36:39], v[76:79]
  ds_read_b128 v[36:39], v17 offset:16384
  s_waitcnt lgkmcnt(8)
  v_mfma_f32_16x16x32_bf16 v[80:83], v[176:179], v[40:43], v[80:83]
  v_mfma_f32_16x16x32_bf16 v[84:87], v[180:183], v[40:43], v[84:87]
  ds_read_b128 v[40:43], v18 offset:16384
  s_waitcnt lgkmcnt(8)
  v_mfma_f32_16x16x32_bf16 v[88:91], v[176:179], v[44:47], v[88:91]
  v_mfma_f32_16x16x32_bf16 v[92:95], v[180:183], v[44:47], v[92:95]
  ds_read_b128 v[44:47], v19 offset:16384
  s_waitcnt lgkmcnt(8)
  v_mfma_f32_16x16x32_bf16 v[28:31], v[24:27], v[48:51], v[28:31]
  v_mfma_f32_16x16x32_bf16 v[64:67], v[184:187], v[48:51], v[64:67]
  v_mfma_f32_16x16x32_bf16 v[68:71], v[188:191], v[48:51], v[68:71]
  ds_read_b128 v[48:51], v20 offset:16384
  s_waitcnt lgkmcnt(8)
  v_mfma_f32_16x16x32_bf16 v[72:75], v[184:187], v[52:55], v[72:75]
  v_mfma_f32_16x16x32_bf16 v[76:79], v[188:191], v[52:55], v[76:79]
  ds_read_b128 v[52:55], v21 offset:16384
  s_waitcnt lgkmcnt(8)
  v_mfma_f32_16x16x32_bf16 v[80:83], v[184:187], v[56:59], v[80:83]
  v_mfma_f32_16x16x32_bf16 v[84:87], v[188:191], v[56:59], v[84:87]
  ds_read_b128 v[56:59], v22 offset:16384
  s_waitcnt lgkmcnt(8)
  v_mfma_f32_16x16x32_bf16 v[88:91], v[184:187], v[60:63], v[88:91]
  v_mfma_f32_16x16x32_bf16 v[92:95], v[188:191], v[60:63], v[92:95]
  ds_read_b128 v[60:63], v23 offset:16384
  s_waitcnt lgkmcnt(7)
.Lc_s14_y:
  v_mfma_f32_16x16x32_bf16 v[28:31], v[24:27], v[32:35], v[28:31]
  v_mfma_f32_16x16x32_bf16 v[64:67], v[192:195], v[32:35], v[64:67]
  v_mfma_f32_16x16x32_bf16 v[68:71], v[196:199], v[32:35], v[68:71]
  ds_read_b32 v13, v10 offset:0
  s_waitcnt lgkmcnt(7)
  v_mfma_f32_16x16x32_bf16 v[72:75], v[192:195], v[36:39], v[72:75]
  v_mfma_f32_16x16x32_bf16 v[76:79], v[196:199], v[36:39], v[76:79]
  s_waitcnt lgkmcnt(6)
  v_mfma_f32_16x16x32_bf16 v[80:83], v[192:195], v[40:43], v[80:83]
  v_mfma_f32_16x16x32_bf16 v[84:87], v[196:199], v[40:43], v[84:87]
  s_waitcnt lgkmcnt(5)
  v_mfma_f32_16x16x32_bf16 v[88:91], v[192:195], v[44:47], v[88:91]
  v_mfma_f32_16x16x32_bf16 v[92:95], v[196:199], v[44:47], v[92:95]
  s_waitcnt lgkmcnt(0)
  v_cmp_gt_u32 vcc, 65, v13
  s_cbranch_vccnz .Lsp_95
.Lrt_96:
.Lc_KA2_y:
  ds_read_b128 v[32:35], v16 offset:24576
  ds_read_b128 v[36:39], v17 offset:24576
  v_mfma_f32_16x16x32_bf16 v[28:31], v[24:27], v[48:51], v[28:31]
  ds_read_b128 v[40:43], v18 offset:24576
  ds_read_b128 v[44:47], v19 offset:24576
  v_mfma_f32_16x16x32_bf16 v[64:67], v[200:203], v[48:51], v[64:67]
  v_mfma_f32_16x16x32_bf16 v[68:71], v[204:207], v[48:51], v[68:71]
  ds_read_b128 v[48:51], v20 offset:24576
  v_mfma_f32_16x16x32_bf16 v[72:75], v[200:203], v[52:55], v[72:75]
  v_mfma_f32_16x16x32_bf16 v[76:79], v[204:207], v[52:55], v[76:79]
  ds_read_b128 v[52:55], v21 offset:24576
  v_mfma_f32_16x16x32_bf16 v[80:83], v[200:203], v[56:59], v[80:83]
  v_mfma_f32_16x16x32_bf16 v[84:87], v[204:207], v[56:59], v[84:87]
  ds_read_b128 v[56:59], v22 offset:24576
  v_mfma_f32_16x16x32_bf16 v[88:91], v[200:203], v[60:63], v[88:91]
  v_mfma_f32_16x16x32_bf16 v[92:95], v[204:207], v[60:63], v[92:95]
  ds_read_b128 v[60:63], v23 offset:24576
  v_mov_b32 v15, 11
  ds_write_b32 v11, v15
  s_waitcnt lgkmcnt(8)
.Lc_s15_y:
  v_mfma_f32_16x16x32_bf16 v[28:31], v[24:27], v[32:35], v[28:31]
  v_mfma_f32_16x16x32_bf16 v[64:67], v[208:211], v[32:35], v[64:67]
  v_mfma_f32_16x16x32_bf16 v[68:71], v[212:215], v[32:35], v[68:71]
  ds_read_b128 v[32:35], v16 offset:32768
  s_waitcnt lgkmcnt(8)
  v_mfma_f32_16x16x32_bf16 v[72:75], v[208:211], v[36:39], v[72:75]
  v_mfma_f32_16x16x32_bf16 v[76:79], v[212:215], v[36:39], v[76:79]
  ds_read_b128 v[36:39], v17 offset:32768
  s_waitcnt lgkmcnt(8)
  v_mfma_f32_16x16x32_bf16 v[80:83], v[208:211], v[40:43], v[80:83]
  v_mfma_f32_16x16x32_bf16 v[84:87], v[212:215], v[40:43], v[84:87]
  ds_read_b128 v[40:43], v18 offset:32768
  s_waitcnt lgkmcnt(8)
  v_mfma_f32_16x16x32_bf16 v[88:91], v[208:211], v[44:47], v[88:91]
  v_mfma_f32_16x16x32_bf16 v[92:95], v[212:215], v[44:47], v[92:95]
  ds_read_b128 v[44:47], v19 offset:32768
  s_waitcnt lgkmcnt(8)
  v_mfma_f32_16x16x32_bf16 v[28:31], v[24:27], v[48:51], v[28:31]
  v_mfma_f32_16x16x32_bf16 v[64:67], v[216:219], v[48:51], v[64:67]
  v_mfma_f32_16x16x32_bf16 v[68:71], v[220:223], v[48:51], v[68:71]
  ds_read_b128 v[48:51], v20 offset:32768
  s_waitcnt lgkmcnt(8)
  v_mfma_f32_16x16x32_bf16 v[72:75], v[216:219], v[52:55], v[72:75]
  v_mfma_f32_16x16x32_bf16 v[76:79], v[220:223], v[52:55], v[76:79]
  ds_read_b128 v[52:55], v21 offset:32768
  s_waitcnt lgkmcnt(8)
  v_mfma_f32_16x16x32_bf16 v[80:83], v[216:219], v[56:59], v[80:83]
  v_mfma_f32_16x16x32_bf16 v[84:87], v[220:223], v[56:59], v[84:87]
  ds_read_b128 v[56:59], v22 offset:32768
  s_waitcnt lgkmcnt(8)
  v_mfma_f32_16x16x32_bf16 v[88:91], v[216:219], v[60:63], v[88:91]
  v_mfma_f32_16x16x32_bf16 v[92:95], v[220:223], v[60:63], v[92:95]
  ds_read_b128 v[60:63], v23 offset:32768
  s_waitcnt lgkmcnt(7)
.Lc_s16_y:
  v_mfma_f32_16x16x32_bf16 v[28:31], v[24:27], v[32:35], v[28:31]
  v_mfma_f32_16x16x32_bf16 v[64:67], v[224:227], v[32:35], v[64:67]
  v_mfma_f32_16x16x32_bf16 v[68:71], v[228:231], v[32:35], v[68:71]
  ds_read_b128 v[32:35], v16 offset:40960
  s_waitcnt lgkmcnt(7)
  v_mfma_f32_16x16x32_bf16 v[72:75], v[224:227], v[36:39], v[72:75]
  v_mfma_f32_16x16x32_bf16 v[76:79], v[228:231], v[36:39], v[76:79]
  ds_read_b128 v[36:39], v20 offset:40960
  s_waitcnt lgkmcnt(7)
  v_mfma_f32_16x16x32_bf16 v[80:83], v[224:227], v[40:43], v[80:83]
  v_mfma_f32_16x16x32_bf16 v[84:87], v[228:231], v[40:43], v[84:87]
  ds_read_b128 v[40:43], v17 offset:40960
  s_waitcnt lgkmcnt(7)
  v_mfma_f32_16x16x32_bf16 v[88:91], v[224:227], v[44:47], v[88:91]
  v_mfma_f32_16x16x32_bf16 v[92:95], v[228:231], v[44:47], v[92:95]
  ds_read_b128 v[44:47], v21 offset:40960
  s_waitcnt lgkmcnt(7)
  v_mfma_f32_16x16x32_bf16 v[28:31], v[24:27], v[48:51], v[28:31]
  v_mfma_f32_16x16x32_bf16 v[64:67], v[232:235], v[48:51], v[64:67]
  v_mfma_f32_16x16x32_bf16 v[68:71], v[236:239], v[48:51], v[68:71]
  ds_read_b128 v[48:51], v18 offset:40960
  s_waitcnt lgkmcnt(7)
  v_mfma_f32_16x16x32_bf16 v[72:75], v[232:235], v[52:55], v[72:75]
  v_mfma_f32_16x16x32_bf16 v[76:79], v[236:239], v[52:55], v[76:79]
  ds_read_b128 v[52:55], v22 offset:40960
  s_waitcnt lgkmcnt(7)
  v_mfma_f32_16x16x32_bf16 v[80:83], v[232:235], v[56:59], v[80:83]
  v_mfma_f32_16x16x32_bf16 v[84:87], v[236:239], v[56:59], v[84:87]
  ds_read_b128 v[56:59], v19 offset:40960
  s_waitcnt lgkmcnt(7)
  v_mfma_f32_16x16x32_bf16 v[88:91], v[232:235], v[60:63], v[88:91]
  v_mfma_f32_16x16x32_bf16 v[92:95], v[236:239], v[60:63], v[92:95]
  ds_read_b128 v[60:63], v23 offset:40960
  s_waitcnt lgkmcnt(7)
.Lc_s17_y:
  v_mfma_f32_16x16x32_bf16 v[28:31], v[24:27], v[32:35], v[28:31]
  v_mfma_f32_16x16x32_bf16 v[64:67], v[240:243], v[32:35], v[64:67]
  v_mfma_f32_16x16x32_bf16 v[68:71], v[244:247], v[32:35], v[68:71]
  s_waitcnt lgkmcnt(6)
  v_mfma_f32_16x16x32_bf16 v[28:31], v[24:27], v[36:39], v[28:31]
  ds_read_b32 v13, v10 offset:0
  v_mfma_f32_16x16x32_bf16 v[64:67], v[248:251], v[36:39], v[64:67]
  v_mfma_f32_16x16x32_bf16 v[68:71], v[252:255], v[36:39], v[68:71]
  s_nop 4
  ds_write_b32 v9, v28 offset:256
  v_mov_b32 v1, v28
  s_waitcnt lgkmcnt(7)
  v_mfma_f32_16x16x32_bf16 v[72:75], v[240:243], v[40:43], v[72:75]
  v_mov_b32 v15, 12
  ds_write_b32 v11, v15
  v_mfma_f32_16x16x32_bf16 v[76:79], v[244:247], v[40:43], v[76:79]
  v_lshrrev_b32 v2, 4, v0
  v_lshl_add_u32 v7, v2, 5, s52
  s_waitcnt lgkmcnt(7)
  v_mfma_f32_16x16x32_bf16 v[72:75], v[248:251], v[44:47], v[72:75]
  v_mfma_f32_16x16x32_bf16 v[76:79], v[252:255], v[44:47], v[76:79]
  s_waitcnt lgkmcnt(2)
  v_cmp_gt_u32 vcc, 73, v13
  s_cbranch_vccnz .Lsp_97
.Lrt_98:
.Lc_KB0_y:
  v_bfe_u32 v17, v0, 2, 2
  v_lshrrev_b32 v16, 4, v0
  v_lshl_add_u32 v17, v16, 3, v17
  v_lshlrev_b32 v17, 7, v17
  v_bfe_u32 v16, v0, 3, 1
  v_lshl_or_b32 v17, v16, 6, v17
  v_bfe_u32 v16, v0, 4, 1
  v_lshl_or_b32 v17, v16, 5, v17
  v_and_b32 v16, 3, v0
  v_lshl_or_b32 v17, v16, 3, v17
  s_lshl_b32 s3, s75, 5
  s_add_u32 s3, s3, 49152
  v_xor_b32 v16, s3, v17
  v_xor_b32 v17, 32, v16
  v_xor_b32 v18, 64, v16
  v_xor_b32 v19, 96, v16
  ds_read_b64_tr_b16 v[32:33], v16 offset:0
  ds_read_b64_tr_b16 v[34:35], v16 offset:512
  v_mfma_f32_16x16x32_bf16 v[80:83], v[240:243], v[48:51], v[80:83]
  ds_read_b64_tr_b16 v[36:37], v17 offset:0
  ds_read_b64_tr_b16 v[38:39], v17 offset:512
  v_mfma_f32_16x16x32_bf16 v[84:87], v[244:247], v[48:51], v[84:87]
  ds_read_b64_tr_b16 v[40:41], v18 offset:0
  ds_read_b64_tr_b16 v[42:43], v18 offset:512
  v_mfma_f32_16x16x32_bf16 v[80:83], v[248:251], v[52:55], v[80:83]
  ds_read_b64_tr_b16 v[44:45], v19 offset:0
  ds_read_b64_tr_b16 v[46:47], v19 offset:512
  v_mfma_f32_16x16x32_bf16 v[84:87], v[252:255], v[52:55], v[84:87]
  ds_read_b64_tr_b16 v[48:49], v16 offset:4096
  ds_read_b64_tr_b16 v[50:51], v16 offset:4608
  v_mfma_f32_16x16x32_bf16 v[88:91], v[240:243], v[56:59], v[88:91]
  ds_read_b64_tr_b16 v[52:53], v17 offset:4096
  ds_read_b64_tr_b16 v[54:55], v17 offset:4608
  v_mfma_f32_16x16x32_bf16 v[92:95], v[244:247], v[56:59], v[92:95]
  ds_read_b64_tr_b16 v[56:57], v18 offset:4096
  ds_read_b64_tr_b16 v[58:59], v18 offset:4608
  v_mfma_f32_16x16x32_bf16 v[88:91], v[248:251], v[60:63], v[88:91]
  v_mfma_f32_16x16x32_bf16 v[92:95], v[252:255], v[60:63], v[92:95]
  ds_read_b64_tr_b16 v[60:61], v19 offset:4096
  ds_read_b64_tr_b16 v[62:63], v19 offset:4608
  s_waitcnt lgkmcnt(14)
.Lc_s20_y:
  v_mfma_f32_16x16x32_bf16 v[28:31], v[32:35], v[24:27], 0
  v_mfma_f32_16x16x32_bf16 v[96:99], v[32:35], v[128:131], 0
  v_mfma_f32_16x16x32_bf16 v[100:103], v[32:35], v[132:135], 0
  ds_read_b64_tr_b16 v[32:33], v16 offset:8192
  ds_read_b64_tr_b16 v[34:35], v16 offset:8704
  s_waitcnt lgkmcnt(14)
  v_mfma_f32_16x16x32_bf16 v[104:107], v[36:39], v[128:131], 0
  v_mfma_f32_16x16x32_bf16 v[108:111], v[36:39], v[132:135], 0
  ds_read_b64_tr_b16 v[36:37], v17 offset:8192
  ds_read_b64_tr_b16 v[38:39], v17 offset:8704
  s_waitcnt lgkmcnt(14)
  v_mfma_f32_16x16x32_bf16 v[112:115], v[40:43], v[128:131], 0
  v_mfma_f32_16x16x32_bf16 v[116:119], v[40:43], v[132:135], 0
  ds_read_b64_tr_b16 v[40:41], v18 offset:8192
  ds_read_b64_tr_b16 v[42:43], v18 offset:8704
  s_waitcnt lgkmcnt(14)
  v_mfma_f32_16x16x32_bf16 v[120:123], v[44:47], v[128:131], 0
  v_mfma_f32_16x16x32_bf16 v[124:127], v[44:47], v[132:135], 0
  ds_read_b64_tr_b16 v[44:45], v19 offset:8192
  ds_read_b64_tr_b16 v[46:47], v19 offset:8704
  s_waitcnt lgkmcnt(14)
  v_mfma_f32_16x16x32_bf16 v[28:31], v[48:51], v[24:27], v[28:31]
  ds_read_b32 v13, v10 offset:1024
  v_mfma_f32_16x16x32_bf16 v[96:99], v[48:51], v[136:139], v[96:99]
  v_mfma_f32_16x16x32_bf16 v[100:103], v[48:51], v[140:143], v[100:103]
  ds_read_b64_tr_b16 v[48:49], v16 offset:12288
  ds_read_b64_tr_b16 v[50:51], v16 offset:12800
  s_waitcnt lgkmcnt(15)
  v_mfma_f32_16x16x32_bf16 v[104:107], v[52:55], v[136:139], v[104:107]
  v_mfma_f32_16x16x32_bf16 v[108:111], v[52:55], v[140:143], v[108:111]
  ds_read_b64_tr_b16 v[52:53], v17 offset:12288
  ds_read_b64_tr_b16 v[54:55], v17 offset:12800
  s_waitcnt lgkmcnt(15)
  v_mfma_f32_16x16x32_bf16 v[112:115], v[56:59], v[136:139], v[112:115]
  v_mfma_f32_16x16x32_bf16 v[116:119], v[56:59], v[140:143], v[116:119]
  ds_read_b64_tr_b16 v[56:57], v18 offset:12288
  ds_read_b64_tr_b16 v[58:59], v18 offset:12800
  s_waitcnt lgkmcnt(6)
  v_cmp_gt_u32 vcc, 12, v13
  s_cbranch_vccnz .Lsp_99
.Lrt_100:
.Lc_KC1_y:
  v_mfma_f32_16x16x32_bf16 v[120:123], v[60:63], v[136:139], v[120:123]
  v_xor_b32 v3, 64, v9
  ds_read_b32 v20, v3 offset:256
  v_mfma_f32_16x16x32_bf16 v[124:127], v[60:63], v[140:143], v[124:127]
  ds_read_b64_tr_b16 v[60:61], v19 offset:12288
  ds_read_b64_tr_b16 v[62:63], v19 offset:12800
.Lc_s21_y:
  v_mfma_f32_16x16x32_bf16 v[28:31], v[32:35], v[24:27], v[28:31]
  v_mov_b32 v15, 13
  ds_write_b32 v11, v15
  v_xor_b32 v2, 128, v9
  v_mfma_f32_16x16x32_bf16 v[96:99], v[32:35], v[144:147], v[96:99]
  ds_read_b32 v21, v2 offset:256
  v_xor_b32 v3, 192, v9
  ds_read_b32 v22, v3 offset:256
  ds_read_b128 v[128:131], v7 offset:0
  v_mfma_f32_16x16x32_bf16 v[100:103], v[32:35], v[148:151], v[100:103]
  ds_read_b64_tr_b16 v[32:33], v16 offset:16384
  ds_read_b64_tr_b16 v[34:35], v16 offset:16896
  ds_read_b128 v[136:139], v7 offset:512
  ds_read_b128 v[132:135], v7 offset:16
  v_mfma_f32_16x16x32_bf16 v[104:107], v[36:39], v[144:147], v[104:107]
  ds_read_b128 v[140:143], v7 offset:528
  s_waitcnt vmcnt(0)
  v_readfirstlane_b32 s73, v12
  s_cmp_lg_u32 s73, 0
  s_cbranch_scc0 .Lno_101
.Lnk_102:
  s_waitcnt lgkmcnt(0)
  v_fma_f32 v64, v128, v1, v64
  v_mfma_f32_16x16x32_bf16 v[108:111], v[36:39], v[148:151], v[108:111]
  ds_read_b64_tr_b16 v[36:37], v17 offset:16384
  ds_read_b64_tr_b16 v[38:39], v17 offset:16896
  v_fma_f32 v65, v129, v1, v65
  v_fma_f32 v66, v130, v1, v66
  v_mfma_f32_16x16x32_bf16 v[112:115], v[40:43], v[144:147], v[112:115]
  v_fma_f32 v67, v131, v1, v67
  v_fma_f32 v68, v132, v1, v68
  v_fma_f32 v69, v133, v1, v69
  v_fma_f32 v70, v134, v1, v70
  v_mfma_f32_16x16x32_bf16 v[116:119], v[40:43], v[148:151], v[116:119]
  ds_read_b64_tr_b16 v[40:41], v18 offset:16384
  ds_read_b64_tr_b16 v[42:43], v18 offset:16896
  v_fma_f32 v71, v135, v1, v71
  v_mul_f32 v64, v64, v136
  v_mfma_f32_16x16x32_bf16 v[120:123], v[44:47], v[144:147], v[120:123]
  v_mul_f32 v65, v65, v137
  v_mul_f32 v66, v66, v138
  v_mul_f32 v67, v67, v139
  v_mul_f32 v68, v68, v140
  v_mfma_f32_16x16x32_bf16 v[124:127], v[44:47], v[148:151], v[124:127]
  ds_read_b64_tr_b16 v[44:45], v19 offset:16384
  ds_read_b64_tr_b16 v[46:47], v19 offset:16896
  v_mul_f32 v69, v69, v141
  v_mul_f32 v70, v70, v142
  v_mfma_f32_16x16x32_bf16 v[28:31], v[48:51], v[24:27], v[28:31]
  v_mul_f32 v71, v71, v143
  v_cvt_pk_bf16_f32 v64, v64, v65
  v_mfma_f32_16x16x32_bf16 v[96:99], v[48:51], v[152:155], v[96:99]
  v_cvt_pk_bf16_f32 v65, v66, v67
  v_cvt_pk_bf16_f32 v66, v68, v69
  v_cvt_pk_bf16_f32 v67, v70, v71
  v_mfma_f32_16x16x32_bf16 v[100:103], v[48:51], v[156:159], v[100:103]
  ds_read_b64_tr_b16 v[48:49], v16 offset:20480
  ds_read_b64_tr_b16 v[50:51], v16 offset:20992
  buffer_store_dwordx4 v[64:67], v6, s[16:19], s48 offen sc1
  v_mfma_f32_16x16x32_bf16 v[104:107], v[52:55], v[152:155], v[104:107]
  v_fma_f32 v72, v128, v20, v72
  v_fma_f32 v73, v129, v20, v73
  v_fma_f32 v74, v130, v20, v74
  v_fma_f32 v75, v131, v20, v75
  v_mfma_f32_16x16x32_bf16 v[108:111], v[52:55], v[156:159], v[108:111]
  ds_read_b64_tr_b16 v[52:53], v17 offset:20480
  ds_read_b64_tr_b16 v[54:55], v17 offset:20992
  v_fma_f32 v76, v132, v20, v76
  v_fma_f32 v77, v133, v20, v77
  v_mfma_f32_16x16x32_bf16 v[112:115], v[56:59], v[152:155], v[112:115]
  v_fma_f32 v78, v134, v20, v78
  v_fma_f32 v79, v135, v20, v79
  v_mul_f32 v72, v72, v136
  v_mul_f32 v73, v73, v137
  v_mfma_f32_16x16x32_bf16 v[116:119], v[56:59], v[156:159], v[116:119]
  ds_read_b64_tr_b16 v[56:57], v18 offset:20480
  ds_read_b64_tr_b16 v[58:59], v18 offset:20992
  v_mul_f32 v74, v74, v138
  v_mul_f32 v75, v75, v139
  v_mfma_f32_16x16x32_bf16 v[120:123], v[60:63], v[152:155], v[120:123]
  v_mul_f32 v76, v76, v140
  v_mul_f32 v77, v77, v141
  v_mul_f32 v78, v78, v142
  v_mul_f32 v79, v79, v143
  v_mfma_f32_16x16x32_bf16 v[124:127], v[60:63], v[156:159], v[124:127]
  ds_read_b64_tr_b16 v[60:61], v19 offset:20480
  ds_read_b64_tr_b16 v[62:63], v19 offset:20992
  v_cvt_pk_bf16_f32 v72, v72, v73
  v_cvt_pk_bf16_f32 v73, v74, v75
.Lc_s22_y:
  v_mfma_f32_16x16x32_bf16 v[28:31], v[32:35], v[24:27], v[28:31]
  v_cvt_pk_bf16_f32 v74, v76, v77
  v_cvt_pk_bf16_f32 v75, v78, v79
  v_mfma_f32_16x16x32_bf16 v[96:99], v[32:35], v[160:163], v[96:99]
  buffer_store_dwordx4 v[72:75], v6, s[16:19], s49 offen sc1
  v_fma_f32 v80, v128, v21, v80
  v_fma_f32 v81, v129, v21, v81
  v_mfma_f32_16x16x32_bf16 v[100:103], v[32:35], v[164:167], v[100:103]
  ds_read_b64_tr_b16 v[32:33], v16 offset:24576
  ds_read_b64_tr_b16 v[34:35], v16 offset:25088
  v_fma_f32 v82, v130, v21, v82
  v_fma_f32 v83, v131, v21, v83
  s_waitcnt lgkmcnt(14)
  v_mfma_f32_16x16x32_bf16 v[104:107], v[36:39], v[160:163], v[104:107]
  v_fma_f32 v84, v132, v21, v84
  v_fma_f32 v85, v133, v21, v85
  v_fma_f32 v86, v134, v21, v86
  v_fma_f32 v87, v135, v21, v87
  v_mfma_f32_16x16x32_bf16 v[108:111], v[36:39], v[164:167], v[108:111]
  ds_read_b64_tr_b16 v[36:37], v17 offset:24576
  ds_read_b64_tr_b16 v[38:39], v17 offset:25088
  v_mul_f32 v80, v80, v136
  v_mul_f32 v81, v81, v137
  s_waitcnt lgkmcnt(14)
  v_mfma_f32_16x16x32_bf16 v[112:115], v[40:43], v[160:163], v[112:115]
  v_mul_f32 v82, v82, v138
  v_mul_f32 v83, v83, v139
  v_mul_f32 v84, v84, v140
  v_mul_f32 v85, v85, v141
  v_mfma_f32_16x16x32_bf16 v[116:119], v[40:43], v[164:167], v[116:119]
  ds_read_b64_tr_b16 v[40:41], v18 offset:24576
  ds_read_b64_tr_b16 v[42:43], v18 offset:25088
  v_mul_f32 v86, v86, v142
  v_mul_f32 v87, v87, v143
  s_waitcnt lgkmcnt(14)
  v_mfma_f32_16x16x32_bf16 v[120:123], v[44:47], v[160:163], v[120:123]
  v_cvt_pk_bf16_f32 v80, v80, v81
  v_cvt_pk_bf16_f32 v81, v82, v83
  v_cvt_pk_bf16_f32 v82, v84, v85
  v_cvt_pk_bf16_f32 v83, v86, v87
  v_mfma_f32_16x16x32_bf16 v[124:127], v[44:47], v[164:167], v[124:127]
  ds_read_b64_tr_b16 v[44:45], v19 offset:24576
  ds_read_b64_tr_b16 v[46:47], v19 offset:25088
  buffer_store_dwordx4 v[80:83], v6, s[16:19], s50 offen sc1
  s_waitcnt lgkmcnt(14)
  v_mfma_f32_16x16x32_bf16 v[28:31], v[48:51], v[24:27], v[28:31]
  v_fma_f32 v88, v128, v22, v88
  v_fma_f32 v89, v129, v22, v89
  v_mfma_f32_16x16x32_bf16 v[96:99], v[48:51], v[168:171], v[96:99]
  v_fma_f32 v90, v130, v22, v90
  v_fma_f32 v91, v131, v22, v91
  v_fma_f32 v92, v132, v22, v92
  v_fma_f32 v93, v133, v22, v93
  v_mfma_f32_16x16x32_bf16 v[100:103], v[48:51], v[172:175], v[100:103]
  ds_read_b64_tr_b16 v[48:49], v16 offset:28672
  ds_read_b64_tr_b16 v[50:51], v16 offset:29184
  v_fma_f32 v94, v134, v22, v94
  v_fma_f32 v95, v135, v22, v95
  s_waitcnt lgkmcnt(14)
  v_mfma_f32_16x16x32_bf16 v[104:107], v[52:55], v[168:171], v[104:107]
  v_mul_f32 v88, v88, v136
  v_mul_f32 v89, v89, v137
  v_mul_f32 v90, v90, v138
  v_mul_f32 v91, v91, v139
  v_mfma_f32_16x16x32_bf16 v[108:111], v[52:55], v[172:175], v[108:111]
  ds_read_b64_tr_b16 v[52:53], v17 offset:28672
  ds_read_b64_tr_b16 v[54:55], v17 offset:29184
  v_mul_f32 v92, v92, v140
  v_mul_f32 v93, v93, v141
  s_waitcnt lgkmcnt(14)
  v_mfma_f32_16x16x32_bf16 v[112:115], v[56:59], v[168:171], v[112:115]
  v_mul_f32 v94, v94, v142
  v_mul_f32 v95, v95, v143
  v_cvt_pk_bf16_f32 v88, v88, v89
  v_cvt_pk_bf16_f32 v89, v90, v91
  v_mfma_f32_16x16x32_bf16 v[116:119], v[56:59], v[172:175], v[116:119]
  ds_read_b64_tr_b16 v[56:57], v18 offset:28672
  ds_read_b64_tr_b16 v[58:59], v18 offset:29184
  v_cvt_pk_bf16_f32 v90, v92, v93
  v_cvt_pk_bf16_f32 v91, v94, v95
  s_waitcnt lgkmcnt(14)
  v_mfma_f32_16x16x32_bf16 v[120:123], v[60:63], v[168:171], v[120:123]
  buffer_store_dwordx4 v[88:91], v6, s[16:19], s51 offen sc1
.Lc_abst_y:
  v_and_b32 v1, 15, v0
  v_and_b32 v2, 12, v0
  v_mfma_f32_16x16x32_bf16 v[124:127], v[60:63], v[172:175], v[124:127]
  ds_read_b64_tr_b16 v[60:61], v19 offset:28672
  ds_read_b64_tr_b16 v[62:63], v19 offset:29184
  v_add_u32 v1, v1, v2
  v_lshl_add_u32 v7, v1, 2, s52
  s_waitcnt lgkmcnt(14)
.Lc_s23_y:
  v_mfma_f32_16x16x32_bf16 v[28:31], v[32:35], v[24:27], v[28:31]
  v_mov_b32 v15, 14
  ds_write_b32 v11, v15
  v_add_u32 v3, 4294962176, v7
  v_mfma_f32_16x16x32_bf16 v[96:99], v[32:35], v[176:179], v[96:99]
  v_lshrrev_b32 v2, 5, v0
  v_lshlrev_b32 v23, 15, v2
  v_lshl_add_u32 v23, v1, 4, v23
  v_bfe_u32 v2, v0, 4, 1
  v_mfma_f32_16x16x32_bf16 v[100:103], v[32:35], v[180:183], v[100:103]
  v_lshl_add_u32 v23, v2, 6, v23
  ds_read2_b32 v[162:163], v7 offset0:128 offset1:132
  ds_read2_b32 v[160:161], v7 offset0:0 offset1:4
  ds_read2_b32 v[164:165], v3 offset0:0 offset1:4
  s_waitcnt lgkmcnt(0)
  ds_read_b32 v13, v10 offset:0
  v_mfma_f32_16x16x32_bf16 v[104:107], v[36:39], v[176:179], v[104:107]
  v_mul_f32 v1, v162, v162
  v_mul_f32 v1, v1, v162
  v_mul_f32 v162, 3222493025, v162
  v_mul_f32 v166, 3184710632, v1
  v_mfma_f32_16x16x32_bf16 v[108:111], v[36:39], v[180:183], v[108:111]
  v_mul_f32 v1, v163, v163
  v_mul_f32 v1, v1, v163
  v_mul_f32 v163, 3222493025, v163
  v_mul_f32 v167, 3184710632, v1
  v_mfma_f32_16x16x32_bf16 v[112:115], v[40:43], v[176:179], v[112:115]
  v_mfma_f32_16x16x32_bf16 v[116:119], v[40:43], v[180:183], v[116:119]
  v_mfma_f32_16x16x32_bf16 v[120:123], v[44:47], v[176:179], v[120:123]
  v_mfma_f32_16x16x32_bf16 v[124:127], v[44:47], v[180:183], v[124:127]
  s_waitcnt lgkmcnt(0)
  v_cmp_gt_u32 vcc, 77, v13
  s_cbranch_vccnz .Lsp_103
.Lrt_104:
.Lc_KB2_y:
  ds_read_b64_tr_b16 v[32:33], v16 offset:32768
  ds_read_b64_tr_b16 v[34:35], v16 offset:33280
  v_mfma_f32_16x16x32_bf16 v[28:31], v[48:51], v[24:27], v[28:31]
  ds_read_b64_tr_b16 v[36:37], v17 offset:32768
  ds_read_b64_tr_b16 v[38:39], v17 offset:33280
  v_mfma_f32_16x16x32_bf16 v[96:99], v[48:51], v[184:187], v[96:99]
  ds_read_b64_tr_b16 v[40:41], v18 offset:32768
  ds_read_b64_tr_b16 v[42:43], v18 offset:33280
  v_mfma_f32_16x16x32_bf16 v[100:103], v[48:51], v[188:191], v[100:103]
  ds_read_b64_tr_b16 v[44:45], v19 offset:32768
  ds_read_b64_tr_b16 v[46:47], v19 offset:33280
  v_mfma_f32_16x16x32_bf16 v[104:107], v[52:55], v[184:187], v[104:107]
  ds_read_b64_tr_b16 v[48:49], v16 offset:36864
  ds_read_b64_tr_b16 v[50:51], v16 offset:37376
  v_mfma_f32_16x16x32_bf16 v[108:111], v[52:55], v[188:191], v[108:111]
  ds_read_b64_tr_b16 v[52:53], v17 offset:36864
  ds_read_b64_tr_b16 v[54:55], v17 offset:37376
  v_mfma_f32_16x16x32_bf16 v[112:115], v[56:59], v[184:187], v[112:115]
  v_mfma_f32_16x16x32_bf16 v[116:119], v[56:59], v[188:191], v[116:119]
  ds_read_b64_tr_b16 v[56:57], v18 offset:36864
  ds_read_b64_tr_b16 v[58:59], v18 offset:37376
  v_mfma_f32_16x16x32_bf16 v[120:123], v[60:63], v[184:187], v[120:123]
  v_mfma_f32_16x16x32_bf16 v[124:127], v[60:63], v[188:191], v[124:127]
  ds_read_b64_tr_b16 v[60:61], v19 offset:36864
  ds_read_b64_tr_b16 v[62:63], v19 offset:37376
  s_waitcnt lgkmcnt(14)
.Lc_s24_y:
  v_mfma_f32_16x16x32_bf16 v[28:31], v[32:35], v[24:27], v[28:31]
  v_mfma_f32_16x16x32_bf16 v[96:99], v[32:35], v[192:195], v[96:99]
  v_mfma_f32_16x16x32_bf16 v[100:103], v[32:35], v[196:199], v[100:103]
  ds_read_b64_tr_b16 v[32:33], v16 offset:40960
  ds_read_b64_tr_b16 v[34:35], v16 offset:41472
  s_waitcnt lgkmcnt(14)
  v_mfma_f32_16x16x32_bf16 v[104:107], v[36:39], v[192:195], v[104:107]
  v_mfma_f32_16x16x32_bf16 v[108:111], v[36:39], v[196:199], v[108:111]
  ds_read_b64_tr_b16 v[36:37], v17 offset:40960
  ds_read_b64_tr_b16 v[38:39], v17 offset:41472
  s_waitcnt lgkmcnt(14)
  v_mfma_f32_16x16x32_bf16 v[112:115], v[40:43], v[192:195], v[112:115]
  v_mfma_f32_16x16x32_bf16 v[116:119], v[40:43], v[196:199], v[116:119]
  ds_read_b64_tr_b16 v[40:41], v18 offset:40960
  ds_read_b64_tr_b16 v[42:43], v18 offset:41472
  s_waitcnt lgkmcnt(14)
  v_mfma_f32_16x16x32_bf16 v[120:123], v[44:47], v[192:195], v[120:123]
  v_mfma_f32_16x16x32_bf16 v[124:127], v[44:47], v[196:199], v[124:127]
  ds_read_b64_tr_b16 v[44:45], v19 offset:40960
  ds_read_b64_tr_b16 v[46:47], v19 offset:41472
  s_waitcnt lgkmcnt(14)
  v_mfma_f32_16x16x32_bf16 v[28:31], v[48:51], v[24:27], v[28:31]
  v_mfma_f32_16x16x32_bf16 v[96:99], v[48:51], v[200:203], v[96:99]
  v_mfma_f32_16x16x32_bf16 v[100:103], v[48:51], v[204:207], v[100:103]
  ds_read_b64_tr_b16 v[48:49], v16 offset:45056
  ds_read_b64_tr_b16 v[50:51], v16 offset:45568
  s_waitcnt lgkmcnt(14)
  v_mfma_f32_16x16x32_bf16 v[104:107], v[52:55], v[200:203], v[104:107]
  v_mfma_f32_16x16x32_bf16 v[108:111], v[52:55], v[204:207], v[108:111]
  ds_read_b64_tr_b16 v[52:53], v17 offset:45056
  ds_read_b64_tr_b16 v[54:55], v17 offset:45568
  s_waitcnt lgkmcnt(14)
  v_mfma_f32_16x16x32_bf16 v[112:115], v[56:59], v[200:203], v[112:115]
  v_mfma_f32_16x16x32_bf16 v[116:119], v[56:59], v[204:207], v[116:119]
  ds_read_b64_tr_b16 v[56:57], v18 offset:45056
  ds_read_b64_tr_b16 v[58:59], v18 offset:45568
  s_waitcnt lgkmcnt(14)
  v_mfma_f32_16x16x32_bf16 v[120:123], v[60:63], v[200:203], v[120:123]
  v_mfma_f32_16x16x32_bf16 v[124:127], v[60:63], v[204:207], v[124:127]
  ds_read_b64_tr_b16 v[60:61], v19 offset:45056
  ds_read_b64_tr_b16 v[62:63], v19 offset:45568
  s_waitcnt lgkmcnt(14)
.Lc_s25_y:
  v_mfma_f32_16x16x32_bf16 v[28:31], v[32:35], v[24:27], v[28:31]
  v_mov_b32 v15, 15
  ds_write_b32 v11, v15
  v_mfma_f32_16x16x32_bf16 v[96:99], v[32:35], v[208:211], v[96:99]
  v_mfma_f32_16x16x32_bf16 v[100:103], v[32:35], v[212:215], v[100:103]
  ds_read_b32 v13, v10 offset:0
  s_waitcnt lgkmcnt(14)
  v_mfma_f32_16x16x32_bf16 v[104:107], v[36:39], v[208:211], v[104:107]
  v_mfma_f32_16x16x32_bf16 v[108:111], v[36:39], v[212:215], v[108:111]
  s_waitcnt lgkmcnt(12)
  v_mfma_f32_16x16x32_bf16 v[112:115], v[40:43], v[208:211], v[112:115]
  v_mfma_f32_16x16x32_bf16 v[116:119], v[40:43], v[212:215], v[116:119]
  s_waitcnt lgkmcnt(10)
  v_mfma_f32_16x16x32_bf16 v[120:123], v[44:47], v[208:211], v[120:123]
  v_mfma_f32_16x16x32_bf16 v[124:127], v[44:47], v[212:215], v[124:127]
  s_waitcnt lgkmcnt(0)
  v_cmp_gt_u32 vcc, 83, v13
  s_cbranch_vccnz .Lsp_105
.Lrt_106:
.Lc_KB3_y:
  v_add_u32 v16, 81920, v16
  ds_read_b64_tr_b16 v[32:33], v16 offset:0
  ds_read_b64_tr_b16 v[34:35], v16 offset:512
  v_mfma_f32_16x16x32_bf16 v[28:31], v[48:51], v[24:27], v[28:31]
  v_add_u32 v17, 81920, v17
  ds_read_b64_tr_b16 v[36:37], v17 offset:0
  ds_read_b64_tr_b16 v[38:39], v17 offset:512
  v_mfma_f32_16x16x32_bf16 v[96:99], v[48:51], v[216:219], v[96:99]
  v_add_u32 v18, 81920, v18
  ds_read_b64_tr_b16 v[40:41], v18 offset:0
  ds_read_b64_tr_b16 v[42:43], v18 offset:512
  v_mfma_f32_16x16x32_bf16 v[100:103], v[48:51], v[220:223], v[100:103]
  v_add_u32 v19, 81920, v19
  ds_read_b64_tr_b16 v[44:45], v19 offset:0
  ds_read_b64_tr_b16 v[46:47], v19 offset:512
  v_mfma_f32_16x16x32_bf16 v[104:107], v[52:55], v[216:219], v[104:107]
  ds_read_b64_tr_b16 v[48:49], v16 offset:4096
  ds_read_b64_tr_b16 v[50:51], v16 offset:4608
  v_mfma_f32_16x16x32_bf16 v[108:111], v[52:55], v[220:223], v[108:111]
  ds_read_b64_tr_b16 v[52:53], v17 offset:4096
  ds_read_b64_tr_b16 v[54:55], v17 offset:4608
  v_mfma_f32_16x16x32_bf16 v[112:115], v[56:59], v[216:219], v[112:115]
  v_mfma_f32_16x16x32_bf16 v[116:119], v[56:59], v[220:223], v[116:119]
  ds_read_b64_tr_b16 v[56:57], v18 offset:4096
  ds_read_b64_tr_b16 v[58:59], v18 offset:4608
  v_mfma_f32_16x16x32_bf16 v[120:123], v[60:63], v[216:219], v[120:123]
  v_mfma_f32_16x16x32_bf16 v[124:127], v[60:63], v[220:223], v[124:127]
  ds_read_b64_tr_b16 v[60:61], v19 offset:4096
  ds_read_b64_tr_b16 v[62:63], v19 offset:4608
  s_waitcnt lgkmcnt(14)
.Lc_s26_y:
  v_mfma_f32_16x16x32_bf16 v[28:31], v[32:35], v[24:27], v[28:31]
  s_waitcnt vmcnt(0)
  s_mov_b64 exec, 1
  buffer_store_dword v12, off, s[16:19], s56 sc1
  s_mov_b64 exec, -1
.Lc_abfl_y:
  v_mfma_f32_16x16x32_bf16 v[96:99], v[32:35], v[224:227], v[96:99]
  v_mfma_f32_16x16x32_bf16 v[100:103], v[32:35], v[228:231], v[100:103]
  ds_read_b64_tr_b16 v[32:33], v16 offset:8192
  ds_read_b64_tr_b16 v[34:35], v16 offset:8704
  s_waitcnt lgkmcnt(14)
  v_mfma_f32_16x16x32_bf16 v[104:107], v[36:39], v[224:227], v[104:107]
  v_mfma_f32_16x16x32_bf16 v[108:111], v[36:39], v[228:231], v[108:111]
  ds_read_b64_tr_b16 v[36:37], v16 offset:12288
  ds_read_b64_tr_b16 v[38:39], v16 offset:12800
  s_waitcnt lgkmcnt(14)
  v_mfma_f32_16x16x32_bf16 v[112:115], v[40:43], v[224:227], v[112:115]
  v_mfma_f32_16x16x32_bf16 v[116:119], v[40:43], v[228:231], v[116:119]
  ds_read_b64_tr_b16 v[40:41], v17 offset:8192
  ds_read_b64_tr_b16 v[42:43], v17 offset:8704
  s_waitcnt lgkmcnt(14)
  v_mfma_f32_16x16x32_bf16 v[120:123], v[44:47], v[224:227], v[120:123]
  v_mfma_f32_16x16x32_bf16 v[124:127], v[44:47], v[228:231], v[124:127]
  ds_read_b64_tr_b16 v[44:45], v17 offset:12288
  ds_read_b64_tr_b16 v[46:47], v17 offset:12800
  s_waitcnt lgkmcnt(14)
  v_mfma_f32_16x16x32_bf16 v[28:31], v[48:51], v[24:27], v[28:31]
  v_mfma_f32_16x16x32_bf16 v[96:99], v[48:51], v[232:235], v[96:99]
  v_mfma_f32_16x16x32_bf16 v[100:103], v[48:51], v[236:239], v[100:103]
  ds_read_b64_tr_b16 v[48:49], v18 offset:8192
  ds_read_b64_tr_b16 v[50:51], v18 offset:8704
  s_waitcnt lgkmcnt(14)
  v_mfma_f32_16x16x32_bf16 v[104:107], v[52:55], v[232:235], v[104:107]
  v_mfma_f32_16x16x32_bf16 v[108:111], v[52:55], v[236:239], v[108:111]
  ds_read_b64_tr_b16 v[52:53], v18 offset:12288
  ds_read_b64_tr_b16 v[54:55], v18 offset:12800
  s_waitcnt lgkmcnt(14)
  v_mfma_f32_16x16x32_bf16 v[112:115], v[56:59], v[232:235], v[112:115]
  v_mfma_f32_16x16x32_bf16 v[116:119], v[56:59], v[236:239], v[116:119]
  ds_read_b64_tr_b16 v[56:57], v19 offset:8192
  ds_read_b64_tr_b16 v[58:59], v19 offset:8704
  s_waitcnt lgkmcnt(14)
  v_mfma_f32_16x16x32_bf16 v[120:123], v[60:63], v[232:235], v[120:123]
  v_mfma_f32_16x16x32_bf16 v[124:127], v[60:63], v[236:239], v[124:127]
  ds_read_b64_tr_b16 v[60:61], v19 offset:12288
  ds_read_b64_tr_b16 v[62:63], v19 offset:12800
  s_waitcnt lgkmcnt(14)
  s_bitcmp1_b32 s2, 2
  s_cbranch_scc1 .Lc_tail_g
.Lshe:
.Lc_s27_y:
  v_mfma_f32_16x16x32_bf16 v[28:31], v[32:35], v[24:27], v[28:31]
  v_mfma_f32_16x16x32_bf16 v[96:99], v[32:35], v[240:243], v[96:99]
  v_mfma_f32_16x16x32_bf16 v[100:103], v[32:35], v[244:247], v[100:103]
  s_waitcnt lgkmcnt(12)
  v_mfma_f32_16x16x32_bf16 v[28:31], v[36:39], v[24:27], v[28:31]
  v_mfma_f32_16x16x32_bf16 v[96:99], v[36:39], v[248:251], v[96:99]
  v_mfma_f32_16x16x32_bf16 v[100:103], v[36:39], v[252:255], v[100:103]
  s_nop 5
  ds_write_b128 v8, v[28:31] offset:512
  s_waitcnt lgkmcnt(11)
  v_mfma_f32_16x16x32_bf16 v[104:107], v[40:43], v[240:243], v[104:107]
  v_mov_b32 v15, 16
  ds_write_b32 v11, v15
  v_mfma_f32_16x16x32_bf16 v[108:111], v[40:43], v[244:247], v[108:111]
  s_and_b32 s76, s2, 1
  s_lshl_b32 s76, s76, 3
  s_waitcnt lgkmcnt(10)
  v_mfma_f32_16x16x32_bf16 v[104:107], v[44:47], v[248:251], v[104:107]
  s_lshr_b32 s3, s2, 5
  s_add_u32 s76, s76, s3
  v_mfma_f32_16x16x32_bf16 v[108:111], v[44:47], v[252:255], v[108:111]
  s_bfe_u32 s60, s2, 131075
  s_bfe_u32 s77, s2, 65537
  s_waitcnt lgkmcnt(8)
  v_mfma_f32_16x16x32_bf16 v[112:115], v[48:51], v[240:243], v[112:115]
  s_lshl2_add_u32 s77, s77, s60
  s_lshl_b32 s60, s60, 3
  ds_read_b32 v13, v10 offset:1024
  v_mfma_f32_16x16x32_bf16 v[116:119], v[48:51], v[244:247], v[116:119]
  s_lshl_b32 s60, s77, 1
  s_lshr_b32 s3, s75, 1
  s_waitcnt lgkmcnt(7)
  v_mfma_f32_16x16x32_bf16 v[112:115], v[52:55], v[248:251], v[112:115]
  s_add_u32 s60, s60, s3
  s_lshl_b32 s60, s60, 8
  v_mfma_f32_16x16x32_bf16 v[116:119], v[52:55], v[252:255], v[116:119]
  s_add_u32 s60, s60, 17301504
  v_lshlrev_b32 v184, 2, v0
  s_waitcnt lgkmcnt(0)
  v_cmp_gt_u32 vcc, 16, v13
  s_cbranch_vccnz .Lsp_107
.Lrt_108:
.Lc_KC2_y:
  v_mfma_f32_16x16x32_bf16 v[120:123], v[56:59], v[240:243], v[120:123]
  v_xor_b32 v3, 64, v8
  ds_read_b128 v[148:151], v3 offset:512
  v_mfma_f32_16x16x32_bf16 v[124:127], v[56:59], v[244:247], v[124:127]
  v_xor_b32 v2, 128, v8
  ds_read_b128 v[152:155], v2 offset:512
  v_mfma_f32_16x16x32_bf16 v[120:123], v[60:63], v[248:251], v[120:123]
  v_xor_b32 v3, 192, v8
  ds_read_b128 v[156:159], v3 offset:512
  v_mfma_f32_16x16x32_bf16 v[124:127], v[60:63], v[252:255], v[124:127]
  v_fma_f32 v96, v160, v28, v96
  v_fma_f32 v97, v160, v29, v97
.Lc_U3E_y:
  v_fma_f32 v98, v160, v30, v98
  v_fma_f32 v99, v160, v31, v99
  v_mul_f32 v168, v96, v96
  v_mul_f32 v169, v97, v97
  v_mul_f32 v170, v98, v98
  v_mul_f32 v171, v99, v99
  v_fma_f32 v168, v166, v168, v162
  v_fma_f32 v169, v166, v169, v162
  v_fma_f32 v170, v166, v170, v162
  v_fma_f32 v171, v166, v171, v162
  v_mul_f32 v168, v96, v168
  v_mul_f32 v169, v97, v169
  v_mul_f32 v170, v98, v170
  v_mul_f32 v171, v99, v171
  v_exp_f32 v168, v168
  v_exp_f32 v169, v169
  v_exp_f32 v170, v170
  v_exp_f32 v171, v171
  v_fma_f32 v168, v168, v164, v164
  v_fma_f32 v169, v169, v164, v164
  v_fma_f32 v170, v170, v164, v164
  v_fma_f32 v171, v171, v164, v164
  v_rcp_f32 v168, v168
  v_rcp_f32 v169, v169
  v_rcp_f32 v170, v170
  v_rcp_f32 v171, v171
  v_mul_f32 v96, v96, v168
  v_mul_f32 v97, v97, v169
  v_mul_f32 v98, v98, v170
  v_mul_f32 v99, v99, v171
  v_cvt_pk_bf16_f32 v192, v96, v97
  v_cvt_pk_bf16_f32 v193, v98, v99
  v_fma_f32 v100, v161, v28, v100
  v_fma_f32 v101, v161, v29, v101
  v_fma_f32 v102, v161, v30, v102
  v_fma_f32 v103, v161, v31, v103
  v_mul_f32 v172, v100, v100
  v_mul_f32 v173, v101, v101
  v_mul_f32 v174, v102, v102
  v_mul_f32 v175, v103, v103
  v_fma_f32 v172, v167, v172, v163
  v_fma_f32 v173, v167, v173, v163
  v_fma_f32 v174, v167, v174, v163
  v_fma_f32 v175, v167, v175, v163
  v_mul_f32 v172, v100, v172
  v_mul_f32 v173, v101, v173
  v_mul_f32 v174, v102, v174
  v_mul_f32 v175, v103, v175
  v_exp_f32 v172, v172
  v_exp_f32 v173, v173
  v_exp_f32 v174, v174
  v_exp_f32 v175, v175
  v_fma_f32 v172, v172, v165, v165
  v_fma_f32 v173, v173, v165, v165
  v_fma_f32 v174, v174, v165, v165
  v_fma_f32 v175, v175, v165, v165
  v_rcp_f32 v172, v172
  v_rcp_f32 v173, v173
  v_rcp_f32 v174, v174
  v_rcp_f32 v175, v175
  v_mul_f32 v100, v100, v172
  v_mul_f32 v101, v101, v173
  v_mul_f32 v102, v102, v174
  v_mul_f32 v103, v103, v175
  v_cvt_pk_bf16_f32 v194, v100, v101
  v_cvt_pk_bf16_f32 v195, v102, v103
  s_nop 0
  v_permlane16_swap_b32 v192, v194
  v_permlane16_swap_b32 v193, v195
  s_waitcnt lgkmcnt(2)
  v_fma_f32 v104, v160, v148, v104
  v_fma_f32 v105, v160, v149, v105
  v_fma_f32 v106, v160, v150, v106
  v_fma_f32 v107, v160, v151, v107
  v_mul_f32 v168, v104, v104
  v_mul_f32 v169, v105, v105
  v_mul_f32 v170, v106, v106
  v_mul_f32 v171, v107, v107
  v_fma_f32 v168, v166, v168, v162
  v_fma_f32 v169, v166, v169, v162
  v_fma_f32 v170, v166, v170, v162
  v_fma_f32 v171, v166, v171, v162
  v_mul_f32 v168, v104, v168
  v_mul_f32 v169, v105, v169
  v_mul_f32 v170, v106, v170
  v_mul_f32 v171, v107, v171
  v_exp_f32 v168, v168
  v_exp_f32 v169, v169
  v_exp_f32 v170, v170
  v_exp_f32 v171, v171
  v_fma_f32 v168, v168, v164, v164
  v_fma_f32 v169, v169, v164, v164
  v_fma_f32 v170, v170, v164, v164
  v_fma_f32 v171, v171, v164, v164
  v_rcp_f32 v168, v168
  v_rcp_f32 v169, v169
  v_rcp_f32 v170, v170
  v_rcp_f32 v171, v171
  v_mul_f32 v104, v104, v168
  v_mul_f32 v105, v105, v169
  v_mul_f32 v106, v106, v170
  v_mul_f32 v107, v107, v171
  v_cvt_pk_bf16_f32 v196, v104, v105
  v_cvt_pk_bf16_f32 v197, v106, v107
  v_fma_f32 v108, v161, v148, v108
  v_fma_f32 v109, v161, v149, v109
  v_fma_f32 v110, v161, v150, v110
  v_fma_f32 v111, v161, v151, v111
  v_mul_f32 v172, v108, v108
  v_mul_f32 v173, v109, v109
  v_mul_f32 v174, v110, v110
  v_mul_f32 v175, v111, v111
  v_fma_f32 v172, v167, v172, v163
  v_fma_f32 v173, v167, v173, v163
  v_fma_f32 v174, v167, v174, v163
  v_fma_f32 v175, v167, v175, v163
  v_mul_f32 v172, v108, v172
  v_mul_f32 v173, v109, v173
  v_mul_f32 v174, v110, v174
  v_mul_f32 v175, v111, v175
  v_exp_f32 v172, v172
  v_exp_f32 v173, v173
  v_exp_f32 v174, v174
  v_exp_f32 v175, v175
  v_fma_f32 v172, v172, v165, v165
  v_fma_f32 v173, v173, v165, v165
  v_fma_f32 v174, v174, v165, v165
  v_fma_f32 v175, v175, v165, v165
  v_rcp_f32 v172, v172
  v_rcp_f32 v173, v173
  v_rcp_f32 v174, v174
  v_rcp_f32 v175, v175
  v_mul_f32 v108, v108, v172
  v_mul_f32 v109, v109, v173
  v_mul_f32 v110, v110, v174
  v_mul_f32 v111, v111, v175
  v_cvt_pk_bf16_f32 v198, v108, v109
  v_cvt_pk_bf16_f32 v199, v110, v111
  s_nop 0
  v_permlane16_swap_b32 v196, v198
  v_permlane16_swap_b32 v197, v199
  buffer_load_dword v184, v184, s[16:19], s60 offen sc1
  s_waitcnt lgkmcnt(1)
  v_fma_f32 v112, v160, v152, v112
  v_fma_f32 v113, v160, v153, v113
  v_fma_f32 v114, v160, v154, v114
  v_fma_f32 v115, v160, v155, v115
  v_mul_f32 v168, v112, v112
  v_mul_f32 v169, v113, v113
  v_mul_f32 v170, v114, v114
  v_mul_f32 v171, v115, v115
  v_fma_f32 v168, v166, v168, v162
  v_fma_f32 v169, v166, v169, v162
  v_fma_f32 v170, v166, v170, v162
  v_fma_f32 v171, v166, v171, v162
  v_mul_f32 v168, v112, v168
  v_mul_f32 v169, v113, v169
  v_mul_f32 v170, v114, v170
  v_mul_f32 v171, v115, v171
  v_exp_f32 v168, v168
  v_exp_f32 v169, v169
  v_exp_f32 v170, v170
  v_exp_f32 v171, v171
  v_fma_f32 v168, v168, v164, v164
  v_fma_f32 v169, v169, v164, v164
  v_fma_f32 v170, v170, v164, v164
  v_fma_f32 v171, v171, v164, v164
  v_rcp_f32 v168, v168
  v_rcp_f32 v169, v169
  v_rcp_f32 v170, v170
  v_rcp_f32 v171, v171
  v_mul_f32 v112, v112, v168
  v_mul_f32 v113, v113, v169
  v_mul_f32 v114, v114, v170
  v_mul_f32 v115, v115, v171
  v_cvt_pk_bf16_f32 v200, v112, v113
  v_cvt_pk_bf16_f32 v201, v114, v115
  v_fma_f32 v116, v161, v152, v116
  v_fma_f32 v117, v161, v153, v117
  v_fma_f32 v118, v161, v154, v118
  v_fma_f32 v119, v161, v155, v119
  v_mul_f32 v172, v116, v116
  v_mul_f32 v173, v117, v117
  v_mul_f32 v174, v118, v118
  v_mul_f32 v175, v119, v119
  v_fma_f32 v172, v167, v172, v163
  v_fma_f32 v173, v167, v173, v163
  v_fma_f32 v174, v167, v174, v163
  v_fma_f32 v175, v167, v175, v163
  v_mul_f32 v172, v116, v172
  v_mul_f32 v173, v117, v173
  v_mul_f32 v174, v118, v174
  v_mul_f32 v175, v119, v175
  v_exp_f32 v172, v172
  v_exp_f32 v173, v173
  v_exp_f32 v174, v174
  v_exp_f32 v175, v175
  v_fma_f32 v172, v172, v165, v165
  v_fma_f32 v173, v173, v165, v165
  v_fma_f32 v174, v174, v165, v165
  v_fma_f32 v175, v175, v165, v165
  v_rcp_f32 v172, v172
  v_rcp_f32 v173, v173
  v_rcp_f32 v174, v174
  v_rcp_f32 v175, v175
  v_mul_f32 v116, v116, v172
  v_mul_f32 v117, v117, v173
  v_mul_f32 v118, v118, v174
  v_mul_f32 v119, v119, v175
  v_cvt_pk_bf16_f32 v202, v116, v117
  v_cvt_pk_bf16_f32 v203, v118, v119
  s_nop 0
  v_permlane16_swap_b32 v200, v202
  v_permlane16_swap_b32 v201, v203
  s_waitcnt lgkmcnt(0)
  v_fma_f32 v120, v160, v156, v120
  v_fma_f32 v121, v160, v157, v121
  v_fma_f32 v122, v160, v158, v122
  v_fma_f32 v123, v160, v159, v123
  v_mul_f32 v168, v120, v120
  v_mul_f32 v169, v121, v121
  v_mul_f32 v170, v122, v122
  v_mul_f32 v171, v123, v123
  v_fma_f32 v168, v166, v168, v162
  v_fma_f32 v169, v166, v169, v162
  v_fma_f32 v170, v166, v170, v162
  v_fma_f32 v171, v166, v171, v162
  v_mul_f32 v168, v120, v168
  v_mul_f32 v169, v121, v169
  v_mul_f32 v170, v122, v170
  v_mul_f32 v171, v123, v171
  v_exp_f32 v168, v168
  v_exp_f32 v169, v169
  v_exp_f32 v170, v170
  v_exp_f32 v171, v171
  v_fma_f32 v168, v168, v164, v164
  v_fma_f32 v169, v169, v164, v164
  v_fma_f32 v170, v170, v164, v164
  v_fma_f32 v171, v171, v164, v164
  v_rcp_f32 v168, v168
  v_rcp_f32 v169, v169
  v_rcp_f32 v170, v170
  v_rcp_f32 v171, v171
  v_mul_f32 v120, v120, v168
  v_mul_f32 v121, v121, v169
  v_mul_f32 v122, v122, v170
  v_mul_f32 v123, v123, v171
  v_cvt_pk_bf16_f32 v204, v120, v121
  v_cvt_pk_bf16_f32 v205, v122, v123
  v_fma_f32 v124, v161, v156, v124
  v_fma_f32 v125, v161, v157, v125
  v_fma_f32 v126, v161, v158, v126
  v_fma_f32 v127, v161, v159, v127
  v_mul_f32 v172, v124, v124
  v_mul_f32 v173, v125, v125
  v_mul_f32 v174, v126, v126
  v_mul_f32 v175, v127, v127
  v_fma_f32 v172, v167, v172, v163
  v_fma_f32 v173, v167, v173, v163
  v_fma_f32 v174, v167, v174, v163
  v_fma_f32 v175, v167, v175, v163
  v_mul_f32 v172, v124, v172
  v_mul_f32 v173, v125, v173
  v_mul_f32 v174, v126, v174
  v_mul_f32 v175, v127, v175
  v_exp_f32 v172, v172
  v_exp_f32 v173, v173
  v_exp_f32 v174, v174
  v_exp_f32 v175, v175
  v_fma_f32 v172, v172, v165, v165
  v_fma_f32 v173, v173, v165, v165
  v_fma_f32 v174, v174, v165, v165
  v_fma_f32 v175, v175, v165, v165
  v_rcp_f32 v172, v172
  v_rcp_f32 v173, v173
  v_rcp_f32 v174, v174
  v_rcp_f32 v175, v175
  v_mul_f32 v124, v124, v172
  v_mul_f32 v125, v125, v173
  v_mul_f32 v126, v126, v174
  v_mul_f32 v127, v127, v175
  v_cvt_pk_bf16_f32 v206, v124, v125
  v_cvt_pk_bf16_f32 v207, v126, v127
  s_nop 0
  v_permlane16_swap_b32 v204, v206
  v_permlane16_swap_b32 v205, v207
.Lc_p1end_y:
  s_and_b32 s48, s2, 1
  s_lshl_b32 s48, s48, 3
  s_lshr_b32 s3, s2, 5
  s_add_u32 s48, s48, s3
  s_bfe_u32 s50, s2, 131075
  s_bfe_u32 s49, s2, 65537
  s_lshl2_add_u32 s49, s49, s50
  s_lshl_b32 s50, s50, 3
  s_mov_b32 s50, 0
  v_lshlrev_b32 v25, 2, v0
  v_and_b32 v1, 15, v0
  v_lshrrev_b32 v2, 4, v0
  v_lshlrev_b32 v24, 15, v2
  v_lshl_add_u32 v24, v1, 4, v24
  v_mul_u32_u24 v20, 30720, v2
  v_lshl_add_u32 v20, v1, 4, v20
  v_add_u32 v21, 122880, v20
  v_lshrrev_b32 v3, 1, v1
  v_xor_b32 v3, v3, v2
  v_lshlrev_b32 v3, 4, v3
  v_lshl_add_u32 v4, v1, 7, v3
  v_xor_b32 v5, 64, v4
  v_add_u32 v6, 65536, v4
  v_add_u32 v7, 65536, v5
  s_lshl2_add_u32 s3, s49, s75
  s_lshl_b32 s51, s3, 9
  s_mul_i32 s50, s50, 245760
  s_lshl_b32 s58, s3, 17
  s_lshl_b32 s61, s3, 2
  s_lshl_b32 s3, s48, 11
  s_add_u32 s58, s58, s3
  s_add_u32 s58, s58, 8388608
  s_add_u32 s59, s58, 5242880
  s_lshl_b32 s3, s48, 8
  s_add_u32 s61, s61, s3
  s_add_u32 s61, s61, 17367168
  s_mov_b32 s52, 92
  s_mov_b32 s53, 3
  v_mov_b32 v30, 16
  v_mov_b32 v64, 0
  v_mov_b32 v65, 0
  v_mov_b32 v66, 0
  v_mov_b32 v67, 0
  v_mov_b32 v68, 0
  v_mov_b32 v69, 0
  v_mov_b32 v70, 0
  v_mov_b32 v71, 0
  v_mov_b32 v72, 0
  v_mov_b32 v73, 0
  v_mov_b32 v74, 0
  v_mov_b32 v75, 0
  v_mov_b32 v76, 0
  v_mov_b32 v77, 0
  v_mov_b32 v78, 0
  v_mov_b32 v79, 0
  v_mov_b32 v80, 0
  v_mov_b32 v81, 0
  v_mov_b32 v82, 0
  v_mov_b32 v83, 0
  v_mov_b32 v84, 0
  v_mov_b32 v85, 0
  v_mov_b32 v86, 0
  v_mov_b32 v87, 0
  v_mov_b32 v88, 0
  v_mov_b32 v89, 0
  v_mov_b32 v90, 0
  v_mov_b32 v91, 0
  v_mov_b32 v92, 0
  v_mov_b32 v93, 0
  v_mov_b32 v94, 0
  v_mov_b32 v95, 0
  v_mov_b32 v96, 0
  v_mov_b32 v97, 0
  v_mov_b32 v98, 0
  v_mov_b32 v99, 0
  v_mov_b32 v100, 0
  v_mov_b32 v101, 0
  v_mov_b32 v102, 0
  v_mov_b32 v103, 0
  v_mov_b32 v104, 0
  v_mov_b32 v105, 0
  v_mov_b32 v106, 0
  v_mov_b32 v107, 0
  v_mov_b32 v108, 0
  v_mov_b32 v109, 0
  v_mov_b32 v110, 0
  v_mov_b32 v111, 0
  v_mov_b32 v112, 0
  v_mov_b32 v113, 0
  v_mov_b32 v114, 0
  v_mov_b32 v115, 0
  v_mov_b32 v116, 0
  v_mov_b32 v117, 0
  v_mov_b32 v118, 0
  v_mov_b32 v119, 0
  v_mov_b32 v120, 0
  v_mov_b32 v121, 0
  v_mov_b32 v122, 0
  v_mov_b32 v123, 0
  v_mov_b32 v124, 0
  v_mov_b32 v125, 0
  v_mov_b32 v126, 0
  v_mov_b32 v127, 0
  s_waitcnt vmcnt(0)
  v_cmp_ne_u32 vcc, s73, v184
  s_nop 1
  s_and_b32 s3, vcc_lo, 0xFFFF
  s_cbranch_scc1 .Lc2_fl_y
.Lc2_go_y:
.Lc_p2go_y:
  s_add_u32 s56, s51, s50
  s_add_u32 s50, s51, 7864320
  ds_read_b32 v13, v10 offset:0
  buffer_load_dwordx4 v[128:131], v20, s[16:19], s56 offen sc1
  buffer_load_dwordx4 v[132:135], v20, s[16:19], s56 offen offset:256 sc1
  buffer_load_dwordx4 v[136:139], v21, s[16:19], s56 offen sc1
  buffer_load_dwordx4 v[140:143], v21, s[16:19], s56 offen offset:256 sc1
  s_add_u32 s56, s56, 245760
  buffer_load_dwordx4 v[144:147], v20, s[16:19], s56 offen sc1
  buffer_load_dwordx4 v[148:151], v20, s[16:19], s56 offen offset:256 sc1
  buffer_load_dwordx4 v[152:155], v21, s[16:19], s56 offen sc1
  buffer_load_dwordx4 v[156:159], v21, s[16:19], s56 offen offset:256 sc1
  s_waitcnt lgkmcnt(0)
  v_cmp_gt_u32 vcc, s52, v13
  s_cbranch_vccnz .Lsp_137
.Lrt_138:
.Lc_p2full0_y:
  ds_read_b128 v[32:35], v4 offset:0
  ds_read_b128 v[36:39], v4 offset:2048
  ds_read_b128 v[40:43], v4 offset:4096
  ds_read_b128 v[44:47], v4 offset:6144
  ds_read_b128 v[48:51], v4 offset:8192
  ds_read_b128 v[52:55], v4 offset:10240
  ds_read_b128 v[56:59], v4 offset:12288
  ds_read_b128 v[60:63], v4 offset:14336
  s_add_u32 s56, s56, 245760
  buffer_load_dwordx4 v[160:163], v20, s[16:19], s56 offen sc1
  buffer_load_dwordx4 v[164:167], v20, s[16:19], s56 offen offset:256 sc1
  buffer_load_dwordx4 v[168:171], v21, s[16:19], s56 offen sc1
  buffer_load_dwordx4 v[172:175], v21, s[16:19], s56 offen offset:256 sc1
  s_add_u32 s56, s56, 245760
  buffer_load_dwordx4 v[176:179], v20, s[16:19], s56 offen sc1
  buffer_load_dwordx4 v[180:183], v20, s[16:19], s56 offen offset:256 sc1
  buffer_store_dwordx4 v[192:195], v23, s[16:19], s66 offen sc1
  buffer_store_dwordx4 v[196:199], v23, s[16:19], s67 offen sc1
  buffer_store_dwordx4 v[200:203], v23, s[16:19], s68 offen sc1
  buffer_store_dwordx4 v[204:207], v23, s[16:19], s69 offen sc1
.Lc2_loop_y:
  s_waitcnt vmcnt(13) lgkmcnt(6)
  v_mfma_f32_16x16x32_bf16 v[64:67], v[128:131], v[32:35], v[64:67]
  buffer_load_dwordx4 v[184:187], v21, s[16:19], s56 offen sc1
  v_mfma_f32_16x16x32_bf16 v[68:71], v[132:135], v[32:35], v[68:71]
  ds_read_b128 v[32:35], v5 offset:0
  v_mfma_f32_16x16x32_bf16 v[72:75], v[128:131], v[36:39], v[72:75]
  buffer_load_dwordx4 v[188:191], v21, s[16:19], s56 offen offset:256 sc1
  v_mfma_f32_16x16x32_bf16 v[76:79], v[132:135], v[36:39], v[76:79]
  ds_read_b128 v[36:39], v5 offset:2048
  s_waitcnt lgkmcnt(6)
  v_mfma_f32_16x16x32_bf16 v[80:83], v[128:131], v[40:43], v[80:83]
  v_mfma_f32_16x16x32_bf16 v[84:87], v[132:135], v[40:43], v[84:87]
  ds_read_b128 v[40:43], v5 offset:4096
  v_mfma_f32_16x16x32_bf16 v[88:91], v[128:131], v[44:47], v[88:91]
  ds_read_b32 v13, v10 offset:0
  v_mfma_f32_16x16x32_bf16 v[92:95], v[132:135], v[44:47], v[92:95]
  ds_read_b128 v[44:47], v5 offset:6144
  s_waitcnt lgkmcnt(7)
  v_mfma_f32_16x16x32_bf16 v[96:99], v[128:131], v[48:51], v[96:99]
  buffer_load_dword v31, v25, s[16:19], s60 offen sc1
  s_add_u32 s56, s56, 245760
  s_cmp_eq_u32 s56, s50
  s_cselect_b32 s56, s51, s56
  v_mfma_f32_16x16x32_bf16 v[100:103], v[132:135], v[48:51], v[100:103]
  ds_read_b128 v[48:51], v5 offset:8192
  v_mfma_f32_16x16x32_bf16 v[104:107], v[128:131], v[52:55], v[104:107]
  v_mfma_f32_16x16x32_bf16 v[108:111], v[132:135], v[52:55], v[108:111]
  ds_read_b128 v[52:55], v5 offset:10240
  s_waitcnt lgkmcnt(7)
  v_mfma_f32_16x16x32_bf16 v[112:115], v[128:131], v[56:59], v[112:115]
  v_add_u32 v30, 1, v30
  s_add_u32 s52, s52, 4
  v_mfma_f32_16x16x32_bf16 v[116:119], v[132:135], v[56:59], v[116:119]
  ds_read_b128 v[56:59], v5 offset:12288
  v_mfma_f32_16x16x32_bf16 v[120:123], v[128:131], v[60:63], v[120:123]
  v_mfma_f32_16x16x32_bf16 v[124:127], v[132:135], v[60:63], v[124:127]
  ds_read_b128 v[60:63], v5 offset:14336
  s_waitcnt vmcnt(14) lgkmcnt(5)
  v_mfma_f32_16x16x32_bf16 v[64:67], v[136:139], v[32:35], v[64:67]
  v_cmp_gt_u32 vcc, s52, v13
  s_cbranch_vccnz .Lsp_157
.Lrt_158:
  v_mfma_f32_16x16x32_bf16 v[68:71], v[140:143], v[32:35], v[68:71]
  ds_read_b128 v[32:35], v4 offset:16384
  v_mfma_f32_16x16x32_bf16 v[72:75], v[136:139], v[36:39], v[72:75]
  ds_write_b32 v11, v30
  v_mfma_f32_16x16x32_bf16 v[76:79], v[140:143], v[36:39], v[76:79]
  ds_read_b128 v[36:39], v4 offset:18432
  s_waitcnt lgkmcnt(7)
  v_mfma_f32_16x16x32_bf16 v[80:83], v[136:139], v[40:43], v[80:83]
  buffer_load_dwordx4 v[192:195], v20, s[16:19], s56 offen sc1
  v_mfma_f32_16x16x32_bf16 v[84:87], v[140:143], v[40:43], v[84:87]
  ds_read_b128 v[40:43], v4 offset:20480
  v_mfma_f32_16x16x32_bf16 v[88:91], v[136:139], v[44:47], v[88:91]
  buffer_load_dwordx4 v[196:199], v20, s[16:19], s56 offen offset:256 sc1
  v_mfma_f32_16x16x32_bf16 v[92:95], v[140:143], v[44:47], v[92:95]
  ds_read_b128 v[44:47], v4 offset:22528
  s_waitcnt lgkmcnt(7)
  v_mfma_f32_16x16x32_bf16 v[96:99], v[136:139], v[48:51], v[96:99]
  v_mfma_f32_16x16x32_bf16 v[100:103], v[140:143], v[48:51], v[100:103]
  ds_read_b128 v[48:51], v4 offset:24576
  v_mfma_f32_16x16x32_bf16 v[104:107], v[136:139], v[52:55], v[104:107]
  v_mfma_f32_16x16x32_bf16 v[108:111], v[140:143], v[52:55], v[108:111]
  ds_read_b128 v[52:55], v4 offset:26624
  s_waitcnt lgkmcnt(7)
  v_mfma_f32_16x16x32_bf16 v[112:115], v[136:139], v[56:59], v[112:115]
  v_mfma_f32_16x16x32_bf16 v[116:119], v[140:143], v[56:59], v[116:119]
  ds_read_b128 v[56:59], v4 offset:28672
  v_mfma_f32_16x16x32_bf16 v[120:123], v[136:139], v[60:63], v[120:123]
  v_mfma_f32_16x16x32_bf16 v[124:127], v[140:143], v[60:63], v[124:127]
  ds_read_b128 v[60:63], v4 offset:30720
  s_waitcnt vmcnt(13) lgkmcnt(6)
  v_mfma_f32_16x16x32_bf16 v[64:67], v[144:147], v[32:35], v[64:67]
  buffer_load_dwordx4 v[200:203], v21, s[16:19], s56 offen sc1
  v_mfma_f32_16x16x32_bf16 v[68:71], v[148:151], v[32:35], v[68:71]
  ds_read_b128 v[32:35], v5 offset:16384
  v_mfma_f32_16x16x32_bf16 v[72:75], v[144:147], v[36:39], v[72:75]
  buffer_load_dwordx4 v[204:207], v21, s[16:19], s56 offen offset:256 sc1
  v_mfma_f32_16x16x32_bf16 v[76:79], v[148:151], v[36:39], v[76:79]
  ds_read_b128 v[36:39], v5 offset:18432
  s_waitcnt lgkmcnt(6)
  v_mfma_f32_16x16x32_bf16 v[80:83], v[144:147], v[40:43], v[80:83]
  v_mfma_f32_16x16x32_bf16 v[84:87], v[148:151], v[40:43], v[84:87]
  ds_read_b128 v[40:43], v5 offset:20480
  v_mfma_f32_16x16x32_bf16 v[88:91], v[144:147], v[44:47], v[88:91]
  ds_read_b32 v13, v10 offset:0
  v_mfma_f32_16x16x32_bf16 v[92:95], v[148:151], v[44:47], v[92:95]
  ds_read_b128 v[44:47], v5 offset:22528
  s_waitcnt lgkmcnt(7)
  v_mfma_f32_16x16x32_bf16 v[96:99], v[144:147], v[48:51], v[96:99]
  s_add_u32 s56, s56, 245760
  v_mfma_f32_16x16x32_bf16 v[100:103], v[148:151], v[48:51], v[100:103]
  ds_read_b128 v[48:51], v5 offset:24576
  v_mfma_f32_16x16x32_bf16 v[104:107], v[144:147], v[52:55], v[104:107]
  v_mfma_f32_16x16x32_bf16 v[108:111], v[148:151], v[52:55], v[108:111]
  ds_read_b128 v[52:55], v5 offset:26624
  s_waitcnt lgkmcnt(7)
  v_mfma_f32_16x16x32_bf16 v[112:115], v[144:147], v[56:59], v[112:115]
  v_add_u32 v30, 1, v30
  s_add_u32 s52, s52, 4
  v_mfma_f32_16x16x32_bf16 v[116:119], v[148:151], v[56:59], v[116:119]
  ds_read_b128 v[56:59], v5 offset:28672
  v_mfma_f32_16x16x32_bf16 v[120:123], v[144:147], v[60:63], v[120:123]
  v_mfma_f32_16x16x32_bf16 v[124:127], v[148:151], v[60:63], v[124:127]
  ds_read_b128 v[60:63], v5 offset:30720
  s_waitcnt vmcnt(13) lgkmcnt(5)
  v_mfma_f32_16x16x32_bf16 v[64:67], v[152:155], v[32:35], v[64:67]
  v_cmp_gt_u32 vcc, s52, v13
  s_cbranch_vccnz .Lsp_159
.Lrt_160:
  v_mfma_f32_16x16x32_bf16 v[68:71], v[156:159], v[32:35], v[68:71]
  ds_read_b128 v[32:35], v4 offset:32768
  v_mfma_f32_16x16x32_bf16 v[72:75], v[152:155], v[36:39], v[72:75]
  ds_write_b32 v11, v30
  v_mfma_f32_16x16x32_bf16 v[76:79], v[156:159], v[36:39], v[76:79]
  ds_read_b128 v[36:39], v4 offset:34816
  s_waitcnt lgkmcnt(7)
  v_mfma_f32_16x16x32_bf16 v[80:83], v[152:155], v[40:43], v[80:83]
  buffer_load_dwordx4 v[208:211], v20, s[16:19], s56 offen sc1
  v_mfma_f32_16x16x32_bf16 v[84:87], v[156:159], v[40:43], v[84:87]
  ds_read_b128 v[40:43], v4 offset:36864
  v_mfma_f32_16x16x32_bf16 v[88:91], v[152:155], v[44:47], v[88:91]
  buffer_load_dwordx4 v[212:215], v20, s[16:19], s56 offen offset:256 sc1
  v_mfma_f32_16x16x32_bf16 v[92:95], v[156:159], v[44:47], v[92:95]
  ds_read_b128 v[44:47], v4 offset:38912
  s_waitcnt lgkmcnt(7)
  v_mfma_f32_16x16x32_bf16 v[96:99], v[152:155], v[48:51], v[96:99]
  v_mfma_f32_16x16x32_bf16 v[100:103], v[156:159], v[48:51], v[100:103]
  ds_read_b128 v[48:51], v4 offset:40960
  v_mfma_f32_16x16x32_bf16 v[104:107], v[152:155], v[52:55], v[104:107]
  v_mfma_f32_16x16x32_bf16 v[108:111], v[156:159], v[52:55], v[108:111]
  ds_read_b128 v[52:55], v4 offset:43008
  s_waitcnt lgkmcnt(7)
  v_mfma_f32_16x16x32_bf16 v[112:115], v[152:155], v[56:59], v[112:115]
  v_mfma_f32_16x16x32_bf16 v[116:119], v[156:159], v[56:59], v[116:119]
  ds_read_b128 v[56:59], v4 offset:45056
  v_mfma_f32_16x16x32_bf16 v[120:123], v[152:155], v[60:63], v[120:123]
  v_mfma_f32_16x16x32_bf16 v[124:127], v[156:159], v[60:63], v[124:127]
  ds_read_b128 v[60:63], v4 offset:47104
  s_waitcnt vmcnt(13) lgkmcnt(6)
  v_mfma_f32_16x16x32_bf16 v[64:67], v[160:163], v[32:35], v[64:67]
  buffer_load_dwordx4 v[216:219], v21, s[16:19], s56 offen sc1
  v_mfma_f32_16x16x32_bf16 v[68:71], v[164:167], v[32:35], v[68:71]
  ds_read_b128 v[32:35], v5 offset:32768
  v_mfma_f32_16x16x32_bf16 v[72:75], v[160:163], v[36:39], v[72:75]
  buffer_load_dwordx4 v[220:223], v21, s[16:19], s56 offen offset:256 sc1
  v_mfma_f32_16x16x32_bf16 v[76:79], v[164:167], v[36:39], v[76:79]
  ds_read_b128 v[36:39], v5 offset:34816
  s_waitcnt lgkmcnt(6)
  v_mfma_f32_16x16x32_bf16 v[80:83], v[160:163], v[40:43], v[80:83]
  v_mfma_f32_16x16x32_bf16 v[84:87], v[164:167], v[40:43], v[84:87]
  ds_read_b128 v[40:43], v5 offset:36864
  v_mfma_f32_16x16x32_bf16 v[88:91], v[160:163], v[44:47], v[88:91]
  ds_read_b32 v13, v10 offset:0
  v_mfma_f32_16x16x32_bf16 v[92:95], v[164:167], v[44:47], v[92:95]
  ds_read_b128 v[44:47], v5 offset:38912
  s_waitcnt lgkmcnt(7)
  v_mfma_f32_16x16x32_bf16 v[96:99], v[160:163], v[48:51], v[96:99]
  s_add_u32 s56, s56, 245760
  v_mfma_f32_16x16x32_bf16 v[100:103], v[164:167], v[48:51], v[100:103]
  ds_read_b128 v[48:51], v5 offset:40960
  v_mfma_f32_16x16x32_bf16 v[104:107], v[160:163], v[52:55], v[104:107]
  v_mfma_f32_16x16x32_bf16 v[108:111], v[164:167], v[52:55], v[108:111]
  ds_read_b128 v[52:55], v5 offset:43008
  s_waitcnt lgkmcnt(7)
  v_mfma_f32_16x16x32_bf16 v[112:115], v[160:163], v[56:59], v[112:115]
  v_add_u32 v30, 1, v30
  s_add_u32 s52, s52, 4
  v_mfma_f32_16x16x32_bf16 v[116:119], v[164:167], v[56:59], v[116:119]
  ds_read_b128 v[56:59], v5 offset:45056
  v_mfma_f32_16x16x32_bf16 v[120:123], v[160:163], v[60:63], v[120:123]
  v_mfma_f32_16x16x32_bf16 v[124:127], v[164:167], v[60:63], v[124:127]
  ds_read_b128 v[60:63], v5 offset:47104
  s_waitcnt vmcnt(13) lgkmcnt(5)
  v_mfma_f32_16x16x32_bf16 v[64:67], v[168:171], v[32:35], v[64:67]
  v_cmp_gt_u32 vcc, s52, v13
  s_cbranch_vccnz .Lsp_161
.Lrt_162:
  v_mfma_f32_16x16x32_bf16 v[68:71], v[172:175], v[32:35], v[68:71]
  ds_read_b128 v[32:35], v4 offset:49152
  v_mfma_f32_16x16x32_bf16 v[72:75], v[168:171], v[36:39], v[72:75]
  ds_write_b32 v11, v30
  v_mfma_f32_16x16x32_bf16 v[76:79], v[172:175], v[36:39], v[76:79]
  ds_read_b128 v[36:39], v4 offset:51200
  s_waitcnt lgkmcnt(7)
  v_mfma_f32_16x16x32_bf16 v[80:83], v[168:171], v[40:43], v[80:83]
  buffer_load_dwordx4 v[224:227], v20, s[16:19], s56 offen sc1
  v_mfma_f32_16x16x32_bf16 v[84:87], v[172:175], v[40:43], v[84:87]
  ds_read_b128 v[40:43], v4 offset:53248
  v_mfma_f32_16x16x32_bf16 v[88:91], v[168:171], v[44:47], v[88:91]
  buffer_load_dwordx4 v[228:231], v20, s[16:19], s56 offen offset:256 sc1
  v_mfma_f32_16x16x32_bf16 v[92:95], v[172:175], v[44:47], v[92:95]
  ds_read_b128 v[44:47], v4 offset:55296
  s_waitcnt lgkmcnt(7)
  v_mfma_f32_16x16x32_bf16 v[96:99], v[168:171], v[48:51], v[96:99]
  v_mfma_f32_16x16x32_bf16 v[100:103], v[172:175], v[48:51], v[100:103]
  ds_read_b128 v[48:51], v4 offset:57344
  v_mfma_f32_16x16x32_bf16 v[104:107], v[168:171], v[52:55], v[104:107]
  v_mfma_f32_16x16x32_bf16 v[108:111], v[172:175], v[52:55], v[108:111]
  ds_read_b128 v[52:55], v4 offset:59392
  s_waitcnt lgkmcnt(7)
  v_mfma_f32_16x16x32_bf16 v[112:115], v[168:171], v[56:59], v[112:115]
  v_mfma_f32_16x16x32_bf16 v[116:119], v[172:175], v[56:59], v[116:119]
  ds_read_b128 v[56:59], v4 offset:61440
  v_mfma_f32_16x16x32_bf16 v[120:123], v[168:171], v[60:63], v[120:123]
  v_mfma_f32_16x16x32_bf16 v[124:127], v[172:175], v[60:63], v[124:127]
  ds_read_b128 v[60:63], v4 offset:63488
  s_waitcnt vmcnt(13) lgkmcnt(6)
  v_mfma_f32_16x16x32_bf16 v[64:67], v[176:179], v[32:35], v[64:67]
  buffer_load_dwordx4 v[232:235], v21, s[16:19], s56 offen sc1
  v_mfma_f32_16x16x32_bf16 v[68:71], v[180:183], v[32:35], v[68:71]
  ds_read_b128 v[32:35], v5 offset:49152
  v_mfma_f32_16x16x32_bf16 v[72:75], v[176:179], v[36:39], v[72:75]
  buffer_load_dwordx4 v[236:239], v21, s[16:19], s56 offen offset:256 sc1
  v_mfma_f32_16x16x32_bf16 v[76:79], v[180:183], v[36:39], v[76:79]
  ds_read_b128 v[36:39], v5 offset:51200
  s_waitcnt lgkmcnt(6)
  v_mfma_f32_16x16x32_bf16 v[80:83], v[176:179], v[40:43], v[80:83]
  v_mfma_f32_16x16x32_bf16 v[84:87], v[180:183], v[40:43], v[84:87]
  ds_read_b128 v[40:43], v5 offset:53248
  v_mfma_f32_16x16x32_bf16 v[88:91], v[176:179], v[44:47], v[88:91]
  ds_read_b32 v13, v10 offset:0
  v_mfma_f32_16x16x32_bf16 v[92:95], v[180:183], v[44:47], v[92:95]
  ds_read_b128 v[44:47], v5 offset:55296
  s_waitcnt lgkmcnt(7)
  v_mfma_f32_16x16x32_bf16 v[96:99], v[176:179], v[48:51], v[96:99]
  s_add_u32 s56, s56, 245760
  v_mfma_f32_16x16x32_bf16 v[100:103], v[180:183], v[48:51], v[100:103]
  ds_read_b128 v[48:51], v5 offset:57344
  v_mfma_f32_16x16x32_bf16 v[104:107], v[176:179], v[52:55], v[104:107]
  v_mfma_f32_16x16x32_bf16 v[108:111], v[180:183], v[52:55], v[108:111]
  ds_read_b128 v[52:55], v5 offset:59392
  s_waitcnt lgkmcnt(7)
  v_mfma_f32_16x16x32_bf16 v[112:115], v[176:179], v[56:59], v[112:115]
  v_add_u32 v30, 1, v30
  s_add_u32 s52, s52, 4
  v_mfma_f32_16x16x32_bf16 v[116:119], v[180:183], v[56:59], v[116:119]
  ds_read_b128 v[56:59], v5 offset:61440
  v_mfma_f32_16x16x32_bf16 v[120:123], v[176:179], v[60:63], v[120:123]
  v_mfma_f32_16x16x32_bf16 v[124:127], v[180:183], v[60:63], v[124:127]
  ds_read_b128 v[60:63], v5 offset:63488
  s_waitcnt vmcnt(13) lgkmcnt(5)
  v_mfma_f32_16x16x32_bf16 v[64:67], v[184:187], v[32:35], v[64:67]
  v_cmp_gt_u32 vcc, s52, v13
  s_cbranch_vccnz .Lsp_163
.Lrt_164:
  v_mfma_f32_16x16x32_bf16 v[68:71], v[188:191], v[32:35], v[68:71]
  ds_read_b128 v[32:35], v6 offset:0
  v_mfma_f32_16x16x32_bf16 v[72:75], v[184:187], v[36:39], v[72:75]
  ds_write_b32 v11, v30
  v_mfma_f32_16x16x32_bf16 v[76:79], v[188:191], v[36:39], v[76:79]
  ds_read_b128 v[36:39], v6 offset:2048
  s_waitcnt lgkmcnt(7)
  v_mfma_f32_16x16x32_bf16 v[80:83], v[184:187], v[40:43], v[80:83]
  buffer_load_dwordx4 v[240:243], v20, s[16:19], s56 offen sc1
  v_mfma_f32_16x16x32_bf16 v[84:87], v[188:191], v[40:43], v[84:87]
  ds_read_b128 v[40:43], v6 offset:4096
  v_mfma_f32_16x16x32_bf16 v[88:91], v[184:187], v[44:47], v[88:91]
  buffer_load_dwordx4 v[244:247], v20, s[16:19], s56 offen offset:256 sc1
  v_mfma_f32_16x16x32_bf16 v[92:95], v[188:191], v[44:47], v[92:95]
  ds_read_b128 v[44:47], v6 offset:6144
  s_waitcnt lgkmcnt(7)
  v_mfma_f32_16x16x32_bf16 v[96:99], v[184:187], v[48:51], v[96:99]
  v_mfma_f32_16x16x32_bf16 v[100:103], v[188:191], v[48:51], v[100:103]
  ds_read_b128 v[48:51], v6 offset:8192
  v_mfma_f32_16x16x32_bf16 v[104:107], v[184:187], v[52:55], v[104:107]
  v_mfma_f32_16x16x32_bf16 v[108:111], v[188:191], v[52:55], v[108:111]
  ds_read_b128 v[52:55], v6 offset:10240
  s_waitcnt lgkmcnt(7)
  v_mfma_f32_16x16x32_bf16 v[112:115], v[184:187], v[56:59], v[112:115]
  v_mfma_f32_16x16x32_bf16 v[116:119], v[188:191], v[56:59], v[116:119]
  ds_read_b128 v[56:59], v6 offset:12288
  v_mfma_f32_16x16x32_bf16 v[120:123], v[184:187], v[60:63], v[120:123]
  v_mfma_f32_16x16x32_bf16 v[124:127], v[188:191], v[60:63], v[124:127]
  ds_read_b128 v[60:63], v6 offset:14336
  s_waitcnt vmcnt(12) lgkmcnt(6)
  v_mfma_f32_16x16x32_bf16 v[64:67], v[192:195], v[32:35], v[64:67]
  buffer_load_dwordx4 v[248:251], v21, s[16:19], s56 offen sc1
  v_mfma_f32_16x16x32_bf16 v[68:71], v[196:199], v[32:35], v[68:71]
  ds_read_b128 v[32:35], v7 offset:0
  v_mfma_f32_16x16x32_bf16 v[72:75], v[192:195], v[36:39], v[72:75]
  buffer_load_dwordx4 v[252:255], v21, s[16:19], s56 offen offset:256 sc1
  v_mfma_f32_16x16x32_bf16 v[76:79], v[196:199], v[36:39], v[76:79]
  ds_read_b128 v[36:39], v7 offset:2048
  s_waitcnt lgkmcnt(6)
  v_mfma_f32_16x16x32_bf16 v[80:83], v[192:195], v[40:43], v[80:83]
  v_mfma_f32_16x16x32_bf16 v[84:87], v[196:199], v[40:43], v[84:87]
  ds_read_b128 v[40:43], v7 offset:4096
  v_mfma_f32_16x16x32_bf16 v[88:91], v[192:195], v[44:47], v[88:91]
  ds_read_b32 v13, v10 offset:0
  v_mfma_f32_16x16x32_bf16 v[92:95], v[196:199], v[44:47], v[92:95]
  ds_read_b128 v[44:47], v7 offset:6144
  s_waitcnt lgkmcnt(7)
  v_mfma_f32_16x16x32_bf16 v[96:99], v[192:195], v[48:51], v[96:99]
  s_add_u32 s56, s56, 245760
  s_cmp_eq_u32 s56, s50
  s_cselect_b32 s56, s51, s56
  v_mfma_f32_16x16x32_bf16 v[100:103], v[196:199], v[48:51], v[100:103]
  ds_read_b128 v[48:51], v7 offset:8192
  v_mfma_f32_16x16x32_bf16 v[104:107], v[192:195], v[52:55], v[104:107]
  s_waitcnt vmcnt(16)
  v_cmp_ne_u32 vcc, s73, v31
  s_cbranch_vccnz .Lsp_165
.Lrt_166:
  v_mfma_f32_16x16x32_bf16 v[108:111], v[196:199], v[52:55], v[108:111]
  ds_read_b128 v[52:55], v7 offset:10240
  s_waitcnt lgkmcnt(7)
  v_mfma_f32_16x16x32_bf16 v[112:115], v[192:195], v[56:59], v[112:115]
  v_add_u32 v30, 1, v30
  s_add_u32 s52, s52, 4
  v_mfma_f32_16x16x32_bf16 v[116:119], v[196:199], v[56:59], v[116:119]
  ds_read_b128 v[56:59], v7 offset:12288
  v_mfma_f32_16x16x32_bf16 v[120:123], v[192:195], v[60:63], v[120:123]
  v_mfma_f32_16x16x32_bf16 v[124:127], v[196:199], v[60:63], v[124:127]
  ds_read_b128 v[60:63], v7 offset:14336
  s_waitcnt vmcnt(12) lgkmcnt(5)
  v_mfma_f32_16x16x32_bf16 v[64:67], v[200:203], v[32:35], v[64:67]
  v_cmp_gt_u32 vcc, s52, v13
  s_cbranch_vccnz .Lsp_167
.Lrt_168:
  v_mfma_f32_16x16x32_bf16 v[68:71], v[204:207], v[32:35], v[68:71]
  ds_read_b128 v[32:35], v6 offset:16384
  v_mfma_f32_16x16x32_bf16 v[72:75], v[200:203], v[36:39], v[72:75]
  ds_write_b32 v11, v30
  v_mfma_f32_16x16x32_bf16 v[76:79], v[204:207], v[36:39], v[76:79]
  ds_read_b128 v[36:39], v6 offset:18432
  s_waitcnt lgkmcnt(7)
  v_mfma_f32_16x16x32_bf16 v[80:83], v[200:203], v[40:43], v[80:83]
  buffer_load_dwordx4 v[128:131], v20, s[16:19], s56 offen sc1
  v_mfma_f32_16x16x32_bf16 v[84:87], v[204:207], v[40:43], v[84:87]
  ds_read_b128 v[40:43], v6 offset:20480
  v_mfma_f32_16x16x32_bf16 v[88:91], v[200:203], v[44:47], v[88:91]
  buffer_load_dwordx4 v[132:135], v20, s[16:19], s56 offen offset:256 sc1
  v_mfma_f32_16x16x32_bf16 v[92:95], v[204:207], v[44:47], v[92:95]
  ds_read_b128 v[44:47], v6 offset:22528
  s_waitcnt lgkmcnt(7)
  v_mfma_f32_16x16x32_bf16 v[96:99], v[200:203], v[48:51], v[96:99]
  v_mfma_f32_16x16x32_bf16 v[100:103], v[204:207], v[48:51], v[100:103]
  ds_read_b128 v[48:51], v6 offset:24576
  v_mfma_f32_16x16x32_bf16 v[104:107], v[200:203], v[52:55], v[104:107]
  v_mfma_f32_16x16x32_bf16 v[108:111], v[204:207], v[52:55], v[108:111]
  ds_read_b128 v[52:55], v6 offset:26624
  s_waitcnt lgkmcnt(7)
  v_mfma_f32_16x16x32_bf16 v[112:115], v[200:203], v[56:59], v[112:115]
  v_mfma_f32_16x16x32_bf16 v[116:119], v[204:207], v[56:59], v[116:119]
  ds_read_b128 v[56:59], v6 offset:28672
  v_mfma_f32_16x16x32_bf16 v[120:123], v[200:203], v[60:63], v[120:123]
  v_mfma_f32_16x16x32_bf16 v[124:127], v[204:207], v[60:63], v[124:127]
  ds_read_b128 v[60:63], v6 offset:30720
  s_waitcnt vmcnt(12) lgkmcnt(6)
  v_mfma_f32_16x16x32_bf16 v[64:67], v[208:211], v[32:35], v[64:67]
  buffer_load_dwordx4 v[136:139], v21, s[16:19], s56 offen sc1
  v_mfma_f32_16x16x32_bf16 v[68:71], v[212:215], v[32:35], v[68:71]
  ds_read_b128 v[32:35], v7 offset:16384
  v_mfma_f32_16x16x32_bf16 v[72:75], v[208:211], v[36:39], v[72:75]
  buffer_load_dwordx4 v[140:143], v21, s[16:19], s56 offen offset:256 sc1
  v_mfma_f32_16x16x32_bf16 v[76:79], v[212:215], v[36:39], v[76:79]
  ds_read_b128 v[36:39], v7 offset:18432
  s_waitcnt lgkmcnt(6)
  v_mfma_f32_16x16x32_bf16 v[80:83], v[208:211], v[40:43], v[80:83]
  v_mfma_f32_16x16x32_bf16 v[84:87], v[212:215], v[40:43], v[84:87]
  ds_read_b128 v[40:43], v7 offset:20480
  v_mfma_f32_16x16x32_bf16 v[88:91], v[208:211], v[44:47], v[88:91]
  ds_read_b32 v13, v10 offset:0
  v_mfma_f32_16x16x32_bf16 v[92:95], v[212:215], v[44:47], v[92:95]
  ds_read_b128 v[44:47], v7 offset:22528
  s_waitcnt lgkmcnt(7)
  v_mfma_f32_16x16x32_bf16 v[96:99], v[208:211], v[48:51], v[96:99]
  s_add_u32 s56, s56, 245760
  v_mfma_f32_16x16x32_bf16 v[100:103], v[212:215], v[48:51], v[100:103]
  ds_read_b128 v[48:51], v7 offset:24576
  v_mfma_f32_16x16x32_bf16 v[104:107], v[208:211], v[52:55], v[104:107]
  v_mfma_f32_16x16x32_bf16 v[108:111], v[212:215], v[52:55], v[108:111]
  ds_read_b128 v[52:55], v7 offset:26624
  s_waitcnt lgkmcnt(7)
  v_mfma_f32_16x16x32_bf16 v[112:115], v[208:211], v[56:59], v[112:115]
  s_mov_b64 exec, 1
  buffer_store_dword v12, off, s[16:19], s57 sc1
  s_mov_b64 exec, -1
  v_add_u32 v30, 1, v30
  s_add_u32 s52, s52, 4
  v_mfma_f32_16x16x32_bf16 v[116:119], v[212:215], v[56:59], v[116:119]
  ds_read_b128 v[56:59], v7 offset:28672
  v_mfma_f32_16x16x32_bf16 v[120:123], v[208:211], v[60:63], v[120:123]
  v_mfma_f32_16x16x32_bf16 v[124:127], v[212:215], v[60:63], v[124:127]
  ds_read_b128 v[60:63], v7 offset:30720
  s_waitcnt vmcnt(13) lgkmcnt(5)
  v_mfma_f32_16x16x32_bf16 v[64:67], v[216:219], v[32:35], v[64:67]
  v_cmp_gt_u32 vcc, s52, v13
  s_cbranch_vccnz .Lsp_169
.Lrt_170:
  v_mfma_f32_16x16x32_bf16 v[68:71], v[220:223], v[32:35], v[68:71]
  ds_read_b128 v[32:35], v6 offset:32768
  v_mfma_f32_16x16x32_bf16 v[72:75], v[216:219], v[36:39], v[72:75]
  ds_write_b32 v11, v30
  v_mfma_f32_16x16x32_bf16 v[76:79], v[220:223], v[36:39], v[76:79]
  ds_read_b128 v[36:39], v6 offset:34816
  s_waitcnt lgkmcnt(7)
  v_mfma_f32_16x16x32_bf16 v[80:83], v[216:219], v[40:43], v[80:83]
  buffer_load_dwordx4 v[144:147], v20, s[16:19], s56 offen sc1
  v_mfma_f32_16x16x32_bf16 v[84:87], v[220:223], v[40:43], v[84:87]
  ds_read_b128 v[40:43], v6 offset:36864
  v_mfma_f32_16x16x32_bf16 v[88:91], v[216:219], v[44:47], v[88:91]
  buffer_load_dwordx4 v[148:151], v20, s[16:19], s56 offen offset:256 sc1
  v_mfma_f32_16x16x32_bf16 v[92:95], v[220:223], v[44:47], v[92:95]
  ds_read_b128 v[44:47], v6 offset:38912
  s_waitcnt lgkmcnt(7)
  v_mfma_f32_16x16x32_bf16 v[96:99], v[216:219], v[48:51], v[96:99]
  v_mfma_f32_16x16x32_bf16 v[100:103], v[220:223], v[48:51], v[100:103]
  ds_read_b128 v[48:51], v6 offset:40960
  v_mfma_f32_16x16x32_bf16 v[104:107], v[216:219], v[52:55], v[104:107]
  v_mfma_f32_16x16x32_bf16 v[108:111], v[220:223], v[52:55], v[108:111]
  ds_read_b128 v[52:55], v6 offset:43008
  s_waitcnt lgkmcnt(7)
  v_mfma_f32_16x16x32_bf16 v[112:115], v[216:219], v[56:59], v[112:115]
  v_mfma_f32_16x16x32_bf16 v[116:119], v[220:223], v[56:59], v[116:119]
  ds_read_b128 v[56:59], v6 offset:45056
  v_mfma_f32_16x16x32_bf16 v[120:123], v[216:219], v[60:63], v[120:123]
  v_mfma_f32_16x16x32_bf16 v[124:127], v[220:223], v[60:63], v[124:127]
  ds_read_b128 v[60:63], v6 offset:47104
  s_waitcnt vmcnt(13) lgkmcnt(6)
  v_mfma_f32_16x16x32_bf16 v[64:67], v[224:227], v[32:35], v[64:67]
  buffer_load_dwordx4 v[152:155], v21, s[16:19], s56 offen sc1
  v_mfma_f32_16x16x32_bf16 v[68:71], v[228:231], v[32:35], v[68:71]
  ds_read_b128 v[32:35], v7 offset:32768
  v_mfma_f32_16x16x32_bf16 v[72:75], v[224:227], v[36:39], v[72:75]
  buffer_load_dwordx4 v[156:159], v21, s[16:19], s56 offen offset:256 sc1
  v_mfma_f32_16x16x32_bf16 v[76:79], v[228:231], v[36:39], v[76:79]
  ds_read_b128 v[36:39], v7 offset:34816
  s_waitcnt lgkmcnt(6)
  v_mfma_f32_16x16x32_bf16 v[80:83], v[224:227], v[40:43], v[80:83]
  v_mfma_f32_16x16x32_bf16 v[84:87], v[228:231], v[40:43], v[84:87]
  ds_read_b128 v[40:43], v7 offset:36864
  v_mfma_f32_16x16x32_bf16 v[88:91], v[224:227], v[44:47], v[88:91]
  ds_read_b32 v13, v10 offset:0
  v_mfma_f32_16x16x32_bf16 v[92:95], v[228:231], v[44:47], v[92:95]
  ds_read_b128 v[44:47], v7 offset:38912
  s_waitcnt lgkmcnt(7)
  v_mfma_f32_16x16x32_bf16 v[96:99], v[224:227], v[48:51], v[96:99]
  s_add_u32 s56, s56, 245760
  v_mfma_f32_16x16x32_bf16 v[100:103], v[228:231], v[48:51], v[100:103]
  ds_read_b128 v[48:51], v7 offset:40960
  v_mfma_f32_16x16x32_bf16 v[104:107], v[224:227], v[52:55], v[104:107]
  v_mfma_f32_16x16x32_bf16 v[108:111], v[228:231], v[52:55], v[108:111]
  ds_read_b128 v[52:55], v7 offset:43008
  s_waitcnt lgkmcnt(7)
  v_mfma_f32_16x16x32_bf16 v[112:115], v[224:227], v[56:59], v[112:115]
  v_add_u32 v30, 1, v30
  s_add_u32 s52, s52, 4
  v_mfma_f32_16x16x32_bf16 v[116:119], v[228:231], v[56:59], v[116:119]
  ds_read_b128 v[56:59], v7 offset:45056
  v_mfma_f32_16x16x32_bf16 v[120:123], v[224:227], v[60:63], v[120:123]
  v_mfma_f32_16x16x32_bf16 v[124:127], v[228:231], v[60:63], v[124:127]
  ds_read_b128 v[60:63], v7 offset:47104
  s_waitcnt vmcnt(13) lgkmcnt(5)
  v_mfma_f32_16x16x32_bf16 v[64:67], v[232:235], v[32:35], v[64:67]
  v_cmp_gt_u32 vcc, s52, v13
  s_cbranch_vccnz .Lsp_171
.Lrt_172:
  v_mfma_f32_16x16x32_bf16 v[68:71], v[236:239], v[32:35], v[68:71]
  ds_read_b128 v[32:35], v6 offset:49152
  v_mfma_f32_16x16x32_bf16 v[72:75], v[232:235], v[36:39], v[72:75]
  ds_write_b32 v11, v30
  v_mfma_f32_16x16x32_bf16 v[76:79], v[236:239], v[36:39], v[76:79]
  ds_read_b128 v[36:39], v6 offset:51200
  s_waitcnt lgkmcnt(7)
  v_mfma_f32_16x16x32_bf16 v[80:83], v[232:235], v[40:43], v[80:83]
  buffer_load_dwordx4 v[160:163], v20, s[16:19], s56 offen sc1
  v_mfma_f32_16x16x32_bf16 v[84:87], v[236:239], v[40:43], v[84:87]
  ds_read_b128 v[40:43], v6 offset:53248
  v_mfma_f32_16x16x32_bf16 v[88:91], v[232:235], v[44:47], v[88:91]
  buffer_load_dwordx4 v[164:167], v20, s[16:19], s56 offen offset:256 sc1
  v_mfma_f32_16x16x32_bf16 v[92:95], v[236:239], v[44:47], v[92:95]
  ds_read_b128 v[44:47], v6 offset:55296
  s_waitcnt lgkmcnt(7)
  v_mfma_f32_16x16x32_bf16 v[96:99], v[232:235], v[48:51], v[96:99]
  v_mfma_f32_16x16x32_bf16 v[100:103], v[236:239], v[48:51], v[100:103]
  ds_read_b128 v[48:51], v6 offset:57344
  v_mfma_f32_16x16x32_bf16 v[104:107], v[232:235], v[52:55], v[104:107]
  v_mfma_f32_16x16x32_bf16 v[108:111], v[236:239], v[52:55], v[108:111]
  ds_read_b128 v[52:55], v6 offset:59392
  s_waitcnt lgkmcnt(7)
  v_mfma_f32_16x16x32_bf16 v[112:115], v[232:235], v[56:59], v[112:115]
  v_mfma_f32_16x16x32_bf16 v[116:119], v[236:239], v[56:59], v[116:119]
  ds_read_b128 v[56:59], v6 offset:61440
  v_mfma_f32_16x16x32_bf16 v[120:123], v[232:235], v[60:63], v[120:123]
  v_mfma_f32_16x16x32_bf16 v[124:127], v[236:239], v[60:63], v[124:127]
  ds_read_b128 v[60:63], v6 offset:63488
  s_waitcnt vmcnt(13) lgkmcnt(6)
  v_mfma_f32_16x16x32_bf16 v[64:67], v[240:243], v[32:35], v[64:67]
  buffer_load_dwordx4 v[168:171], v21, s[16:19], s56 offen sc1
  v_mfma_f32_16x16x32_bf16 v[68:71], v[244:247], v[32:35], v[68:71]
  ds_read_b128 v[32:35], v7 offset:49152
  v_mfma_f32_16x16x32_bf16 v[72:75], v[240:243], v[36:39], v[72:75]
  buffer_load_dwordx4 v[172:175], v21, s[16:19], s56 offen offset:256 sc1
  v_mfma_f32_16x16x32_bf16 v[76:79], v[244:247], v[36:39], v[76:79]
  ds_read_b128 v[36:39], v7 offset:51200
  s_waitcnt lgkmcnt(6)
  v_mfma_f32_16x16x32_bf16 v[80:83], v[240:243], v[40:43], v[80:83]
  v_mfma_f32_16x16x32_bf16 v[84:87], v[244:247], v[40:43], v[84:87]
  ds_read_b128 v[40:43], v7 offset:53248
  v_mfma_f32_16x16x32_bf16 v[88:91], v[240:243], v[44:47], v[88:91]
  ds_read_b32 v13, v10 offset:0
  v_mfma_f32_16x16x32_bf16 v[92:95], v[244:247], v[44:47], v[92:95]
  ds_read_b128 v[44:47], v7 offset:55296
  s_waitcnt lgkmcnt(7)
  v_mfma_f32_16x16x32_bf16 v[96:99], v[240:243], v[48:51], v[96:99]
  s_add_u32 s56, s56, 245760
  v_mfma_f32_16x16x32_bf16 v[100:103], v[244:247], v[48:51], v[100:103]
  ds_read_b128 v[48:51], v7 offset:57344
  v_mfma_f32_16x16x32_bf16 v[104:107], v[240:243], v[52:55], v[104:107]
  v_mfma_f32_16x16x32_bf16 v[108:111], v[244:247], v[52:55], v[108:111]
  ds_read_b128 v[52:55], v7 offset:59392
  s_waitcnt lgkmcnt(7)
  v_mfma_f32_16x16x32_bf16 v[112:115], v[240:243], v[56:59], v[112:115]
  v_add_u32 v30, 1, v30
  s_add_u32 s52, s52, 4
  v_mfma_f32_16x16x32_bf16 v[116:119], v[244:247], v[56:59], v[116:119]
  ds_read_b128 v[56:59], v7 offset:61440
  v_mfma_f32_16x16x32_bf16 v[120:123], v[240:243], v[60:63], v[120:123]
  v_mfma_f32_16x16x32_bf16 v[124:127], v[244:247], v[60:63], v[124:127]
  ds_read_b128 v[60:63], v7 offset:63488
  s_waitcnt vmcnt(13) lgkmcnt(5)
  v_mfma_f32_16x16x32_bf16 v[64:67], v[248:251], v[32:35], v[64:67]
  v_cmp_gt_u32 vcc, s52, v13
  s_cbranch_vccnz .Lsp_173
.Lrt_174:
  v_mfma_f32_16x16x32_bf16 v[68:71], v[252:255], v[32:35], v[68:71]
  ds_read_b128 v[32:35], v4 offset:0
  v_mfma_f32_16x16x32_bf16 v[72:75], v[248:251], v[36:39], v[72:75]
  ds_write_b32 v11, v30
  v_mfma_f32_16x16x32_bf16 v[76:79], v[252:255], v[36:39], v[76:79]
  ds_read_b128 v[36:39], v4 offset:2048
  s_waitcnt lgkmcnt(7)
  v_mfma_f32_16x16x32_bf16 v[80:83], v[248:251], v[40:43], v[80:83]
  buffer_load_dwordx4 v[176:179], v20, s[16:19], s56 offen sc1
  v_mfma_f32_16x16x32_bf16 v[84:87], v[252:255], v[40:43], v[84:87]
  ds_read_b128 v[40:43], v4 offset:4096
  v_mfma_f32_16x16x32_bf16 v[88:91], v[248:251], v[44:47], v[88:91]
  buffer_load_dwordx4 v[180:183], v20, s[16:19], s56 offen offset:256 sc1
  v_mfma_f32_16x16x32_bf16 v[92:95], v[252:255], v[44:47], v[92:95]
  ds_read_b128 v[44:47], v4 offset:6144
  s_waitcnt lgkmcnt(7)
  v_mfma_f32_16x16x32_bf16 v[96:99], v[248:251], v[48:51], v[96:99]
  v_mfma_f32_16x16x32_bf16 v[100:103], v[252:255], v[48:51], v[100:103]
  ds_read_b128 v[48:51], v4 offset:8192
  v_mfma_f32_16x16x32_bf16 v[104:107], v[248:251], v[52:55], v[104:107]
  v_mfma_f32_16x16x32_bf16 v[108:111], v[252:255], v[52:55], v[108:111]
  ds_read_b128 v[52:55], v4 offset:10240
  s_waitcnt lgkmcnt(7)
  v_mfma_f32_16x16x32_bf16 v[112:115], v[248:251], v[56:59], v[112:115]
  s_sub_u32 s53, s53, 1
  s_cmp_lg_u32 s53, 0
  v_mfma_f32_16x16x32_bf16 v[116:119], v[252:255], v[56:59], v[116:119]
  ds_read_b128 v[56:59], v4 offset:12288
  v_mfma_f32_16x16x32_bf16 v[120:123], v[248:251], v[60:63], v[120:123]
  v_mfma_f32_16x16x32_bf16 v[124:127], v[252:255], v[60:63], v[124:127]
  ds_read_b128 v[60:63], v4 offset:14336
  s_cbranch_scc1 .Lc2_loop_y
.Lc2_last_y:
.Lc2_n24_y:
  s_waitcnt vmcnt(13) lgkmcnt(6)
  v_mfma_f32_16x16x32_bf16 v[64:67], v[128:131], v[32:35], v[64:67]
  buffer_load_dwordx4 v[184:187], v21, s[16:19], s56 offen sc1
  v_mfma_f32_16x16x32_bf16 v[68:71], v[132:135], v[32:35], v[68:71]
  ds_read_b128 v[32:35], v5 offset:0
  v_mfma_f32_16x16x32_bf16 v[72:75], v[128:131], v[36:39], v[72:75]
  buffer_load_dwordx4 v[188:191], v21, s[16:19], s56 offen offset:256 sc1
  v_mfma_f32_16x16x32_bf16 v[76:79], v[132:135], v[36:39], v[76:79]
  ds_read_b128 v[36:39], v5 offset:2048
  s_waitcnt lgkmcnt(6)
  v_mfma_f32_16x16x32_bf16 v[80:83], v[128:131], v[40:43], v[80:83]
  v_mfma_f32_16x16x32_bf16 v[84:87], v[132:135], v[40:43], v[84:87]
  ds_read_b128 v[40:43], v5 offset:4096
  v_mfma_f32_16x16x32_bf16 v[88:91], v[128:131], v[44:47], v[88:91]
  ds_read_b32 v13, v10 offset:0
  v_mfma_f32_16x16x32_bf16 v[92:95], v[132:135], v[44:47], v[92:95]
  ds_read_b128 v[44:47], v5 offset:6144
  s_waitcnt lgkmcnt(7)
  v_mfma_f32_16x16x32_bf16 v[96:99], v[128:131], v[48:51], v[96:99]
  s_add_u32 s56, s56, 245760
  s_cmp_eq_u32 s56, s50
  s_cselect_b32 s56, s51, s56
  v_mfma_f32_16x16x32_bf16 v[100:103], v[132:135], v[48:51], v[100:103]
  ds_read_b128 v[48:51], v5 offset:8192
  v_mfma_f32_16x16x32_bf16 v[104:107], v[128:131], v[52:55], v[104:107]
  v_mfma_f32_16x16x32_bf16 v[108:111], v[132:135], v[52:55], v[108:111]
  ds_read_b128 v[52:55], v5 offset:10240
  s_waitcnt lgkmcnt(7)
  v_mfma_f32_16x16x32_bf16 v[112:115], v[128:131], v[56:59], v[112:115]
  v_add_u32 v30, 1, v30
  s_add_u32 s52, s52, 4
  v_mfma_f32_16x16x32_bf16 v[116:119], v[132:135], v[56:59], v[116:119]
  ds_read_b128 v[56:59], v5 offset:12288
  v_mfma_f32_16x16x32_bf16 v[120:123], v[128:131], v[60:63], v[120:123]
  v_mfma_f32_16x16x32_bf16 v[124:127], v[132:135], v[60:63], v[124:127]
  ds_read_b128 v[60:63], v5 offset:14336
  s_waitcnt vmcnt(13) lgkmcnt(5)
  v_mfma_f32_16x16x32_bf16 v[64:67], v[136:139], v[32:35], v[64:67]
  v_cmp_gt_u32 vcc, s52, v13
  s_cbranch_vccnz .Lsp_193
.Lrt_194:
  v_mfma_f32_16x16x32_bf16 v[68:71], v[140:143], v[32:35], v[68:71]
  ds_read_b128 v[32:35], v4 offset:16384
  v_mfma_f32_16x16x32_bf16 v[72:75], v[136:139], v[36:39], v[72:75]
  ds_write_b32 v11, v30
  v_mfma_f32_16x16x32_bf16 v[76:79], v[140:143], v[36:39], v[76:79]
  ds_read_b128 v[36:39], v4 offset:18432
  s_waitcnt lgkmcnt(7)
  v_mfma_f32_16x16x32_bf16 v[80:83], v[136:139], v[40:43], v[80:83]
  buffer_load_dwordx4 v[192:195], v20, s[16:19], s56 offen sc1
  v_mfma_f32_16x16x32_bf16 v[84:87], v[140:143], v[40:43], v[84:87]
  ds_read_b128 v[40:43], v4 offset:20480
  v_mfma_f32_16x16x32_bf16 v[88:91], v[136:139], v[44:47], v[88:91]
  buffer_load_dwordx4 v[196:199], v20, s[16:19], s56 offen offset:256 sc1
  v_mfma_f32_16x16x32_bf16 v[92:95], v[140:143], v[44:47], v[92:95]
  ds_read_b128 v[44:47], v4 offset:22528
  s_waitcnt lgkmcnt(7)
  v_mfma_f32_16x16x32_bf16 v[96:99], v[136:139], v[48:51], v[96:99]
  v_mfma_f32_16x16x32_bf16 v[100:103], v[140:143], v[48:51], v[100:103]
  ds_read_b128 v[48:51], v4 offset:24576
  v_mfma_f32_16x16x32_bf16 v[104:107], v[136:139], v[52:55], v[104:107]
  v_mfma_f32_16x16x32_bf16 v[108:111], v[140:143], v[52:55], v[108:111]
  ds_read_b128 v[52:55], v4 offset:26624
  s_waitcnt lgkmcnt(7)
  v_mfma_f32_16x16x32_bf16 v[112:115], v[136:139], v[56:59], v[112:115]
  v_mfma_f32_16x16x32_bf16 v[116:119], v[140:143], v[56:59], v[116:119]
  ds_read_b128 v[56:59], v4 offset:28672
  v_mfma_f32_16x16x32_bf16 v[120:123], v[136:139], v[60:63], v[120:123]
  v_mfma_f32_16x16x32_bf16 v[124:127], v[140:143], v[60:63], v[124:127]
  ds_read_b128 v[60:63], v4 offset:30720
.Lc2_n25_y:
  s_waitcnt vmcnt(12) lgkmcnt(6)
  v_mfma_f32_16x16x32_bf16 v[64:67], v[144:147], v[32:35], v[64:67]
  buffer_load_dwordx4 v[200:203], v21, s[16:19], s56 offen sc1
  v_mfma_f32_16x16x32_bf16 v[68:71], v[148:151], v[32:35], v[68:71]
  ds_read_b128 v[32:35], v5 offset:16384
  v_mfma_f32_16x16x32_bf16 v[72:75], v[144:147], v[36:39], v[72:75]
  buffer_load_dwordx4 v[204:207], v21, s[16:19], s56 offen offset:256 sc1
  v_mfma_f32_16x16x32_bf16 v[76:79], v[148:151], v[36:39], v[76:79]
  ds_read_b128 v[36:39], v5 offset:18432
  s_waitcnt lgkmcnt(6)
  v_mfma_f32_16x16x32_bf16 v[80:83], v[144:147], v[40:43], v[80:83]
  v_mfma_f32_16x16x32_bf16 v[84:87], v[148:151], v[40:43], v[84:87]
  ds_read_b128 v[40:43], v5 offset:20480
  v_mfma_f32_16x16x32_bf16 v[88:91], v[144:147], v[44:47], v[88:91]
  ds_read_b32 v13, v10 offset:0
  v_mfma_f32_16x16x32_bf16 v[92:95], v[148:151], v[44:47], v[92:95]
  ds_read_b128 v[44:47], v5 offset:22528
  s_waitcnt lgkmcnt(7)
  v_mfma_f32_16x16x32_bf16 v[96:99], v[144:147], v[48:51], v[96:99]
  s_add_u32 s56, s56, 245760
  v_mfma_f32_16x16x32_bf16 v[100:103], v[148:151], v[48:51], v[100:103]
  ds_read_b128 v[48:51], v5 offset:24576
  v_mfma_f32_16x16x32_bf16 v[104:107], v[144:147], v[52:55], v[104:107]
  v_mfma_f32_16x16x32_bf16 v[108:111], v[148:151], v[52:55], v[108:111]
  ds_read_b128 v[52:55], v5 offset:26624
  s_waitcnt lgkmcnt(7)
  v_mfma_f32_16x16x32_bf16 v[112:115], v[144:147], v[56:59], v[112:115]
  v_add_u32 v30, 1, v30
  s_add_u32 s52, s52, 4
  v_mfma_f32_16x16x32_bf16 v[116:119], v[148:151], v[56:59], v[116:119]
  ds_read_b128 v[56:59], v5 offset:28672
  v_mfma_f32_16x16x32_bf16 v[120:123], v[144:147], v[60:63], v[120:123]
  v_mfma_f32_16x16x32_bf16 v[124:127], v[148:151], v[60:63], v[124:127]
  ds_read_b128 v[60:63], v5 offset:30720
  s_waitcnt vmcnt(12) lgkmcnt(5)
  v_mfma_f32_16x16x32_bf16 v[64:67], v[152:155], v[32:35], v[64:67]
  v_cmp_gt_u32 vcc, s52, v13
  s_cbranch_vccnz .Lsp_195
.Lrt_196:
  v_mfma_f32_16x16x32_bf16 v[68:71], v[156:159], v[32:35], v[68:71]
  ds_read_b128 v[32:35], v4 offset:32768
  v_mfma_f32_16x16x32_bf16 v[72:75], v[152:155], v[36:39], v[72:75]
  ds_write_b32 v11, v30
  v_mfma_f32_16x16x32_bf16 v[76:79], v[156:159], v[36:39], v[76:79]
  ds_read_b128 v[36:39], v4 offset:34816
  s_waitcnt lgkmcnt(7)
  v_mfma_f32_16x16x32_bf16 v[80:83], v[152:155], v[40:43], v[80:83]
  buffer_load_dwordx4 v[208:211], v20, s[16:19], s56 offen sc1
  v_mfma_f32_16x16x32_bf16 v[84:87], v[156:159], v[40:43], v[84:87]
  ds_read_b128 v[40:43], v4 offset:36864
  v_mfma_f32_16x16x32_bf16 v[88:91], v[152:155], v[44:47], v[88:91]
  buffer_load_dwordx4 v[212:215], v20, s[16:19], s56 offen offset:256 sc1
  v_mfma_f32_16x16x32_bf16 v[92:95], v[156:159], v[44:47], v[92:95]
  ds_read_b128 v[44:47], v4 offset:38912
  s_waitcnt lgkmcnt(7)
  v_mfma_f32_16x16x32_bf16 v[96:99], v[152:155], v[48:51], v[96:99]
  v_mfma_f32_16x16x32_bf16 v[100:103], v[156:159], v[48:51], v[100:103]
  ds_read_b128 v[48:51], v4 offset:40960
  v_mfma_f32_16x16x32_bf16 v[104:107], v[152:155], v[52:55], v[104:107]
  v_mfma_f32_16x16x32_bf16 v[108:111], v[156:159], v[52:55], v[108:111]
  ds_read_b128 v[52:55], v4 offset:43008
  s_waitcnt lgkmcnt(7)
  v_mfma_f32_16x16x32_bf16 v[112:115], v[152:155], v[56:59], v[112:115]
  v_mfma_f32_16x16x32_bf16 v[116:119], v[156:159], v[56:59], v[116:119]
  ds_read_b128 v[56:59], v4 offset:45056
  v_mfma_f32_16x16x32_bf16 v[120:123], v[152:155], v[60:63], v[120:123]
  v_mfma_f32_16x16x32_bf16 v[124:127], v[156:159], v[60:63], v[124:127]
  ds_read_b128 v[60:63], v4 offset:47104
.Lc2_n26_y:
  s_waitcnt vmcnt(12) lgkmcnt(6)
  v_mfma_f32_16x16x32_bf16 v[64:67], v[160:163], v[32:35], v[64:67]
  buffer_load_dwordx4 v[216:219], v21, s[16:19], s56 offen sc1
  v_mfma_f32_16x16x32_bf16 v[68:71], v[164:167], v[32:35], v[68:71]
  ds_read_b128 v[32:35], v5 offset:32768
  v_mfma_f32_16x16x32_bf16 v[72:75], v[160:163], v[36:39], v[72:75]
  buffer_load_dwordx4 v[220:223], v21, s[16:19], s56 offen offset:256 sc1
  v_mfma_f32_16x16x32_bf16 v[76:79], v[164:167], v[36:39], v[76:79]
  ds_read_b128 v[36:39], v5 offset:34816
  s_waitcnt lgkmcnt(6)
  v_mfma_f32_16x16x32_bf16 v[80:83], v[160:163], v[40:43], v[80:83]
  v_mfma_f32_16x16x32_bf16 v[84:87], v[164:167], v[40:43], v[84:87]
  ds_read_b128 v[40:43], v5 offset:36864
  v_mfma_f32_16x16x32_bf16 v[88:91], v[160:163], v[44:47], v[88:91]
  ds_read_b32 v13, v10 offset:0
  v_mfma_f32_16x16x32_bf16 v[92:95], v[164:167], v[44:47], v[92:95]
  ds_read_b128 v[44:47], v5 offset:38912
  s_waitcnt lgkmcnt(7)
  v_mfma_f32_16x16x32_bf16 v[96:99], v[160:163], v[48:51], v[96:99]
  s_add_u32 s56, s56, 245760
  v_mfma_f32_16x16x32_bf16 v[100:103], v[164:167], v[48:51], v[100:103]
  ds_read_b128 v[48:51], v5 offset:40960
  v_mfma_f32_16x16x32_bf16 v[104:107], v[160:163], v[52:55], v[104:107]
  v_mfma_f32_16x16x32_bf16 v[108:111], v[164:167], v[52:55], v[108:111]
  ds_read_b128 v[52:55], v5 offset:43008
  s_waitcnt lgkmcnt(7)
  v_mfma_f32_16x16x32_bf16 v[112:115], v[160:163], v[56:59], v[112:115]
  v_add_u32 v30, 1, v30
  s_add_u32 s52, s52, 4
  v_mfma_f32_16x16x32_bf16 v[116:119], v[164:167], v[56:59], v[116:119]
  ds_read_b128 v[56:59], v5 offset:45056
  v_mfma_f32_16x16x32_bf16 v[120:123], v[160:163], v[60:63], v[120:123]
  v_mfma_f32_16x16x32_bf16 v[124:127], v[164:167], v[60:63], v[124:127]
  ds_read_b128 v[60:63], v5 offset:47104
  s_waitcnt vmcnt(12) lgkmcnt(5)
  v_mfma_f32_16x16x32_bf16 v[64:67], v[168:171], v[32:35], v[64:67]
  v_cmp_gt_u32 vcc, s52, v13
  s_cbranch_vccnz .Lsp_197
.Lrt_198:
  v_mfma_f32_16x16x32_bf16 v[68:71], v[172:175], v[32:35], v[68:71]
  ds_read_b128 v[32:35], v4 offset:49152
  v_mfma_f32_16x16x32_bf16 v[72:75], v[168:171], v[36:39], v[72:75]
  ds_write_b32 v11, v30
  v_mfma_f32_16x16x32_bf16 v[76:79], v[172:175], v[36:39], v[76:79]
  ds_read_b128 v[36:39], v4 offset:51200
  s_waitcnt lgkmcnt(7)
  v_mfma_f32_16x16x32_bf16 v[80:83], v[168:171], v[40:43], v[80:83]
  buffer_load_dwordx4 v[224:227], v20, s[16:19], s56 offen sc1
  v_mfma_f32_16x16x32_bf16 v[84:87], v[172:175], v[40:43], v[84:87]
  ds_read_b128 v[40:43], v4 offset:53248
  v_mfma_f32_16x16x32_bf16 v[88:91], v[168:171], v[44:47], v[88:91]
  buffer_load_dwordx4 v[228:231], v20, s[16:19], s56 offen offset:256 sc1
  v_mfma_f32_16x16x32_bf16 v[92:95], v[172:175], v[44:47], v[92:95]
  ds_read_b128 v[44:47], v4 offset:55296
  s_waitcnt lgkmcnt(7)
  v_mfma_f32_16x16x32_bf16 v[96:99], v[168:171], v[48:51], v[96:99]
  v_mfma_f32_16x16x32_bf16 v[100:103], v[172:175], v[48:51], v[100:103]
  ds_read_b128 v[48:51], v4 offset:57344
  v_mfma_f32_16x16x32_bf16 v[104:107], v[168:171], v[52:55], v[104:107]
  v_mfma_f32_16x16x32_bf16 v[108:111], v[172:175], v[52:55], v[108:111]
  ds_read_b128 v[52:55], v4 offset:59392
  s_waitcnt lgkmcnt(7)
  v_mfma_f32_16x16x32_bf16 v[112:115], v[168:171], v[56:59], v[112:115]
  v_mfma_f32_16x16x32_bf16 v[116:119], v[172:175], v[56:59], v[116:119]
  ds_read_b128 v[56:59], v4 offset:61440
  v_mfma_f32_16x16x32_bf16 v[120:123], v[168:171], v[60:63], v[120:123]
  v_mfma_f32_16x16x32_bf16 v[124:127], v[172:175], v[60:63], v[124:127]
  ds_read_b128 v[60:63], v4 offset:63488
.Lc2_n27_y:
  s_waitcnt vmcnt(12) lgkmcnt(6)
  v_mfma_f32_16x16x32_bf16 v[64:67], v[176:179], v[32:35], v[64:67]
  buffer_load_dwordx4 v[232:235], v21, s[16:19], s56 offen sc1
  v_mfma_f32_16x16x32_bf16 v[68:71], v[180:183], v[32:35], v[68:71]
  ds_read_b128 v[32:35], v5 offset:49152
  v_mfma_f32_16x16x32_bf16 v[72:75], v[176:179], v[36:39], v[72:75]
  buffer_load_dwordx4 v[236:239], v21, s[16:19], s56 offen offset:256 sc1
  v_mfma_f32_16x16x32_bf16 v[76:79], v[180:183], v[36:39], v[76:79]
  ds_read_b128 v[36:39], v5 offset:51200
  s_waitcnt lgkmcnt(6)
  v_mfma_f32_16x16x32_bf16 v[80:83], v[176:179], v[40:43], v[80:83]
  v_mfma_f32_16x16x32_bf16 v[84:87], v[180:183], v[40:43], v[84:87]
  ds_read_b128 v[40:43], v5 offset:53248
  v_mfma_f32_16x16x32_bf16 v[88:91], v[176:179], v[44:47], v[88:91]
  ds_read_b32 v13, v10 offset:0
  v_mfma_f32_16x16x32_bf16 v[92:95], v[180:183], v[44:47], v[92:95]
  ds_read_b128 v[44:47], v5 offset:55296
  s_waitcnt lgkmcnt(7)
  v_mfma_f32_16x16x32_bf16 v[96:99], v[176:179], v[48:51], v[96:99]
  s_add_u32 s56, s56, 245760
  v_mfma_f32_16x16x32_bf16 v[100:103], v[180:183], v[48:51], v[100:103]
  ds_read_b128 v[48:51], v5 offset:57344
  v_mfma_f32_16x16x32_bf16 v[104:107], v[176:179], v[52:55], v[104:107]
  v_mfma_f32_16x16x32_bf16 v[108:111], v[180:183], v[52:55], v[108:111]
  ds_read_b128 v[52:55], v5 offset:59392
  s_waitcnt lgkmcnt(7)
  v_mfma_f32_16x16x32_bf16 v[112:115], v[176:179], v[56:59], v[112:115]
  v_add_u32 v30, 1, v30
  s_add_u32 s52, s52, 4
  v_mfma_f32_16x16x32_bf16 v[116:119], v[180:183], v[56:59], v[116:119]
  ds_read_b128 v[56:59], v5 offset:61440
  v_mfma_f32_16x16x32_bf16 v[120:123], v[176:179], v[60:63], v[120:123]
  v_mfma_f32_16x16x32_bf16 v[124:127], v[180:183], v[60:63], v[124:127]
  ds_read_b128 v[60:63], v5 offset:63488
  s_waitcnt vmcnt(12) lgkmcnt(5)
  v_mfma_f32_16x16x32_bf16 v[64:67], v[184:187], v[32:35], v[64:67]
  v_cmp_gt_u32 vcc, s52, v13
  s_cbranch_vccnz .Lsp_199
.Lrt_200:
  v_mfma_f32_16x16x32_bf16 v[68:71], v[188:191], v[32:35], v[68:71]
  ds_read_b128 v[32:35], v6 offset:0
  v_mfma_f32_16x16x32_bf16 v[72:75], v[184:187], v[36:39], v[72:75]
  ds_write_b32 v11, v30
  v_mfma_f32_16x16x32_bf16 v[76:79], v[188:191], v[36:39], v[76:79]
  ds_read_b128 v[36:39], v6 offset:2048
  s_waitcnt lgkmcnt(7)
  v_mfma_f32_16x16x32_bf16 v[80:83], v[184:187], v[40:43], v[80:83]
  buffer_load_dwordx4 v[240:243], v20, s[16:19], s56 offen sc1
  v_mfma_f32_16x16x32_bf16 v[84:87], v[188:191], v[40:43], v[84:87]
  ds_read_b128 v[40:43], v6 offset:4096
  v_mfma_f32_16x16x32_bf16 v[88:91], v[184:187], v[44:47], v[88:91]
  buffer_load_dwordx4 v[244:247], v20, s[16:19], s56 offen offset:256 sc1
  v_mfma_f32_16x16x32_bf16 v[92:95], v[188:191], v[44:47], v[92:95]
  ds_read_b128 v[44:47], v6 offset:6144
  s_waitcnt lgkmcnt(7)
  v_mfma_f32_16x16x32_bf16 v[96:99], v[184:187], v[48:51], v[96:99]
  v_mfma_f32_16x16x32_bf16 v[100:103], v[188:191], v[48:51], v[100:103]
  ds_read_b128 v[48:51], v6 offset:8192
  v_mfma_f32_16x16x32_bf16 v[104:107], v[184:187], v[52:55], v[104:107]
  v_mfma_f32_16x16x32_bf16 v[108:111], v[188:191], v[52:55], v[108:111]
  ds_read_b128 v[52:55], v6 offset:10240
  s_waitcnt lgkmcnt(7)
  v_mfma_f32_16x16x32_bf16 v[112:115], v[184:187], v[56:59], v[112:115]
  v_mfma_f32_16x16x32_bf16 v[116:119], v[188:191], v[56:59], v[116:119]
  ds_read_b128 v[56:59], v6 offset:12288
  v_mfma_f32_16x16x32_bf16 v[120:123], v[184:187], v[60:63], v[120:123]
  v_mfma_f32_16x16x32_bf16 v[124:127], v[188:191], v[60:63], v[124:127]
  ds_read_b128 v[60:63], v6 offset:14336
.Lc2_n28_y:
  s_waitcnt vmcnt(12) lgkmcnt(6)
  v_mfma_f32_16x16x32_bf16 v[64:67], v[192:195], v[32:35], v[64:67]
  buffer_load_dwordx4 v[248:251], v21, s[16:19], s56 offen sc1
  v_mfma_f32_16x16x32_bf16 v[68:71], v[196:199], v[32:35], v[68:71]
  ds_read_b128 v[32:35], v7 offset:0
  v_mfma_f32_16x16x32_bf16 v[72:75], v[192:195], v[36:39], v[72:75]
  buffer_load_dwordx4 v[252:255], v21, s[16:19], s56 offen offset:256 sc1
  v_mfma_f32_16x16x32_bf16 v[76:79], v[196:199], v[36:39], v[76:79]
  ds_read_b128 v[36:39], v7 offset:2048
  s_waitcnt lgkmcnt(6)
  v_mfma_f32_16x16x32_bf16 v[80:83], v[192:195], v[40:43], v[80:83]
  v_mfma_f32_16x16x32_bf16 v[84:87], v[196:199], v[40:43], v[84:87]
  ds_read_b128 v[40:43], v7 offset:4096
  v_mfma_f32_16x16x32_bf16 v[88:91], v[192:195], v[44:47], v[88:91]
  ds_read_b32 v13, v10 offset:0
  v_mfma_f32_16x16x32_bf16 v[92:95], v[196:199], v[44:47], v[92:95]
  ds_read_b128 v[44:47], v7 offset:6144
  s_waitcnt lgkmcnt(7)
  v_mfma_f32_16x16x32_bf16 v[96:99], v[192:195], v[48:51], v[96:99]
  v_mfma_f32_16x16x32_bf16 v[100:103], v[196:199], v[48:51], v[100:103]
  ds_read_b128 v[48:51], v7 offset:8192
  v_mfma_f32_16x16x32_bf16 v[104:107], v[192:195], v[52:55], v[104:107]
  v_mfma_f32_16x16x32_bf16 v[108:111], v[196:199], v[52:55], v[108:111]
  ds_read_b128 v[52:55], v7 offset:10240
  s_waitcnt lgkmcnt(7)
  v_mfma_f32_16x16x32_bf16 v[112:115], v[192:195], v[56:59], v[112:115]
  v_add_u32 v30, 1, v30
  s_add_u32 s52, s52, 4
  v_mfma_f32_16x16x32_bf16 v[116:119], v[196:199], v[56:59], v[116:119]
  ds_read_b128 v[56:59], v7 offset:12288
  v_mfma_f32_16x16x32_bf16 v[120:123], v[192:195], v[60:63], v[120:123]
  v_mfma_f32_16x16x32_bf16 v[124:127], v[196:199], v[60:63], v[124:127]
  ds_read_b128 v[60:63], v7 offset:14336
  s_waitcnt vmcnt(12) lgkmcnt(5)
  v_mfma_f32_16x16x32_bf16 v[64:67], v[200:203], v[32:35], v[64:67]
  v_cmp_gt_u32 vcc, s52, v13
  s_cbranch_vccnz .Lsp_201
.Lrt_202:
  v_mfma_f32_16x16x32_bf16 v[68:71], v[204:207], v[32:35], v[68:71]
  ds_read_b128 v[32:35], v6 offset:16384
  v_mfma_f32_16x16x32_bf16 v[72:75], v[200:203], v[36:39], v[72:75]
  ds_write_b32 v11, v30
  v_mfma_f32_16x16x32_bf16 v[76:79], v[204:207], v[36:39], v[76:79]
  ds_read_b128 v[36:39], v6 offset:18432
  s_waitcnt lgkmcnt(7)
  v_mfma_f32_16x16x32_bf16 v[80:83], v[200:203], v[40:43], v[80:83]
  v_mfma_f32_16x16x32_bf16 v[84:87], v[204:207], v[40:43], v[84:87]
  ds_read_b128 v[40:43], v6 offset:20480
  v_mfma_f32_16x16x32_bf16 v[88:91], v[200:203], v[44:47], v[88:91]
  v_mfma_f32_16x16x32_bf16 v[92:95], v[204:207], v[44:47], v[92:95]
  ds_read_b128 v[44:47], v6 offset:22528
  s_waitcnt lgkmcnt(7)
  v_mfma_f32_16x16x32_bf16 v[96:99], v[200:203], v[48:51], v[96:99]
  v_mfma_f32_16x16x32_bf16 v[100:103], v[204:207], v[48:51], v[100:103]
  ds_read_b128 v[48:51], v6 offset:24576
  v_mfma_f32_16x16x32_bf16 v[104:107], v[200:203], v[52:55], v[104:107]
  v_mfma_f32_16x16x32_bf16 v[108:111], v[204:207], v[52:55], v[108:111]
  ds_read_b128 v[52:55], v6 offset:26624
  s_waitcnt lgkmcnt(7)
  v_mfma_f32_16x16x32_bf16 v[112:115], v[200:203], v[56:59], v[112:115]
  v_mfma_f32_16x16x32_bf16 v[116:119], v[204:207], v[56:59], v[116:119]
  ds_read_b128 v[56:59], v6 offset:28672
  v_mfma_f32_16x16x32_bf16 v[120:123], v[200:203], v[60:63], v[120:123]
  v_mfma_f32_16x16x32_bf16 v[124:127], v[204:207], v[60:63], v[124:127]
  ds_read_b128 v[60:63], v6 offset:30720
.Lc2_n29_y:
  s_waitcnt vmcnt(10) lgkmcnt(6)
  v_mfma_f32_16x16x32_bf16 v[64:67], v[208:211], v[32:35], v[64:67]
  v_mfma_f32_16x16x32_bf16 v[68:71], v[212:215], v[32:35], v[68:71]
  ds_read_b128 v[32:35], v7 offset:16384
  v_mfma_f32_16x16x32_bf16 v[72:75], v[208:211], v[36:39], v[72:75]
  v_mfma_f32_16x16x32_bf16 v[76:79], v[212:215], v[36:39], v[76:79]
  ds_read_b128 v[36:39], v7 offset:18432
  s_waitcnt lgkmcnt(6)
  v_mfma_f32_16x16x32_bf16 v[80:83], v[208:211], v[40:43], v[80:83]
  v_mfma_f32_16x16x32_bf16 v[84:87], v[212:215], v[40:43], v[84:87]
  ds_read_b128 v[40:43], v7 offset:20480
  v_mfma_f32_16x16x32_bf16 v[88:91], v[208:211], v[44:47], v[88:91]
  ds_read_b32 v13, v10 offset:0
  v_mfma_f32_16x16x32_bf16 v[92:95], v[212:215], v[44:47], v[92:95]
  ds_read_b128 v[44:47], v7 offset:22528
  s_waitcnt lgkmcnt(7)
  v_mfma_f32_16x16x32_bf16 v[96:99], v[208:211], v[48:51], v[96:99]
  v_mfma_f32_16x16x32_bf16 v[100:103], v[212:215], v[48:51], v[100:103]
  ds_read_b128 v[48:51], v7 offset:24576
  v_mfma_f32_16x16x32_bf16 v[104:107], v[208:211], v[52:55], v[104:107]
  v_mfma_f32_16x16x32_bf16 v[108:111], v[212:215], v[52:55], v[108:111]
  ds_read_b128 v[52:55], v7 offset:26624
  s_waitcnt lgkmcnt(7)
  v_mfma_f32_16x16x32_bf16 v[112:115], v[208:211], v[56:59], v[112:115]
  v_add_u32 v30, 1, v30
  s_add_u32 s52, s52, 8
  v_mfma_f32_16x16x32_bf16 v[116:119], v[212:215], v[56:59], v[116:119]
  ds_read_b128 v[56:59], v7 offset:28672
  v_mfma_f32_16x16x32_bf16 v[120:123], v[208:211], v[60:63], v[120:123]
  v_mfma_f32_16x16x32_bf16 v[124:127], v[212:215], v[60:63], v[124:127]
  ds_read_b128 v[60:63], v7 offset:30720
  s_waitcnt vmcnt(8) lgkmcnt(5)
  v_mfma_f32_16x16x32_bf16 v[64:67], v[216:219], v[32:35], v[64:67]
  v_cmp_gt_u32 vcc, s52, v13
  s_cbranch_vccnz .Lsp_203
.Lrt_204:
  v_mfma_f32_16x16x32_bf16 v[68:71], v[220:223], v[32:35], v[68:71]
  ds_read_b128 v[32:35], v6 offset:32768
  v_mfma_f32_16x16x32_bf16 v[72:75], v[216:219], v[36:39], v[72:75]
  ds_write_b32 v11, v30
  v_mfma_f32_16x16x32_bf16 v[76:79], v[220:223], v[36:39], v[76:79]
  ds_read_b128 v[36:39], v7 offset:32768
  s_waitcnt lgkmcnt(7)
  v_mfma_f32_16x16x32_bf16 v[80:83], v[216:219], v[40:43], v[80:83]
  v_mfma_f32_16x16x32_bf16 v[84:87], v[220:223], v[40:43], v[84:87]
  ds_read_b128 v[40:43], v6 offset:49152
  v_mfma_f32_16x16x32_bf16 v[88:91], v[216:219], v[44:47], v[88:91]
  v_mfma_f32_16x16x32_bf16 v[92:95], v[220:223], v[44:47], v[92:95]
  ds_read_b128 v[44:47], v7 offset:49152
  s_waitcnt lgkmcnt(7)
  v_mfma_f32_16x16x32_bf16 v[96:99], v[216:219], v[48:51], v[96:99]
  v_mfma_f32_16x16x32_bf16 v[100:103], v[220:223], v[48:51], v[100:103]
  ds_read_b128 v[48:51], v6 offset:34816
  v_mfma_f32_16x16x32_bf16 v[104:107], v[216:219], v[52:55], v[104:107]
  v_mfma_f32_16x16x32_bf16 v[108:111], v[220:223], v[52:55], v[108:111]
  ds_read_b128 v[52:55], v7 offset:34816
  s_waitcnt lgkmcnt(7)
  v_mfma_f32_16x16x32_bf16 v[112:115], v[216:219], v[56:59], v[112:115]
  v_mfma_f32_16x16x32_bf16 v[116:119], v[220:223], v[56:59], v[116:119]
  ds_read_b128 v[56:59], v6 offset:51200
  v_mfma_f32_16x16x32_bf16 v[120:123], v[216:219], v[60:63], v[120:123]
  v_mfma_f32_16x16x32_bf16 v[124:127], v[220:223], v[60:63], v[124:127]
  ds_read_b128 v[60:63], v7 offset:51200
.Lc2_n30_y:
  s_waitcnt vmcnt(6) lgkmcnt(6)
  v_mfma_f32_16x16x32_bf16 v[64:67], v[224:227], v[32:35], v[64:67]
  v_mfma_f32_16x16x32_bf16 v[68:71], v[228:231], v[32:35], v[68:71]
  ds_read_b128 v[32:35], v6 offset:36864
  s_waitcnt vmcnt(4)
  v_mfma_f32_16x16x32_bf16 v[64:67], v[232:235], v[36:39], v[64:67]
  v_mfma_f32_16x16x32_bf16 v[68:71], v[236:239], v[36:39], v[68:71]
  ds_read_b128 v[36:39], v7 offset:36864
.Lc2_n31_y:
  s_waitcnt vmcnt(2) lgkmcnt(6)
  v_mfma_f32_16x16x32_bf16 v[64:67], v[240:243], v[40:43], v[64:67]
  v_mfma_f32_16x16x32_bf16 v[68:71], v[244:247], v[40:43], v[68:71]
  ds_read_b128 v[40:43], v6 offset:53248
  s_waitcnt vmcnt(0)
  v_mfma_f32_16x16x32_bf16 v[64:67], v[248:251], v[44:47], v[64:67]
  v_mfma_f32_16x16x32_bf16 v[68:71], v[252:255], v[44:47], v[68:71]
  ds_read_b128 v[44:47], v7 offset:53248
  s_waitcnt lgkmcnt(6)
  v_mfma_f32_16x16x32_bf16 v[72:75], v[224:227], v[48:51], v[72:75]
  v_mfma_f32_16x16x32_bf16 v[76:79], v[228:231], v[48:51], v[76:79]
  ds_read_b128 v[48:51], v6 offset:38912
  v_mfma_f32_16x16x32_bf16 v[72:75], v[232:235], v[52:55], v[72:75]
  s_nop 0
  v_cvt_pk_bf16_f32 v64, v64, v65
  v_cvt_pk_bf16_f32 v65, v66, v67
  v_mfma_f32_16x16x32_bf16 v[76:79], v[236:239], v[52:55], v[76:79]
  ds_read_b128 v[52:55], v7 offset:38912
  v_cvt_pk_bf16_f32 v66, v68, v69
  s_waitcnt lgkmcnt(6)
  v_mfma_f32_16x16x32_bf16 v[72:75], v[240:243], v[56:59], v[72:75]
  v_cvt_pk_bf16_f32 v67, v70, v71
  buffer_store_dwordx4 v[64:67], v24, s[16:19], s58 offen offset:0 sc1
  v_mfma_f32_16x16x32_bf16 v[76:79], v[244:247], v[56:59], v[76:79]
  ds_read_b128 v[56:59], v6 offset:55296
  v_mfma_f32_16x16x32_bf16 v[72:75], v[248:251], v[60:63], v[72:75]
  v_mfma_f32_16x16x32_bf16 v[76:79], v[252:255], v[60:63], v[76:79]
  ds_read_b128 v[60:63], v7 offset:55296
  s_waitcnt lgkmcnt(6)
  v_mfma_f32_16x16x32_bf16 v[80:83], v[224:227], v[32:35], v[80:83]
  v_mfma_f32_16x16x32_bf16 v[84:87], v[228:231], v[32:35], v[84:87]
  ds_read_b128 v[32:35], v6 offset:40960
  v_mfma_f32_16x16x32_bf16 v[80:83], v[232:235], v[36:39], v[80:83]
  s_nop 0
  v_cvt_pk_bf16_f32 v72, v72, v73
  v_cvt_pk_bf16_f32 v73, v74, v75
  v_mfma_f32_16x16x32_bf16 v[84:87], v[236:239], v[36:39], v[84:87]
  ds_read_b128 v[36:39], v7 offset:40960
  v_cvt_pk_bf16_f32 v74, v76, v77
  s_waitcnt lgkmcnt(6)
  v_mfma_f32_16x16x32_bf16 v[80:83], v[240:243], v[40:43], v[80:83]
  v_cvt_pk_bf16_f32 v75, v78, v79
  buffer_store_dwordx4 v[72:75], v24, s[16:19], s58 offen offset:256 sc1
  v_mfma_f32_16x16x32_bf16 v[84:87], v[244:247], v[40:43], v[84:87]
  ds_read_b128 v[40:43], v6 offset:57344
  v_mfma_f32_16x16x32_bf16 v[80:83], v[248:251], v[44:47], v[80:83]
  v_mfma_f32_16x16x32_bf16 v[84:87], v[252:255], v[44:47], v[84:87]
  ds_read_b128 v[44:47], v7 offset:57344
  s_waitcnt lgkmcnt(6)
  v_mfma_f32_16x16x32_bf16 v[88:91], v[224:227], v[48:51], v[88:91]
  v_mfma_f32_16x16x32_bf16 v[92:95], v[228:231], v[48:51], v[92:95]
  ds_read_b128 v[48:51], v6 offset:43008
  v_mfma_f32_16x16x32_bf16 v[88:91], v[232:235], v[52:55], v[88:91]
  s_nop 0
  v_cvt_pk_bf16_f32 v80, v80, v81
  v_cvt_pk_bf16_f32 v81, v82, v83
  v_mfma_f32_16x16x32_bf16 v[92:95], v[236:239], v[52:55], v[92:95]
  ds_read_b128 v[52:55], v7 offset:43008
  v_cvt_pk_bf16_f32 v82, v84, v85
  s_waitcnt lgkmcnt(6)
  v_mfma_f32_16x16x32_bf16 v[88:91], v[240:243], v[56:59], v[88:91]
  v_cvt_pk_bf16_f32 v83, v86, v87
  buffer_store_dwordx4 v[80:83], v24, s[16:19], s58 offen offset:512 sc1
  v_mfma_f32_16x16x32_bf16 v[92:95], v[244:247], v[56:59], v[92:95]
  ds_read_b128 v[56:59], v6 offset:59392
  v_mfma_f32_16x16x32_bf16 v[88:91], v[248:251], v[60:63], v[88:91]
  v_mfma_f32_16x16x32_bf16 v[92:95], v[252:255], v[60:63], v[92:95]
  ds_read_b128 v[60:63], v7 offset:59392
  s_waitcnt lgkmcnt(6)
  v_mfma_f32_16x16x32_bf16 v[96:99], v[224:227], v[32:35], v[96:99]
  v_mfma_f32_16x16x32_bf16 v[100:103], v[228:231], v[32:35], v[100:103]
  ds_read_b128 v[32:35], v6 offset:45056
  v_mfma_f32_16x16x32_bf16 v[96:99], v[232:235], v[36:39], v[96:99]
  s_nop 0
  v_cvt_pk_bf16_f32 v88, v88, v89
  v_cvt_pk_bf16_f32 v89, v90, v91
  v_mfma_f32_16x16x32_bf16 v[100:103], v[236:239], v[36:39], v[100:103]
  ds_read_b128 v[36:39], v7 offset:45056
  v_cvt_pk_bf16_f32 v90, v92, v93
  s_waitcnt lgkmcnt(6)
  v_mfma_f32_16x16x32_bf16 v[96:99], v[240:243], v[40:43], v[96:99]
  v_cvt_pk_bf16_f32 v91, v94, v95
  buffer_store_dwordx4 v[88:91], v24, s[16:19], s58 offen offset:768 sc1
  v_mfma_f32_16x16x32_bf16 v[100:103], v[244:247], v[40:43], v[100:103]
  ds_read_b128 v[40:43], v6 offset:61440
  v_mfma_f32_16x16x32_bf16 v[96:99], v[248:251], v[44:47], v[96:99]
  v_mfma_f32_16x16x32_bf16 v[100:103], v[252:255], v[44:47], v[100:103]
  ds_read_b128 v[44:47], v7 offset:61440
  s_waitcnt lgkmcnt(6)
  v_mfma_f32_16x16x32_bf16 v[104:107], v[224:227], v[48:51], v[104:107]
  v_mfma_f32_16x16x32_bf16 v[108:111], v[228:231], v[48:51], v[108:111]
  ds_read_b128 v[48:51], v6 offset:47104
  v_mfma_f32_16x16x32_bf16 v[104:107], v[232:235], v[52:55], v[104:107]
  s_nop 0
  v_cvt_pk_bf16_f32 v96, v96, v97
  v_cvt_pk_bf16_f32 v97, v98, v99
  v_mfma_f32_16x16x32_bf16 v[108:111], v[236:239], v[52:55], v[108:111]
  ds_read_b128 v[52:55], v7 offset:47104
  v_cvt_pk_bf16_f32 v98, v100, v101
  s_waitcnt lgkmcnt(6)
  v_mfma_f32_16x16x32_bf16 v[104:107], v[240:243], v[56:59], v[104:107]
  v_add_u32 v30, 2, v30
  v_cvt_pk_bf16_f32 v99, v102, v103
  buffer_store_dwordx4 v[96:99], v24, s[16:19], s58 offen offset:1024 sc1
  v_mfma_f32_16x16x32_bf16 v[108:111], v[244:247], v[56:59], v[108:111]
  ds_read_b128 v[56:59], v6 offset:63488
  v_mfma_f32_16x16x32_bf16 v[104:107], v[248:251], v[60:63], v[104:107]
  v_mfma_f32_16x16x32_bf16 v[108:111], v[252:255], v[60:63], v[108:111]
  ds_read_b128 v[60:63], v7 offset:63488
  s_waitcnt lgkmcnt(6)
  v_mfma_f32_16x16x32_bf16 v[112:115], v[224:227], v[32:35], v[112:115]
  v_mfma_f32_16x16x32_bf16 v[116:119], v[228:231], v[32:35], v[116:119]
  v_mfma_f32_16x16x32_bf16 v[112:115], v[232:235], v[36:39], v[112:115]
  ds_write_b32 v11, v30
  s_nop 0
  v_cvt_pk_bf16_f32 v104, v104, v105
  v_cvt_pk_bf16_f32 v105, v106, v107
  v_mfma_f32_16x16x32_bf16 v[116:119], v[236:239], v[36:39], v[116:119]
  v_cvt_pk_bf16_f32 v106, v108, v109
  s_waitcnt lgkmcnt(5)
  v_mfma_f32_16x16x32_bf16 v[112:115], v[240:243], v[40:43], v[112:115]
  v_cvt_pk_bf16_f32 v107, v110, v111
  buffer_store_dwordx4 v[104:107], v24, s[16:19], s58 offen offset:1280 sc1
  v_mfma_f32_16x16x32_bf16 v[116:119], v[244:247], v[40:43], v[116:119]
  v_mfma_f32_16x16x32_bf16 v[112:115], v[248:251], v[44:47], v[112:115]
  v_mfma_f32_16x16x32_bf16 v[116:119], v[252:255], v[44:47], v[116:119]
  s_waitcnt lgkmcnt(3)
  v_mfma_f32_16x16x32_bf16 v[120:123], v[224:227], v[48:51], v[120:123]
  v_mfma_f32_16x16x32_bf16 v[124:127], v[228:231], v[48:51], v[124:127]
  v_mfma_f32_16x16x32_bf16 v[120:123], v[232:235], v[52:55], v[120:123]
  s_nop 2
  v_cvt_pk_bf16_f32 v112, v112, v113
  v_cvt_pk_bf16_f32 v113, v114, v115
  v_mfma_f32_16x16x32_bf16 v[124:127], v[236:239], v[52:55], v[124:127]
  v_cvt_pk_bf16_f32 v114, v116, v117
  s_waitcnt lgkmcnt(1)
  v_mfma_f32_16x16x32_bf16 v[120:123], v[240:243], v[56:59], v[120:123]
  v_cvt_pk_bf16_f32 v115, v118, v119
  buffer_store_dwordx4 v[112:115], v24, s[16:19], s58 offen offset:1536 sc1
  v_mfma_f32_16x16x32_bf16 v[124:127], v[244:247], v[56:59], v[124:127]
  v_mfma_f32_16x16x32_bf16 v[120:123], v[248:251], v[60:63], v[120:123]
  v_mfma_f32_16x16x32_bf16 v[124:127], v[252:255], v[60:63], v[124:127]
.Lc2_mmend_y:
  s_nop 6
  v_cvt_pk_bf16_f32 v120, v120, v121
  v_cvt_pk_bf16_f32 v121, v122, v123
  v_cvt_pk_bf16_f32 v122, v124, v125
  v_cvt_pk_bf16_f32 v123, v126, v127
  buffer_store_dwordx4 v[120:123], v24, s[16:19], s58 offen offset:1792 sc1
  s_waitcnt vmcnt(0)
  s_mov_b64 exec, 1
  buffer_store_dword v12, off, s[16:19], s61 sc1
  s_mov_b64 exec, -1
  s_waitcnt lgkmcnt(0)
.Lc_p2end_y:
  s_xor_b32 s72, s72, 4
  s_and_b32 s48, s2, 3
  s_lshl_b32 s48, s48, 2
  s_lshr_b32 s48, 5380, s48
  s_and_b32 s48, s48, 7
  s_lshr_b32 s3, s2, 6
  s_lshl2_add_u32 s48, s48, s3
  s_lshr_b32 s52, s48, 1
  s_lshl_b32 s52, s52, 8
  s_add_u32 s52, s52, 17367040
  v_lshlrev_b32 v25, 2, v0
  buffer_load_dword v31, v25, s[16:19], s52 offen sc1
  s_lshr_b32 s53, s75, 1
  s_and_b32 s3, s75, 1
  s_lshl1_add_u32 s48, s48, s3
  v_and_b32 v1, 31, v0
  v_lshrrev_b32 v2, 5, v0
  v_lshlrev_b32 v7, 4, v2
  v_lshl_add_u32 v7, v1, 10, v7
  s_lshl_b32 s50, s48, 15
  s_lshl1_add_u32 s3, s72, s53
  s_lshl_b32 s51, s3, 17
  s_lshl_b32 s3, s3, 6
  s_add_u32 s50, s50, s3
  buffer_load_dwordx4 v[96:99], v7, s[4:7], s50 offen offset:0
  buffer_load_dwordx4 v[100:103], v7, s[4:7], s50 offen offset:32
  v_lshlrev_b32 v6, 15, v2
  v_lshl_add_u32 v6, v1, 4, v6
  s_lshl_b32 s48, s48, 9
  s_mul_i32 s49, s53, 1835008
  s_add_u32 s49, s49, s48
  s_add_u32 s49, s49, 12582912
  s_add_u32 s51, s51, s48
  s_add_u32 s51, s51, 8388608
  v_bfe_u32 v3, v0, 2, 2
  v_lshl_add_u32 v3, v2, 3, v3
  v_lshlrev_b32 v3, 7, v3
  v_bfe_u32 v1, v0, 4, 1
  v_bfe_u32 v2, v0, 3, 1
  v_lshl_add_u32 v1, v2, 1, v1
  v_lshl_add_u32 v3, v1, 5, v3
  v_and_b32 v1, 1, v0
  v_lshl_add_u32 v3, v1, 4, v3
  v_bfe_u32 v1, v0, 1, 1
  v_lshl_add_u32 v3, v1, 3, v3
  s_mul_i32 s3, s53, 8256
  v_xor_b32 v4, s3, v3
  v_xor_b32 v5, 64, v4
  s_lshl_b32 s3, s75, 12
  s_add_u32 s3, s3, 98304
  v_lshl_add_u32 v16, v0, 4, s3
  s_xor_b32 s3, s75, 2
  s_lshl_b32 s3, s3, 8
  s_add_u32 s3, s3, 157696
  v_mov_b32 v17, s3
  s_lshl_b32 s3, s72, 1
  s_lshl_b32 s55, 0x30003, s3
  s_mov_b32 s54, 0x0FFFFFFF
  ds_read_b32 v13, v10 offset:0
.Lc3_pre_y:
  s_waitcnt vmcnt(2)
.Lc3_fl1_y:
  v_cmp_ne_u32 vcc, s73, v31
  s_and_b32 s3, vcc_lo, s54
  s_cbranch_scc1 .Lc3_fl_y
.Lc3_go_y:
.Lc_p3go_y:
  buffer_load_dwordx4 v[128:131], v6, s[16:19], s49 offen sc1
  s_add_u32 s49, s49, 65536
  buffer_load_dwordx4 v[132:135], v6, s[16:19], s49 offen sc1
  s_add_u32 s49, s49, 65536
  buffer_load_dwordx4 v[136:139], v6, s[16:19], s49 offen sc1
  s_add_u32 s49, s49, 65536
  buffer_load_dwordx4 v[140:143], v6, s[16:19], s49 offen sc1
  s_add_u32 s49, s49, 65536
  buffer_load_dwordx4 v[144:147], v6, s[16:19], s49 offen sc1
  s_add_u32 s49, s49, 65536
  buffer_load_dwordx4 v[148:151], v6, s[16:19], s49 offen sc1
  s_add_u32 s49, s49, 65536
  buffer_load_dwordx4 v[152:155], v6, s[16:19], s49 offen sc1
  s_add_u32 s49, s49, 65536
  buffer_load_dwordx4 v[156:159], v6, s[16:19], s49 offen sc1
  s_add_u32 s49, s49, 65536
  buffer_load_dwordx4 v[160:163], v6, s[16:19], s49 offen sc1
  s_add_u32 s49, s49, 65536
  buffer_load_dwordx4 v[164:167], v6, s[16:19], s49 offen sc1
  s_add_u32 s49, s49, 65536
  buffer_load_dwordx4 v[168:171], v6, s[16:19], s49 offen sc1
  s_add_u32 s49, s49, 65536
  buffer_load_dwordx4 v[172:175], v6, s[16:19], s49 offen sc1
  s_add_u32 s49, s49, 65536
  buffer_load_dwordx4 v[176:179], v6, s[16:19], s49 offen sc1
  s_add_u32 s49, s49, 65536
  buffer_load_dwordx4 v[180:183], v6, s[16:19], s49 offen sc1
  s_add_u32 s49, s49, 65536
  s_waitcnt lgkmcnt(0)
  v_cmp_gt_u32 vcc, 244, v13
  s_cbranch_vccnz .Lsp_205
.Lrt_206:
  ds_read_b32 v13, v10 offset:1024
  v_add_u32 v5, 131072, v5
  ds_read_b64_tr_b16 v[32:33], v5 offset:0
  ds_read_b64_tr_b16 v[34:35], v5 offset:512
  v_add_u32 v4, 131072, v4
  ds_read_b64_tr_b16 v[36:37], v4 offset:0
  ds_read_b64_tr_b16 v[38:39], v4 offset:512
  ds_read_b64_tr_b16 v[40:41], v5 offset:2048
  ds_read_b64_tr_b16 v[42:43], v5 offset:2560
  ds_read_b64_tr_b16 v[44:45], v4 offset:2048
  ds_read_b64_tr_b16 v[46:47], v4 offset:2560
  ds_read_b64_tr_b16 v[48:49], v5 offset:4096
  ds_read_b64_tr_b16 v[50:51], v5 offset:4608
  ds_read_b64_tr_b16 v[52:53], v4 offset:4096
  ds_read_b64_tr_b16 v[54:55], v4 offset:4608
  ds_read_b64_tr_b16 v[56:57], v5 offset:6144
  ds_read_b64_tr_b16 v[58:59], v5 offset:6656
  s_waitcnt vmcnt(13) lgkmcnt(12)
  v_mfma_f32_32x32x16_bf16 v[80:95], v[32:35], v[128:131], 0
.Lc3_m0_y:
  ds_read_b64_tr_b16 v[60:61], v4 offset:6144
  ds_read_b64_tr_b16 v[62:63], v4 offset:6656
  s_waitcnt lgkmcnt(12)
  v_mfma_f32_32x32x16_bf16 v[64:79], v[36:39], v[128:131], 0
  v_add_u32 v5, 4294836224, v5
  ds_read_b64_tr_b16 v[32:33], v5 offset:0
  ds_read_b64_tr_b16 v[34:35], v5 offset:512
  s_waitcnt vmcnt(12) lgkmcnt(12)
  v_mfma_f32_32x32x16_bf16 v[80:95], v[40:43], v[132:135], v[80:95]
  v_add_u32 v4, 4294836224, v4
  ds_read_b64_tr_b16 v[36:37], v4 offset:0
  ds_read_b64_tr_b16 v[38:39], v4 offset:512
  s_waitcnt lgkmcnt(12)
  v_mfma_f32_32x32x16_bf16 v[64:79], v[44:47], v[132:135], v[64:79]
  ds_read_b64_tr_b16 v[40:41], v5 offset:2048
  ds_read_b64_tr_b16 v[42:43], v5 offset:2560
  s_waitcnt vmcnt(11) lgkmcnt(12)
  v_mfma_f32_32x32x16_bf16 v[80:95], v[48:51], v[136:139], v[80:95]
  ds_read_b64_tr_b16 v[44:45], v4 offset:2048
  ds_read_b64_tr_b16 v[46:47], v4 offset:2560
  s_waitcnt lgkmcnt(12)
  v_mfma_f32_32x32x16_bf16 v[64:79], v[52:55], v[136:139], v[64:79]
  ds_read_b64_tr_b16 v[48:49], v5 offset:4096
  ds_read_b64_tr_b16 v[50:51], v5 offset:4608
  s_waitcnt vmcnt(10) lgkmcnt(12)
  v_mfma_f32_32x32x16_bf16 v[80:95], v[56:59], v[140:143], v[80:95]
  ds_read_b64_tr_b16 v[52:53], v4 offset:4096
  ds_read_b64_tr_b16 v[54:55], v4 offset:4608
  s_waitcnt lgkmcnt(12)
  v_mfma_f32_32x32x16_bf16 v[64:79], v[60:63], v[140:143], v[64:79]
  ds_read_b64_tr_b16 v[56:57], v5 offset:6144
  ds_read_b64_tr_b16 v[58:59], v5 offset:6656
  s_waitcnt vmcnt(9) lgkmcnt(12)
  v_mfma_f32_32x32x16_bf16 v[80:95], v[32:35], v[144:147], v[80:95]
  ds_read_b64_tr_b16 v[60:61], v4 offset:6144
  ds_read_b64_tr_b16 v[62:63], v4 offset:6656
  s_waitcnt lgkmcnt(12)
  v_mfma_f32_32x32x16_bf16 v[64:79], v[36:39], v[144:147], v[64:79]
  ds_read_b64_tr_b16 v[32:33], v5 offset:16384
  ds_read_b64_tr_b16 v[34:35], v5 offset:16896
  s_waitcnt vmcnt(8) lgkmcnt(12)
  v_mfma_f32_32x32x16_bf16 v[80:95], v[40:43], v[148:151], v[80:95]
  ds_read_b64_tr_b16 v[36:37], v4 offset:16384
  ds_read_b64_tr_b16 v[38:39], v4 offset:16896
  buffer_load_dword v30, v25, s[16:19], s52 offen sc1
  buffer_load_dwordx4 v[184:187], v6, s[16:19], s49 offen sc1
  s_add_u32 s49, s49, 65536
  buffer_load_dwordx4 v[188:191], v6, s[16:19], s49 offen sc1
  s_add_u32 s49, s49, 65536
  buffer_load_dwordx4 v[192:195], v6, s[16:19], s49 offen sc1
  s_add_u32 s49, s49, 65536
  buffer_load_dwordx4 v[196:199], v6, s[16:19], s49 offen sc1
  s_add_u32 s49, s49, 65536
  buffer_load_dwordx4 v[200:203], v6, s[16:19], s49 offen sc1
  s_add_u32 s49, s49, 65536
  buffer_load_dwordx4 v[204:207], v6, s[16:19], s49 offen sc1
  s_add_u32 s49, s49, 65536
  buffer_load_dwordx4 v[208:211], v6, s[16:19], s49 offen sc1
  s_add_u32 s49, s49, 65536
  buffer_load_dwordx4 v[212:215], v6, s[16:19], s49 offen sc1
  s_add_u32 s49, s49, 65536
  s_waitcnt lgkmcnt(12)
  v_mfma_f32_32x32x16_bf16 v[64:79], v[44:47], v[148:151], v[64:79]
  ds_read_b64_tr_b16 v[40:41], v5 offset:18432
  ds_read_b64_tr_b16 v[42:43], v5 offset:18944
  s_waitcnt vmcnt(16) lgkmcnt(12)
  v_mfma_f32_32x32x16_bf16 v[80:95], v[48:51], v[152:155], v[80:95]
  ds_read_b64_tr_b16 v[44:45], v4 offset:18432
  ds_read_b64_tr_b16 v[46:47], v4 offset:18944
  s_waitcnt lgkmcnt(12)
  v_mfma_f32_32x32x16_bf16 v[64:79], v[52:55], v[152:155], v[64:79]
  ds_read_b64_tr_b16 v[48:49], v5 offset:20480
  ds_read_b64_tr_b16 v[50:51], v5 offset:20992
  s_waitcnt vmcnt(15) lgkmcnt(12)
  v_mfma_f32_32x32x16_bf16 v[80:95], v[56:59], v[156:159], v[80:95]
  ds_read_b64_tr_b16 v[52:53], v4 offset:20480
  ds_read_b64_tr_b16 v[54:55], v4 offset:20992
  s_waitcnt lgkmcnt(12)
  v_mfma_f32_32x32x16_bf16 v[64:79], v[60:63], v[156:159], v[64:79]
  ds_read_b64_tr_b16 v[56:57], v5 offset:22528
  ds_read_b64_tr_b16 v[58:59], v5 offset:23040
  s_waitcnt vmcnt(14) lgkmcnt(12)
  v_mfma_f32_32x32x16_bf16 v[80:95], v[32:35], v[160:163], v[80:95]
  ds_read_b64_tr_b16 v[60:61], v4 offset:22528
  ds_read_b64_tr_b16 v[62:63], v4 offset:23040
  s_waitcnt lgkmcnt(12)
  v_mfma_f32_32x32x16_bf16 v[64:79], v[36:39], v[160:163], v[64:79]
  ds_read_b64_tr_b16 v[32:33], v5 offset:32768
  ds_read_b64_tr_b16 v[34:35], v5 offset:33280
  s_waitcnt vmcnt(13) lgkmcnt(12)
  v_mfma_f32_32x32x16_bf16 v[80:95], v[40:43], v[164:167], v[80:95]
  ds_read_b64_tr_b16 v[36:37], v4 offset:32768
  ds_read_b64_tr_b16 v[38:39], v4 offset:33280
  s_waitcnt lgkmcnt(12)
  v_mfma_f32_32x32x16_bf16 v[64:79], v[44:47], v[164:167], v[64:79]
  ds_read_b64_tr_b16 v[40:41], v5 offset:34816
  ds_read_b64_tr_b16 v[42:43], v5 offset:35328
  s_waitcnt vmcnt(12) lgkmcnt(12)
  v_mfma_f32_32x32x16_bf16 v[80:95], v[48:51], v[168:171], v[80:95]
  ds_read_b64_tr_b16 v[44:45], v4 offset:34816
  ds_read_b64_tr_b16 v[46:47], v4 offset:35328
  s_waitcnt lgkmcnt(12)
  v_mfma_f32_32x32x16_bf16 v[64:79], v[52:55], v[168:171], v[64:79]
  ds_read_b64_tr_b16 v[48:49], v5 offset:36864
  ds_read_b64_tr_b16 v[50:51], v5 offset:37376
  s_waitcnt vmcnt(11) lgkmcnt(12)
  v_mfma_f32_32x32x16_bf16 v[80:95], v[56:59], v[172:175], v[80:95]
  ds_read_b64_tr_b16 v[52:53], v4 offset:36864
  ds_read_b64_tr_b16 v[54:55], v4 offset:37376
  s_waitcnt lgkmcnt(12)
  v_mfma_f32_32x32x16_bf16 v[64:79], v[60:63], v[172:175], v[64:79]
  ds_read_b64_tr_b16 v[56:57], v5 offset:38912
  ds_read_b64_tr_b16 v[58:59], v5 offset:39424
  s_waitcnt vmcnt(10) lgkmcnt(12)
  v_mfma_f32_32x32x16_bf16 v[80:95], v[32:35], v[176:179], v[80:95]
  ds_read_b64_tr_b16 v[60:61], v4 offset:38912
  ds_read_b64_tr_b16 v[62:63], v4 offset:39424
  s_waitcnt lgkmcnt(12)
  v_mfma_f32_32x32x16_bf16 v[64:79], v[36:39], v[176:179], v[64:79]
  ds_read_b64_tr_b16 v[32:33], v5 offset:49152
  ds_read_b64_tr_b16 v[34:35], v5 offset:49664
  s_waitcnt vmcnt(9) lgkmcnt(12)
  v_mfma_f32_32x32x16_bf16 v[80:95], v[40:43], v[180:183], v[80:95]
  ds_read_b64_tr_b16 v[36:37], v4 offset:49152
  ds_read_b64_tr_b16 v[38:39], v4 offset:49664
  s_waitcnt lgkmcnt(12)
  v_mfma_f32_32x32x16_bf16 v[64:79], v[44:47], v[180:183], v[64:79]
  ds_read_b64_tr_b16 v[40:41], v5 offset:51200
  ds_read_b64_tr_b16 v[42:43], v5 offset:51712
  s_waitcnt vmcnt(8)
  v_cmp_ne_u32 vcc, s73, v30
  s_and_b32 s3, vcc_hi, s55
  s_cbranch_scc1 .Lc3_f2_y
.Lc3_g2_y:
  s_add_u32 s3, s51, 65536
  buffer_load_dwordx4 v[104:107], v6, s[16:19], s51 offen sc1
  buffer_load_dwordx4 v[108:111], v6, s[16:19], s3 offen sc1
  s_add_u32 s51, s51, 2097152
  s_add_u32 s3, s3, 2097152
  buffer_load_dwordx4 v[112:115], v6, s[16:19], s51 offen sc1
  buffer_load_dwordx4 v[116:119], v6, s[16:19], s3 offen sc1
  buffer_load_dwordx4 v[216:219], v6, s[16:19], s49 offen sc1
  s_add_u32 s49, s49, 65536
  buffer_load_dwordx4 v[220:223], v6, s[16:19], s49 offen sc1
  s_add_u32 s49, s49, 65536
  buffer_load_dwordx4 v[224:227], v6, s[16:19], s49 offen sc1
  s_add_u32 s49, s49, 65536
  buffer_load_dwordx4 v[228:231], v6, s[16:19], s49 offen sc1
  s_add_u32 s49, s49, 65536
  buffer_load_dwordx4 v[232:235], v6, s[16:19], s49 offen sc1
  s_add_u32 s49, s49, 65536
  buffer_load_dwordx4 v[236:239], v6, s[16:19], s49 offen sc1
  s_waitcnt vmcnt(17) lgkmcnt(12)
  v_mfma_f32_32x32x16_bf16 v[80:95], v[48:51], v[184:187], v[80:95]
  ds_read_b64_tr_b16 v[44:45], v4 offset:51200
  ds_read_b64_tr_b16 v[46:47], v4 offset:51712
  s_waitcnt lgkmcnt(12)
  v_mfma_f32_32x32x16_bf16 v[64:79], v[52:55], v[184:187], v[64:79]
  ds_read_b64_tr_b16 v[48:49], v5 offset:53248
  ds_read_b64_tr_b16 v[50:51], v5 offset:53760
  s_waitcnt vmcnt(16) lgkmcnt(12)
  v_mfma_f32_32x32x16_bf16 v[80:95], v[56:59], v[188:191], v[80:95]
  ds_read_b64_tr_b16 v[52:53], v4 offset:53248
  ds_read_b64_tr_b16 v[54:55], v4 offset:53760
  s_waitcnt lgkmcnt(12)
  v_mfma_f32_32x32x16_bf16 v[64:79], v[60:63], v[188:191], v[64:79]
  ds_read_b64_tr_b16 v[56:57], v5 offset:55296
  ds_read_b64_tr_b16 v[58:59], v5 offset:55808
  s_waitcnt vmcnt(15) lgkmcnt(12)
  v_mfma_f32_32x32x16_bf16 v[80:95], v[32:35], v[192:195], v[80:95]
  ds_read_b64_tr_b16 v[60:61], v4 offset:55296
  ds_read_b64_tr_b16 v[62:63], v4 offset:55808
  s_waitcnt lgkmcnt(12)
  v_mfma_f32_32x32x16_bf16 v[64:79], v[36:39], v[192:195], v[64:79]
  v_add_u32 v5, 65536, v5
  ds_read_b64_tr_b16 v[32:33], v5 offset:0
  ds_read_b64_tr_b16 v[34:35], v5 offset:512
  s_waitcnt vmcnt(14) lgkmcnt(12)
  v_mfma_f32_32x32x16_bf16 v[80:95], v[40:43], v[196:199], v[80:95]
  v_add_u32 v4, 65536, v4
  ds_read_b64_tr_b16 v[36:37], v4 offset:0
  ds_read_b64_tr_b16 v[38:39], v4 offset:512
  s_waitcnt lgkmcnt(12)
  v_mfma_f32_32x32x16_bf16 v[64:79], v[44:47], v[196:199], v[64:79]
  ds_read_b64_tr_b16 v[40:41], v5 offset:2048
  ds_read_b64_tr_b16 v[42:43], v5 offset:2560
  s_waitcnt vmcnt(13) lgkmcnt(12)
  v_mfma_f32_32x32x16_bf16 v[80:95], v[48:51], v[200:203], v[80:95]
  ds_read_b64_tr_b16 v[44:45], v4 offset:2048
  ds_read_b64_tr_b16 v[46:47], v4 offset:2560
  s_waitcnt lgkmcnt(12)
  v_mfma_f32_32x32x16_bf16 v[64:79], v[52:55], v[200:203], v[64:79]
  ds_read_b64_tr_b16 v[48:49], v5 offset:4096
  ds_read_b64_tr_b16 v[50:51], v5 offset:4608
  s_waitcnt vmcnt(12) lgkmcnt(12)
  v_mfma_f32_32x32x16_bf16 v[80:95], v[56:59], v[204:207], v[80:95]
  ds_read_b64_tr_b16 v[52:53], v4 offset:4096
  ds_read_b64_tr_b16 v[54:55], v4 offset:4608
  s_waitcnt lgkmcnt(12)
  v_mfma_f32_32x32x16_bf16 v[64:79], v[60:63], v[204:207], v[64:79]
  ds_read_b64_tr_b16 v[56:57], v5 offset:6144
  ds_read_b64_tr_b16 v[58:59], v5 offset:6656
  s_waitcnt vmcnt(11) lgkmcnt(12)
  v_mfma_f32_32x32x16_bf16 v[80:95], v[32:35], v[208:211], v[80:95]
  ds_read_b64_tr_b16 v[60:61], v4 offset:6144
  ds_read_b64_tr_b16 v[62:63], v4 offset:6656
  s_waitcnt lgkmcnt(12)
  v_mfma_f32_32x32x16_bf16 v[64:79], v[36:39], v[208:211], v[64:79]
  ds_read_b64_tr_b16 v[32:33], v5 offset:16384
  ds_read_b64_tr_b16 v[34:35], v5 offset:16896
  s_waitcnt vmcnt(10) lgkmcnt(12)
  v_mfma_f32_32x32x16_bf16 v[80:95], v[40:43], v[212:215], v[80:95]
  ds_read_b64_tr_b16 v[36:37], v5 offset:18432
  ds_read_b64_tr_b16 v[38:39], v5 offset:18944
  s_waitcnt lgkmcnt(12)
  v_mfma_f32_32x32x16_bf16 v[64:79], v[44:47], v[212:215], v[64:79]
  ds_read_b64_tr_b16 v[40:41], v5 offset:20480
  ds_read_b64_tr_b16 v[42:43], v5 offset:20992
  s_waitcnt vmcnt(5) lgkmcnt(12)
  v_mfma_f32_32x32x16_bf16 v[80:95], v[48:51], v[216:219], v[80:95]
  ds_read_b64_tr_b16 v[44:45], v5 offset:22528
  ds_read_b64_tr_b16 v[46:47], v5 offset:23040
  s_waitcnt vmcnt(6)
  v_lshlrev_b32 v240, 16, v104
  v_and_b32 v241, 0xffff0000, v104
  v_lshlrev_b32 v8, 16, v112
  v_and_b32 v9, 0xffff0000, v112
  v_sub_f32 v240, v240, v8
  v_sub_f32 v241, v241, v9
  v_cvt_pk_bf16_f32 v241, v240, v241
  v_lshlrev_b32 v8, 16, v96
  s_waitcnt lgkmcnt(12)
  v_mfma_f32_32x32x16_bf16 v[64:79], v[52:55], v[216:219], v[64:79]
  ds_read_b64_tr_b16 v[48:49], v4 offset:16384
  ds_read_b64_tr_b16 v[50:51], v4 offset:16896
  v_and_b32 v9, 0xffff0000, v96
  v_lshlrev_b32 v240, 16, v241
  v_and_b32 v241, 0xffff0000, v241
  v_add_f32 v240, v240, v8
  v_add_f32 v241, v241, v9
  v_cvt_pk_bf16_f32 v241, v240, v241
  v_lshlrev_b32 v240, 16, v241
  v_and_b32 v241, 0xffff0000, v241
  s_waitcnt vmcnt(4) lgkmcnt(12)
  v_mfma_f32_32x32x16_bf16 v[80:95], v[56:59], v[220:223], v[80:95]
  ds_read_b64_tr_b16 v[52:53], v4 offset:18432
  ds_read_b64_tr_b16 v[54:55], v4 offset:18944
  v_lshlrev_b32 v242, 16, v105
  v_and_b32 v243, 0xffff0000, v105
  v_lshlrev_b32 v2, 16, v113
  v_and_b32 v3, 0xffff0000, v113
  v_sub_f32 v242, v242, v2
  v_sub_f32 v243, v243, v3
  v_cvt_pk_bf16_f32 v243, v242, v243
  v_lshlrev_b32 v2, 16, v97
  s_waitcnt lgkmcnt(12)
  v_mfma_f32_32x32x16_bf16 v[64:79], v[60:63], v[220:223], v[64:79]
  ds_read_b64_tr_b16 v[56:57], v4 offset:20480
  ds_read_b64_tr_b16 v[58:59], v4 offset:20992
  v_and_b32 v3, 0xffff0000, v97
  v_lshlrev_b32 v242, 16, v243
  v_and_b32 v243, 0xffff0000, v243
  v_add_f32 v242, v242, v2
  v_add_f32 v243, v243, v3
  v_cvt_pk_bf16_f32 v243, v242, v243
  v_lshlrev_b32 v242, 16, v243
  v_and_b32 v243, 0xffff0000, v243
  s_waitcnt vmcnt(3) lgkmcnt(12)
  v_mfma_f32_32x32x16_bf16 v[80:95], v[32:35], v[224:227], v[80:95]
  ds_read_b64_tr_b16 v[60:61], v4 offset:22528
  ds_read_b64_tr_b16 v[62:63], v4 offset:23040
  v_lshlrev_b32 v244, 16, v106
  v_and_b32 v245, 0xffff0000, v106
  v_lshlrev_b32 v8, 16, v114
  v_and_b32 v9, 0xffff0000, v114
  v_sub_f32 v244, v244, v8
  v_sub_f32 v245, v245, v9
  v_cvt_pk_bf16_f32 v245, v244, v245
  v_lshlrev_b32 v8, 16, v98
  s_waitcnt vmcnt(2) lgkmcnt(12)
  v_mfma_f32_32x32x16_bf16 v[80:95], v[36:39], v[228:231], v[80:95]
  v_and_b32 v9, 0xffff0000, v98
  v_lshlrev_b32 v244, 16, v245
  v_and_b32 v245, 0xffff0000, v245
  v_add_f32 v244, v244, v8
  v_add_f32 v245, v245, v9
  v_cvt_pk_bf16_f32 v245, v244, v245
  v_lshlrev_b32 v244, 16, v245
  v_and_b32 v245, 0xffff0000, v245
  s_waitcnt vmcnt(1) lgkmcnt(10)
  v_mfma_f32_32x32x16_bf16 v[80:95], v[40:43], v[232:235], v[80:95]
  v_lshlrev_b32 v246, 16, v107
  v_and_b32 v247, 0xffff0000, v107
  v_lshlrev_b32 v2, 16, v115
  v_and_b32 v3, 0xffff0000, v115
  v_sub_f32 v246, v246, v2
  v_sub_f32 v247, v247, v3
  v_cvt_pk_bf16_f32 v247, v246, v247
  v_lshlrev_b32 v2, 16, v99
  s_waitcnt vmcnt(0) lgkmcnt(8)
  v_mfma_f32_32x32x16_bf16 v[80:95], v[44:47], v[236:239], v[80:95]
  v_and_b32 v3, 0xffff0000, v99
  v_lshlrev_b32 v246, 16, v247
  v_and_b32 v247, 0xffff0000, v247
  v_add_f32 v246, v246, v2
  v_add_f32 v247, v247, v3
  v_cvt_pk_bf16_f32 v247, v246, v247
  v_lshlrev_b32 v246, 16, v247
  v_and_b32 v247, 0xffff0000, v247
  s_waitcnt lgkmcnt(6)
  v_mfma_f32_32x32x16_bf16 v[64:79], v[48:51], v[224:227], v[64:79]
  v_lshlrev_b32 v248, 16, v108
  v_and_b32 v249, 0xffff0000, v108
  v_lshlrev_b32 v8, 16, v116
  v_and_b32 v9, 0xffff0000, v116
  v_sub_f32 v248, v248, v8
  v_sub_f32 v249, v249, v9
  v_cvt_pk_bf16_f32 v249, v248, v249
  v_lshlrev_b32 v8, 16, v100
  s_waitcnt lgkmcnt(4)
  v_mfma_f32_32x32x16_bf16 v[64:79], v[52:55], v[228:231], v[64:79]
  v_and_b32 v9, 0xffff0000, v100
  v_lshlrev_b32 v248, 16, v249
  v_and_b32 v249, 0xffff0000, v249
  v_add_f32 v248, v248, v8
  v_add_f32 v249, v249, v9
  v_cvt_pk_bf16_f32 v249, v248, v249
  v_lshlrev_b32 v248, 16, v249
  v_and_b32 v249, 0xffff0000, v249
  s_waitcnt lgkmcnt(2)
  v_mfma_f32_32x32x16_bf16 v[64:79], v[56:59], v[232:235], v[64:79]
  v_lshlrev_b32 v250, 16, v109
  v_and_b32 v251, 0xffff0000, v109
  v_lshlrev_b32 v2, 16, v117
  v_and_b32 v3, 0xffff0000, v117
  v_sub_f32 v250, v250, v2
  v_sub_f32 v251, v251, v3
  v_cvt_pk_bf16_f32 v251, v250, v251
  v_lshlrev_b32 v2, 16, v101
  s_waitcnt lgkmcnt(0)
  v_mfma_f32_32x32x16_bf16 v[64:79], v[60:63], v[236:239], v[64:79]
  v_and_b32 v3, 0xffff0000, v101
  v_lshlrev_b32 v250, 16, v251
  v_and_b32 v251, 0xffff0000, v251
  v_add_f32 v250, v250, v2
  v_add_f32 v251, v251, v3
  v_cvt_pk_bf16_f32 v251, v250, v251
  v_lshlrev_b32 v250, 16, v251
  v_and_b32 v251, 0xffff0000, v251
  v_lshlrev_b32 v252, 16, v110
  v_and_b32 v253, 0xffff0000, v110
  v_lshlrev_b32 v8, 16, v118
  v_and_b32 v9, 0xffff0000, v118
  v_sub_f32 v252, v252, v8
  v_sub_f32 v253, v253, v9
  v_cvt_pk_bf16_f32 v253, v252, v253
  v_lshlrev_b32 v8, 16, v102
  v_and_b32 v9, 0xffff0000, v102
  v_lshlrev_b32 v252, 16, v253
  v_and_b32 v253, 0xffff0000, v253
  v_add_f32 v252, v252, v8
  v_add_f32 v253, v253, v9
  v_cvt_pk_bf16_f32 v253, v252, v253
  v_lshlrev_b32 v252, 16, v253
  v_and_b32 v253, 0xffff0000, v253
  v_lshlrev_b32 v254, 16, v111
  v_and_b32 v255, 0xffff0000, v111
  v_lshlrev_b32 v2, 16, v119
  v_and_b32 v3, 0xffff0000, v119
  v_sub_f32 v254, v254, v2
  v_sub_f32 v255, v255, v3
  v_cvt_pk_bf16_f32 v255, v254, v255
  v_lshlrev_b32 v2, 16, v103
  v_and_b32 v3, 0xffff0000, v103
  v_lshlrev_b32 v254, 16, v255
  v_and_b32 v255, 0xffff0000, v255
  v_add_f32 v254, v254, v2
  v_add_f32 v255, v255, v3
  v_cvt_pk_bf16_f32 v255, v254, v255
  v_lshlrev_b32 v254, 16, v255
  v_and_b32 v255, 0xffff0000, v255
  v_cmp_gt_u32 vcc, 48, v13
  s_cbranch_vccnz .Lsp_207
.Lrt_208:
  ds_write_b128 v16, v[80:83] offset:0
  ds_write_b128 v16, v[84:87] offset:1024
  ds_write_b128 v16, v[88:91] offset:2048
  ds_write_b128 v16, v[92:95] offset:3072
  v_mov_b32 v15, 4
  ds_write_b32 v11, v15 offset:9216
  v_xor_b32 v16, 8192, v16
.Lc_p3mm_y:
  ds_read_b32 v13, v17
  s_waitcnt lgkmcnt(0)
  v_cmp_gt_u32 vcc, 4, v13
  s_cbranch_vccnz .Lsp_209
.Lrt_210:
  ds_read_b128 v[80:83], v16 offset:0
  ds_read_b128 v[84:87], v16 offset:1024
  ds_read_b128 v[88:91], v16 offset:2048
  ds_read_b128 v[92:95], v16 offset:3072
  s_waitcnt lgkmcnt(3)
  v_pk_add_f32 v[64:65], v[64:65], v[80:81]
  v_cvt_pk_bf16_f32 v65, v64, v65
  v_lshlrev_b32 v64, 16, v65
  v_and_b32 v65, 0xffff0000, v65
  v_pk_add_f32 v[64:65], v[64:65], v[240:241]
  v_cvt_pk_bf16_f32 v96, v64, v65
  v_pk_add_f32 v[66:67], v[66:67], v[82:83]
  v_cvt_pk_bf16_f32 v67, v66, v67
  v_lshlrev_b32 v66, 16, v67
  v_and_b32 v67, 0xffff0000, v67
  v_pk_add_f32 v[66:67], v[66:67], v[242:243]
  v_cvt_pk_bf16_f32 v97, v66, v67
  s_waitcnt lgkmcnt(2)
  v_pk_add_f32 v[68:69], v[68:69], v[84:85]
  v_cvt_pk_bf16_f32 v69, v68, v69
  v_lshlrev_b32 v68, 16, v69
  v_and_b32 v69, 0xffff0000, v69
  v_pk_add_f32 v[68:69], v[68:69], v[244:245]
  v_cvt_pk_bf16_f32 v98, v68, v69
  v_pk_add_f32 v[70:71], v[70:71], v[86:87]
  v_cvt_pk_bf16_f32 v71, v70, v71
  v_lshlrev_b32 v70, 16, v71
  v_and_b32 v71, 0xffff0000, v71
  v_pk_add_f32 v[70:71], v[70:71], v[246:247]
  v_cvt_pk_bf16_f32 v99, v70, v71
  buffer_store_dwordx4 v[96:99], v7, s[32:35], s50 offen offset:0
  s_waitcnt lgkmcnt(1)
  v_pk_add_f32 v[72:73], v[72:73], v[88:89]
  v_cvt_pk_bf16_f32 v73, v72, v73
  v_lshlrev_b32 v72, 16, v73
  v_and_b32 v73, 0xffff0000, v73
  v_pk_add_f32 v[72:73], v[72:73], v[248:249]
  v_cvt_pk_bf16_f32 v100, v72, v73
  v_pk_add_f32 v[74:75], v[74:75], v[90:91]
  v_cvt_pk_bf16_f32 v75, v74, v75
  v_lshlrev_b32 v74, 16, v75
  v_and_b32 v75, 0xffff0000, v75
  v_pk_add_f32 v[74:75], v[74:75], v[250:251]
  v_cvt_pk_bf16_f32 v101, v74, v75
  s_waitcnt lgkmcnt(0)
  v_pk_add_f32 v[76:77], v[76:77], v[92:93]
  v_cvt_pk_bf16_f32 v77, v76, v77
  v_lshlrev_b32 v76, 16, v77
  v_and_b32 v77, 0xffff0000, v77
  v_pk_add_f32 v[76:77], v[76:77], v[252:253]
  v_cvt_pk_bf16_f32 v102, v76, v77
  v_pk_add_f32 v[78:79], v[78:79], v[94:95]
  v_cvt_pk_bf16_f32 v79, v78, v79
  v_lshlrev_b32 v78, 16, v79
  v_and_b32 v79, 0xffff0000, v79
  v_pk_add_f32 v[78:79], v[78:79], v[254:255]
  v_cvt_pk_bf16_f32 v103, v78, v79
  buffer_store_dwordx4 v[100:103], v7, s[32:35], s50 offen offset:32
.Lc_p3end_y:
.Lexit:
  s_endpgm
.Lh_tail_y:
  v_lshrrev_b32 v126, 3, v0
  v_and_b32 v127, 7, v0
  v_lshlrev_b32 v127, 7, v127
  v_lshl_add_u32 v126, v126, 12, v127
  s_lshr_b32 s3, s2, 6
  s_mul_i32 s3, s3, 7
  s_add_u32 s3, s3, s72
  s_lshl2_add_u32 s3, s3, s75
  s_and_b32 s64, s2, 1
  s_lshl_b32 s64, s64, 7
  s_add_u32 s3, s3, s64
  s_lshl_b32 s3, s3, 15
  buffer_load_dword v127, v126, s[24:27], s3 offen offset:3072
  ds_read_b32 v12, v10 offset:10240
  s_waitcnt lgkmcnt(0)
  v_cmp_gt_u32 vcc, 2, v12
  s_cbranch_vccnz .Lsp_35
.Lrt_36:
.Lh_dump_y:
  s_setprio 2
  ds_read2_b32 v[16:17], v63 offset0:128 offset1:132
  ds_read2_b32 v[14:15], v63 offset0:0 offset1:4
  ds_read2_b32 v[18:19], v100 offset0:0 offset1:4
  ds_read_b128 v[32:35], v62
  ds_read_b128 v[80:83], v57 offset:0
  ds_read_b128 v[84:87], v57 offset:1024
  ds_read_b128 v[36:39], v101
  ds_read_b128 v[88:91], v57 offset:2048
  ds_read_b128 v[92:95], v57 offset:3072
  s_waitcnt lgkmcnt(6)
  v_mul_f32 v1, v16, v16
  v_mul_f32 v20, 3222493025, v16
  v_mul_f32 v1, v1, v16
  v_mul_f32 v22, 3184710632, v1
  v_mul_f32 v1, v17, v17
  v_mul_f32 v21, 3222493025, v17
  v_mul_f32 v1, v1, v17
  v_mul_f32 v23, 3184710632, v1
  s_waitcnt vmcnt(25)
  v_readfirstlane_b32 s73, v52
  s_cmp_lg_u32 s73, 0
  s_cbranch_scc0 .Lno_37
.Lnk_38:
  v_mov_b32 v55, s73
  v_add_u32 v52, 10240, v11
  s_waitcnt lgkmcnt(4)
  v_fma_f32 v80, v14, v32, v80
  v_fma_f32 v81, v14, v33, v81
  v_fma_f32 v82, v14, v34, v82
  v_fma_f32 v83, v14, v35, v83
  v_mul_f32 v100, v80, v80
  v_mul_f32 v101, v81, v81
  v_mul_f32 v102, v82, v82
  v_mul_f32 v103, v83, v83
  v_fma_f32 v100, v22, v100, v20
  v_fma_f32 v101, v22, v101, v20
  v_fma_f32 v102, v22, v102, v20
  v_fma_f32 v103, v22, v103, v20
  v_mul_f32 v100, v80, v100
  v_mul_f32 v101, v81, v101
  v_mul_f32 v102, v82, v102
  v_mul_f32 v103, v83, v103
  v_exp_f32 v100, v100
  v_exp_f32 v101, v101
  v_exp_f32 v102, v102
  v_exp_f32 v103, v103
  v_fma_f32 v100, v100, v18, v18
  v_fma_f32 v101, v101, v18, v18
  v_fma_f32 v102, v102, v18, v18
  v_fma_f32 v103, v103, v18, v18
  v_rcp_f32 v100, v100
  v_rcp_f32 v101, v101
  v_rcp_f32 v102, v102
  v_rcp_f32 v103, v103
  v_mul_f32 v80, v80, v100
  v_mul_f32 v81, v81, v101
  v_mul_f32 v82, v82, v102
  v_mul_f32 v83, v83, v103
  v_add_f32 v54, v54, v80
  v_fma_f32 v56, v80, v80, v56
  v_add_f32 v54, v54, v81
  v_fma_f32 v56, v81, v81, v56
  v_add_f32 v54, v54, v82
  v_fma_f32 v56, v82, v82, v56
  v_add_f32 v54, v54, v83
  v_fma_f32 v56, v83, v83, v56
  s_waitcnt lgkmcnt(3)
  v_fma_f32 v84, v15, v32, v84
  v_fma_f32 v85, v15, v33, v85
  v_fma_f32 v86, v15, v34, v86
  v_fma_f32 v87, v15, v35, v87
  v_mul_f32 v104, v84, v84
  v_mul_f32 v105, v85, v85
  v_mul_f32 v106, v86, v86
  v_mul_f32 v107, v87, v87
  v_fma_f32 v104, v23, v104, v21
  v_fma_f32 v105, v23, v105, v21
  v_fma_f32 v106, v23, v106, v21
  v_fma_f32 v107, v23, v107, v21
  v_mul_f32 v104, v84, v104
  v_mul_f32 v105, v85, v105
  v_mul_f32 v106, v86, v106
  v_mul_f32 v107, v87, v107
  v_exp_f32 v104, v104
  v_exp_f32 v105, v105
  v_exp_f32 v106, v106
  v_exp_f32 v107, v107
  v_fma_f32 v104, v104, v19, v19
  v_fma_f32 v105, v105, v19, v19
  v_fma_f32 v106, v106, v19, v19
  v_fma_f32 v107, v107, v19, v19
  v_rcp_f32 v104, v104
  v_rcp_f32 v105, v105
  v_rcp_f32 v106, v106
  v_rcp_f32 v107, v107
  v_mul_f32 v84, v84, v104
  v_mul_f32 v85, v85, v105
  v_mul_f32 v86, v86, v106
  v_mul_f32 v87, v87, v107
  v_add_f32 v50, v50, v84
  v_fma_f32 v51, v84, v84, v51
  v_add_f32 v50, v50, v85
  v_fma_f32 v51, v85, v85, v51
  v_add_f32 v50, v50, v86
  v_fma_f32 v51, v86, v86, v51
  v_add_f32 v50, v50, v87
  v_fma_f32 v51, v87, v87, v51
  s_getreg_b32 s3, hwreg(HW_REG_IB_STS)
  s_bfe_u32 s79, s3, 131094
  s_and_b32 s3, s3, 15
  s_lshl4_add_u32 s3, s79, s3
  s_sub_u32 s3, 78, s3
  v_mov_b32 v13, s3
  ds_write_b32 v11, v13
  s_waitcnt lgkmcnt(2)
  v_fma_f32 v88, v14, v36, v88
  v_fma_f32 v89, v14, v37, v89
  v_fma_f32 v90, v14, v38, v90
  v_fma_f32 v91, v14, v39, v91
  v_mul_f32 v100, v88, v88
  v_mul_f32 v101, v89, v89
  v_mul_f32 v102, v90, v90
  v_mul_f32 v103, v91, v91
  v_fma_f32 v100, v22, v100, v20
  v_fma_f32 v101, v22, v101, v20
  v_fma_f32 v102, v22, v102, v20
  v_fma_f32 v103, v22, v103, v20
  v_mul_f32 v100, v88, v100
  v_mul_f32 v101, v89, v101
  v_mul_f32 v102, v90, v102
  v_mul_f32 v103, v91, v103
  v_exp_f32 v100, v100
  v_exp_f32 v101, v101
  v_exp_f32 v102, v102
  v_exp_f32 v103, v103
  v_fma_f32 v100, v100, v18, v18
  v_fma_f32 v101, v101, v18, v18
  v_fma_f32 v102, v102, v18, v18
  v_fma_f32 v103, v103, v18, v18
  v_rcp_f32 v100, v100
  v_rcp_f32 v101, v101
  v_rcp_f32 v102, v102
  v_rcp_f32 v103, v103
  v_mul_f32 v88, v88, v100
  v_mul_f32 v89, v89, v101
  v_mul_f32 v90, v90, v102
  v_mul_f32 v91, v91, v103
  v_add_f32 v54, v54, v88
  v_fma_f32 v56, v88, v88, v56
  v_add_f32 v54, v54, v89
  v_fma_f32 v56, v89, v89, v56
  v_add_f32 v54, v54, v90
  v_fma_f32 v56, v90, v90, v56
  v_add_f32 v54, v54, v91
  v_fma_f32 v56, v91, v91, v56
  s_waitcnt lgkmcnt(1)
  v_fma_f32 v92, v15, v36, v92
  v_fma_f32 v93, v15, v37, v93
  v_fma_f32 v94, v15, v38, v94
  v_fma_f32 v95, v15, v39, v95
  v_mul_f32 v104, v92, v92
  v_mul_f32 v105, v93, v93
  v_mul_f32 v106, v94, v94
  v_mul_f32 v107, v95, v95
  v_fma_f32 v104, v23, v104, v21
  v_fma_f32 v105, v23, v105, v21
  v_fma_f32 v106, v23, v106, v21
  v_fma_f32 v107, v23, v107, v21
  v_mul_f32 v104, v92, v104
  v_mul_f32 v105, v93, v105
  v_mul_f32 v106, v94, v106
  v_mul_f32 v107, v95, v107
  v_exp_f32 v104, v104
  v_exp_f32 v105, v105
  v_exp_f32 v106, v106
  v_exp_f32 v107, v107
  v_fma_f32 v104, v104, v19, v19
  v_fma_f32 v105, v105, v19, v19
  v_fma_f32 v106, v106, v19, v19
  v_fma_f32 v107, v107, v19, v19
  v_rcp_f32 v104, v104
  v_rcp_f32 v105, v105
  v_rcp_f32 v106, v106
  v_rcp_f32 v107, v107
  v_mul_f32 v92, v92, v104
  v_mul_f32 v93, v93, v105
  v_mul_f32 v94, v94, v106
  v_mul_f32 v95, v95, v107
  v_add_f32 v50, v50, v92
  v_fma_f32 v51, v92, v92, v51
  v_add_f32 v50, v50, v93
  v_fma_f32 v51, v93, v93, v51
  v_add_f32 v50, v50, v94
  v_fma_f32 v51, v94, v94, v51
  v_add_f32 v50, v50, v95
  v_fma_f32 v51, v95, v95, v51
  ds_read_b32 v12, v52 offset:0
  s_waitcnt lgkmcnt(0)
  v_cmp_gt_u32 vcc, 3, v12
  s_cbranch_vccnz .Lsp_39
.Lrt_40:
  ds_read_b128 v[40:43], v57 offset:6144
  ds_read_b128 v[108:111], v57 offset:4096
  ds_read_b128 v[112:115], v57 offset:5120
  s_waitcnt lgkmcnt(2)
  v_add_f32 v54, v54, v40
  v_add_f32 v50, v50, v42
  v_add_f32 v56, v56, v41
  v_add_f32 v51, v51, v43
  v_permlane32_swap_b32 v54, v50
  s_nop 0
  v_permlane32_swap_b32 v56, v51
  v_add_f32 v54, v54, v50
  v_add_f32 v56, v56, v51
  s_nop 1
  v_permlane16_swap_b32 v54, v56
  v_add_f32 v54, v54, v56
  buffer_store_dwordx2 v[54:55], v58, s[16:19], s60 offen sc1
.Lh_gran_y:
  s_getreg_b32 s3, hwreg(HW_REG_IB_STS)
  s_bfe_u32 s79, s3, 131094
  s_and_b32 s3, s3, 15
  s_lshl4_add_u32 s3, s79, s3
  s_sub_u32 s3, 79, s3
  v_mov_b32 v13, s3
  ds_write_b32 v11, v13
  ds_read_b32 v12, v10 offset:1024
  s_waitcnt lgkmcnt(2)
  v_lshlrev_b32 v64, 16, v108
  v_and_b32 v65, 0xffff0000, v108
  v_lshlrev_b32 v66, 16, v109
  v_and_b32 v67, 0xffff0000, v109
  v_lshlrev_b32 v68, 16, v110
  v_and_b32 v69, 0xffff0000, v110
  v_lshlrev_b32 v70, 16, v111
  v_and_b32 v71, 0xffff0000, v111
  v_lshlrev_b32 v72, 16, v112
  v_and_b32 v73, 0xffff0000, v112
  v_lshlrev_b32 v74, 16, v113
  v_and_b32 v75, 0xffff0000, v113
  v_lshlrev_b32 v76, 16, v114
  v_and_b32 v77, 0xffff0000, v114
  v_lshlrev_b32 v78, 16, v115
  v_and_b32 v79, 0xffff0000, v115
  v_cvt_pk_bf16_f32 v81, v80, v81
  v_lshlrev_b32 v80, 16, v81
  v_and_b32 v81, 0xffff0000, v81
  v_cvt_pk_bf16_f32 v83, v82, v83
  v_lshlrev_b32 v82, 16, v83
  v_and_b32 v83, 0xffff0000, v83
  v_cvt_pk_bf16_f32 v85, v84, v85
  v_lshlrev_b32 v84, 16, v85
  v_and_b32 v85, 0xffff0000, v85
  v_cvt_pk_bf16_f32 v87, v86, v87
  v_lshlrev_b32 v86, 16, v87
  v_and_b32 v87, 0xffff0000, v87
  v_cvt_pk_bf16_f32 v89, v88, v89
  v_lshlrev_b32 v88, 16, v89
  v_and_b32 v89, 0xffff0000, v89
  v_cvt_pk_bf16_f32 v91, v90, v91
  v_lshlrev_b32 v90, 16, v91
  v_and_b32 v91, 0xffff0000, v91
  v_cvt_pk_bf16_f32 v93, v92, v93
  v_lshlrev_b32 v92, 16, v93
  v_and_b32 v93, 0xffff0000, v93
  v_cvt_pk_bf16_f32 v95, v94, v95
  v_lshlrev_b32 v94, 16, v95
  v_and_b32 v95, 0xffff0000, v95
  v_lshlrev_b32 v58, 4, v0
  s_waitcnt lgkmcnt(0)
  v_cmp_gt_u32 vcc, 9, v12
  s_cbranch_vccnz .Lsp_41
.Lrt_42:
  s_add_u32 s47, s76, 6
  s_and_b32 s47, s47, 7
  s_mul_i32 s3, s47, 229376
  s_add_u32 m0, s48, 131072
  s_add_u32 s3, s3, s44
  buffer_load_dwordx4 v8, s[8:11], s3 offen lds
  buffer_load_dwordx4 v9, s[8:11], s3 offen offset:1024 lds
  s_add_u32 s47, s76, 7
  s_and_b32 s47, s47, 7
  s_mul_i32 s3, s47, 229376
  s_add_u32 m0, s48, 139264
  s_add_u32 s3, s3, s44
  buffer_load_dwordx4 v8, s[8:11], s3 offen lds
  buffer_load_dwordx4 v9, s[8:11], s3 offen offset:1024 lds
  v_mov_b32 v13, 83
.Lh_poll_y:
  buffer_load_dwordx4 v[128:131], v58, s[16:19], s58 offen offset:0 sc1
  buffer_load_dwordx4 v[132:135], v58, s[16:19], s58 offen offset:1024 sc1
  buffer_load_dwordx4 v[136:139], v58, s[16:19], s58 offen offset:2048 sc1
  buffer_load_dwordx4 v[140:143], v58, s[16:19], s58 offen offset:3072 sc1
  buffer_load_dwordx4 v[144:147], v58, s[16:19], s59 offen offset:0 sc1
  buffer_load_dwordx4 v[148:151], v58, s[16:19], s59 offen offset:1024 sc1
  buffer_load_dwordx4 v[152:155], v58, s[16:19], s59 offen offset:2048 sc1
  s_waitcnt vmcnt(7)
  ds_write_b32 v11, v13
  s_waitcnt vmcnt(6)
  v_min_u32 v1, v129, v131
  v_max_u32 v2, v129, v131
  s_waitcnt vmcnt(5)
  v_min3_u32 v1, v1, v133, v135
  v_max3_u32 v2, v2, v133, v135
  v_add_f32 v128, v128, v132
  v_add_f32 v130, v130, v134
  s_waitcnt vmcnt(4)
  v_min3_u32 v1, v1, v137, v139
  v_max3_u32 v2, v2, v137, v139
  v_add_f32 v128, v128, v136
  v_add_f32 v130, v130, v138
  s_waitcnt vmcnt(3)
  v_min3_u32 v1, v1, v141, v143
  v_max3_u32 v2, v2, v141, v143
  v_add_f32 v128, v128, v140
  v_add_f32 v130, v130, v142
  s_waitcnt vmcnt(2)
  v_min3_u32 v1, v1, v145, v147
  v_max3_u32 v2, v2, v145, v147
  v_add_f32 v128, v128, v144
  v_add_f32 v130, v130, v146
  s_waitcnt vmcnt(1)
  v_min3_u32 v1, v1, v149, v151
  v_max3_u32 v2, v2, v149, v151
  v_add_f32 v128, v128, v148
  v_add_f32 v130, v130, v150
  s_waitcnt vmcnt(0)
  v_min3_u32 v1, v1, v153, v155
  v_max3_u32 v2, v2, v153, v155
  v_add_f32 v128, v128, v152
  v_add_f32 v130, v130, v154
  v_cmp_ne_u32 vcc, s73, v1
  v_cmp_ne_u32 s[64:65], s73, v2
  s_or_b64 vcc, vcc, s[64:65]
  s_cbranch_scc0 .Lh_poll_ok_y
  s_cmp_eq_u32 s74, 0
  s_cbranch_scc1 .Lh_poll_ok_y
  s_sub_u32 s74, s74, 16
  s_max_i32 s74, s74, 0
  s_sleep 0
  s_branch .Lh_poll_y
.Lh_poll_ok_y:
  s_waitcnt lgkmcnt(0)
  v_mov_b32 v1, v128
  v_mov_b32 v2, v130
  s_nop 0
  v_permlane32_swap_b32 v128, v1
  v_permlane32_swap_b32 v130, v2
  v_add_f32 v128, v128, v1
  v_add_f32 v130, v130, v2
  v_mul_f32 v128, 982665509, v128
  v_mul_f32 v130, 982665509, v130
  v_fma_f32 v130, -v128, v128, v130
  v_cvt_pk_bf16_f32 v128, v128, v130
  v_and_b32 v130, 0xffff0000, v128
  v_add_f32 v130, 925353388, v130
  v_cvt_pk_bf16_f32 v130, v130, v130
  v_lshlrev_b32 v130, 16, v130
  v_sqrt_f32 v130, v130
  v_lshlrev_b32 v128, 16, v128
  v_cvt_pk_bf16_f32 v130, v130, v130
  v_lshlrev_b32 v130, 16, v130
  v_rcp_f32 v130, v130
  s_nop 0
  v_mul_f32 v128, -v128, v130
  v_mov_b32 v131, v130
  v_mov_b32 v129, v128
  s_nop 0
  v_permlane16_swap_b32 v130, v131
  v_permlane16_swap_b32 v128, v129
  v_fma_f32 v64, v64, v130, v128
  v_fma_f32 v65, v65, v130, v128
  v_fma_f32 v66, v66, v130, v128
  v_fma_f32 v67, v67, v130, v128
  v_cvt_pk_bf16_f32 v108, v64, v65
  v_cvt_pk_bf16_f32 v109, v66, v67
  ds_write_b64 v59, v[108:109]
  v_fma_f32 v68, v68, v131, v129
  v_fma_f32 v69, v69, v131, v129
  v_fma_f32 v70, v70, v131, v129
  v_fma_f32 v71, v71, v131, v129
  v_cvt_pk_bf16_f32 v110, v68, v69
  v_cvt_pk_bf16_f32 v111, v70, v71
  v_xor_b32 v101, 32, v59
  ds_write_b64 v101, v[110:111] offset:512
  v_fma_f32 v72, v72, v130, v128
  v_fma_f32 v73, v73, v130, v128
  v_fma_f32 v74, v74, v130, v128
  v_fma_f32 v75, v75, v130, v128
  v_cvt_pk_bf16_f32 v112, v72, v73
  v_cvt_pk_bf16_f32 v113, v74, v75
  v_xor_b32 v102, 32, v59
  ds_write_b64 v102, v[112:113]
  v_fma_f32 v76, v76, v131, v129
  v_fma_f32 v77, v77, v131, v129
  v_fma_f32 v78, v78, v131, v129
  v_fma_f32 v79, v79, v131, v129
  v_cvt_pk_bf16_f32 v114, v76, v77
  v_cvt_pk_bf16_f32 v115, v78, v79
  ds_write_b64 v59, v[114:115] offset:512
  v_fma_f32 v80, v80, v130, v128
  v_fma_f32 v81, v81, v130, v128
  v_fma_f32 v82, v82, v130, v128
  v_fma_f32 v83, v83, v130, v128
  v_cvt_pk_bf16_f32 v116, v80, v81
  v_cvt_pk_bf16_f32 v117, v82, v83
  v_xor_b32 v100, 64, v59
  ds_write_b64 v100, v[116:117]
  v_fma_f32 v84, v84, v131, v129
  v_fma_f32 v85, v85, v131, v129
  v_fma_f32 v86, v86, v131, v129
  v_fma_f32 v87, v87, v131, v129
  v_cvt_pk_bf16_f32 v118, v84, v85
  v_cvt_pk_bf16_f32 v119, v86, v87
  v_xor_b32 v101, 96, v59
  ds_write_b64 v101, v[118:119] offset:512
  v_fma_f32 v88, v88, v130, v128
  v_fma_f32 v89, v89, v130, v128
  v_fma_f32 v90, v90, v130, v128
  v_fma_f32 v91, v91, v130, v128
  v_cvt_pk_bf16_f32 v120, v88, v89
  v_cvt_pk_bf16_f32 v121, v90, v91
  v_xor_b32 v102, 96, v59
  ds_write_b64 v102, v[120:121]
  v_fma_f32 v92, v92, v131, v129
  v_fma_f32 v93, v93, v131, v129
  v_fma_f32 v94, v94, v131, v129
  v_fma_f32 v95, v95, v131, v129
  v_cvt_pk_bf16_f32 v122, v92, v93
  v_cvt_pk_bf16_f32 v123, v94, v95
  v_xor_b32 v103, 64, v59
  ds_write_b64 v103, v[122:123] offset:512
  v_xor_b32 v104, 0, v60
  v_xor_b32 v105, 32, v60
  ds_read_b64_tr_b16 v[64:65], v104
  ds_read_b64_tr_b16 v[66:67], v105 offset:512
  v_xor_b32 v106, 32, v60
  v_xor_b32 v107, 0, v60
  ds_read_b64_tr_b16 v[72:73], v106
  ds_read_b64_tr_b16 v[74:75], v107 offset:512
  v_xor_b32 v104, 64, v60
  v_xor_b32 v105, 96, v60
  ds_read_b64_tr_b16 v[80:81], v104
  ds_read_b64_tr_b16 v[82:83], v105 offset:512
  v_xor_b32 v106, 96, v60
  v_xor_b32 v107, 64, v60
  ds_read_b64_tr_b16 v[88:89], v106
  ds_read_b64_tr_b16 v[90:91], v107 offset:512
  s_waitcnt lgkmcnt(6)
  buffer_store_dwordx4 v[64:67], v61, s[16:19], s61 offen offset:0 sc1
  s_waitcnt lgkmcnt(4)
  buffer_store_dwordx4 v[72:75], v61, s[16:19], s61 offen offset:128 sc1
  s_waitcnt lgkmcnt(2)
  buffer_store_dwordx4 v[80:83], v61, s[16:19], s61 offen offset:512 sc1
  s_waitcnt lgkmcnt(0)
  buffer_store_dwordx4 v[88:91], v61, s[16:19], s61 offen offset:640 sc1
.Lh_zst_y:
  v_mov_b32 v13, 4
  ds_write_b32 v11, v13 offset:2048
  s_waitcnt vmcnt(0)
  s_mov_b64 exec, 1
  buffer_store_dword v55, off, s[16:19], s62 sc1
  s_mov_b64 exec, -1
  s_setprio 0
.Lh_p1end_y:
  s_waitcnt lgkmcnt(0)
.Lh_tjoin_y:
  ds_read_b32 v12, v10 offset:1024
  s_waitcnt lgkmcnt(0)
  v_cmp_gt_u32 vcc, 10, v12
  s_cbranch_vccnz .Lsp_109
.Lrt_110:
  s_add_u32 m0, s49, 0
  s_add_u32 s3, s50, s51
  buffer_load_dwordx4 v200, s[24:27], s3 offen lds
  buffer_load_dwordx4 v201, s[24:27], s3 offen offset:1024 lds
  buffer_load_dwordx4 v202, s[24:27], s3 offen offset:2048 lds
  buffer_load_dwordx4 v203, s[24:27], s3 offen offset:3072 lds
  s_add_u32 s51, s51, 128
  s_and_b32 s51, s51, 4095
  ds_read_b32 v12, v10 offset:1024
  s_waitcnt lgkmcnt(0)
  v_cmp_gt_u32 vcc, 11, v12
  s_cbranch_vccnz .Lsp_111
.Lrt_112:
  s_add_u32 m0, s49, 16384
  s_add_u32 s3, s50, s51
  buffer_load_dwordx4 v200, s[24:27], s3 offen lds
  buffer_load_dwordx4 v201, s[24:27], s3 offen offset:1024 lds
  buffer_load_dwordx4 v202, s[24:27], s3 offen offset:2048 lds
  buffer_load_dwordx4 v203, s[24:27], s3 offen offset:3072 lds
  s_add_u32 s51, s51, 128
  s_and_b32 s51, s51, 4095
  s_getreg_b32 s3, hwreg(HW_REG_IB_STS)
  s_bfe_u32 s79, s3, 131094
  s_and_b32 s3, s3, 15
  s_lshl4_add_u32 s3, s79, s3
  s_sub_u32 s3, 96, s3
  v_mov_b32 v13, s3
  ds_write_b32 v11, v13
  ds_read_b32 v12, v10 offset:1024
  s_waitcnt lgkmcnt(0)
  v_cmp_gt_u32 vcc, 12, v12
  s_cbranch_vccnz .Lsp_113
.Lrt_114:
  s_add_u32 m0, s49, 32768
  s_add_u32 s3, s50, s51
  buffer_load_dwordx4 v200, s[24:27], s3 offen lds
  buffer_load_dwordx4 v201, s[24:27], s3 offen offset:1024 lds
  buffer_load_dwordx4 v202, s[24:27], s3 offen offset:2048 lds
  buffer_load_dwordx4 v203, s[24:27], s3 offen offset:3072 lds
  s_add_u32 s51, s51, 128
  s_and_b32 s51, s51, 4095
  s_getreg_b32 s3, hwreg(HW_REG_IB_STS)
  s_bfe_u32 s79, s3, 131094
  s_and_b32 s3, s3, 15
  s_lshl4_add_u32 s3, s79, s3
  s_sub_u32 s3, 100, s3
  v_mov_b32 v13, s3
  ds_write_b32 v11, v13
  ds_read_b32 v12, v10 offset:1024
  s_waitcnt lgkmcnt(0)
  v_cmp_gt_u32 vcc, 13, v12
  s_cbranch_vccnz .Lsp_115
.Lrt_116:
  s_add_u32 m0, s49, 49152
  s_add_u32 s3, s50, s51
  buffer_load_dwordx4 v200, s[24:27], s3 offen lds
  buffer_load_dwordx4 v201, s[24:27], s3 offen offset:1024 lds
  buffer_load_dwordx4 v202, s[24:27], s3 offen offset:2048 lds
  buffer_load_dwordx4 v203, s[24:27], s3 offen offset:3072 lds
  s_add_u32 s51, s51, 128
  s_and_b32 s51, s51, 4095
  s_getreg_b32 s3, hwreg(HW_REG_IB_STS)
  s_bfe_u32 s79, s3, 131094
  s_and_b32 s3, s3, 15
  s_lshl4_add_u32 s3, s79, s3
  s_sub_u32 s3, 104, s3
  v_mov_b32 v13, s3
  ds_write_b32 v11, v13
.Lh_pre4_y:
  ds_read_b32 v12, v10 offset:1024
  s_waitcnt lgkmcnt(0)
  v_cmp_gt_u32 vcc, 14, v12
  s_cbranch_vccnz .Lsp_117
.Lrt_118:
  s_add_u32 m0, s49, 65536
  s_add_u32 s3, s50, s51
  buffer_load_dwordx4 v200, s[24:27], s3 offen lds
  buffer_load_dwordx4 v201, s[24:27], s3 offen offset:1024 lds
  buffer_load_dwordx4 v202, s[24:27], s3 offen offset:2048 lds
  buffer_load_dwordx4 v203, s[24:27], s3 offen offset:3072 lds
  s_add_u32 s51, s51, 128
  s_and_b32 s51, s51, 4095
  s_getreg_b32 s3, hwreg(HW_REG_IB_STS)
  s_bfe_u32 s79, s3, 131094
  s_and_b32 s3, s3, 15
  s_lshl4_add_u32 s3, s79, s3
  s_sub_u32 s3, 108, s3
  v_mov_b32 v13, s3
  ds_write_b32 v11, v13
  ds_read_b32 v12, v10 offset:1024
  s_waitcnt lgkmcnt(0)
  v_cmp_gt_u32 vcc, 15, v12
  s_cbranch_vccnz .Lsp_119
.Lrt_120:
  s_add_u32 m0, s49, 81920
  s_add_u32 s3, s50, s51
  buffer_load_dwordx4 v200, s[24:27], s3 offen lds
  buffer_load_dwordx4 v201, s[24:27], s3 offen offset:1024 lds
  buffer_load_dwordx4 v202, s[24:27], s3 offen offset:2048 lds
  buffer_load_dwordx4 v203, s[24:27], s3 offen offset:3072 lds
  s_add_u32 s51, s51, 128
  s_and_b32 s51, s51, 4095
  s_getreg_b32 s3, hwreg(HW_REG_IB_STS)
  s_bfe_u32 s79, s3, 131094
  s_and_b32 s3, s3, 15
  s_lshl4_add_u32 s3, s79, s3
  s_sub_u32 s3, 112, s3
  v_mov_b32 v13, s3
  ds_write_b32 v11, v13
  ds_read_b32 v12, v10 offset:2048
  s_waitcnt lgkmcnt(0)
  v_cmp_gt_u32 vcc, 4, v12
  s_cbranch_vccnz .Lsp_121
.Lrt_122:
  s_add_u32 m0, s49, 98304
  s_add_u32 s3, s50, s51
  buffer_load_dwordx4 v200, s[24:27], s3 offen lds
  buffer_load_dwordx4 v201, s[24:27], s3 offen offset:1024 lds
  buffer_load_dwordx4 v202, s[24:27], s3 offen offset:2048 lds
  buffer_load_dwordx4 v203, s[24:27], s3 offen offset:3072 lds
  s_add_u32 s51, s51, 128
  s_and_b32 s51, s51, 4095
  s_getreg_b32 s3, hwreg(HW_REG_IB_STS)
  s_bfe_u32 s79, s3, 131094
  s_and_b32 s3, s3, 15
  s_lshl4_add_u32 s3, s79, s3
  s_sub_u32 s3, 116, s3
  v_mov_b32 v13, s3
  ds_write_b32 v11, v13
  s_add_u32 m0, s49, 114688
  s_add_u32 s3, s50, s51
  buffer_load_dwordx4 v200, s[24:27], s3 offen lds
  buffer_load_dwordx4 v201, s[24:27], s3 offen offset:1024 lds
  buffer_load_dwordx4 v202, s[24:27], s3 offen offset:2048 lds
  buffer_load_dwordx4 v203, s[24:27], s3 offen offset:3072 lds
  s_add_u32 s51, s51, 128
  s_and_b32 s51, s51, 4095
  s_getreg_b32 s3, hwreg(HW_REG_IB_STS)
  s_bfe_u32 s79, s3, 131094
  s_and_b32 s3, s3, 15
  s_lshl4_add_u32 s3, s79, s3
  s_sub_u32 s3, 120, s3
  v_mov_b32 v13, s3
  ds_write_b32 v11, v13
.Lh_pre8_y:
  s_waitcnt lgkmcnt(0)
  s_mov_b32 s66, 120
  s_mov_b32 s67, 17
  s_mov_b32 s63, 0
  s_mov_b32 s68, -1
.Lh2_loop_y:
  ds_read_b32 v12, v10 offset:1024
  s_getreg_b32 s3, hwreg(HW_REG_IB_STS)
  s_bfe_u32 s79, s3, 131094
  s_and_b32 s3, s3, 15
  s_lshl4_add_u32 s3, s79, s3
  s_sub_u32 s3, s66, s3
  s_cmp_eq_u32 s3, s68
  s_cbranch_scc1 .Lh2_np_y
  s_mov_b32 s68, s3
  v_mov_b32 v13, s3
  ds_write_b32 v11, v13
.Lh2_np_y:
  s_waitcnt lgkmcnt(0)
  v_cmp_gt_u32 vcc, s67, v12
  s_cbranch_vccz .Lh2_go_y
  s_cmp_eq_u32 s74, 0
  s_cbranch_scc1 .Lh2_go_y
  s_sub_u32 s74, s74, 1
  s_sleep 1
  s_branch .Lh2_loop_y
.Lh2_go_y:
  s_add_u32 m0, s49, s63
  s_add_u32 s3, s50, s51
  buffer_load_dwordx4 v200, s[24:27], s3 offen lds
  buffer_load_dwordx4 v201, s[24:27], s3 offen offset:1024 lds
  buffer_load_dwordx4 v202, s[24:27], s3 offen offset:2048 lds
  buffer_load_dwordx4 v203, s[24:27], s3 offen offset:3072 lds
  s_add_u32 s51, s51, 128
  s_and_b32 s51, s51, 4095
  s_add_u32 s63, s63, 16384
  s_and_b32 s63, s63, 131071
  s_add_u32 s66, s66, 4
  s_add_u32 s67, s67, 1
  s_cmp_lt_u32 s67, 41
  s_cbranch_scc1 .Lh2_loop_y
.Lh2_done_y:
  s_lshr_b32 s3, s2, 3
  s_lshl2_add_u32 s3, s3, s75
  s_min_u32 s3, s3, 111
  s_lshl_b32 s3, s3, 13
  ds_read_b32 v12, v10 offset:1024
  s_waitcnt lgkmcnt(0)
  v_cmp_gt_u32 vcc, 16, v12
  s_cbranch_vccnz .Lsp_123
.Lrt_124:
  s_add_u32 m0, s48, 131072
  s_add_u32 s3, s69, 0
  buffer_load_dwordx4 v204, s[28:31], s3 offen lds
  buffer_load_dwordx4 v205, s[28:31], s3 offen offset:1024 lds
  s_add_u32 m0, s48, 139264
  s_add_u32 s3, s69, 458752
  buffer_load_dwordx4 v204, s[28:31], s3 offen lds
  buffer_load_dwordx4 v205, s[28:31], s3 offen offset:1024 lds
  s_getreg_b32 s3, hwreg(HW_REG_IB_STS)
  s_bfe_u32 s79, s3, 131094
  s_and_b32 s3, s3, 15
  s_lshl4_add_u32 s3, s79, s3
  s_sub_u32 s3, 220, s3
  v_mov_b32 v13, s3
  ds_write_b32 v11, v13
  ds_read_b32 v12, v10 offset:1024
  s_waitcnt lgkmcnt(0)
  v_cmp_gt_u32 vcc, 41, v12
  s_cbranch_vccnz .Lsp_125
.Lrt_126:
  s_add_u32 m0, s48, 0
  s_add_u32 s3, s69, 65536
  buffer_load_dwordx4 v204, s[28:31], s3 offen lds
  buffer_load_dwordx4 v205, s[28:31], s3 offen offset:1024 lds
  s_add_u32 m0, s48, 8192
  s_add_u32 s3, s69, 524288
  buffer_load_dwordx4 v204, s[28:31], s3 offen lds
  buffer_load_dwordx4 v205, s[28:31], s3 offen offset:1024 lds
  s_getreg_b32 s3, hwreg(HW_REG_IB_STS)
  s_bfe_u32 s79, s3, 131094
  s_and_b32 s3, s3, 15
  s_lshl4_add_u32 s3, s79, s3
  s_sub_u32 s3, 224, s3
  v_mov_b32 v13, s3
  ds_write_b32 v11, v13
  ds_read_b32 v12, v10 offset:1024
  s_waitcnt lgkmcnt(0)
  v_cmp_gt_u32 vcc, 42, v12
  s_cbranch_vccnz .Lsp_127
.Lrt_128:
  s_add_u32 m0, s48, 16384
  s_add_u32 s3, s69, 131072
  buffer_load_dwordx4 v204, s[28:31], s3 offen lds
  buffer_load_dwordx4 v205, s[28:31], s3 offen offset:1024 lds
  s_add_u32 m0, s48, 24576
  s_add_u32 s3, s69, 589824
  buffer_load_dwordx4 v204, s[28:31], s3 offen lds
  buffer_load_dwordx4 v205, s[28:31], s3 offen offset:1024 lds
  s_getreg_b32 s3, hwreg(HW_REG_IB_STS)
  s_bfe_u32 s79, s3, 131094
  s_and_b32 s3, s3, 15
  s_lshl4_add_u32 s3, s79, s3
  s_sub_u32 s3, 228, s3
  v_mov_b32 v13, s3
  ds_write_b32 v11, v13
  ds_read_b32 v12, v10 offset:1024
  s_waitcnt lgkmcnt(0)
  v_cmp_gt_u32 vcc, 43, v12
  s_cbranch_vccnz .Lsp_129
.Lrt_130:
  s_add_u32 m0, s48, 32768
  s_add_u32 s3, s69, 196608
  buffer_load_dwordx4 v204, s[28:31], s3 offen lds
  buffer_load_dwordx4 v205, s[28:31], s3 offen offset:1024 lds
  s_add_u32 m0, s48, 40960
  s_add_u32 s3, s69, 655360
  buffer_load_dwordx4 v204, s[28:31], s3 offen lds
  buffer_load_dwordx4 v205, s[28:31], s3 offen offset:1024 lds
  s_getreg_b32 s3, hwreg(HW_REG_IB_STS)
  s_bfe_u32 s79, s3, 131094
  s_and_b32 s3, s3, 15
  s_lshl4_add_u32 s3, s79, s3
  s_sub_u32 s3, 232, s3
  v_mov_b32 v13, s3
  ds_write_b32 v11, v13
  ds_read_b32 v12, v10 offset:1024
  s_waitcnt lgkmcnt(0)
  v_cmp_gt_u32 vcc, 44, v12
  s_cbranch_vccnz .Lsp_131
.Lrt_132:
  s_add_u32 m0, s48, 49152
  s_add_u32 s3, s69, 262144
  buffer_load_dwordx4 v204, s[28:31], s3 offen lds
  buffer_load_dwordx4 v205, s[28:31], s3 offen offset:1024 lds
  s_add_u32 m0, s48, 57344
  s_add_u32 s3, s69, 720896
  buffer_load_dwordx4 v204, s[28:31], s3 offen lds
  buffer_load_dwordx4 v205, s[28:31], s3 offen offset:1024 lds
  s_getreg_b32 s3, hwreg(HW_REG_IB_STS)
  s_bfe_u32 s79, s3, 131094
  s_and_b32 s3, s3, 15
  s_lshl4_add_u32 s3, s79, s3
  s_sub_u32 s3, 236, s3
  v_mov_b32 v13, s3
  ds_write_b32 v11, v13
  ds_read_b32 v12, v10 offset:1024
  s_waitcnt lgkmcnt(0)
  v_cmp_gt_u32 vcc, 45, v12
  s_cbranch_vccnz .Lsp_133
.Lrt_134:
  s_add_u32 m0, s48, 65536
  s_add_u32 s3, s69, 327680
  buffer_load_dwordx4 v204, s[28:31], s3 offen lds
  buffer_load_dwordx4 v205, s[28:31], s3 offen offset:1024 lds
  s_add_u32 m0, s48, 73728
  s_add_u32 s3, s69, 786432
  buffer_load_dwordx4 v204, s[28:31], s3 offen lds
  buffer_load_dwordx4 v205, s[28:31], s3 offen offset:1024 lds
  s_getreg_b32 s3, hwreg(HW_REG_IB_STS)
  s_bfe_u32 s79, s3, 131094
  s_and_b32 s3, s3, 15
  s_lshl4_add_u32 s3, s79, s3
  s_sub_u32 s3, 240, s3
  v_mov_b32 v13, s3
  ds_write_b32 v11, v13
  ds_read_b32 v12, v10 offset:1024
  s_waitcnt lgkmcnt(0)
  v_cmp_gt_u32 vcc, 46, v12
  s_cbranch_vccnz .Lsp_135
.Lrt_136:
  s_add_u32 m0, s48, 81920
  s_add_u32 s3, s69, 393216
  buffer_load_dwordx4 v204, s[28:31], s3 offen lds
  buffer_load_dwordx4 v205, s[28:31], s3 offen offset:1024 lds
  s_add_u32 m0, s48, 90112
  s_add_u32 s3, s69, 851968
  buffer_load_dwordx4 v204, s[28:31], s3 offen lds
  buffer_load_dwordx4 v205, s[28:31], s3 offen offset:1024 lds
  s_getreg_b32 s3, hwreg(HW_REG_IB_STS)
  s_bfe_u32 s79, s3, 131094
  s_and_b32 s3, s3, 15
  s_lshl4_add_u32 s3, s79, s3
  s_sub_u32 s3, 244, s3
  v_mov_b32 v13, s3
  ds_write_b32 v11, v13
.Lh2_dr_y:
  s_getreg_b32 s3, hwreg(HW_REG_IB_STS)
  s_bfe_u32 s79, s3, 131094
  s_and_b32 s3, s3, 15
  s_lshl4_add_u32 s3, s79, s3
  s_sub_u32 s3, 244, s3
  v_mov_b32 v13, s3
  ds_write_b32 v11, v13
  s_cmp_eq_u32 s3, 244
  s_cbranch_scc1 .Lh2_end_y
  s_sleep 1
  s_branch .Lh2_dr_y
.Lh2_end_y:
  s_waitcnt vmcnt(0) lgkmcnt(0)
.Lh_p2end_y:
  s_endpgm
.Lsp_1:
  s_getreg_b32 s3, hwreg(HW_REG_IB_STS)
  s_bfe_u32 s79, s3, 131094
  s_and_b32 s3, s3, 15
  s_lshl4_add_u32 s3, s79, s3
  s_sub_u32 s3, 24, s3
  v_mov_b32 v13, s3
  ds_write_b32 v11, v13
  ds_read_b32 v12, v11 offset:11264
  s_cmp_eq_u32 s74, 0
  s_waitcnt lgkmcnt(0)
  s_cbranch_scc1 .Lrt_2
  s_sub_u32 s74, s74, 1
  v_cmp_gt_u32 vcc, 1, v12
  s_cbranch_vccnz .Lsp_1
  s_branch .Lrt_2
.Lsp_3:
  s_getreg_b32 s3, hwreg(HW_REG_IB_STS)
  s_bfe_u32 s79, s3, 131094
  s_and_b32 s3, s3, 15
  s_lshl4_add_u32 s3, s79, s3
  s_sub_u32 s3, 30, s3
  v_mov_b32 v13, s3
  ds_write_b32 v11, v13
  ds_read_b32 v12, v11 offset:11264
  s_cmp_eq_u32 s74, 0
  s_waitcnt lgkmcnt(0)
  s_cbranch_scc1 .Lrt_4
  s_sub_u32 s74, s74, 1
  v_cmp_gt_u32 vcc, 2, v12
  s_cbranch_vccnz .Lsp_3
  s_branch .Lrt_4
.Lsp_5:
  s_getreg_b32 s3, hwreg(HW_REG_IB_STS)
  s_bfe_u32 s79, s3, 131094
  s_and_b32 s3, s3, 15
  s_lshl4_add_u32 s3, s79, s3
  s_sub_u32 s3, 36, s3
  v_mov_b32 v13, s3
  ds_write_b32 v11, v13
  ds_read_b32 v12, v11 offset:11264
  s_cmp_eq_u32 s74, 0
  s_waitcnt lgkmcnt(0)
  s_cbranch_scc1 .Lrt_6
  s_sub_u32 s74, s74, 1
  v_cmp_gt_u32 vcc, 3, v12
  s_cbranch_vccnz .Lsp_5
  s_branch .Lrt_6
.Lsp_7:
  s_getreg_b32 s3, hwreg(HW_REG_IB_STS)
  s_bfe_u32 s79, s3, 131094
  s_and_b32 s3, s3, 15
  s_lshl4_add_u32 s3, s79, s3
  s_sub_u32 s3, 42, s3
  v_mov_b32 v13, s3
  ds_write_b32 v11, v13
  ds_read_b32 v12, v11 offset:11264
  s_cmp_eq_u32 s74, 0
  s_waitcnt lgkmcnt(0)
  s_cbranch_scc1 .Lrt_8
  s_sub_u32 s74, s74, 1
  v_cmp_gt_u32 vcc, 4, v12
  s_cbranch_vccnz .Lsp_7
  s_branch .Lrt_8
.Lsp_9:
  s_getreg_b32 s3, hwreg(HW_REG_IB_STS)
  s_bfe_u32 s79, s3, 131094
  s_and_b32 s3, s3, 15
  s_lshl4_add_u32 s3, s79, s3
  s_sub_u32 s3, 56, s3
  v_mov_b32 v13, s3
  ds_write_b32 v11, v13
  ds_read_b32 v12, v10 offset:1024
  s_cmp_eq_u32 s74, 0
  s_waitcnt lgkmcnt(0)
  s_cbranch_scc1 .Lrt_10
  s_sub_u32 s74, s74, 1
  v_cmp_gt_u32 vcc, 5, v12
  s_cbranch_vccnz .Lsp_9
  s_branch .Lrt_10
.Lsp_11:
  s_getreg_b32 s3, hwreg(HW_REG_IB_STS)
  s_bfe_u32 s79, s3, 131094
  s_and_b32 s3, s3, 15
  s_lshl4_add_u32 s3, s79, s3
  s_sub_u32 s3, 60, s3
  v_mov_b32 v13, s3
  ds_write_b32 v11, v13
  ds_read_b32 v12, v10 offset:1024
  s_cmp_eq_u32 s74, 0
  s_waitcnt lgkmcnt(0)
  s_cbranch_scc1 .Lrt_12
  s_sub_u32 s74, s74, 1
  v_cmp_gt_u32 vcc, 6, v12
  s_cbranch_vccnz .Lsp_11
  s_branch .Lrt_12
.Lsp_13:
  s_getreg_b32 s3, hwreg(HW_REG_IB_STS)
  s_bfe_u32 s79, s3, 131094
  s_and_b32 s3, s3, 15
  s_lshl4_add_u32 s3, s79, s3
  s_sub_u32 s3, 64, s3
  v_mov_b32 v13, s3
  ds_write_b32 v11, v13
  ds_read_b32 v12, v10 offset:1024
  s_cmp_eq_u32 s74, 0
  s_waitcnt lgkmcnt(0)
  s_cbranch_scc1 .Lrt_14
  s_sub_u32 s74, s74, 1
  v_cmp_gt_u32 vcc, 7, v12
  s_cbranch_vccnz .Lsp_13
  s_branch .Lrt_14
.Lsp_15:
  s_getreg_b32 s3, hwreg(HW_REG_IB_STS)
  s_bfe_u32 s79, s3, 131094
  s_and_b32 s3, s3, 15
  s_lshl4_add_u32 s3, s79, s3
  s_sub_u32 s3, 68, s3
  v_mov_b32 v13, s3
  ds_write_b32 v11, v13
  ds_read_b32 v12, v10 offset:10240
  s_cmp_eq_u32 s74, 0
  s_waitcnt lgkmcnt(0)
  s_cbranch_scc1 .Lrt_16
  s_sub_u32 s74, s74, 1
  v_cmp_gt_u32 vcc, 1, v12
  s_cbranch_vccnz .Lsp_15
  s_branch .Lrt_16
.Lh_v7:
  s_add_u32 m0, s49, 65536
  s_add_u32 s3, s45, 256
  buffer_load_dwordx4 v44, s[4:7], s3 offen lds
  buffer_load_dwordx4 v45, s[4:7], s3 offen offset:1024 lds
  buffer_load_dwordx4 v46, s[4:7], s3 offen offset:2048 lds
  buffer_load_dwordx4 v47, s[4:7], s3 offen offset:3072 lds
  s_add_u32 m0, s49, 81920
  s_add_u32 s3, s45, 384
  buffer_load_dwordx4 v44, s[4:7], s3 offen lds
  buffer_load_dwordx4 v45, s[4:7], s3 offen offset:1024 lds
  buffer_load_dwordx4 v46, s[4:7], s3 offen offset:2048 lds
  buffer_load_dwordx4 v47, s[4:7], s3 offen offset:3072 lds
  s_add_u32 m0, s48, 16384
  s_add_u32 s3, s77, 0
  buffer_load_dwordx4 v4, s[12:15], s3 offen lds
  buffer_load_dwordx4 v5, s[12:15], s3 offen offset:1024 lds
  s_add_u32 m0, s48, 24576
  s_add_u32 s3, s77, 128
  buffer_load_dwordx4 v4, s[12:15], s3 offen lds
  buffer_load_dwordx4 v5, s[12:15], s3 offen offset:1024 lds
  s_getreg_b32 s3, hwreg(HW_REG_IB_STS)
  s_bfe_u32 s79, s3, 131094
  s_and_b32 s3, s3, 15
  s_lshl4_add_u32 s3, s79, s3
  s_sub_u32 s3, 24, s3
  v_mov_b32 v13, s3
  ds_write_b32 v11, v13
  ds_read_b32 v12, v11 offset:11264
  s_waitcnt lgkmcnt(0)
  v_cmp_gt_u32 vcc, 1, v12
  s_cbranch_vccnz .Lsp_1
.Lrt_2:
  s_add_u32 m0, s49, 98304
  s_add_u32 s3, s45, 512
  buffer_load_dwordx4 v44, s[4:7], s3 offen lds
  buffer_load_dwordx4 v45, s[4:7], s3 offen offset:1024 lds
  buffer_load_dwordx4 v46, s[4:7], s3 offen offset:2048 lds
  buffer_load_dwordx4 v47, s[4:7], s3 offen offset:3072 lds
  s_add_u32 m0, s48, 32768
  s_add_u32 s3, s77, 256
  buffer_load_dwordx4 v4, s[12:15], s3 offen lds
  buffer_load_dwordx4 v5, s[12:15], s3 offen offset:1024 lds
  s_getreg_b32 s3, hwreg(HW_REG_IB_STS)
  s_bfe_u32 s79, s3, 131094
  s_and_b32 s3, s3, 15
  s_lshl4_add_u32 s3, s79, s3
  s_sub_u32 s3, 30, s3
  v_mov_b32 v13, s3
  ds_write_b32 v11, v13
  ds_read_b32 v12, v11 offset:11264
  s_waitcnt lgkmcnt(0)
  v_cmp_gt_u32 vcc, 2, v12
  s_cbranch_vccnz .Lsp_3
.Lrt_4:
  s_add_u32 m0, s49, 114688
  s_add_u32 s3, s45, 640
  buffer_load_dwordx4 v44, s[4:7], s3 offen lds
  buffer_load_dwordx4 v45, s[4:7], s3 offen offset:1024 lds
  buffer_load_dwordx4 v46, s[4:7], s3 offen offset:2048 lds
  buffer_load_dwordx4 v47, s[4:7], s3 offen offset:3072 lds
  s_add_u32 m0, s48, 40960
  s_add_u32 s3, s77, 384
  buffer_load_dwordx4 v4, s[12:15], s3 offen lds
  buffer_load_dwordx4 v5, s[12:15], s3 offen offset:1024 lds
  s_getreg_b32 s3, hwreg(HW_REG_IB_STS)
  s_bfe_u32 s79, s3, 131094
  s_and_b32 s3, s3, 15
  s_lshl4_add_u32 s3, s79, s3
  s_sub_u32 s3, 36, s3
  v_mov_b32 v13, s3
  ds_write_b32 v11, v13
  ds_read_b32 v12, v11 offset:11264
  s_waitcnt lgkmcnt(0)
  v_cmp_gt_u32 vcc, 3, v12
  s_cbranch_vccnz .Lsp_5
.Lrt_6:
  s_add_u32 m0, s49, 65536
  s_add_u32 s3, s45, 768
  buffer_load_dwordx4 v44, s[4:7], s3 offen lds
  buffer_load_dwordx4 v45, s[4:7], s3 offen offset:1024 lds
  buffer_load_dwordx4 v46, s[4:7], s3 offen offset:2048 lds
  buffer_load_dwordx4 v47, s[4:7], s3 offen offset:3072 lds
  s_add_u32 m0, s48, 49152
  s_add_u32 s3, s77, 512
  buffer_load_dwordx4 v4, s[12:15], s3 offen lds
  buffer_load_dwordx4 v5, s[12:15], s3 offen offset:1024 lds
  s_getreg_b32 s3, hwreg(HW_REG_IB_STS)
  s_bfe_u32 s79, s3, 131094
  s_and_b32 s3, s3, 15
  s_lshl4_add_u32 s3, s79, s3
  s_sub_u32 s3, 42, s3
  v_mov_b32 v13, s3
  ds_write_b32 v11, v13
  ds_read_b32 v12, v11 offset:11264
  s_waitcnt lgkmcnt(0)
  v_cmp_gt_u32 vcc, 4, v12
  s_cbranch_vccnz .Lsp_7
.Lrt_8:
  s_add_u32 m0, s49, 81920
  s_add_u32 s3, s45, 896
  buffer_load_dwordx4 v44, s[4:7], s3 offen lds
  buffer_load_dwordx4 v45, s[4:7], s3 offen offset:1024 lds
  buffer_load_dwordx4 v46, s[4:7], s3 offen offset:2048 lds
  buffer_load_dwordx4 v47, s[4:7], s3 offen offset:3072 lds
  s_add_u32 m0, s48, 57344
  s_add_u32 s3, s77, 640
  buffer_load_dwordx4 v4, s[12:15], s3 offen lds
  buffer_load_dwordx4 v5, s[12:15], s3 offen offset:1024 lds
  s_add_u32 m0, s48, 131072
  s_add_u32 s3, s77, 768
  buffer_load_dwordx4 v4, s[12:15], s3 offen lds
  buffer_load_dwordx4 v5, s[12:15], s3 offen offset:1024 lds
  s_add_u32 m0, s48, 139264
  s_add_u32 s3, s77, 896
  buffer_load_dwordx4 v4, s[12:15], s3 offen lds
  buffer_load_dwordx4 v5, s[12:15], s3 offen offset:1024 lds
  s_add_u32 m0, s48, 0
  s_add_u32 s3, s77, 0
  buffer_load_dwordx4 v4, s[40:43], s3 offen lds
  buffer_load_dwordx4 v5, s[40:43], s3 offen offset:1024 lds
  s_add_u32 m0, s48, 8192
  s_add_u32 s3, s77, 128
  buffer_load_dwordx4 v4, s[40:43], s3 offen lds
  buffer_load_dwordx4 v5, s[40:43], s3 offen offset:1024 lds
  s_getreg_b32 s3, hwreg(HW_REG_IB_STS)
  s_bfe_u32 s79, s3, 131094
  s_and_b32 s3, s3, 15
  s_lshl4_add_u32 s3, s79, s3
  s_sub_u32 s3, 56, s3
  v_mov_b32 v13, s3
  ds_write_b32 v11, v13
  ds_read_b32 v12, v10 offset:1024
  s_waitcnt lgkmcnt(0)
  v_cmp_gt_u32 vcc, 5, v12
  s_cbranch_vccnz .Lsp_9
.Lrt_10:
  s_add_u32 m0, s48, 98304
  s_add_u32 s3, s77, 256
  buffer_load_dwordx4 v4, s[40:43], s3 offen lds
  buffer_load_dwordx4 v5, s[40:43], s3 offen offset:1024 lds
  s_add_u32 m0, s48, 106496
  s_add_u32 s3, s77, 384
  buffer_load_dwordx4 v4, s[40:43], s3 offen lds
  buffer_load_dwordx4 v5, s[40:43], s3 offen offset:1024 lds
  s_getreg_b32 s3, hwreg(HW_REG_IB_STS)
  s_bfe_u32 s79, s3, 131094
  s_and_b32 s3, s3, 15
  s_lshl4_add_u32 s3, s79, s3
  s_sub_u32 s3, 60, s3
  v_mov_b32 v13, s3
  ds_write_b32 v11, v13
  ds_read_b32 v12, v10 offset:1024
  s_waitcnt lgkmcnt(0)
  v_cmp_gt_u32 vcc, 6, v12
  s_cbranch_vccnz .Lsp_11
.Lrt_12:
  s_add_u32 m0, s48, 114688
  s_add_u32 s3, s77, 512
  buffer_load_dwordx4 v4, s[40:43], s3 offen lds
  buffer_load_dwordx4 v5, s[40:43], s3 offen offset:1024 lds
  s_add_u32 m0, s48, 122880
  s_add_u32 s3, s77, 640
  buffer_load_dwordx4 v4, s[40:43], s3 offen lds
  buffer_load_dwordx4 v5, s[40:43], s3 offen offset:1024 lds
  s_getreg_b32 s3, hwreg(HW_REG_IB_STS)
  s_bfe_u32 s79, s3, 131094
  s_and_b32 s3, s3, 15
  s_lshl4_add_u32 s3, s79, s3
  s_sub_u32 s3, 64, s3
  v_mov_b32 v13, s3
  ds_write_b32 v11, v13
  ds_read_b32 v12, v10 offset:1024
  s_waitcnt lgkmcnt(0)
  v_cmp_gt_u32 vcc, 7, v12
  s_cbranch_vccnz .Lsp_13
.Lrt_14:
  s_add_u32 m0, s48, 65536
  s_add_u32 s3, s77, 768
  buffer_load_dwordx4 v4, s[40:43], s3 offen lds
  buffer_load_dwordx4 v5, s[40:43], s3 offen offset:1024 lds
  s_add_u32 m0, s48, 73728
  s_add_u32 s3, s77, 896
  buffer_load_dwordx4 v4, s[40:43], s3 offen lds
  buffer_load_dwordx4 v5, s[40:43], s3 offen offset:1024 lds
  ds_read_b32 v12, v10 offset:10240
  s_waitcnt lgkmcnt(0)
  v_cmp_gt_u32 vcc, 1, v12
  s_cbranch_vccnz .Lsp_15
.Lrt_16:
  s_branch .Lh_tch_y
.Lsp_35:
  s_getreg_b32 s3, hwreg(HW_REG_IB_STS)
  s_bfe_u32 s79, s3, 131094
  s_and_b32 s3, s3, 15
  s_lshl4_add_u32 s3, s79, s3
  s_sub_u32 s3, 78, s3
  v_mov_b32 v13, s3
  ds_write_b32 v11, v13
  ds_read_b32 v12, v10 offset:10240
  s_cmp_eq_u32 s74, 0
  s_waitcnt lgkmcnt(0)
  s_cbranch_scc1 .Lrt_36
  s_sub_u32 s74, s74, 1
  v_cmp_gt_u32 vcc, 2, v12
  s_cbranch_vccnz .Lsp_35
  s_branch .Lrt_36
.Lno_37:
  buffer_load_dword v52, off, s[20:23], 0 sc1
  s_cmp_eq_u32 s74, 0
  s_waitcnt vmcnt(0)
  s_cbranch_scc1 .Lnk_38
  s_sub_u32 s74, s74, 1
  v_readfirstlane_b32 s73, v52
  s_cmp_lg_u32 s73, 0
  s_cbranch_scc0 .Lno_37
  s_branch .Lnk_38
.Lsp_39:
  s_getreg_b32 s3, hwreg(HW_REG_IB_STS)
  s_bfe_u32 s79, s3, 131094
  s_and_b32 s3, s3, 15
  s_lshl4_add_u32 s3, s79, s3
  s_sub_u32 s3, 78, s3
  v_mov_b32 v13, s3
  ds_write_b32 v11, v13
  ds_read_b32 v12, v52 offset:0
  s_cmp_eq_u32 s74, 0
  s_waitcnt lgkmcnt(0)
  s_cbranch_scc1 .Lrt_40
  s_sub_u32 s74, s74, 1
  v_cmp_gt_u32 vcc, 3, v12
  s_cbranch_vccnz .Lsp_39
  s_branch .Lrt_40
.Lsp_41:
  s_getreg_b32 s3, hwreg(HW_REG_IB_STS)
  s_bfe_u32 s79, s3, 131094
  s_and_b32 s3, s3, 15
  s_lshl4_add_u32 s3, s79, s3
  s_sub_u32 s3, 79, s3
  v_mov_b32 v13, s3
  ds_write_b32 v11, v13
  ds_read_b32 v12, v10 offset:1024
  s_cmp_eq_u32 s74, 0
  s_waitcnt lgkmcnt(0)
  s_cbranch_scc1 .Lrt_42
  s_sub_u32 s74, s74, 1
  v_cmp_gt_u32 vcc, 9, v12
  s_cbranch_vccnz .Lsp_41
  s_branch .Lrt_42
.Lsp_43:
  ds_read_b32 v13, v10 offset:0
  s_cmp_eq_u32 s74, 0
  s_waitcnt lgkmcnt(0)
  s_cbranch_scc1 .Lrt_44
  s_sub_u32 s74, s74, 1
  v_cmp_gt_u32 vcc, 4, v13
  s_cbranch_vccnz .Lsp_43
  s_branch .Lrt_44
.Lsp_45:
  ds_read_b32 v13, v10 offset:0
  s_cmp_eq_u32 s74, 0
  s_waitcnt lgkmcnt(0)
  s_cbranch_scc1 .Lrt_46
  s_sub_u32 s74, s74, 1
  v_cmp_gt_u32 vcc, 10, v13
  s_cbranch_vccnz .Lsp_45
  s_branch .Lrt_46
.Lsp_47:
  ds_read_b32 v13, v10 offset:0
  s_cmp_eq_u32 s74, 0
  s_waitcnt lgkmcnt(0)
  s_cbranch_scc1 .Lrt_48
  s_sub_u32 s74, s74, 1
  v_cmp_gt_u32 vcc, 16, v13
  s_cbranch_vccnz .Lsp_47
  s_branch .Lrt_48
.Lsp_49:
  ds_read_b32 v13, v10 offset:0
  s_cmp_eq_u32 s74, 0
  s_waitcnt lgkmcnt(0)
  s_cbranch_scc1 .Lrt_50
  s_sub_u32 s74, s74, 1
  v_cmp_gt_u32 vcc, 20, v13
  s_cbranch_vccnz .Lsp_49
  s_branch .Lrt_50
.Lsp_51:
  ds_read_b32 v13, v10 offset:0
  s_cmp_eq_u32 s74, 0
  s_waitcnt lgkmcnt(0)
  s_cbranch_scc1 .Lrt_52
  s_sub_u32 s74, s74, 1
  v_cmp_gt_u32 vcc, 28, v13
  s_cbranch_vccnz .Lsp_51
  s_branch .Lrt_52
.Lsp_53:
  ds_read_b32 v13, v10 offset:0
  s_cmp_eq_u32 s74, 0
  s_waitcnt lgkmcnt(0)
  s_cbranch_scc1 .Lrt_54
  s_sub_u32 s74, s74, 1
  v_cmp_gt_u32 vcc, 34, v13
  s_cbranch_vccnz .Lsp_53
  s_branch .Lrt_54
.Lsp_55:
  ds_read_b32 v13, v10 offset:0
  s_cmp_eq_u32 s74, 0
  s_waitcnt lgkmcnt(0)
  s_cbranch_scc1 .Lrt_56
  s_sub_u32 s74, s74, 1
  v_cmp_gt_u32 vcc, 40, v13
  s_cbranch_vccnz .Lsp_55
  s_branch .Lrt_56
.Lsp_57:
  ds_read_b32 v13, v10 offset:0
  s_cmp_eq_u32 s74, 0
  s_waitcnt lgkmcnt(0)
  s_cbranch_scc1 .Lrt_58
  s_sub_u32 s74, s74, 1
  v_cmp_gt_u32 vcc, 46, v13
  s_cbranch_vccnz .Lsp_57
  s_branch .Lrt_58
.Lsp_59:
  ds_read_b32 v13, v10 offset:0
  s_cmp_eq_u32 s74, 0
  s_waitcnt lgkmcnt(0)
  s_cbranch_scc1 .Lrt_60
  s_sub_u32 s74, s74, 1
  v_cmp_gt_u32 vcc, 52, v13
  s_cbranch_vccnz .Lsp_59
  s_branch .Lrt_60
.Lno_61:
  buffer_load_dword v12, off, s[20:23], 0 sc1
  s_cmp_eq_u32 s74, 0
  s_waitcnt vmcnt(0)
  s_cbranch_scc1 .Lnk_62
  s_sub_u32 s74, s74, 1
  v_readfirstlane_b32 s73, v12
  s_cmp_lg_u32 s73, 0
  s_cbranch_scc0 .Lno_61
  s_branch .Lnk_62
.Lsp_63:
  ds_read_b32 v13, v10 offset:0
  s_cmp_eq_u32 s74, 0
  s_waitcnt lgkmcnt(0)
  s_cbranch_scc1 .Lrt_64
  s_sub_u32 s74, s74, 1
  v_cmp_gt_u32 vcc, 68, v13
  s_cbranch_vccnz .Lsp_63
  s_branch .Lrt_64
.Lsp_65:
  ds_read_b32 v13, v10 offset:1024
  s_cmp_eq_u32 s74, 0
  s_waitcnt lgkmcnt(0)
  s_cbranch_scc1 .Lrt_66
  s_sub_u32 s74, s74, 1
  v_cmp_gt_u32 vcc, 9, v13
  s_cbranch_vccnz .Lsp_65
  s_branch .Lrt_66
.Lsp_67:
  ds_read_b32 v13, v10 offset:1024
  s_cmp_eq_u32 s74, 0
  s_waitcnt lgkmcnt(0)
  s_cbranch_scc1 .Lrt_68
  s_sub_u32 s74, s74, 1
  v_cmp_gt_u32 vcc, 16, v13
  s_cbranch_vccnz .Lsp_67
  s_branch .Lrt_68
.Lsp_69:
  s_sleep 2
  ds_read_b32 v13, v10 offset:0
  s_cmp_eq_u32 s74, 0
  s_waitcnt lgkmcnt(0)
  s_cbranch_scc1 .Lrt_70
  s_sub_u32 s74, s74, 1
  v_cmp_gt_u32 vcc, 104, v13
  s_cbranch_vccnz .Lsp_69
  s_branch .Lrt_70
.Lc_v7:
  buffer_load_dword v12, off, s[20:23], 0 sc1
  ds_read_b32 v13, v10 offset:0
  s_waitcnt lgkmcnt(0)
  v_cmp_gt_u32 vcc, 4, v13
  s_cbranch_vccnz .Lsp_43
.Lrt_44:
  ds_read_b128 v[128:131], v20 offset:32768
  ds_read_b128 v[132:135], v20 offset:34816
  ds_read_b128 v[136:139], v21 offset:32768
  ds_read_b128 v[140:143], v21 offset:34816
  v_mov_b32 v15, 1
  ds_write_b32 v11, v15 offset:10240
  s_waitcnt lgkmcnt(4)
  v_mfma_f32_16x16x32_bf16 v[80:83], v[128:131], v[128:131], 0
  v_mfma_f32_16x16x32_bf16 v[88:91], v[24:27], v[128:131], 0
  s_waitcnt lgkmcnt(3)
  v_mfma_f32_16x16x32_bf16 v[84:87], v[132:135], v[132:135], 0
  v_mfma_f32_16x16x32_bf16 v[92:95], v[24:27], v[132:135], 0
  s_waitcnt lgkmcnt(2)
  v_mfma_f32_16x16x32_bf16 v[80:83], v[136:139], v[136:139], v[80:83]
  v_mfma_f32_16x16x32_bf16 v[88:91], v[24:27], v[136:139], v[88:91]
  s_waitcnt lgkmcnt(1)
  v_mfma_f32_16x16x32_bf16 v[84:87], v[140:143], v[140:143], v[84:87]
  v_mfma_f32_16x16x32_bf16 v[92:95], v[24:27], v[140:143], v[92:95]
  ds_read_b32 v13, v10 offset:0
  s_waitcnt lgkmcnt(0)
  v_cmp_gt_u32 vcc, 10, v13
  s_cbranch_vccnz .Lsp_45
.Lrt_46:
  ds_read_b128 v[144:147], v20 offset:49152
  ds_read_b128 v[148:151], v20 offset:51200
  ds_read_b128 v[152:155], v21 offset:49152
  ds_read_b128 v[156:159], v21 offset:51200
  v_mov_b32 v15, 2
  ds_write_b32 v11, v15 offset:10240
  s_waitcnt lgkmcnt(4)
  v_mfma_f32_16x16x32_bf16 v[80:83], v[144:147], v[144:147], v[80:83]
  v_mfma_f32_16x16x32_bf16 v[88:91], v[24:27], v[144:147], v[88:91]
  s_waitcnt lgkmcnt(3)
  v_mfma_f32_16x16x32_bf16 v[84:87], v[148:151], v[148:151], v[84:87]
  v_mfma_f32_16x16x32_bf16 v[92:95], v[24:27], v[148:151], v[92:95]
  s_waitcnt lgkmcnt(2)
  v_mfma_f32_16x16x32_bf16 v[80:83], v[152:155], v[152:155], v[80:83]
  v_mfma_f32_16x16x32_bf16 v[88:91], v[24:27], v[152:155], v[88:91]
  s_waitcnt lgkmcnt(1)
  v_mfma_f32_16x16x32_bf16 v[84:87], v[156:159], v[156:159], v[84:87]
  v_mfma_f32_16x16x32_bf16 v[92:95], v[24:27], v[156:159], v[92:95]
  ds_read_b32 v13, v10 offset:0
  s_waitcnt lgkmcnt(0)
  v_cmp_gt_u32 vcc, 16, v13
  s_cbranch_vccnz .Lsp_47
.Lrt_48:
  ds_read_b128 v[160:163], v20 offset:0
  ds_read_b128 v[164:167], v20 offset:2048
  ds_read_b128 v[168:171], v21 offset:0
  ds_read_b128 v[172:175], v21 offset:2048
  v_mov_b32 v15, 3
  ds_write_b32 v11, v15 offset:10240
  s_waitcnt lgkmcnt(4)
  v_mfma_f32_16x16x32_bf16 v[80:83], v[160:163], v[160:163], v[80:83]
  v_mfma_f32_16x16x32_bf16 v[88:91], v[24:27], v[160:163], v[88:91]
  s_waitcnt lgkmcnt(3)
  v_mfma_f32_16x16x32_bf16 v[84:87], v[164:167], v[164:167], v[84:87]
  v_mfma_f32_16x16x32_bf16 v[92:95], v[24:27], v[164:167], v[92:95]
  s_waitcnt lgkmcnt(2)
  v_mfma_f32_16x16x32_bf16 v[80:83], v[168:171], v[168:171], v[80:83]
  v_mfma_f32_16x16x32_bf16 v[88:91], v[24:27], v[168:171], v[88:91]
  s_waitcnt lgkmcnt(1)
  v_mfma_f32_16x16x32_bf16 v[84:87], v[172:175], v[172:175], v[84:87]
  v_mfma_f32_16x16x32_bf16 v[92:95], v[24:27], v[172:175], v[92:95]
  ds_read_b32 v13, v10 offset:0
  s_waitcnt lgkmcnt(0)
  v_cmp_gt_u32 vcc, 20, v13
  s_cbranch_vccnz .Lsp_49
.Lrt_50:
  ds_read_b128 v[176:179], v20 offset:16384
  ds_read_b128 v[180:183], v20 offset:18432
  ds_read_b128 v[184:187], v21 offset:16384
  ds_read_b128 v[188:191], v21 offset:18432
  v_mov_b32 v15, 4
  ds_write_b32 v11, v15 offset:10240
  s_waitcnt lgkmcnt(4)
  v_mfma_f32_16x16x32_bf16 v[80:83], v[176:179], v[176:179], v[80:83]
  v_mfma_f32_16x16x32_bf16 v[88:91], v[24:27], v[176:179], v[88:91]
  s_waitcnt lgkmcnt(3)
  v_mfma_f32_16x16x32_bf16 v[84:87], v[180:183], v[180:183], v[84:87]
  v_mfma_f32_16x16x32_bf16 v[92:95], v[24:27], v[180:183], v[92:95]
  s_waitcnt lgkmcnt(2)
  v_mfma_f32_16x16x32_bf16 v[80:83], v[184:187], v[184:187], v[80:83]
  v_mfma_f32_16x16x32_bf16 v[88:91], v[24:27], v[184:187], v[88:91]
  s_waitcnt lgkmcnt(1)
  v_mfma_f32_16x16x32_bf16 v[84:87], v[188:191], v[188:191], v[84:87]
  v_mfma_f32_16x16x32_bf16 v[92:95], v[24:27], v[188:191], v[92:95]
  ds_read_b32 v13, v10 offset:0
  s_waitcnt lgkmcnt(0)
  v_cmp_gt_u32 vcc, 28, v13
  s_cbranch_vccnz .Lsp_51
.Lrt_52:
  ds_read_b128 v[192:195], v20 offset:32768
  ds_read_b128 v[196:199], v20 offset:34816
  ds_read_b128 v[200:203], v21 offset:32768
  ds_read_b128 v[204:207], v21 offset:34816
  v_mov_b32 v15, 5
  ds_write_b32 v11, v15
  s_waitcnt lgkmcnt(4)
  v_mfma_f32_16x16x32_bf16 v[80:83], v[192:195], v[192:195], v[80:83]
  v_mfma_f32_16x16x32_bf16 v[88:91], v[24:27], v[192:195], v[88:91]
  s_waitcnt lgkmcnt(3)
  v_mfma_f32_16x16x32_bf16 v[84:87], v[196:199], v[196:199], v[84:87]
  v_mfma_f32_16x16x32_bf16 v[92:95], v[24:27], v[196:199], v[92:95]
  s_waitcnt lgkmcnt(2)
  v_mfma_f32_16x16x32_bf16 v[80:83], v[200:203], v[200:203], v[80:83]
  v_mfma_f32_16x16x32_bf16 v[88:91], v[24:27], v[200:203], v[88:91]
  s_waitcnt lgkmcnt(1)
  v_mfma_f32_16x16x32_bf16 v[84:87], v[204:207], v[204:207], v[84:87]
  v_mfma_f32_16x16x32_bf16 v[92:95], v[24:27], v[204:207], v[92:95]
  ds_read_b32 v13, v10 offset:0
  s_waitcnt lgkmcnt(0)
  v_cmp_gt_u32 vcc, 34, v13
  s_cbranch_vccnz .Lsp_53
.Lrt_54:
  ds_read_b128 v[208:211], v20 offset:49152
  ds_read_b128 v[212:215], v20 offset:51200
  ds_read_b128 v[216:219], v21 offset:49152
  ds_read_b128 v[220:223], v21 offset:51200
  v_mov_b32 v15, 6
  ds_write_b32 v11, v15
  s_waitcnt lgkmcnt(4)
  v_mfma_f32_16x16x32_bf16 v[80:83], v[208:211], v[208:211], v[80:83]
  v_mfma_f32_16x16x32_bf16 v[88:91], v[24:27], v[208:211], v[88:91]
  s_waitcnt lgkmcnt(3)
  v_mfma_f32_16x16x32_bf16 v[84:87], v[212:215], v[212:215], v[84:87]
  v_mfma_f32_16x16x32_bf16 v[92:95], v[24:27], v[212:215], v[92:95]
  s_waitcnt lgkmcnt(2)
  v_mfma_f32_16x16x32_bf16 v[80:83], v[216:219], v[216:219], v[80:83]
  v_mfma_f32_16x16x32_bf16 v[88:91], v[24:27], v[216:219], v[88:91]
  s_waitcnt lgkmcnt(1)
  v_mfma_f32_16x16x32_bf16 v[84:87], v[220:223], v[220:223], v[84:87]
  v_mfma_f32_16x16x32_bf16 v[92:95], v[24:27], v[220:223], v[92:95]
  ds_read_b32 v13, v10 offset:0
  s_waitcnt lgkmcnt(0)
  v_cmp_gt_u32 vcc, 40, v13
  s_cbranch_vccnz .Lsp_55
.Lrt_56:
  ds_read_b128 v[224:227], v20 offset:0
  ds_read_b128 v[228:231], v20 offset:2048
  ds_read_b128 v[232:235], v21 offset:0
  ds_read_b128 v[236:239], v21 offset:2048
  v_mov_b32 v15, 7
  ds_write_b32 v11, v15
  s_waitcnt lgkmcnt(4)
  v_mfma_f32_16x16x32_bf16 v[80:83], v[224:227], v[224:227], v[80:83]
  v_mfma_f32_16x16x32_bf16 v[88:91], v[24:27], v[224:227], v[88:91]
  s_waitcnt lgkmcnt(3)
  v_mfma_f32_16x16x32_bf16 v[84:87], v[228:231], v[228:231], v[84:87]
  v_mfma_f32_16x16x32_bf16 v[92:95], v[24:27], v[228:231], v[92:95]
  s_waitcnt lgkmcnt(2)
  v_mfma_f32_16x16x32_bf16 v[80:83], v[232:235], v[232:235], v[80:83]
  v_mfma_f32_16x16x32_bf16 v[88:91], v[24:27], v[232:235], v[88:91]
  s_waitcnt lgkmcnt(1)
  v_mfma_f32_16x16x32_bf16 v[84:87], v[236:239], v[236:239], v[84:87]
  v_mfma_f32_16x16x32_bf16 v[92:95], v[24:27], v[236:239], v[92:95]
  ds_read_b32 v13, v10 offset:0
  s_waitcnt lgkmcnt(0)
  v_cmp_gt_u32 vcc, 46, v13
  s_cbranch_vccnz .Lsp_57
.Lrt_58:
  ds_read_b128 v[240:243], v20 offset:16384
  ds_read_b128 v[244:247], v20 offset:18432
  ds_read_b128 v[248:251], v21 offset:16384
  ds_read_b128 v[252:255], v21 offset:18432
  v_mov_b32 v15, 8
  ds_write_b32 v11, v15
  s_waitcnt lgkmcnt(4)
  v_mfma_f32_16x16x32_bf16 v[80:83], v[240:243], v[240:243], v[80:83]
  v_mfma_f32_16x16x32_bf16 v[88:91], v[24:27], v[240:243], v[88:91]
  s_waitcnt lgkmcnt(3)
  v_mfma_f32_16x16x32_bf16 v[84:87], v[244:247], v[244:247], v[84:87]
  v_mfma_f32_16x16x32_bf16 v[92:95], v[24:27], v[244:247], v[92:95]
  s_waitcnt lgkmcnt(2)
  v_mfma_f32_16x16x32_bf16 v[80:83], v[248:251], v[248:251], v[80:83]
  v_mfma_f32_16x16x32_bf16 v[88:91], v[24:27], v[248:251], v[88:91]
  s_waitcnt lgkmcnt(1)
  v_mfma_f32_16x16x32_bf16 v[84:87], v[252:255], v[252:255], v[84:87]
  v_mfma_f32_16x16x32_bf16 v[92:95], v[24:27], v[252:255], v[92:95]
  ds_read_b32 v13, v10 offset:0
  s_waitcnt lgkmcnt(0)
  v_cmp_gt_u32 vcc, 52, v13
  s_cbranch_vccnz .Lsp_59
.Lrt_60:
  v_and_b32 v18, 15, v0
  v_lshrrev_b32 v16, 1, v18
  v_lshrrev_b32 v17, 4, v0
  v_xor_b32 v16, v16, v17
  v_lshlrev_b32 v16, 4, v16
  v_lshl_add_u32 v16, v18, 7, v16
  s_lshl_b32 s3, s75, 11
  v_add_u32 v16, s3, v16
  v_xor_b32 v17, 2048, v16
  v_xor_b32 v18, 4096, v16
  v_xor_b32 v19, 6144, v16
  v_xor_b32 v20, 64, v16
  v_xor_b32 v21, 2112, v16
  v_xor_b32 v22, 4160, v16
  v_xor_b32 v23, 6208, v16
  ds_read_b128 v[32:35], v16 offset:16384
  ds_read_b128 v[36:39], v17 offset:16384
  ds_read_b128 v[40:43], v18 offset:16384
  ds_read_b128 v[44:47], v19 offset:16384
  ds_read_b128 v[48:51], v20 offset:16384
  s_waitcnt lgkmcnt(4)
  v_mfma_f32_16x16x32_bf16 v[28:31], v[24:27], v[32:35], 0
  ds_read_b128 v[52:55], v21 offset:16384
  ds_read_b128 v[56:59], v22 offset:16384
  v_mfma_f32_16x16x32_bf16 v[96:99], v[128:131], v[32:35], 0
  ds_read_b128 v[60:63], v23 offset:16384
  v_cndmask_b32_e64 v1, v80, v81, s[44:45]
  v_cndmask_b32_e64 v2, v82, v83, s[44:45]
  v_mfma_f32_16x16x32_bf16 v[100:103], v[132:135], v[32:35], 0
  ds_read_b128 v[32:35], v16 offset:24576
  v_cndmask_b32_e64 v3, v84, v85, s[44:45]
  v_cndmask_b32_e64 v1, v1, v2, s[46:47]
  s_waitcnt lgkmcnt(7)
  v_mfma_f32_16x16x32_bf16 v[104:107], v[128:131], v[36:39], 0
  v_cndmask_b32_e64 v2, v86, v87, s[44:45]
  v_cndmask_b32_e64 v14, v88, v92, s[64:65]
  v_cndmask_b32_e64 v3, v3, v2, s[46:47]
  v_mfma_f32_16x16x32_bf16 v[108:111], v[132:135], v[36:39], 0
  ds_read_b128 v[36:39], v17 offset:24576
  v_cndmask_b32_e64 v1, 0, v1, s[62:63]
  v_cndmask_b32_e64 v3, 0, v3, s[62:63]
  s_waitcnt lgkmcnt(7)
  v_mfma_f32_16x16x32_bf16 v[112:115], v[128:131], v[40:43], 0
  v_mul_f32 v14, 989855744, v14
  v_permlane32_swap_b32 v1, v3
  v_add_f32 v1, v1, v3
  v_mfma_f32_16x16x32_bf16 v[116:119], v[132:135], v[40:43], 0
  ds_read_b128 v[40:43], v18 offset:24576
  v_mov_b32 v2, v1
  v_cvt_pk_bf16_f32 v3, v14, v14
  s_waitcnt lgkmcnt(7)
  v_mfma_f32_16x16x32_bf16 v[120:123], v[128:131], v[44:47], 0
  v_permlane16_swap_b32 v1, v2
  v_add_f32 v1, v1, v2
  v_mul_f32 v1, 989855744, v1
  v_mfma_f32_16x16x32_bf16 v[124:127], v[132:135], v[44:47], 0
  ds_read_b128 v[44:47], v19 offset:24576
  v_fma_f32 v1, -v14, v14, v1
  v_cvt_pk_bf16_f32 v1, v1, v1
  s_waitcnt lgkmcnt(7)
  v_mfma_f32_16x16x32_bf16 v[28:31], v[24:27], v[48:51], v[28:31]
  v_lshlrev_b32 v1, 16, v1
  v_add_f32 v1, 925353388, v1
  v_cvt_pk_bf16_f32 v1, v1, v1
  v_mfma_f32_16x16x32_bf16 v[96:99], v[136:139], v[48:51], v[96:99]
  v_lshlrev_b32 v1, 16, v1
  v_sqrt_f32 v1, v1
  v_mfma_f32_16x16x32_bf16 v[100:103], v[140:143], v[48:51], v[100:103]
  ds_read_b128 v[48:51], v20 offset:24576
  v_lshlrev_b32 v3, 16, v3
  v_cvt_pk_bf16_f32 v1, v1, v1
  s_waitcnt lgkmcnt(7)
  v_mfma_f32_16x16x32_bf16 v[104:107], v[136:139], v[52:55], v[104:107]
  v_lshlrev_b32 v72, 16, v1
  v_rcp_f32 v70, v72
  v_mfma_f32_16x16x32_bf16 v[108:111], v[140:143], v[52:55], v[108:111]
  ds_read_b128 v[52:55], v21 offset:24576
  v_xor_b32 v68, 0x80000000, v3
  ds_write_b32 v7, v68
  s_waitcnt lgkmcnt(8)
  v_mfma_f32_16x16x32_bf16 v[112:115], v[136:139], v[56:59], v[112:115]
  ds_write_b32 v7, v70 offset:512
  s_waitcnt vmcnt(0)
  v_readfirstlane_b32 s73, v12
  s_cmp_lg_u32 s73, 0
  s_cbranch_scc0 .Lno_61
.Lnk_62:
  v_mfma_f32_16x16x32_bf16 v[116:119], v[140:143], v[56:59], v[116:119]
  ds_read_b128 v[56:59], v22 offset:24576
  v_lshrrev_b32 v2, 4, v0
  v_lshl_add_u32 v7, v2, 5, s52
  s_waitcnt lgkmcnt(9)
  v_mfma_f32_16x16x32_bf16 v[120:123], v[136:139], v[60:63], v[120:123]
  v_mfma_f32_16x16x32_bf16 v[124:127], v[140:143], v[60:63], v[124:127]
  ds_read_b128 v[60:63], v23 offset:24576
  s_waitcnt lgkmcnt(9)
  v_mfma_f32_16x16x32_bf16 v[28:31], v[24:27], v[32:35], v[28:31]
  v_mfma_f32_16x16x32_bf16 v[96:99], v[144:147], v[32:35], v[96:99]
  v_mfma_f32_16x16x32_bf16 v[100:103], v[148:151], v[32:35], v[100:103]
  ds_read_b128 v[32:35], v16 offset:32768
  s_waitcnt lgkmcnt(9)
  v_mfma_f32_16x16x32_bf16 v[104:107], v[144:147], v[36:39], v[104:107]
  v_mfma_f32_16x16x32_bf16 v[108:111], v[148:151], v[36:39], v[108:111]
  ds_read_b128 v[36:39], v17 offset:32768
  s_waitcnt lgkmcnt(9)
  v_mfma_f32_16x16x32_bf16 v[112:115], v[144:147], v[40:43], v[112:115]
  v_mfma_f32_16x16x32_bf16 v[116:119], v[148:151], v[40:43], v[116:119]
  ds_read_b128 v[40:43], v18 offset:32768
  s_waitcnt lgkmcnt(9)
  v_mfma_f32_16x16x32_bf16 v[120:123], v[144:147], v[44:47], v[120:123]
  v_mfma_f32_16x16x32_bf16 v[124:127], v[148:151], v[44:47], v[124:127]
  ds_read_b128 v[44:47], v19 offset:32768
  s_waitcnt lgkmcnt(9)
  v_mfma_f32_16x16x32_bf16 v[28:31], v[24:27], v[48:51], v[28:31]
  v_mfma_f32_16x16x32_bf16 v[96:99], v[152:155], v[48:51], v[96:99]
  v_mfma_f32_16x16x32_bf16 v[100:103], v[156:159], v[48:51], v[100:103]
  ds_read_b128 v[48:51], v20 offset:32768
  s_waitcnt lgkmcnt(9)
  v_mfma_f32_16x16x32_bf16 v[104:107], v[152:155], v[52:55], v[104:107]
  v_mfma_f32_16x16x32_bf16 v[108:111], v[156:159], v[52:55], v[108:111]
  ds_read_b128 v[52:55], v21 offset:32768
  s_waitcnt lgkmcnt(7)
  v_mfma_f32_16x16x32_bf16 v[112:115], v[152:155], v[56:59], v[112:115]
  v_mfma_f32_16x16x32_bf16 v[116:119], v[156:159], v[56:59], v[116:119]
  ds_read_b128 v[56:59], v22 offset:32768
  s_waitcnt lgkmcnt(7)
  v_mfma_f32_16x16x32_bf16 v[120:123], v[152:155], v[60:63], v[120:123]
  v_mfma_f32_16x16x32_bf16 v[124:127], v[156:159], v[60:63], v[124:127]
  ds_read_b128 v[60:63], v23 offset:32768
  s_waitcnt lgkmcnt(7)
  v_mfma_f32_16x16x32_bf16 v[28:31], v[24:27], v[32:35], v[28:31]
  v_mfma_f32_16x16x32_bf16 v[96:99], v[160:163], v[32:35], v[96:99]
  v_mfma_f32_16x16x32_bf16 v[100:103], v[164:167], v[32:35], v[100:103]
  ds_read_b128 v[32:35], v16 offset:40960
  s_waitcnt lgkmcnt(7)
  v_mfma_f32_16x16x32_bf16 v[104:107], v[160:163], v[36:39], v[104:107]
  v_mfma_f32_16x16x32_bf16 v[108:111], v[164:167], v[36:39], v[108:111]
  ds_read_b128 v[36:39], v17 offset:40960
  s_waitcnt lgkmcnt(7)
  v_mfma_f32_16x16x32_bf16 v[112:115], v[160:163], v[40:43], v[112:115]
  v_mfma_f32_16x16x32_bf16 v[116:119], v[164:167], v[40:43], v[116:119]
  ds_read_b128 v[40:43], v18 offset:40960
  s_waitcnt lgkmcnt(7)
  v_mfma_f32_16x16x32_bf16 v[120:123], v[160:163], v[44:47], v[120:123]
  v_mfma_f32_16x16x32_bf16 v[124:127], v[164:167], v[44:47], v[124:127]
  ds_read_b128 v[44:47], v19 offset:40960
  s_waitcnt lgkmcnt(7)
  v_mfma_f32_16x16x32_bf16 v[28:31], v[24:27], v[48:51], v[28:31]
  v_mfma_f32_16x16x32_bf16 v[96:99], v[168:171], v[48:51], v[96:99]
  v_mfma_f32_16x16x32_bf16 v[100:103], v[172:175], v[48:51], v[100:103]
  ds_read_b128 v[48:51], v20 offset:40960
  s_waitcnt lgkmcnt(7)
  v_mfma_f32_16x16x32_bf16 v[104:107], v[168:171], v[52:55], v[104:107]
  v_mfma_f32_16x16x32_bf16 v[108:111], v[172:175], v[52:55], v[108:111]
  ds_read_b128 v[52:55], v21 offset:40960
  s_waitcnt lgkmcnt(7)
  v_mfma_f32_16x16x32_bf16 v[112:115], v[168:171], v[56:59], v[112:115]
  v_mfma_f32_16x16x32_bf16 v[116:119], v[172:175], v[56:59], v[116:119]
  ds_read_b128 v[56:59], v22 offset:40960
  s_waitcnt lgkmcnt(7)
  v_mfma_f32_16x16x32_bf16 v[120:123], v[168:171], v[60:63], v[120:123]
  v_mfma_f32_16x16x32_bf16 v[124:127], v[172:175], v[60:63], v[124:127]
  ds_read_b128 v[60:63], v23 offset:40960
  s_waitcnt lgkmcnt(7)
  v_mfma_f32_16x16x32_bf16 v[28:31], v[24:27], v[32:35], v[28:31]
  v_mfma_f32_16x16x32_bf16 v[96:99], v[176:179], v[32:35], v[96:99]
  v_mfma_f32_16x16x32_bf16 v[100:103], v[180:183], v[32:35], v[100:103]
  ds_read_b128 v[32:35], v16 offset:49152
  s_waitcnt lgkmcnt(7)
  v_mfma_f32_16x16x32_bf16 v[104:107], v[176:179], v[36:39], v[104:107]
  v_mfma_f32_16x16x32_bf16 v[108:111], v[180:183], v[36:39], v[108:111]
  ds_read_b128 v[36:39], v17 offset:49152
  s_waitcnt lgkmcnt(7)
  v_mfma_f32_16x16x32_bf16 v[112:115], v[176:179], v[40:43], v[112:115]
  v_mfma_f32_16x16x32_bf16 v[116:119], v[180:183], v[40:43], v[116:119]
  ds_read_b128 v[40:43], v18 offset:49152
  s_waitcnt lgkmcnt(7)
  v_mfma_f32_16x16x32_bf16 v[120:123], v[176:179], v[44:47], v[120:123]
  v_mfma_f32_16x16x32_bf16 v[124:127], v[180:183], v[44:47], v[124:127]
  ds_read_b128 v[44:47], v19 offset:49152
  s_waitcnt lgkmcnt(7)
  v_mfma_f32_16x16x32_bf16 v[28:31], v[24:27], v[48:51], v[28:31]
  v_mfma_f32_16x16x32_bf16 v[96:99], v[184:187], v[48:51], v[96:99]
  v_mfma_f32_16x16x32_bf16 v[100:103], v[188:191], v[48:51], v[100:103]
  ds_read_b128 v[48:51], v20 offset:49152
  s_waitcnt lgkmcnt(7)
  v_mfma_f32_16x16x32_bf16 v[104:107], v[184:187], v[52:55], v[104:107]
  v_mfma_f32_16x16x32_bf16 v[108:111], v[188:191], v[52:55], v[108:111]
  ds_read_b128 v[52:55], v21 offset:49152
  s_waitcnt lgkmcnt(7)
  v_mfma_f32_16x16x32_bf16 v[112:115], v[184:187], v[56:59], v[112:115]
  v_mfma_f32_16x16x32_bf16 v[116:119], v[188:191], v[56:59], v[116:119]
  ds_read_b128 v[56:59], v22 offset:49152
  s_waitcnt lgkmcnt(7)
  v_mfma_f32_16x16x32_bf16 v[120:123], v[184:187], v[60:63], v[120:123]
  v_mfma_f32_16x16x32_bf16 v[124:127], v[188:191], v[60:63], v[124:127]
  ds_read_b128 v[60:63], v23 offset:49152
  s_waitcnt lgkmcnt(7)
  v_mfma_f32_16x16x32_bf16 v[28:31], v[24:27], v[32:35], v[28:31]
  v_mfma_f32_16x16x32_bf16 v[96:99], v[192:195], v[32:35], v[96:99]
  v_mfma_f32_16x16x32_bf16 v[100:103], v[196:199], v[32:35], v[100:103]
  ds_read_b128 v[32:35], v16 offset:57344
  s_waitcnt lgkmcnt(7)
  v_mfma_f32_16x16x32_bf16 v[104:107], v[192:195], v[36:39], v[104:107]
  v_mfma_f32_16x16x32_bf16 v[108:111], v[196:199], v[36:39], v[108:111]
  ds_read_b128 v[36:39], v17 offset:57344
  s_waitcnt lgkmcnt(7)
  v_mfma_f32_16x16x32_bf16 v[112:115], v[192:195], v[40:43], v[112:115]
  v_mfma_f32_16x16x32_bf16 v[116:119], v[196:199], v[40:43], v[116:119]
  ds_read_b128 v[40:43], v18 offset:57344
  s_waitcnt lgkmcnt(7)
  v_mfma_f32_16x16x32_bf16 v[120:123], v[192:195], v[44:47], v[120:123]
  v_mfma_f32_16x16x32_bf16 v[124:127], v[196:199], v[44:47], v[124:127]
  ds_read_b128 v[44:47], v19 offset:57344
  s_waitcnt lgkmcnt(7)
  v_mfma_f32_16x16x32_bf16 v[28:31], v[24:27], v[48:51], v[28:31]
  v_mfma_f32_16x16x32_bf16 v[96:99], v[200:203], v[48:51], v[96:99]
  v_mfma_f32_16x16x32_bf16 v[100:103], v[204:207], v[48:51], v[100:103]
  ds_read_b128 v[48:51], v20 offset:57344
  s_waitcnt lgkmcnt(7)
  v_mfma_f32_16x16x32_bf16 v[104:107], v[200:203], v[52:55], v[104:107]
  v_mfma_f32_16x16x32_bf16 v[108:111], v[204:207], v[52:55], v[108:111]
  ds_read_b128 v[52:55], v21 offset:57344
  s_waitcnt lgkmcnt(7)
  v_mfma_f32_16x16x32_bf16 v[112:115], v[200:203], v[56:59], v[112:115]
  v_mfma_f32_16x16x32_bf16 v[116:119], v[204:207], v[56:59], v[116:119]
  ds_read_b128 v[56:59], v22 offset:57344
  s_waitcnt lgkmcnt(7)
  v_mfma_f32_16x16x32_bf16 v[120:123], v[200:203], v[60:63], v[120:123]
  v_mfma_f32_16x16x32_bf16 v[124:127], v[204:207], v[60:63], v[124:127]
  ds_read_b128 v[60:63], v23 offset:57344
  s_waitcnt lgkmcnt(7)
  v_mfma_f32_16x16x32_bf16 v[28:31], v[24:27], v[32:35], v[28:31]
  v_mfma_f32_16x16x32_bf16 v[96:99], v[208:211], v[32:35], v[96:99]
  v_mfma_f32_16x16x32_bf16 v[100:103], v[212:215], v[32:35], v[100:103]
  v_add_u32 v16, 131072, v16
  ds_read_b128 v[32:35], v16 offset:0
  s_waitcnt lgkmcnt(7)
  v_mfma_f32_16x16x32_bf16 v[104:107], v[208:211], v[36:39], v[104:107]
  v_mfma_f32_16x16x32_bf16 v[108:111], v[212:215], v[36:39], v[108:111]
  v_add_u32 v17, 131072, v17
  ds_read_b128 v[36:39], v17 offset:0
  s_waitcnt lgkmcnt(7)
  v_mfma_f32_16x16x32_bf16 v[112:115], v[208:211], v[40:43], v[112:115]
  v_mfma_f32_16x16x32_bf16 v[116:119], v[212:215], v[40:43], v[116:119]
  v_add_u32 v18, 131072, v18
  ds_read_b128 v[40:43], v18 offset:0
  s_waitcnt lgkmcnt(7)
  v_mfma_f32_16x16x32_bf16 v[120:123], v[208:211], v[44:47], v[120:123]
  v_mfma_f32_16x16x32_bf16 v[124:127], v[212:215], v[44:47], v[124:127]
  v_add_u32 v19, 131072, v19
  ds_read_b128 v[44:47], v19 offset:0
  s_waitcnt lgkmcnt(7)
  v_mfma_f32_16x16x32_bf16 v[28:31], v[24:27], v[48:51], v[28:31]
  v_mfma_f32_16x16x32_bf16 v[96:99], v[216:219], v[48:51], v[96:99]
  v_mfma_f32_16x16x32_bf16 v[100:103], v[220:223], v[48:51], v[100:103]
  v_add_u32 v20, 131072, v20
  ds_read_b128 v[48:51], v20 offset:0
  s_waitcnt lgkmcnt(7)
  v_mfma_f32_16x16x32_bf16 v[104:107], v[216:219], v[52:55], v[104:107]
  v_mfma_f32_16x16x32_bf16 v[108:111], v[220:223], v[52:55], v[108:111]
  v_add_u32 v21, 131072, v21
  ds_read_b128 v[52:55], v21 offset:0
  s_waitcnt lgkmcnt(7)
  v_mfma_f32_16x16x32_bf16 v[112:115], v[216:219], v[56:59], v[112:115]
  v_mfma_f32_16x16x32_bf16 v[116:119], v[220:223], v[56:59], v[116:119]
  v_add_u32 v22, 131072, v22
  ds_read_b128 v[56:59], v22 offset:0
  s_waitcnt lgkmcnt(7)
  v_mfma_f32_16x16x32_bf16 v[120:123], v[216:219], v[60:63], v[120:123]
  v_mfma_f32_16x16x32_bf16 v[124:127], v[220:223], v[60:63], v[124:127]
  v_add_u32 v23, 131072, v23
  ds_read_b128 v[60:63], v23 offset:0
  s_waitcnt lgkmcnt(7)
  v_mfma_f32_16x16x32_bf16 v[28:31], v[24:27], v[32:35], v[28:31]
  v_mfma_f32_16x16x32_bf16 v[96:99], v[224:227], v[32:35], v[96:99]
  v_mfma_f32_16x16x32_bf16 v[100:103], v[228:231], v[32:35], v[100:103]
  ds_read_b128 v[32:35], v16 offset:8192
  s_waitcnt lgkmcnt(7)
  v_mfma_f32_16x16x32_bf16 v[104:107], v[224:227], v[36:39], v[104:107]
  v_mfma_f32_16x16x32_bf16 v[108:111], v[228:231], v[36:39], v[108:111]
  ds_read_b128 v[36:39], v17 offset:8192
  s_waitcnt lgkmcnt(7)
  v_mfma_f32_16x16x32_bf16 v[112:115], v[224:227], v[40:43], v[112:115]
  v_mfma_f32_16x16x32_bf16 v[116:119], v[228:231], v[40:43], v[116:119]
  ds_read_b128 v[40:43], v18 offset:8192
  s_waitcnt lgkmcnt(7)
  v_mfma_f32_16x16x32_bf16 v[120:123], v[224:227], v[44:47], v[120:123]
  v_mfma_f32_16x16x32_bf16 v[124:127], v[228:231], v[44:47], v[124:127]
  ds_read_b128 v[44:47], v19 offset:8192
  s_waitcnt lgkmcnt(7)
  v_mfma_f32_16x16x32_bf16 v[28:31], v[24:27], v[48:51], v[28:31]
  v_mfma_f32_16x16x32_bf16 v[96:99], v[232:235], v[48:51], v[96:99]
  v_mfma_f32_16x16x32_bf16 v[100:103], v[236:239], v[48:51], v[100:103]
  ds_read_b128 v[48:51], v20 offset:8192
  s_waitcnt lgkmcnt(7)
  v_mfma_f32_16x16x32_bf16 v[104:107], v[232:235], v[52:55], v[104:107]
  v_mfma_f32_16x16x32_bf16 v[108:111], v[236:239], v[52:55], v[108:111]
  ds_read_b128 v[52:55], v21 offset:8192
  s_waitcnt lgkmcnt(7)
  v_mfma_f32_16x16x32_bf16 v[112:115], v[232:235], v[56:59], v[112:115]
  v_mfma_f32_16x16x32_bf16 v[116:119], v[236:239], v[56:59], v[116:119]
  ds_read_b128 v[56:59], v22 offset:8192
  s_waitcnt lgkmcnt(7)
  v_mfma_f32_16x16x32_bf16 v[120:123], v[232:235], v[60:63], v[120:123]
  v_mfma_f32_16x16x32_bf16 v[124:127], v[236:239], v[60:63], v[124:127]
  ds_read_b128 v[60:63], v23 offset:8192
  s_waitcnt lgkmcnt(7)
  v_mfma_f32_16x16x32_bf16 v[28:31], v[24:27], v[32:35], v[28:31]
  v_mfma_f32_16x16x32_bf16 v[96:99], v[240:243], v[32:35], v[96:99]
  v_mfma_f32_16x16x32_bf16 v[100:103], v[244:247], v[32:35], v[100:103]
  s_waitcnt lgkmcnt(6)
  v_mfma_f32_16x16x32_bf16 v[104:107], v[240:243], v[36:39], v[104:107]
  v_mfma_f32_16x16x32_bf16 v[108:111], v[244:247], v[36:39], v[108:111]
  s_waitcnt lgkmcnt(5)
  v_mfma_f32_16x16x32_bf16 v[112:115], v[240:243], v[40:43], v[112:115]
  v_mfma_f32_16x16x32_bf16 v[116:119], v[244:247], v[40:43], v[116:119]
  s_waitcnt lgkmcnt(4)
  v_mfma_f32_16x16x32_bf16 v[120:123], v[240:243], v[44:47], v[120:123]
  v_mfma_f32_16x16x32_bf16 v[124:127], v[244:247], v[44:47], v[124:127]
  s_waitcnt lgkmcnt(3)
  v_mfma_f32_16x16x32_bf16 v[28:31], v[24:27], v[48:51], v[28:31]
  v_mfma_f32_16x16x32_bf16 v[96:99], v[248:251], v[48:51], v[96:99]
  v_mfma_f32_16x16x32_bf16 v[100:103], v[252:255], v[48:51], v[100:103]
  s_nop 5
  ds_write_b32 v9, v28 offset:256
  v_mov_b32 v1, v28
  s_waitcnt lgkmcnt(3)
  v_mfma_f32_16x16x32_bf16 v[104:107], v[248:251], v[52:55], v[104:107]
  v_mfma_f32_16x16x32_bf16 v[108:111], v[252:255], v[52:55], v[108:111]
  s_waitcnt lgkmcnt(2)
  v_mfma_f32_16x16x32_bf16 v[112:115], v[248:251], v[56:59], v[112:115]
  v_mfma_f32_16x16x32_bf16 v[116:119], v[252:255], v[56:59], v[116:119]
  s_waitcnt lgkmcnt(1)
  v_mfma_f32_16x16x32_bf16 v[120:123], v[248:251], v[60:63], v[120:123]
  v_mov_b32 v15, 9
  ds_write_b32 v11, v15
  v_mfma_f32_16x16x32_bf16 v[124:127], v[252:255], v[60:63], v[124:127]
  ds_read_b32 v13, v10 offset:0
  s_waitcnt lgkmcnt(0)
  v_cmp_gt_u32 vcc, 68, v13
  s_cbranch_vccnz .Lsp_63
.Lrt_64:
  v_add_u32 v16, 4294836224, v16
  ds_read_b128 v[32:35], v16 offset:0
  v_add_u32 v17, 4294836224, v17
  ds_read_b128 v[36:39], v17 offset:0
  v_add_u32 v18, 4294836224, v18
  ds_read_b128 v[40:43], v18 offset:0
  v_add_u32 v19, 4294836224, v19
  ds_read_b128 v[44:47], v19 offset:0
  v_add_u32 v20, 4294836224, v20
  ds_read_b128 v[48:51], v20 offset:0
  s_waitcnt lgkmcnt(4)
  v_mfma_f32_16x16x32_bf16 v[28:31], v[24:27], v[32:35], 0
  v_add_u32 v21, 4294836224, v21
  ds_read_b128 v[52:55], v21 offset:0
  v_add_u32 v22, 4294836224, v22
  ds_read_b128 v[56:59], v22 offset:0
  v_mfma_f32_16x16x32_bf16 v[64:67], v[128:131], v[32:35], 0
  v_add_u32 v23, 4294836224, v23
  ds_read_b128 v[60:63], v23 offset:0
  v_mfma_f32_16x16x32_bf16 v[68:71], v[132:135], v[32:35], 0
  ds_read_b128 v[32:35], v16 offset:8192
  s_waitcnt lgkmcnt(7)
  v_mfma_f32_16x16x32_bf16 v[72:75], v[128:131], v[36:39], 0
  v_mfma_f32_16x16x32_bf16 v[76:79], v[132:135], v[36:39], 0
  ds_read_b128 v[36:39], v17 offset:8192
  s_waitcnt lgkmcnt(7)
  v_mfma_f32_16x16x32_bf16 v[80:83], v[128:131], v[40:43], 0
  v_mfma_f32_16x16x32_bf16 v[84:87], v[132:135], v[40:43], 0
  ds_read_b128 v[40:43], v18 offset:8192
  s_waitcnt lgkmcnt(7)
  v_mfma_f32_16x16x32_bf16 v[88:91], v[128:131], v[44:47], 0
  v_mfma_f32_16x16x32_bf16 v[92:95], v[132:135], v[44:47], 0
  ds_read_b128 v[44:47], v19 offset:8192
  s_waitcnt lgkmcnt(7)
  v_mfma_f32_16x16x32_bf16 v[28:31], v[24:27], v[48:51], v[28:31]
  v_mfma_f32_16x16x32_bf16 v[64:67], v[136:139], v[48:51], v[64:67]
  v_mfma_f32_16x16x32_bf16 v[68:71], v[140:143], v[48:51], v[68:71]
  ds_read_b128 v[48:51], v20 offset:8192
  s_waitcnt lgkmcnt(7)
  v_mfma_f32_16x16x32_bf16 v[72:75], v[136:139], v[52:55], v[72:75]
  v_mfma_f32_16x16x32_bf16 v[76:79], v[140:143], v[52:55], v[76:79]
  ds_read_b128 v[52:55], v21 offset:8192
  s_waitcnt lgkmcnt(7)
  v_mfma_f32_16x16x32_bf16 v[80:83], v[136:139], v[56:59], v[80:83]
  v_mfma_f32_16x16x32_bf16 v[84:87], v[140:143], v[56:59], v[84:87]
  ds_read_b128 v[56:59], v22 offset:8192
  s_waitcnt lgkmcnt(7)
  v_mfma_f32_16x16x32_bf16 v[88:91], v[136:139], v[60:63], v[88:91]
  v_mfma_f32_16x16x32_bf16 v[92:95], v[140:143], v[60:63], v[92:95]
  ds_read_b128 v[60:63], v23 offset:8192
  ds_read_b32 v13, v10 offset:1024
  s_waitcnt lgkmcnt(0)
  v_cmp_gt_u32 vcc, 9, v13
  s_cbranch_vccnz .Lsp_65
.Lrt_66:
  v_mfma_f32_16x16x32_bf16 v[28:31], v[24:27], v[32:35], v[28:31]
  v_mfma_f32_16x16x32_bf16 v[64:67], v[144:147], v[32:35], v[64:67]
  v_mfma_f32_16x16x32_bf16 v[68:71], v[148:151], v[32:35], v[68:71]
  v_add_u32 v16, 98304, v16
  ds_read_b128 v[32:35], v16 offset:0
  v_mfma_f32_16x16x32_bf16 v[72:75], v[144:147], v[36:39], v[72:75]
  v_mfma_f32_16x16x32_bf16 v[76:79], v[148:151], v[36:39], v[76:79]
  v_add_u32 v17, 98304, v17
  ds_read_b128 v[36:39], v17 offset:0
  v_mfma_f32_16x16x32_bf16 v[80:83], v[144:147], v[40:43], v[80:83]
  v_mfma_f32_16x16x32_bf16 v[84:87], v[148:151], v[40:43], v[84:87]
  v_add_u32 v18, 98304, v18
  ds_read_b128 v[40:43], v18 offset:0
  v_mfma_f32_16x16x32_bf16 v[88:91], v[144:147], v[44:47], v[88:91]
  v_mfma_f32_16x16x32_bf16 v[92:95], v[148:151], v[44:47], v[92:95]
  v_add_u32 v19, 98304, v19
  ds_read_b128 v[44:47], v19 offset:0
  v_mfma_f32_16x16x32_bf16 v[28:31], v[24:27], v[48:51], v[28:31]
  v_mfma_f32_16x16x32_bf16 v[64:67], v[152:155], v[48:51], v[64:67]
  v_mfma_f32_16x16x32_bf16 v[68:71], v[156:159], v[48:51], v[68:71]
  v_add_u32 v20, 98304, v20
  ds_read_b128 v[48:51], v20 offset:0
  v_mfma_f32_16x16x32_bf16 v[72:75], v[152:155], v[52:55], v[72:75]
  v_mfma_f32_16x16x32_bf16 v[76:79], v[156:159], v[52:55], v[76:79]
  v_add_u32 v21, 98304, v21
  ds_read_b128 v[52:55], v21 offset:0
  v_mfma_f32_16x16x32_bf16 v[80:83], v[152:155], v[56:59], v[80:83]
  v_mfma_f32_16x16x32_bf16 v[84:87], v[156:159], v[56:59], v[84:87]
  v_add_u32 v22, 98304, v22
  ds_read_b128 v[56:59], v22 offset:0
  v_mfma_f32_16x16x32_bf16 v[88:91], v[152:155], v[60:63], v[88:91]
  v_mfma_f32_16x16x32_bf16 v[92:95], v[156:159], v[60:63], v[92:95]
  v_add_u32 v23, 98304, v23
  ds_read_b128 v[60:63], v23 offset:0
  ds_read_b128 v[128:131], v7 offset:0
  ds_read_b128 v[136:139], v7 offset:512
  s_waitcnt lgkmcnt(9)
  v_mfma_f32_16x16x32_bf16 v[28:31], v[24:27], v[32:35], v[28:31]
  ds_read_b128 v[132:135], v7 offset:16
  ds_read_b128 v[140:143], v7 offset:528
  v_xor_b32 v3, 64, v9
  v_mfma_f32_16x16x32_bf16 v[64:67], v[160:163], v[32:35], v[64:67]
  ds_read_b32 v144, v3 offset:256
  v_xor_b32 v2, 128, v9
  ds_read_b32 v145, v2 offset:256
  v_mfma_f32_16x16x32_bf16 v[68:71], v[164:167], v[32:35], v[68:71]
  ds_read_b128 v[32:35], v16 offset:8192
  v_xor_b32 v3, 192, v9
  ds_read_b32 v146, v3 offset:256
  s_waitcnt lgkmcnt(0)
  v_mfma_f32_16x16x32_bf16 v[72:75], v[160:163], v[36:39], v[72:75]
  v_fma_f32 v96, v128, v1, v96
  v_fma_f32 v97, v129, v1, v97
  v_fma_f32 v98, v130, v1, v98
  v_mfma_f32_16x16x32_bf16 v[76:79], v[164:167], v[36:39], v[76:79]
  ds_read_b128 v[36:39], v17 offset:8192
  v_fma_f32 v99, v131, v1, v99
  v_fma_f32 v100, v132, v1, v100
  v_mfma_f32_16x16x32_bf16 v[80:83], v[160:163], v[40:43], v[80:83]
  v_fma_f32 v101, v133, v1, v101
  v_fma_f32 v102, v134, v1, v102
  v_fma_f32 v103, v135, v1, v103
  v_mfma_f32_16x16x32_bf16 v[84:87], v[164:167], v[40:43], v[84:87]
  ds_read_b128 v[40:43], v18 offset:8192
  v_mul_f32 v96, v96, v136
  v_mul_f32 v97, v97, v137
  v_mfma_f32_16x16x32_bf16 v[88:91], v[160:163], v[44:47], v[88:91]
  v_mul_f32 v98, v98, v138
  v_mul_f32 v99, v99, v139
  v_mul_f32 v100, v100, v140
  v_mfma_f32_16x16x32_bf16 v[92:95], v[164:167], v[44:47], v[92:95]
  ds_read_b128 v[44:47], v19 offset:8192
  v_mul_f32 v101, v101, v141
  v_mul_f32 v102, v102, v142
  v_mfma_f32_16x16x32_bf16 v[28:31], v[24:27], v[48:51], v[28:31]
  v_mul_f32 v103, v103, v143
  v_cvt_pk_bf16_f32 v96, v96, v97
  v_cvt_pk_bf16_f32 v97, v98, v99
  v_mfma_f32_16x16x32_bf16 v[64:67], v[168:171], v[48:51], v[64:67]
  v_cvt_pk_bf16_f32 v98, v100, v101
  v_cvt_pk_bf16_f32 v99, v102, v103
  v_mfma_f32_16x16x32_bf16 v[68:71], v[172:175], v[48:51], v[68:71]
  ds_read_b128 v[48:51], v20 offset:8192
  buffer_store_dwordx4 v[96:99], v6, s[16:19], s48 offen sc1
  v_mfma_f32_16x16x32_bf16 v[72:75], v[168:171], v[52:55], v[72:75]
  v_fma_f32 v104, v128, v144, v104
  v_fma_f32 v105, v129, v144, v105
  v_fma_f32 v106, v130, v144, v106
  v_mfma_f32_16x16x32_bf16 v[76:79], v[172:175], v[52:55], v[76:79]
  ds_read_b128 v[52:55], v21 offset:8192
  v_fma_f32 v107, v131, v144, v107
  v_fma_f32 v108, v132, v144, v108
  v_mfma_f32_16x16x32_bf16 v[80:83], v[168:171], v[56:59], v[80:83]
  v_fma_f32 v109, v133, v144, v109
  v_fma_f32 v110, v134, v144, v110
  v_fma_f32 v111, v135, v144, v111
  v_mfma_f32_16x16x32_bf16 v[84:87], v[172:175], v[56:59], v[84:87]
  ds_read_b128 v[56:59], v22 offset:8192
  v_mul_f32 v104, v104, v136
  v_mul_f32 v105, v105, v137
  v_mfma_f32_16x16x32_bf16 v[88:91], v[168:171], v[60:63], v[88:91]
  v_mul_f32 v106, v106, v138
  v_mul_f32 v107, v107, v139
  v_mul_f32 v108, v108, v140
  v_mfma_f32_16x16x32_bf16 v[92:95], v[172:175], v[60:63], v[92:95]
  ds_read_b128 v[60:63], v23 offset:8192
  v_mul_f32 v109, v109, v141
  v_mul_f32 v110, v110, v142
  v_mfma_f32_16x16x32_bf16 v[28:31], v[24:27], v[32:35], v[28:31]
  v_mul_f32 v111, v111, v143
  v_cvt_pk_bf16_f32 v104, v104, v105
  v_cvt_pk_bf16_f32 v105, v106, v107
  v_mfma_f32_16x16x32_bf16 v[64:67], v[176:179], v[32:35], v[64:67]
  v_cvt_pk_bf16_f32 v106, v108, v109
  v_cvt_pk_bf16_f32 v107, v110, v111
  v_mfma_f32_16x16x32_bf16 v[68:71], v[180:183], v[32:35], v[68:71]
  ds_read_b128 v[32:35], v16 offset:16384
  buffer_store_dwordx4 v[104:107], v6, s[16:19], s49 offen sc1
  s_waitcnt lgkmcnt(7)
  v_mfma_f32_16x16x32_bf16 v[72:75], v[176:179], v[36:39], v[72:75]
  v_fma_f32 v112, v128, v145, v112
  v_fma_f32 v113, v129, v145, v113
  v_fma_f32 v114, v130, v145, v114
  v_mfma_f32_16x16x32_bf16 v[76:79], v[180:183], v[36:39], v[76:79]
  ds_read_b128 v[36:39], v17 offset:16384
  v_fma_f32 v115, v131, v145, v115
  v_fma_f32 v116, v132, v145, v116
  s_waitcnt lgkmcnt(7)
  v_mfma_f32_16x16x32_bf16 v[80:83], v[176:179], v[40:43], v[80:83]
  v_fma_f32 v117, v133, v145, v117
  v_fma_f32 v118, v134, v145, v118
  v_fma_f32 v119, v135, v145, v119
  v_mfma_f32_16x16x32_bf16 v[84:87], v[180:183], v[40:43], v[84:87]
  ds_read_b128 v[40:43], v18 offset:16384
  v_mul_f32 v112, v112, v136
  v_mul_f32 v113, v113, v137
  s_waitcnt lgkmcnt(7)
  v_mfma_f32_16x16x32_bf16 v[88:91], v[176:179], v[44:47], v[88:91]
  v_mul_f32 v114, v114, v138
  v_mul_f32 v115, v115, v139
  v_mul_f32 v116, v116, v140
  v_mfma_f32_16x16x32_bf16 v[92:95], v[180:183], v[44:47], v[92:95]
  ds_read_b128 v[44:47], v19 offset:16384
  v_mul_f32 v117, v117, v141
  v_mul_f32 v118, v118, v142
  s_waitcnt lgkmcnt(7)
  v_mfma_f32_16x16x32_bf16 v[28:31], v[24:27], v[48:51], v[28:31]
  v_mul_f32 v119, v119, v143
  v_cvt_pk_bf16_f32 v112, v112, v113
  v_cvt_pk_bf16_f32 v113, v114, v115
  v_mfma_f32_16x16x32_bf16 v[64:67], v[184:187], v[48:51], v[64:67]
  v_cvt_pk_bf16_f32 v114, v116, v117
  v_cvt_pk_bf16_f32 v115, v118, v119
  v_mfma_f32_16x16x32_bf16 v[68:71], v[188:191], v[48:51], v[68:71]
  ds_read_b128 v[48:51], v20 offset:16384
  buffer_store_dwordx4 v[112:115], v6, s[16:19], s50 offen sc1
  s_waitcnt lgkmcnt(7)
  v_mfma_f32_16x16x32_bf16 v[72:75], v[184:187], v[52:55], v[72:75]
  v_fma_f32 v120, v128, v146, v120
  v_fma_f32 v121, v129, v146, v121
  v_fma_f32 v122, v130, v146, v122
  v_mfma_f32_16x16x32_bf16 v[76:79], v[188:191], v[52:55], v[76:79]
  ds_read_b128 v[52:55], v21 offset:16384
  v_fma_f32 v123, v131, v146, v123
  v_fma_f32 v124, v132, v146, v124
  s_waitcnt lgkmcnt(7)
  v_mfma_f32_16x16x32_bf16 v[80:83], v[184:187], v[56:59], v[80:83]
  v_fma_f32 v125, v133, v146, v125
  v_fma_f32 v126, v134, v146, v126
  v_fma_f32 v127, v135, v146, v127
  v_mfma_f32_16x16x32_bf16 v[84:87], v[188:191], v[56:59], v[84:87]
  ds_read_b128 v[56:59], v22 offset:16384
  v_mul_f32 v120, v120, v136
  v_mul_f32 v121, v121, v137
  s_waitcnt lgkmcnt(7)
  v_mfma_f32_16x16x32_bf16 v[88:91], v[184:187], v[60:63], v[88:91]
  v_mul_f32 v122, v122, v138
  v_mul_f32 v123, v123, v139
  v_mul_f32 v124, v124, v140
  v_mfma_f32_16x16x32_bf16 v[92:95], v[188:191], v[60:63], v[92:95]
  ds_read_b128 v[60:63], v23 offset:16384
  v_mul_f32 v125, v125, v141
  v_mul_f32 v126, v126, v142
  s_waitcnt lgkmcnt(7)
  v_mfma_f32_16x16x32_bf16 v[28:31], v[24:27], v[32:35], v[28:31]
  v_mul_f32 v127, v127, v143
  v_cvt_pk_bf16_f32 v120, v120, v121
  v_cvt_pk_bf16_f32 v121, v122, v123
  v_mfma_f32_16x16x32_bf16 v[64:67], v[192:195], v[32:35], v[64:67]
  v_cvt_pk_bf16_f32 v122, v124, v125
  v_cvt_pk_bf16_f32 v123, v126, v127
  v_mfma_f32_16x16x32_bf16 v[68:71], v[196:199], v[32:35], v[68:71]
  ds_read_b128 v[32:35], v16 offset:24576
  buffer_store_dwordx4 v[120:123], v6, s[16:19], s51 offen sc1
  s_waitcnt lgkmcnt(7)
  v_mfma_f32_16x16x32_bf16 v[72:75], v[192:195], v[36:39], v[72:75]
  v_mfma_f32_16x16x32_bf16 v[76:79], v[196:199], v[36:39], v[76:79]
  ds_read_b128 v[36:39], v17 offset:24576
  s_waitcnt lgkmcnt(7)
  v_mfma_f32_16x16x32_bf16 v[80:83], v[192:195], v[40:43], v[80:83]
  v_mfma_f32_16x16x32_bf16 v[84:87], v[196:199], v[40:43], v[84:87]
  ds_read_b128 v[40:43], v18 offset:24576
  s_waitcnt lgkmcnt(7)
  v_mfma_f32_16x16x32_bf16 v[88:91], v[192:195], v[44:47], v[88:91]
  v_mfma_f32_16x16x32_bf16 v[92:95], v[196:199], v[44:47], v[92:95]
  ds_read_b128 v[44:47], v19 offset:24576
  s_waitcnt lgkmcnt(7)
  v_mfma_f32_16x16x32_bf16 v[28:31], v[24:27], v[48:51], v[28:31]
  v_mfma_f32_16x16x32_bf16 v[64:67], v[200:203], v[48:51], v[64:67]
  v_mfma_f32_16x16x32_bf16 v[68:71], v[204:207], v[48:51], v[68:71]
  ds_read_b128 v[48:51], v20 offset:24576
  s_waitcnt lgkmcnt(7)
  v_mfma_f32_16x16x32_bf16 v[72:75], v[200:203], v[52:55], v[72:75]
  v_mfma_f32_16x16x32_bf16 v[76:79], v[204:207], v[52:55], v[76:79]
  ds_read_b128 v[52:55], v21 offset:24576
  s_waitcnt lgkmcnt(7)
  v_mfma_f32_16x16x32_bf16 v[80:83], v[200:203], v[56:59], v[80:83]
  v_mfma_f32_16x16x32_bf16 v[84:87], v[204:207], v[56:59], v[84:87]
  ds_read_b128 v[56:59], v22 offset:24576
  s_waitcnt lgkmcnt(7)
  v_mfma_f32_16x16x32_bf16 v[88:91], v[200:203], v[60:63], v[88:91]
  v_mfma_f32_16x16x32_bf16 v[92:95], v[204:207], v[60:63], v[92:95]
  ds_read_b128 v[60:63], v23 offset:24576
  s_waitcnt lgkmcnt(7)
  v_mfma_f32_16x16x32_bf16 v[28:31], v[24:27], v[32:35], v[28:31]
  v_mfma_f32_16x16x32_bf16 v[64:67], v[208:211], v[32:35], v[64:67]
  v_mfma_f32_16x16x32_bf16 v[68:71], v[212:215], v[32:35], v[68:71]
  v_add_u32 v16, 4294934528, v16
  ds_read_b128 v[32:35], v16 offset:0
  s_waitcnt lgkmcnt(7)
  v_mfma_f32_16x16x32_bf16 v[72:75], v[208:211], v[36:39], v[72:75]
  v_mfma_f32_16x16x32_bf16 v[76:79], v[212:215], v[36:39], v[76:79]
  v_add_u32 v17, 4294934528, v17
  ds_read_b128 v[36:39], v17 offset:0
  s_waitcnt lgkmcnt(7)
  v_mfma_f32_16x16x32_bf16 v[80:83], v[208:211], v[40:43], v[80:83]
  v_mfma_f32_16x16x32_bf16 v[84:87], v[212:215], v[40:43], v[84:87]
  v_add_u32 v18, 4294934528, v18
  ds_read_b128 v[40:43], v18 offset:0
  s_waitcnt lgkmcnt(7)
  v_mfma_f32_16x16x32_bf16 v[88:91], v[208:211], v[44:47], v[88:91]
  v_mfma_f32_16x16x32_bf16 v[92:95], v[212:215], v[44:47], v[92:95]
  v_add_u32 v19, 4294934528, v19
  ds_read_b128 v[44:47], v19 offset:0
  s_waitcnt lgkmcnt(7)
  v_mfma_f32_16x16x32_bf16 v[28:31], v[24:27], v[48:51], v[28:31]
  v_mfma_f32_16x16x32_bf16 v[64:67], v[216:219], v[48:51], v[64:67]
  v_mfma_f32_16x16x32_bf16 v[68:71], v[220:223], v[48:51], v[68:71]
  v_add_u32 v20, 4294934528, v20
  ds_read_b128 v[48:51], v20 offset:0
  s_waitcnt lgkmcnt(7)
  v_mfma_f32_16x16x32_bf16 v[72:75], v[216:219], v[52:55], v[72:75]
  v_mfma_f32_16x16x32_bf16 v[76:79], v[220:223], v[52:55], v[76:79]
  v_add_u32 v21, 4294934528, v21
  ds_read_b128 v[52:55], v21 offset:0
  s_waitcnt lgkmcnt(7)
  v_mfma_f32_16x16x32_bf16 v[80:83], v[216:219], v[56:59], v[80:83]
  v_mfma_f32_16x16x32_bf16 v[84:87], v[220:223], v[56:59], v[84:87]
  v_add_u32 v22, 4294934528, v22
  ds_read_b128 v[56:59], v22 offset:0
  s_waitcnt lgkmcnt(7)
  v_mfma_f32_16x16x32_bf16 v[88:91], v[216:219], v[60:63], v[88:91]
  v_mfma_f32_16x16x32_bf16 v[92:95], v[220:223], v[60:63], v[92:95]
  v_add_u32 v23, 4294934528, v23
  ds_read_b128 v[60:63], v23 offset:0
  s_waitcnt lgkmcnt(7)
  v_mfma_f32_16x16x32_bf16 v[28:31], v[24:27], v[32:35], v[28:31]
  v_mfma_f32_16x16x32_bf16 v[64:67], v[224:227], v[32:35], v[64:67]
  v_mfma_f32_16x16x32_bf16 v[68:71], v[228:231], v[32:35], v[68:71]
  ds_read_b128 v[32:35], v16 offset:8192
  s_waitcnt lgkmcnt(7)
  v_mfma_f32_16x16x32_bf16 v[72:75], v[224:227], v[36:39], v[72:75]
  v_mfma_f32_16x16x32_bf16 v[76:79], v[228:231], v[36:39], v[76:79]
  ds_read_b128 v[36:39], v17 offset:8192
  s_waitcnt lgkmcnt(7)
  v_mfma_f32_16x16x32_bf16 v[80:83], v[224:227], v[40:43], v[80:83]
  v_mfma_f32_16x16x32_bf16 v[84:87], v[228:231], v[40:43], v[84:87]
  ds_read_b128 v[40:43], v18 offset:8192
  s_waitcnt lgkmcnt(7)
  v_mfma_f32_16x16x32_bf16 v[88:91], v[224:227], v[44:47], v[88:91]
  v_mfma_f32_16x16x32_bf16 v[92:95], v[228:231], v[44:47], v[92:95]
  ds_read_b128 v[44:47], v19 offset:8192
  s_waitcnt lgkmcnt(7)
  v_mfma_f32_16x16x32_bf16 v[28:31], v[24:27], v[48:51], v[28:31]
  v_mfma_f32_16x16x32_bf16 v[64:67], v[232:235], v[48:51], v[64:67]
  v_mfma_f32_16x16x32_bf16 v[68:71], v[236:239], v[48:51], v[68:71]
  ds_read_b128 v[48:51], v20 offset:8192
  s_waitcnt lgkmcnt(7)
  v_mfma_f32_16x16x32_bf16 v[72:75], v[232:235], v[52:55], v[72:75]
  v_mfma_f32_16x16x32_bf16 v[76:79], v[236:239], v[52:55], v[76:79]
  ds_read_b128 v[52:55], v21 offset:8192
  s_waitcnt lgkmcnt(7)
  v_mfma_f32_16x16x32_bf16 v[80:83], v[232:235], v[56:59], v[80:83]
  v_mfma_f32_16x16x32_bf16 v[84:87], v[236:239], v[56:59], v[84:87]
  ds_read_b128 v[56:59], v22 offset:8192
  s_waitcnt lgkmcnt(7)
  v_mfma_f32_16x16x32_bf16 v[88:91], v[232:235], v[60:63], v[88:91]
  v_mfma_f32_16x16x32_bf16 v[92:95], v[236:239], v[60:63], v[92:95]
  ds_read_b128 v[60:63], v23 offset:8192
  s_waitcnt lgkmcnt(7)
  v_mfma_f32_16x16x32_bf16 v[28:31], v[24:27], v[32:35], v[28:31]
  v_mfma_f32_16x16x32_bf16 v[64:67], v[240:243], v[32:35], v[64:67]
  v_mfma_f32_16x16x32_bf16 v[68:71], v[244:247], v[32:35], v[68:71]
  s_waitcnt lgkmcnt(6)
  v_mfma_f32_16x16x32_bf16 v[72:75], v[240:243], v[36:39], v[72:75]
  v_mfma_f32_16x16x32_bf16 v[76:79], v[244:247], v[36:39], v[76:79]
  s_waitcnt lgkmcnt(5)
  v_mfma_f32_16x16x32_bf16 v[80:83], v[240:243], v[40:43], v[80:83]
  v_mfma_f32_16x16x32_bf16 v[84:87], v[244:247], v[40:43], v[84:87]
  s_waitcnt lgkmcnt(4)
  v_mfma_f32_16x16x32_bf16 v[88:91], v[240:243], v[44:47], v[88:91]
  v_mfma_f32_16x16x32_bf16 v[92:95], v[244:247], v[44:47], v[92:95]
  s_waitcnt lgkmcnt(3)
  v_mfma_f32_16x16x32_bf16 v[28:31], v[24:27], v[48:51], v[28:31]
  v_mfma_f32_16x16x32_bf16 v[64:67], v[248:251], v[48:51], v[64:67]
  v_mfma_f32_16x16x32_bf16 v[68:71], v[252:255], v[48:51], v[68:71]
  s_nop 5
  ds_write_b32 v9, v28 offset:512
  v_mov_b32 v1, v28
  s_waitcnt lgkmcnt(3)
  v_mfma_f32_16x16x32_bf16 v[72:75], v[248:251], v[52:55], v[72:75]
  v_mfma_f32_16x16x32_bf16 v[76:79], v[252:255], v[52:55], v[76:79]
  s_waitcnt lgkmcnt(2)
  v_mfma_f32_16x16x32_bf16 v[80:83], v[248:251], v[56:59], v[80:83]
  v_mfma_f32_16x16x32_bf16 v[84:87], v[252:255], v[56:59], v[84:87]
  s_waitcnt lgkmcnt(1)
  v_mfma_f32_16x16x32_bf16 v[88:91], v[248:251], v[60:63], v[88:91]
  v_mov_b32 v15, 16
  ds_write_b32 v11, v15
  v_mfma_f32_16x16x32_bf16 v[92:95], v[252:255], v[60:63], v[92:95]
  ds_read_b32 v13, v10 offset:1024
  s_waitcnt lgkmcnt(0)
  v_cmp_gt_u32 vcc, 16, v13
  s_cbranch_vccnz .Lsp_67
.Lrt_68:
  v_xor_b32 v3, 64, v9
  ds_read_b32 v144, v3 offset:512
  v_xor_b32 v2, 128, v9
  ds_read_b32 v145, v2 offset:512
  v_xor_b32 v3, 192, v9
  ds_read_b32 v146, v3 offset:512
  s_waitcnt lgkmcnt(0)
  v_fma_f32 v64, v128, v1, v64
  v_fma_f32 v65, v129, v1, v65
  v_fma_f32 v66, v130, v1, v66
  v_fma_f32 v67, v131, v1, v67
  v_fma_f32 v68, v132, v1, v68
  v_fma_f32 v69, v133, v1, v69
  v_fma_f32 v70, v134, v1, v70
  v_fma_f32 v71, v135, v1, v71
  v_mul_f32 v64, v64, v136
  v_mul_f32 v65, v65, v137
  v_mul_f32 v66, v66, v138
  v_mul_f32 v67, v67, v139
  v_mul_f32 v68, v68, v140
  v_mul_f32 v69, v69, v141
  v_mul_f32 v70, v70, v142
  v_mul_f32 v71, v71, v143
  v_cvt_pk_bf16_f32 v64, v64, v65
  v_cvt_pk_bf16_f32 v65, v66, v67
  v_cvt_pk_bf16_f32 v66, v68, v69
  v_cvt_pk_bf16_f32 v67, v70, v71
  s_add_u32 s48, s48, 8192
  buffer_store_dwordx4 v[64:67], v6, s[16:19], s48 offen sc1
  v_fma_f32 v72, v128, v144, v72
  v_fma_f32 v73, v129, v144, v73
  v_fma_f32 v74, v130, v144, v74
  v_fma_f32 v75, v131, v144, v75
  v_fma_f32 v76, v132, v144, v76
  v_fma_f32 v77, v133, v144, v77
  v_fma_f32 v78, v134, v144, v78
  v_fma_f32 v79, v135, v144, v79
  v_mul_f32 v72, v72, v136
  v_mul_f32 v73, v73, v137
  v_mul_f32 v74, v74, v138
  v_mul_f32 v75, v75, v139
  v_mul_f32 v76, v76, v140
  v_mul_f32 v77, v77, v141
  v_mul_f32 v78, v78, v142
  v_mul_f32 v79, v79, v143
  v_cvt_pk_bf16_f32 v72, v72, v73
  v_cvt_pk_bf16_f32 v73, v74, v75
  v_cvt_pk_bf16_f32 v74, v76, v77
  v_cvt_pk_bf16_f32 v75, v78, v79
  s_add_u32 s49, s49, 8192
  buffer_store_dwordx4 v[72:75], v6, s[16:19], s49 offen sc1
  v_fma_f32 v80, v128, v145, v80
  v_fma_f32 v81, v129, v145, v81
  v_fma_f32 v82, v130, v145, v82
  v_fma_f32 v83, v131, v145, v83
  v_fma_f32 v84, v132, v145, v84
  v_fma_f32 v85, v133, v145, v85
  v_fma_f32 v86, v134, v145, v86
  v_fma_f32 v87, v135, v145, v87
  v_mul_f32 v80, v80, v136
  v_mul_f32 v81, v81, v137
  v_mul_f32 v82, v82, v138
  v_mul_f32 v83, v83, v139
  v_mul_f32 v84, v84, v140
  v_mul_f32 v85, v85, v141
  v_mul_f32 v86, v86, v142
  v_mul_f32 v87, v87, v143
  v_cvt_pk_bf16_f32 v80, v80, v81
  v_cvt_pk_bf16_f32 v81, v82, v83
  v_cvt_pk_bf16_f32 v82, v84, v85
  v_cvt_pk_bf16_f32 v83, v86, v87
  s_add_u32 s50, s50, 8192
  buffer_store_dwordx4 v[80:83], v6, s[16:19], s50 offen sc1
  v_fma_f32 v88, v128, v146, v88
  v_fma_f32 v89, v129, v146, v89
  v_fma_f32 v90, v130, v146, v90
  v_fma_f32 v91, v131, v146, v91
  v_fma_f32 v92, v132, v146, v92
  v_fma_f32 v93, v133, v146, v93
  v_fma_f32 v94, v134, v146, v94
  v_fma_f32 v95, v135, v146, v95
  v_mul_f32 v88, v88, v136
  v_mul_f32 v89, v89, v137
  v_mul_f32 v90, v90, v138
  v_mul_f32 v91, v91, v139
  v_mul_f32 v92, v92, v140
  v_mul_f32 v93, v93, v141
  v_mul_f32 v94, v94, v142
  v_mul_f32 v95, v95, v143
  v_cvt_pk_bf16_f32 v88, v88, v89
  v_cvt_pk_bf16_f32 v89, v90, v91
  v_cvt_pk_bf16_f32 v90, v92, v93
  v_cvt_pk_bf16_f32 v91, v94, v95
  s_add_u32 s51, s51, 8192
  buffer_store_dwordx4 v[88:91], v6, s[16:19], s51 offen sc1
  s_waitcnt vmcnt(0)
  s_mov_b64 exec, 1
  buffer_store_dword v12, off, s[16:19], s56 sc1
  buffer_store_dword v12, off, s[16:19], s56 offset:2048 sc1
  s_mov_b64 exec, -1
.Lc_abfl7_y:
  v_mov_b32 v15, 1
  ds_write_b32 v11, v15 offset:9216
  s_and_b32 s76, s2, 1
  s_lshl_b32 s76, s76, 3
  s_lshr_b32 s3, s2, 5
  s_add_u32 s76, s76, s3
  s_bfe_u32 s60, s2, 131075
  s_bfe_u32 s77, s2, 65537
  s_lshl2_add_u32 s77, s77, s60
  s_lshl_b32 s60, s60, 3
  s_lshl_b32 s60, s77, 1
  s_lshr_b32 s3, s75, 1
  s_add_u32 s60, s60, s3
  s_lshl_b32 s60, s60, 8
  s_add_u32 s60, s60, 17301504
  v_lshlrev_b32 v184, 2, v0
  ds_read_b32 v13, v10 offset:0
  s_waitcnt lgkmcnt(0)
  v_cmp_gt_u32 vcc, 104, v13
  s_cbranch_vccnz .Lsp_69
.Lrt_70:
  buffer_load_dword v184, v184, s[16:19], s60 offen sc1
  s_waitcnt vmcnt(0) lgkmcnt(0)
  v_lshlrev_b32 v23, 4, v0
  s_branch .Lc_p1end_y
.Lsp_107:
  ds_read_b32 v13, v10 offset:1024
  s_cmp_eq_u32 s74, 0
  s_waitcnt lgkmcnt(0)
  s_cbranch_scc1 .Lrt_108
  s_sub_u32 s74, s74, 1
  v_cmp_gt_u32 vcc, 16, v13
  s_cbranch_vccnz .Lsp_107
  s_branch .Lrt_108
.Lsp_109:
  s_getreg_b32 s3, hwreg(HW_REG_IB_STS)
  s_bfe_u32 s79, s3, 131094
  s_and_b32 s3, s3, 15
  s_lshl4_add_u32 s3, s79, s3
  s_sub_u32 s3, 88, s3
  v_mov_b32 v13, s3
  ds_write_b32 v11, v13
  ds_read_b32 v12, v10 offset:1024
  s_cmp_eq_u32 s74, 0
  s_waitcnt lgkmcnt(0)
  s_cbranch_scc1 .Lrt_110
  s_sub_u32 s74, s74, 1
  v_cmp_gt_u32 vcc, 10, v12
  s_cbranch_vccnz .Lsp_109
  s_branch .Lrt_110
.Lsp_111:
  s_getreg_b32 s3, hwreg(HW_REG_IB_STS)
  s_bfe_u32 s79, s3, 131094
  s_and_b32 s3, s3, 15
  s_lshl4_add_u32 s3, s79, s3
  s_sub_u32 s3, 92, s3
  v_mov_b32 v13, s3
  ds_write_b32 v11, v13
  ds_read_b32 v12, v10 offset:1024
  s_cmp_eq_u32 s74, 0
  s_waitcnt lgkmcnt(0)
  s_cbranch_scc1 .Lrt_112
  s_sub_u32 s74, s74, 1
  v_cmp_gt_u32 vcc, 11, v12
  s_cbranch_vccnz .Lsp_111
  s_branch .Lrt_112
.Lsp_113:
  s_getreg_b32 s3, hwreg(HW_REG_IB_STS)
  s_bfe_u32 s79, s3, 131094
  s_and_b32 s3, s3, 15
  s_lshl4_add_u32 s3, s79, s3
  s_sub_u32 s3, 96, s3
  v_mov_b32 v13, s3
  ds_write_b32 v11, v13
  ds_read_b32 v12, v10 offset:1024
  s_cmp_eq_u32 s74, 0
  s_waitcnt lgkmcnt(0)
  s_cbranch_scc1 .Lrt_114
  s_sub_u32 s74, s74, 1
  v_cmp_gt_u32 vcc, 12, v12
  s_cbranch_vccnz .Lsp_113
  s_branch .Lrt_114
.Lsp_115:
  s_getreg_b32 s3, hwreg(HW_REG_IB_STS)
  s_bfe_u32 s79, s3, 131094
  s_and_b32 s3, s3, 15
  s_lshl4_add_u32 s3, s79, s3
  s_sub_u32 s3, 100, s3
  v_mov_b32 v13, s3
  ds_write_b32 v11, v13
  ds_read_b32 v12, v10 offset:1024
  s_cmp_eq_u32 s74, 0
  s_waitcnt lgkmcnt(0)
  s_cbranch_scc1 .Lrt_116
  s_sub_u32 s74, s74, 1
  v_cmp_gt_u32 vcc, 13, v12
  s_cbranch_vccnz .Lsp_115
  s_branch .Lrt_116
.Lsp_117:
  s_getreg_b32 s3, hwreg(HW_REG_IB_STS)
  s_bfe_u32 s79, s3, 131094
  s_and_b32 s3, s3, 15
  s_lshl4_add_u32 s3, s79, s3
  s_sub_u32 s3, 104, s3
  v_mov_b32 v13, s3
  ds_write_b32 v11, v13
  ds_read_b32 v12, v10 offset:1024
  s_cmp_eq_u32 s74, 0
  s_waitcnt lgkmcnt(0)
  s_cbranch_scc1 .Lrt_118
  s_sub_u32 s74, s74, 1
  v_cmp_gt_u32 vcc, 14, v12
  s_cbranch_vccnz .Lsp_117
  s_branch .Lrt_118
.Lsp_119:
  s_getreg_b32 s3, hwreg(HW_REG_IB_STS)
  s_bfe_u32 s79, s3, 131094
  s_and_b32 s3, s3, 15
  s_lshl4_add_u32 s3, s79, s3
  s_sub_u32 s3, 108, s3
  v_mov_b32 v13, s3
  ds_write_b32 v11, v13
  ds_read_b32 v12, v10 offset:1024
  s_cmp_eq_u32 s74, 0
  s_waitcnt lgkmcnt(0)
  s_cbranch_scc1 .Lrt_120
  s_sub_u32 s74, s74, 1
  v_cmp_gt_u32 vcc, 15, v12
  s_cbranch_vccnz .Lsp_119
  s_branch .Lrt_120
.Lsp_121:
  s_getreg_b32 s3, hwreg(HW_REG_IB_STS)
  s_bfe_u32 s79, s3, 131094
  s_and_b32 s3, s3, 15
  s_lshl4_add_u32 s3, s79, s3
  s_sub_u32 s3, 112, s3
  v_mov_b32 v13, s3
  ds_write_b32 v11, v13
  ds_read_b32 v12, v10 offset:2048
  s_cmp_eq_u32 s74, 0
  s_waitcnt lgkmcnt(0)
  s_cbranch_scc1 .Lrt_122
  s_sub_u32 s74, s74, 1
  v_cmp_gt_u32 vcc, 4, v12
  s_cbranch_vccnz .Lsp_121
  s_branch .Lrt_122
.Lh_tch_y:
  s_getreg_b32 s3, hwreg(HW_REG_IB_STS)
  s_bfe_u32 s79, s3, 131094
  s_and_b32 s3, s3, 15
  s_lshl4_add_u32 s3, s79, s3
  s_sub_u32 s3, 68, s3
  v_mov_b32 v13, s3
  ds_write_b32 v11, v13
  s_cmp_eq_u32 s3, 68
  s_cbranch_scc0 .Lh_tch_y
  v_mov_b32 v13, 88
  ds_write_b32 v11, v13
  v_mov_b32 v13, 4
  ds_write_b32 v11, v13 offset:2048
  v_lshrrev_b32 v1, 2, v0
  v_and_b32 v2, 3, v0
  v_lshlrev_b32 v2, 7, v2
  v_lshl_add_u32 v1, v1, 12, v2
  s_lshr_b32 s3, s2, 6
  s_lshl2_add_u32 s3, s3, s75
  s_and_b32 s64, s2, 1
  s_lshl_b32 s64, s64, 4
  s_add_u32 s64, s64, s3
  s_lshl_b32 s64, s64, 18
  s_and_b32 s65, s2, 3
  s_lshl_b32 s65, s65, 4
  s_add_u32 s65, s65, s3
  s_lshl_b32 s65, s65, 17
.Lh_tchi_y:
  s_waitcnt vmcnt(0) lgkmcnt(0)
.Lh_tche_y:
  s_branch .Lh_tjoin_y
.Lsp_123:
  s_getreg_b32 s3, hwreg(HW_REG_IB_STS)
  s_bfe_u32 s79, s3, 131094
  s_and_b32 s3, s3, 15
  s_lshl4_add_u32 s3, s79, s3
  s_sub_u32 s3, 216, s3
  v_mov_b32 v13, s3
  ds_write_b32 v11, v13
  ds_read_b32 v12, v10 offset:1024
  s_cmp_eq_u32 s74, 0
  s_waitcnt lgkmcnt(0)
  s_cbranch_scc1 .Lrt_124
  s_sub_u32 s74, s74, 1
  v_cmp_gt_u32 vcc, 16, v12
  s_cbranch_vccnz .Lsp_123
  s_branch .Lrt_124
.Lsp_125:
  s_getreg_b32 s3, hwreg(HW_REG_IB_STS)
  s_bfe_u32 s79, s3, 131094
  s_and_b32 s3, s3, 15
  s_lshl4_add_u32 s3, s79, s3
  s_sub_u32 s3, 220, s3
  v_mov_b32 v13, s3
  ds_write_b32 v11, v13
  ds_read_b32 v12, v10 offset:1024
  s_cmp_eq_u32 s74, 0
  s_waitcnt lgkmcnt(0)
  s_cbranch_scc1 .Lrt_126
  s_sub_u32 s74, s74, 1
  v_cmp_gt_u32 vcc, 41, v12
  s_cbranch_vccnz .Lsp_125
  s_branch .Lrt_126
.Lsp_127:
  s_getreg_b32 s3, hwreg(HW_REG_IB_STS)
  s_bfe_u32 s79, s3, 131094
  s_and_b32 s3, s3, 15
  s_lshl4_add_u32 s3, s79, s3
  s_sub_u32 s3, 224, s3
  v_mov_b32 v13, s3
  ds_write_b32 v11, v13
  ds_read_b32 v12, v10 offset:1024
  s_cmp_eq_u32 s74, 0
  s_waitcnt lgkmcnt(0)
  s_cbranch_scc1 .Lrt_128
  s_sub_u32 s74, s74, 1
  v_cmp_gt_u32 vcc, 42, v12
  s_cbranch_vccnz .Lsp_127
  s_branch .Lrt_128
.Lsp_129:
  s_getreg_b32 s3, hwreg(HW_REG_IB_STS)
  s_bfe_u32 s79, s3, 131094
  s_and_b32 s3, s3, 15
  s_lshl4_add_u32 s3, s79, s3
  s_sub_u32 s3, 228, s3
  v_mov_b32 v13, s3
  ds_write_b32 v11, v13
  ds_read_b32 v12, v10 offset:1024
  s_cmp_eq_u32 s74, 0
  s_waitcnt lgkmcnt(0)
  s_cbranch_scc1 .Lrt_130
  s_sub_u32 s74, s74, 1
  v_cmp_gt_u32 vcc, 43, v12
  s_cbranch_vccnz .Lsp_129
  s_branch .Lrt_130
.Lsp_131:
  s_getreg_b32 s3, hwreg(HW_REG_IB_STS)
  s_bfe_u32 s79, s3, 131094
  s_and_b32 s3, s3, 15
  s_lshl4_add_u32 s3, s79, s3
  s_sub_u32 s3, 232, s3
  v_mov_b32 v13, s3
  ds_write_b32 v11, v13
  ds_read_b32 v12, v10 offset:1024
  s_cmp_eq_u32 s74, 0
  s_waitcnt lgkmcnt(0)
  s_cbranch_scc1 .Lrt_132
  s_sub_u32 s74, s74, 1
  v_cmp_gt_u32 vcc, 44, v12
  s_cbranch_vccnz .Lsp_131
  s_branch .Lrt_132
.Lsp_133:
  s_getreg_b32 s3, hwreg(HW_REG_IB_STS)
  s_bfe_u32 s79, s3, 131094
  s_and_b32 s3, s3, 15
  s_lshl4_add_u32 s3, s79, s3
  s_sub_u32 s3, 236, s3
  v_mov_b32 v13, s3
  ds_write_b32 v11, v13
  ds_read_b32 v12, v10 offset:1024
  s_cmp_eq_u32 s74, 0
  s_waitcnt lgkmcnt(0)
  s_cbranch_scc1 .Lrt_134
  s_sub_u32 s74, s74, 1
  v_cmp_gt_u32 vcc, 45, v12
  s_cbranch_vccnz .Lsp_133
  s_branch .Lrt_134
.Lsp_135:
  s_getreg_b32 s3, hwreg(HW_REG_IB_STS)
  s_bfe_u32 s79, s3, 131094
  s_and_b32 s3, s3, 15
  s_lshl4_add_u32 s3, s79, s3
  s_sub_u32 s3, 240, s3
  v_mov_b32 v13, s3
  ds_write_b32 v11, v13
  ds_read_b32 v12, v10 offset:1024
  s_cmp_eq_u32 s74, 0
  s_waitcnt lgkmcnt(0)
  s_cbranch_scc1 .Lrt_136
  s_sub_u32 s74, s74, 1
  v_cmp_gt_u32 vcc, 46, v12
  s_cbranch_vccnz .Lsp_135
  s_branch .Lrt_136
.Lc2_fl_y:
  s_sleep 0
  buffer_load_dword v31, v25, s[16:19], s60 offen sc1
  s_cmp_eq_u32 s74, 0
  s_waitcnt vmcnt(0)
  s_cbranch_scc1 .Lc2_go_y
  s_sub_u32 s74, s74, 16
  s_max_i32 s74, s74, 0
  v_cmp_ne_u32 vcc, s73, v31
  s_nop 1
  s_and_b32 s3, vcc_lo, 0xFFFF
  s_cbranch_scc1 .Lc2_fl_y
  s_branch .Lc2_go_y
.Lsp_137:
  ds_read_b32 v13, v10 offset:0
  s_cmp_eq_u32 s74, 0
  s_waitcnt lgkmcnt(0)
  s_cbranch_scc1 .Lrt_138
  s_sub_u32 s74, s74, 1
  v_cmp_gt_u32 vcc, s52, v13
  s_cbranch_vccnz .Lsp_137
  s_branch .Lrt_138
.Lsp_157:
  ds_read_b32 v13, v10 offset:0
  s_cmp_eq_u32 s74, 0
  s_waitcnt lgkmcnt(0)
  s_cbranch_scc1 .Lrt_158
  s_sub_u32 s74, s74, 1
  v_cmp_gt_u32 vcc, s52, v13
  s_cbranch_vccnz .Lsp_157
  s_branch .Lrt_158
.Lsp_159:
  ds_read_b32 v13, v10 offset:0
  s_cmp_eq_u32 s74, 0
  s_waitcnt lgkmcnt(0)
  s_cbranch_scc1 .Lrt_160
  s_sub_u32 s74, s74, 1
  v_cmp_gt_u32 vcc, s52, v13
  s_cbranch_vccnz .Lsp_159
  s_branch .Lrt_160
.Lsp_161:
  ds_read_b32 v13, v10 offset:0
  s_cmp_eq_u32 s74, 0
  s_waitcnt lgkmcnt(0)
  s_cbranch_scc1 .Lrt_162
  s_sub_u32 s74, s74, 1
  v_cmp_gt_u32 vcc, s52, v13
  s_cbranch_vccnz .Lsp_161
  s_branch .Lrt_162
.Lsp_163:
  ds_read_b32 v13, v10 offset:0
  s_cmp_eq_u32 s74, 0
  s_waitcnt lgkmcnt(0)
  s_cbranch_scc1 .Lrt_164
  s_sub_u32 s74, s74, 1
  v_cmp_gt_u32 vcc, s52, v13
  s_cbranch_vccnz .Lsp_163
  s_branch .Lrt_164
.Lsp_165:
  buffer_load_dword v31, v25, s[16:19], s60 offen sc1
  s_cmp_eq_u32 s74, 0
  s_waitcnt vmcnt(0)
  s_cbranch_scc1 .Lrt_166
  s_sub_u32 s74, s74, 16
  s_max_i32 s74, s74, 0
  v_cmp_ne_u32 vcc, s73, v31
  s_cbranch_vccnz .Lsp_165
  s_branch .Lrt_166
.Lsp_167:
  ds_read_b32 v13, v10 offset:0
  s_cmp_eq_u32 s74, 0
  s_waitcnt lgkmcnt(0)
  s_cbranch_scc1 .Lrt_168
  s_sub_u32 s74, s74, 1
  v_cmp_gt_u32 vcc, s52, v13
  s_cbranch_vccnz .Lsp_167
  s_branch .Lrt_168
.Lsp_169:
  ds_read_b32 v13, v10 offset:0
  s_cmp_eq_u32 s74, 0
  s_waitcnt lgkmcnt(0)
  s_cbranch_scc1 .Lrt_170
  s_sub_u32 s74, s74, 1
  v_cmp_gt_u32 vcc, s52, v13
  s_cbranch_vccnz .Lsp_169
  s_branch .Lrt_170
.Lsp_171:
  ds_read_b32 v13, v10 offset:0
  s_cmp_eq_u32 s74, 0
  s_waitcnt lgkmcnt(0)
  s_cbranch_scc1 .Lrt_172
  s_sub_u32 s74, s74, 1
  v_cmp_gt_u32 vcc, s52, v13
  s_cbranch_vccnz .Lsp_171
  s_branch .Lrt_172
.Lsp_173:
  ds_read_b32 v13, v10 offset:0
  s_cmp_eq_u32 s74, 0
  s_waitcnt lgkmcnt(0)
  s_cbranch_scc1 .Lrt_174
  s_sub_u32 s74, s74, 1
  v_cmp_gt_u32 vcc, s52, v13
  s_cbranch_vccnz .Lsp_173
  s_branch .Lrt_174
.Lsp_193:
  ds_read_b32 v13, v10 offset:0
  s_cmp_eq_u32 s74, 0
  s_waitcnt lgkmcnt(0)
  s_cbranch_scc1 .Lrt_194
  s_sub_u32 s74, s74, 1
  v_cmp_gt_u32 vcc, s52, v13
  s_cbranch_vccnz .Lsp_193
  s_branch .Lrt_194
.Lsp_195:
  ds_read_b32 v13, v10 offset:0
  s_cmp_eq_u32 s74, 0
  s_waitcnt lgkmcnt(0)
  s_cbranch_scc1 .Lrt_196
  s_sub_u32 s74, s74, 1
  v_cmp_gt_u32 vcc, s52, v13
  s_cbranch_vccnz .Lsp_195
  s_branch .Lrt_196
.Lsp_197:
  ds_read_b32 v13, v10 offset:0
  s_cmp_eq_u32 s74, 0
  s_waitcnt lgkmcnt(0)
  s_cbranch_scc1 .Lrt_198
  s_sub_u32 s74, s74, 1
  v_cmp_gt_u32 vcc, s52, v13
  s_cbranch_vccnz .Lsp_197
  s_branch .Lrt_198
.Lsp_199:
  ds_read_b32 v13, v10 offset:0
  s_cmp_eq_u32 s74, 0
  s_waitcnt lgkmcnt(0)
  s_cbranch_scc1 .Lrt_200
  s_sub_u32 s74, s74, 1
  v_cmp_gt_u32 vcc, s52, v13
  s_cbranch_vccnz .Lsp_199
  s_branch .Lrt_200
.Lsp_201:
  ds_read_b32 v13, v10 offset:0
  s_cmp_eq_u32 s74, 0
  s_waitcnt lgkmcnt(0)
  s_cbranch_scc1 .Lrt_202
  s_sub_u32 s74, s74, 1
  v_cmp_gt_u32 vcc, s52, v13
  s_cbranch_vccnz .Lsp_201
  s_branch .Lrt_202
.Lsp_203:
  ds_read_b32 v13, v10 offset:0
  s_cmp_eq_u32 s74, 0
  s_waitcnt lgkmcnt(0)
  s_cbranch_scc1 .Lrt_204
  s_sub_u32 s74, s74, 1
  v_cmp_gt_u32 vcc, s52, v13
  s_cbranch_vccnz .Lsp_203
  s_branch .Lrt_204
.Lc3_fl_y:
  s_sleep 8
  buffer_load_dword v31, v25, s[16:19], s52 offen sc1
  s_cmp_eq_u32 s74, 0
  s_waitcnt vmcnt(0)
  s_cbranch_scc1 .Lc3_go_y
  s_sub_u32 s74, s74, 16
  s_max_i32 s74, s74, 0
  v_cmp_ne_u32 vcc, s73, v31
  s_nop 1
  s_and_b32 s3, vcc_lo, s54
  s_cbranch_scc1 .Lc3_fl_y
  s_branch .Lc3_go_y
.Lsp_205:
  ds_read_b32 v13, v10 offset:0
  s_cmp_eq_u32 s74, 0
  s_waitcnt lgkmcnt(0)
  s_cbranch_scc1 .Lrt_206
  s_sub_u32 s74, s74, 1
  v_cmp_gt_u32 vcc, 244, v13
  s_cbranch_vccnz .Lsp_205
  s_branch .Lrt_206
.Lc3_f2_y:
  buffer_load_dword v30, v25, s[16:19], s52 offen sc1
  s_cmp_eq_u32 s74, 0
  s_waitcnt vmcnt(0)
  s_cbranch_scc1 .Lc3_g2_y
  s_sub_u32 s74, s74, 16
  s_max_i32 s74, s74, 0
  v_cmp_ne_u32 vcc, s73, v30
  s_nop 1
  s_and_b32 s3, vcc_hi, s55
  s_cbranch_scc0 .Lc3_g2_y
  s_sleep 4
  s_branch .Lc3_f2_y
.Lsp_207:
  ds_read_b32 v13, v10 offset:1024
  s_cmp_eq_u32 s74, 0
  s_waitcnt lgkmcnt(0)
  s_cbranch_scc1 .Lrt_208
  s_sub_u32 s74, s74, 1
  v_cmp_gt_u32 vcc, 48, v13
  s_cbranch_vccnz .Lsp_207
  s_branch .Lrt_208
.Lsp_209:
  ds_read_b32 v13, v17 offset:0
  s_cmp_eq_u32 s74, 0
  s_waitcnt lgkmcnt(0)
  s_cbranch_scc1 .Lrt_210
  s_sub_u32 s74, s74, 1
  v_cmp_gt_u32 vcc, 4, v13
  s_cbranch_vccnz .Lsp_209
  s_branch .Lrt_210
.Lend_y:
.Lside_g:
.Lh_tail_g:
  v_lshrrev_b32 v126, 3, v0
  v_and_b32 v127, 7, v0
  v_lshlrev_b32 v127, 7, v127
  v_lshl_add_u32 v126, v126, 12, v127
  s_lshr_b32 s3, s2, 6
  s_mul_i32 s3, s3, 7
  s_add_u32 s3, s3, s72
  s_lshl2_add_u32 s3, s3, s75
  s_cmp_lt_u32 s3, 64
  s_cbranch_scc0 .Lh_dt2
  s_and_b32 s64, s2, 3
  s_lshl_b32 s64, s64, 6
  s_add_u32 s3, s3, s64
  s_lshl_b32 s3, s3, 15
  buffer_load_dword v127, v126, s[24:27], s3 offen offset:3072
.Lh_dt3:
  ds_read_b32 v12, v10 offset:10240
  s_waitcnt lgkmcnt(0)
  v_cmp_gt_u32 vcc, 2, v12
  s_cbranch_vccnz .Lsp_229
.Lrt_230:
.Lh_dump_g:
  s_setprio 2
  ds_read2_b32 v[16:17], v63 offset0:128 offset1:132
  ds_read2_b32 v[14:15], v63 offset0:0 offset1:4
  ds_read2_b32 v[18:19], v100 offset0:0 offset1:4
  ds_read_b128 v[32:35], v62
  ds_read_b128 v[80:83], v57 offset:0
  ds_read_b128 v[84:87], v57 offset:1024
  ds_read_b128 v[36:39], v101
  ds_read_b128 v[88:91], v57 offset:2048
  ds_read_b128 v[92:95], v57 offset:3072
  s_waitcnt lgkmcnt(6)
  v_mul_f32 v1, v16, v16
  v_mul_f32 v20, 3222493025, v16
  v_mul_f32 v1, v1, v16
  v_mul_f32 v22, 3184710632, v1
  v_mul_f32 v1, v17, v17
  v_mul_f32 v21, 3222493025, v17
  v_mul_f32 v1, v1, v17
  v_mul_f32 v23, 3184710632, v1
  s_waitcnt vmcnt(25)
  v_readfirstlane_b32 s73, v52
  s_cmp_lg_u32 s73, 0
  s_cbranch_scc0 .Lno_231
.Lnk_232:
  v_mov_b32 v55, s73
  v_add_u32 v52, 10240, v11
  s_waitcnt lgkmcnt(4)
  v_fma_f32 v80, v14, v32, v80
  v_fma_f32 v81, v14, v33, v81
  v_fma_f32 v82, v14, v34, v82
  v_fma_f32 v83, v14, v35, v83
  v_mul_f32 v100, v80, v80
  v_mul_f32 v101, v81, v81
  v_mul_f32 v102, v82, v82
  v_mul_f32 v103, v83, v83
  v_fma_f32 v100, v22, v100, v20
  v_fma_f32 v101, v22, v101, v20
  v_fma_f32 v102, v22, v102, v20
  v_fma_f32 v103, v22, v103, v20
  v_mul_f32 v100, v80, v100
  v_mul_f32 v101, v81, v101
  v_mul_f32 v102, v82, v102
  v_mul_f32 v103, v83, v103
  v_exp_f32 v100, v100
  v_exp_f32 v101, v101
  v_exp_f32 v102, v102
  v_exp_f32 v103, v103
  v_fma_f32 v100, v100, v18, v18
  v_fma_f32 v101, v101, v18, v18
  v_fma_f32 v102, v102, v18, v18
  v_fma_f32 v103, v103, v18, v18
  v_rcp_f32 v100, v100
  v_rcp_f32 v101, v101
  v_rcp_f32 v102, v102
  v_rcp_f32 v103, v103
  v_mul_f32 v80, v80, v100
  v_mul_f32 v81, v81, v101
  v_mul_f32 v82, v82, v102
  v_mul_f32 v83, v83, v103
  v_add_f32 v54, v54, v80
  v_fma_f32 v56, v80, v80, v56
  v_add_f32 v54, v54, v81
  v_fma_f32 v56, v81, v81, v56
  v_add_f32 v54, v54, v82
  v_fma_f32 v56, v82, v82, v56
  v_add_f32 v54, v54, v83
  v_fma_f32 v56, v83, v83, v56
  s_waitcnt lgkmcnt(3)
  v_fma_f32 v84, v15, v32, v84
  v_fma_f32 v85, v15, v33, v85
  v_fma_f32 v86, v15, v34, v86
  v_fma_f32 v87, v15, v35, v87
  v_mul_f32 v104, v84, v84
  v_mul_f32 v105, v85, v85
  v_mul_f32 v106, v86, v86
  v_mul_f32 v107, v87, v87
  v_fma_f32 v104, v23, v104, v21
  v_fma_f32 v105, v23, v105, v21
  v_fma_f32 v106, v23, v106, v21
  v_fma_f32 v107, v23, v107, v21
  v_mul_f32 v104, v84, v104
  v_mul_f32 v105, v85, v105
  v_mul_f32 v106, v86, v106
  v_mul_f32 v107, v87, v107
  v_exp_f32 v104, v104
  v_exp_f32 v105, v105
  v_exp_f32 v106, v106
  v_exp_f32 v107, v107
  v_fma_f32 v104, v104, v19, v19
  v_fma_f32 v105, v105, v19, v19
  v_fma_f32 v106, v106, v19, v19
  v_fma_f32 v107, v107, v19, v19
  v_rcp_f32 v104, v104
  v_rcp_f32 v105, v105
  v_rcp_f32 v106, v106
  v_rcp_f32 v107, v107
  v_mul_f32 v84, v84, v104
  v_mul_f32 v85, v85, v105
  v_mul_f32 v86, v86, v106
  v_mul_f32 v87, v87, v107
  v_add_f32 v50, v50, v84
  v_fma_f32 v51, v84, v84, v51
  v_add_f32 v50, v50, v85
  v_fma_f32 v51, v85, v85, v51
  v_add_f32 v50, v50, v86
  v_fma_f32 v51, v86, v86, v51
  v_add_f32 v50, v50, v87
  v_fma_f32 v51, v87, v87, v51
  s_getreg_b32 s3, hwreg(HW_REG_IB_STS)
  s_bfe_u32 s79, s3, 131094
  s_and_b32 s3, s3, 15
  s_lshl4_add_u32 s3, s79, s3
  s_sub_u32 s3, 78, s3
  v_mov_b32 v13, s3
  ds_write_b32 v11, v13
  s_waitcnt lgkmcnt(2)
  v_fma_f32 v88, v14, v36, v88
  v_fma_f32 v89, v14, v37, v89
  v_fma_f32 v90, v14, v38, v90
  v_fma_f32 v91, v14, v39, v91
  v_mul_f32 v100, v88, v88
  v_mul_f32 v101, v89, v89
  v_mul_f32 v102, v90, v90
  v_mul_f32 v103, v91, v91
  v_fma_f32 v100, v22, v100, v20
  v_fma_f32 v101, v22, v101, v20
  v_fma_f32 v102, v22, v102, v20
  v_fma_f32 v103, v22, v103, v20
  v_mul_f32 v100, v88, v100
  v_mul_f32 v101, v89, v101
  v_mul_f32 v102, v90, v102
  v_mul_f32 v103, v91, v103
  v_exp_f32 v100, v100
  v_exp_f32 v101, v101
  v_exp_f32 v102, v102
  v_exp_f32 v103, v103
  v_fma_f32 v100, v100, v18, v18
  v_fma_f32 v101, v101, v18, v18
  v_fma_f32 v102, v102, v18, v18
  v_fma_f32 v103, v103, v18, v18
  v_rcp_f32 v100, v100
  v_rcp_f32 v101, v101
  v_rcp_f32 v102, v102
  v_rcp_f32 v103, v103
  v_mul_f32 v88, v88, v100
  v_mul_f32 v89, v89, v101
  v_mul_f32 v90, v90, v102
  v_mul_f32 v91, v91, v103
  v_add_f32 v54, v54, v88
  v_fma_f32 v56, v88, v88, v56
  v_add_f32 v54, v54, v89
  v_fma_f32 v56, v89, v89, v56
  v_add_f32 v54, v54, v90
  v_fma_f32 v56, v90, v90, v56
  v_add_f32 v54, v54, v91
  v_fma_f32 v56, v91, v91, v56
  s_waitcnt lgkmcnt(1)
  v_fma_f32 v92, v15, v36, v92
  v_fma_f32 v93, v15, v37, v93
  v_fma_f32 v94, v15, v38, v94
  v_fma_f32 v95, v15, v39, v95
  v_mul_f32 v104, v92, v92
  v_mul_f32 v105, v93, v93
  v_mul_f32 v106, v94, v94
  v_mul_f32 v107, v95, v95
  v_fma_f32 v104, v23, v104, v21
  v_fma_f32 v105, v23, v105, v21
  v_fma_f32 v106, v23, v106, v21
  v_fma_f32 v107, v23, v107, v21
  v_mul_f32 v104, v92, v104
  v_mul_f32 v105, v93, v105
  v_mul_f32 v106, v94, v106
  v_mul_f32 v107, v95, v107
  v_exp_f32 v104, v104
  v_exp_f32 v105, v105
  v_exp_f32 v106, v106
  v_exp_f32 v107, v107
  v_fma_f32 v104, v104, v19, v19
  v_fma_f32 v105, v105, v19, v19
  v_fma_f32 v106, v106, v19, v19
  v_fma_f32 v107, v107, v19, v19
  v_rcp_f32 v104, v104
  v_rcp_f32 v105, v105
  v_rcp_f32 v106, v106
  v_rcp_f32 v107, v107
  v_mul_f32 v92, v92, v104
  v_mul_f32 v93, v93, v105
  v_mul_f32 v94, v94, v106
  v_mul_f32 v95, v95, v107
  v_add_f32 v50, v50, v92
  v_fma_f32 v51, v92, v92, v51
  v_add_f32 v50, v50, v93
  v_fma_f32 v51, v93, v93, v51
  v_add_f32 v50, v50, v94
  v_fma_f32 v51, v94, v94, v51
  v_add_f32 v50, v50, v95
  v_fma_f32 v51, v95, v95, v51
  ds_read_b32 v12, v52 offset:0
  s_waitcnt lgkmcnt(0)
  v_cmp_gt_u32 vcc, 3, v12
  s_cbranch_vccnz .Lsp_233
.Lrt_234:
  ds_read_b128 v[40:43], v57 offset:6144
  ds_read_b128 v[108:111], v57 offset:4096
  ds_read_b128 v[112:115], v57 offset:5120
  s_waitcnt lgkmcnt(2)
  v_add_f32 v54, v54, v40
  v_add_f32 v50, v50, v42
  v_add_f32 v56, v56, v41
  v_add_f32 v51, v51, v43
  v_permlane32_swap_b32 v54, v50
  s_nop 0
  v_permlane32_swap_b32 v56, v51
  v_add_f32 v54, v54, v50
  v_add_f32 v56, v56, v51
  s_nop 1
  v_permlane16_swap_b32 v54, v56
  v_add_f32 v54, v54, v56
  buffer_store_dwordx2 v[54:55], v58, s[16:19], s60 offen sc1
.Lh_gran_g:
  s_getreg_b32 s3, hwreg(HW_REG_IB_STS)
  s_bfe_u32 s79, s3, 131094
  s_and_b32 s3, s3, 15
  s_lshl4_add_u32 s3, s79, s3
  s_sub_u32 s3, 79, s3
  v_mov_b32 v13, s3
  ds_write_b32 v11, v13
  ds_read_b32 v12, v10 offset:1024
  s_waitcnt lgkmcnt(2)
  v_lshlrev_b32 v64, 16, v108
  v_and_b32 v65, 0xffff0000, v108
  v_lshlrev_b32 v66, 16, v109
  v_and_b32 v67, 0xffff0000, v109
  v_lshlrev_b32 v68, 16, v110
  v_and_b32 v69, 0xffff0000, v110
  v_lshlrev_b32 v70, 16, v111
  v_and_b32 v71, 0xffff0000, v111
  v_lshlrev_b32 v72, 16, v112
  v_and_b32 v73, 0xffff0000, v112
  v_lshlrev_b32 v74, 16, v113
  v_and_b32 v75, 0xffff0000, v113
  v_lshlrev_b32 v76, 16, v114
  v_and_b32 v77, 0xffff0000, v114
  v_lshlrev_b32 v78, 16, v115
  v_and_b32 v79, 0xffff0000, v115
  v_cvt_pk_bf16_f32 v81, v80, v81
  v_lshlrev_b32 v80, 16, v81
  v_and_b32 v81, 0xffff0000, v81
  v_cvt_pk_bf16_f32 v83, v82, v83
  v_lshlrev_b32 v82, 16, v83
  v_and_b32 v83, 0xffff0000, v83
  v_cvt_pk_bf16_f32 v85, v84, v85
  v_lshlrev_b32 v84, 16, v85
  v_and_b32 v85, 0xffff0000, v85
  v_cvt_pk_bf16_f32 v87, v86, v87
  v_lshlrev_b32 v86, 16, v87
  v_and_b32 v87, 0xffff0000, v87
  v_cvt_pk_bf16_f32 v89, v88, v89
  v_lshlrev_b32 v88, 16, v89
  v_and_b32 v89, 0xffff0000, v89
  v_cvt_pk_bf16_f32 v91, v90, v91
  v_lshlrev_b32 v90, 16, v91
  v_and_b32 v91, 0xffff0000, v91
  v_cvt_pk_bf16_f32 v93, v92, v93
  v_lshlrev_b32 v92, 16, v93
  v_and_b32 v93, 0xffff0000, v93
  v_cvt_pk_bf16_f32 v95, v94, v95
  v_lshlrev_b32 v94, 16, v95
  v_and_b32 v95, 0xffff0000, v95
  v_lshlrev_b32 v58, 4, v0
  s_waitcnt lgkmcnt(0)
  v_cmp_gt_u32 vcc, 9, v12
  s_cbranch_vccnz .Lsp_235
.Lrt_236:
  s_add_u32 s47, s76, 6
  s_and_b32 s47, s47, 7
  s_mul_i32 s3, s47, 229376
  s_add_u32 m0, s48, 131072
  s_add_u32 s3, s3, s44
  buffer_load_dwordx4 v8, s[8:11], s3 offen lds
  buffer_load_dwordx4 v9, s[8:11], s3 offen offset:1024 lds
  s_add_u32 s47, s76, 7
  s_and_b32 s47, s47, 7
  s_mul_i32 s3, s47, 229376
  s_add_u32 m0, s48, 139264
  s_add_u32 s3, s3, s44
  buffer_load_dwordx4 v8, s[8:11], s3 offen lds
  buffer_load_dwordx4 v9, s[8:11], s3 offen offset:1024 lds
  v_mov_b32 v13, 83
.Lh_poll_g:
  buffer_load_dwordx4 v[128:131], v58, s[16:19], s58 offen offset:0 sc1
  buffer_load_dwordx4 v[132:135], v58, s[16:19], s58 offen offset:1024 sc1
  buffer_load_dwordx4 v[136:139], v58, s[16:19], s58 offen offset:2048 sc1
  buffer_load_dwordx4 v[140:143], v58, s[16:19], s58 offen offset:3072 sc1
  buffer_load_dwordx4 v[144:147], v58, s[16:19], s59 offen offset:0 sc1
  buffer_load_dwordx4 v[148:151], v58, s[16:19], s59 offen offset:1024 sc1
  buffer_load_dwordx4 v[152:155], v58, s[16:19], s59 offen offset:2048 sc1
  s_waitcnt vmcnt(7)
  ds_write_b32 v11, v13
  s_waitcnt vmcnt(6)
  v_min_u32 v1, v129, v131
  v_max_u32 v2, v129, v131
  s_waitcnt vmcnt(5)
  v_min3_u32 v1, v1, v133, v135
  v_max3_u32 v2, v2, v133, v135
  v_add_f32 v128, v128, v132
  v_add_f32 v130, v130, v134
  s_waitcnt vmcnt(4)
  v_min3_u32 v1, v1, v137, v139
  v_max3_u32 v2, v2, v137, v139
  v_add_f32 v128, v128, v136
  v_add_f32 v130, v130, v138
  s_waitcnt vmcnt(3)
  v_min3_u32 v1, v1, v141, v143
  v_max3_u32 v2, v2, v141, v143
  v_add_f32 v128, v128, v140
  v_add_f32 v130, v130, v142
  s_waitcnt vmcnt(2)
  v_min3_u32 v1, v1, v145, v147
  v_max3_u32 v2, v2, v145, v147
  v_add_f32 v128, v128, v144
  v_add_f32 v130, v130, v146
  s_waitcnt vmcnt(1)
  v_min3_u32 v1, v1, v149, v151
  v_max3_u32 v2, v2, v149, v151
  v_add_f32 v128, v128, v148
  v_add_f32 v130, v130, v150
  s_waitcnt vmcnt(0)
  v_min3_u32 v1, v1, v153, v155
  v_max3_u32 v2, v2, v153, v155
  v_add_f32 v128, v128, v152
  v_add_f32 v130, v130, v154
  v_cmp_ne_u32 vcc, s73, v1
  v_cmp_ne_u32 s[64:65], s73, v2
  s_or_b64 vcc, vcc, s[64:65]
  s_cbranch_scc0 .Lh_poll_ok_g
  s_cmp_eq_u32 s74, 0
  s_cbranch_scc1 .Lh_poll_ok_g
  s_sub_u32 s74, s74, 16
  s_max_i32 s74, s74, 0
  s_sleep 0
  s_branch .Lh_poll_g
.Lh_poll_ok_g:
  s_waitcnt lgkmcnt(0)
  v_mov_b32 v1, v128
  v_mov_b32 v2, v130
  s_nop 0
  v_permlane32_swap_b32 v128, v1
  v_permlane32_swap_b32 v130, v2
  v_add_f32 v128, v128, v1
  v_add_f32 v130, v130, v2
  v_mul_f32 v128, 982665509, v128
  v_mul_f32 v130, 982665509, v130
  v_fma_f32 v130, -v128, v128, v130
  v_cvt_pk_bf16_f32 v128, v128, v130
  v_and_b32 v130, 0xffff0000, v128
  v_add_f32 v130, 925353388, v130
  v_cvt_pk_bf16_f32 v130, v130, v130
  v_lshlrev_b32 v130, 16, v130
  v_sqrt_f32 v130, v130
  v_lshlrev_b32 v128, 16, v128
  v_cvt_pk_bf16_f32 v130, v130, v130
  v_lshlrev_b32 v130, 16, v130
  v_rcp_f32 v130, v130
  s_nop 0
  v_mul_f32 v128, -v128, v130
  v_mov_b32 v131, v130
  v_mov_b32 v129, v128
  s_nop 0
  v_permlane16_swap_b32 v130, v131
  v_permlane16_swap_b32 v128, v129
  v_fma_f32 v64, v64, v130, v128
  v_fma_f32 v65, v65, v130, v128
  v_fma_f32 v66, v66, v130, v128
  v_fma_f32 v67, v67, v130, v128
  v_cvt_pk_bf16_f32 v108, v64, v65
  v_cvt_pk_bf16_f32 v109, v66, v67
  ds_write_b64 v59, v[108:109]
  v_fma_f32 v68, v68, v131, v129
  v_fma_f32 v69, v69, v131, v129
  v_fma_f32 v70, v70, v131, v129
  v_fma_f32 v71, v71, v131, v129
  v_cvt_pk_bf16_f32 v110, v68, v69
  v_cvt_pk_bf16_f32 v111, v70, v71
  v_xor_b32 v101, 32, v59
  ds_write_b64 v101, v[110:111] offset:512
  v_fma_f32 v72, v72, v130, v128
  v_fma_f32 v73, v73, v130, v128
  v_fma_f32 v74, v74, v130, v128
  v_fma_f32 v75, v75, v130, v128
  v_cvt_pk_bf16_f32 v112, v72, v73
  v_cvt_pk_bf16_f32 v113, v74, v75
  v_xor_b32 v102, 32, v59
  ds_write_b64 v102, v[112:113]
  v_fma_f32 v76, v76, v131, v129
  v_fma_f32 v77, v77, v131, v129
  v_fma_f32 v78, v78, v131, v129
  v_fma_f32 v79, v79, v131, v129
  v_cvt_pk_bf16_f32 v114, v76, v77
  v_cvt_pk_bf16_f32 v115, v78, v79
  ds_write_b64 v59, v[114:115] offset:512
  v_fma_f32 v80, v80, v130, v128
  v_fma_f32 v81, v81, v130, v128
  v_fma_f32 v82, v82, v130, v128
  v_fma_f32 v83, v83, v130, v128
  v_cvt_pk_bf16_f32 v116, v80, v81
  v_cvt_pk_bf16_f32 v117, v82, v83
  v_xor_b32 v100, 64, v59
  ds_write_b64 v100, v[116:117]
  v_fma_f32 v84, v84, v131, v129
  v_fma_f32 v85, v85, v131, v129
  v_fma_f32 v86, v86, v131, v129
  v_fma_f32 v87, v87, v131, v129
  v_cvt_pk_bf16_f32 v118, v84, v85
  v_cvt_pk_bf16_f32 v119, v86, v87
  v_xor_b32 v101, 96, v59
  ds_write_b64 v101, v[118:119] offset:512
  v_fma_f32 v88, v88, v130, v128
  v_fma_f32 v89, v89, v130, v128
  v_fma_f32 v90, v90, v130, v128
  v_fma_f32 v91, v91, v130, v128
  v_cvt_pk_bf16_f32 v120, v88, v89
  v_cvt_pk_bf16_f32 v121, v90, v91
  v_xor_b32 v102, 96, v59
  ds_write_b64 v102, v[120:121]
  v_fma_f32 v92, v92, v131, v129
  v_fma_f32 v93, v93, v131, v129
  v_fma_f32 v94, v94, v131, v129
  v_fma_f32 v95, v95, v131, v129
  v_cvt_pk_bf16_f32 v122, v92, v93
  v_cvt_pk_bf16_f32 v123, v94, v95
  v_xor_b32 v103, 64, v59
  ds_write_b64 v103, v[122:123] offset:512
  v_xor_b32 v104, 0, v60
  v_xor_b32 v105, 32, v60
  ds_read_b64_tr_b16 v[64:65], v104
  ds_read_b64_tr_b16 v[66:67], v105 offset:512
  v_xor_b32 v106, 32, v60
  v_xor_b32 v107, 0, v60
  ds_read_b64_tr_b16 v[72:73], v106
  ds_read_b64_tr_b16 v[74:75], v107 offset:512
  v_xor_b32 v104, 64, v60
  v_xor_b32 v105, 96, v60
  ds_read_b64_tr_b16 v[80:81], v104
  ds_read_b64_tr_b16 v[82:83], v105 offset:512
  v_xor_b32 v106, 96, v60
  v_xor_b32 v107, 64, v60
  ds_read_b64_tr_b16 v[88:89], v106
  ds_read_b64_tr_b16 v[90:91], v107 offset:512
  s_waitcnt lgkmcnt(6)
  buffer_store_dwordx4 v[64:67], v61, s[16:19], s61 offen offset:0 sc1
  s_waitcnt lgkmcnt(4)
  buffer_store_dwordx4 v[72:75], v61, s[16:19], s61 offen offset:128 sc1
  s_waitcnt lgkmcnt(2)
  buffer_store_dwordx4 v[80:83], v61, s[16:19], s61 offen offset:512 sc1
  s_waitcnt lgkmcnt(0)
  buffer_store_dwordx4 v[88:91], v61, s[16:19], s61 offen offset:640 sc1
.Lh_zst_g:
  v_mov_b32 v13, 4
  ds_write_b32 v11, v13 offset:2048
  s_waitcnt vmcnt(0)
  s_mov_b64 exec, 1
  buffer_store_dword v55, off, s[16:19], s62 sc1
  s_mov_b64 exec, -1
  s_setprio 0
.Lh_p1end_g:
  s_waitcnt lgkmcnt(0)
.Lh_tjoin_g:
  ds_read_b32 v12, v10 offset:1024
  s_waitcnt lgkmcnt(0)
  v_cmp_gt_u32 vcc, 10, v12
  s_cbranch_vccnz .Lsp_275
.Lrt_276:
  s_add_u32 m0, s49, 0
  s_add_u32 s3, s50, s51
  buffer_load_dwordx4 v200, s[24:27], s3 offen lds
  buffer_load_dwordx4 v201, s[24:27], s3 offen offset:1024 lds
  buffer_load_dwordx4 v202, s[24:27], s3 offen offset:2048 lds
  buffer_load_dwordx4 v203, s[24:27], s3 offen offset:3072 lds
  s_add_u32 s51, s51, 128
  s_and_b32 s51, s51, 4095
  ds_read_b32 v12, v10 offset:1024
  s_waitcnt lgkmcnt(0)
  v_cmp_gt_u32 vcc, 11, v12
  s_cbranch_vccnz .Lsp_277
.Lrt_278:
  s_add_u32 m0, s49, 16384
  s_add_u32 s3, s50, s51
  buffer_load_dwordx4 v200, s[24:27], s3 offen lds
  buffer_load_dwordx4 v201, s[24:27], s3 offen offset:1024 lds
  buffer_load_dwordx4 v202, s[24:27], s3 offen offset:2048 lds
  buffer_load_dwordx4 v203, s[24:27], s3 offen offset:3072 lds
  s_add_u32 s51, s51, 128
  s_and_b32 s51, s51, 4095
  s_getreg_b32 s3, hwreg(HW_REG_IB_STS)
  s_bfe_u32 s79, s3, 131094
  s_and_b32 s3, s3, 15
  s_lshl4_add_u32 s3, s79, s3
  s_sub_u32 s3, 96, s3
  v_mov_b32 v13, s3
  ds_write_b32 v11, v13
  ds_read_b32 v12, v10 offset:1024
  s_waitcnt lgkmcnt(0)
  v_cmp_gt_u32 vcc, 12, v12
  s_cbranch_vccnz .Lsp_279
.Lrt_280:
  s_add_u32 m0, s49, 32768
  s_add_u32 s3, s50, s51
  buffer_load_dwordx4 v200, s[24:27], s3 offen lds
  buffer_load_dwordx4 v201, s[24:27], s3 offen offset:1024 lds
  buffer_load_dwordx4 v202, s[24:27], s3 offen offset:2048 lds
  buffer_load_dwordx4 v203, s[24:27], s3 offen offset:3072 lds
  s_add_u32 s51, s51, 128
  s_and_b32 s51, s51, 4095
  s_getreg_b32 s3, hwreg(HW_REG_IB_STS)
  s_bfe_u32 s79, s3, 131094
  s_and_b32 s3, s3, 15
  s_lshl4_add_u32 s3, s79, s3
  s_sub_u32 s3, 100, s3
  v_mov_b32 v13, s3
  ds_write_b32 v11, v13
  ds_read_b32 v12, v10 offset:1024
  s_waitcnt lgkmcnt(0)
  v_cmp_gt_u32 vcc, 13, v12
  s_cbranch_vccnz .Lsp_281
.Lrt_282:
  s_add_u32 m0, s49, 49152
  s_add_u32 s3, s50, s51
  buffer_load_dwordx4 v200, s[24:27], s3 offen lds
  buffer_load_dwordx4 v201, s[24:27], s3 offen offset:1024 lds
  buffer_load_dwordx4 v202, s[24:27], s3 offen offset:2048 lds
  buffer_load_dwordx4 v203, s[24:27], s3 offen offset:3072 lds
  s_add_u32 s51, s51, 128
  s_and_b32 s51, s51, 4095
  s_getreg_b32 s3, hwreg(HW_REG_IB_STS)
  s_bfe_u32 s79, s3, 131094
  s_and_b32 s3, s3, 15
  s_lshl4_add_u32 s3, s79, s3
  s_sub_u32 s3, 104, s3
  v_mov_b32 v13, s3
  ds_write_b32 v11, v13
.Lh_pre4_g:
  ds_read_b32 v12, v10 offset:1024
  s_waitcnt lgkmcnt(0)
  v_cmp_gt_u32 vcc, 14, v12
  s_cbranch_vccnz .Lsp_283
.Lrt_284:
  s_add_u32 m0, s49, 65536
  s_add_u32 s3, s50, s51
  buffer_load_dwordx4 v200, s[24:27], s3 offen lds
  buffer_load_dwordx4 v201, s[24:27], s3 offen offset:1024 lds
  buffer_load_dwordx4 v202, s[24:27], s3 offen offset:2048 lds
  buffer_load_dwordx4 v203, s[24:27], s3 offen offset:3072 lds
  s_add_u32 s51, s51, 128
  s_and_b32 s51, s51, 4095
  s_getreg_b32 s3, hwreg(HW_REG_IB_STS)
  s_bfe_u32 s79, s3, 131094
  s_and_b32 s3, s3, 15
  s_lshl4_add_u32 s3, s79, s3
  s_sub_u32 s3, 108, s3
  v_mov_b32 v13, s3
  ds_write_b32 v11, v13
  ds_read_b32 v12, v10 offset:1024
  s_waitcnt lgkmcnt(0)
  v_cmp_gt_u32 vcc, 15, v12
  s_cbranch_vccnz .Lsp_285
.Lrt_286:
  s_add_u32 m0, s49, 81920
  s_add_u32 s3, s50, s51
  buffer_load_dwordx4 v200, s[24:27], s3 offen lds
  buffer_load_dwordx4 v201, s[24:27], s3 offen offset:1024 lds
  buffer_load_dwordx4 v202, s[24:27], s3 offen offset:2048 lds
  buffer_load_dwordx4 v203, s[24:27], s3 offen offset:3072 lds
  s_add_u32 s51, s51, 128
  s_and_b32 s51, s51, 4095
  s_getreg_b32 s3, hwreg(HW_REG_IB_STS)
  s_bfe_u32 s79, s3, 131094
  s_and_b32 s3, s3, 15
  s_lshl4_add_u32 s3, s79, s3
  s_sub_u32 s3, 112, s3
  v_mov_b32 v13, s3
  ds_write_b32 v11, v13
  ds_read_b32 v12, v10 offset:2048
  s_waitcnt lgkmcnt(0)
  v_cmp_gt_u32 vcc, 4, v12
  s_cbranch_vccnz .Lsp_287
.Lrt_288:
  s_add_u32 m0, s49, 98304
  s_add_u32 s3, s50, s51
  buffer_load_dwordx4 v200, s[24:27], s3 offen lds
  buffer_load_dwordx4 v201, s[24:27], s3 offen offset:1024 lds
  buffer_load_dwordx4 v202, s[24:27], s3 offen offset:2048 lds
  buffer_load_dwordx4 v203, s[24:27], s3 offen offset:3072 lds
  s_add_u32 s51, s51, 128
  s_and_b32 s51, s51, 4095
  s_getreg_b32 s3, hwreg(HW_REG_IB_STS)
  s_bfe_u32 s79, s3, 131094
  s_and_b32 s3, s3, 15
  s_lshl4_add_u32 s3, s79, s3
  s_sub_u32 s3, 116, s3
  v_mov_b32 v13, s3
  ds_write_b32 v11, v13
  s_add_u32 m0, s49, 114688
  s_add_u32 s3, s50, s51
  buffer_load_dwordx4 v200, s[24:27], s3 offen lds
  buffer_load_dwordx4 v201, s[24:27], s3 offen offset:1024 lds
  buffer_load_dwordx4 v202, s[24:27], s3 offen offset:2048 lds
  buffer_load_dwordx4 v203, s[24:27], s3 offen offset:3072 lds
  s_add_u32 s51, s51, 128
  s_and_b32 s51, s51, 4095
  s_getreg_b32 s3, hwreg(HW_REG_IB_STS)
  s_bfe_u32 s79, s3, 131094
  s_and_b32 s3, s3, 15
  s_lshl4_add_u32 s3, s79, s3
  s_sub_u32 s3, 120, s3
  v_mov_b32 v13, s3
  ds_write_b32 v11, v13
.Lh_pre8_g:
  s_waitcnt lgkmcnt(0)
  s_mov_b32 s66, 120
  s_mov_b32 s67, 17
  s_mov_b32 s63, 0
  s_mov_b32 s68, -1
  s_cmp_lt_u32 s72, 7
  s_cbranch_scc1 .Lh2_loop_g
  s_waitcnt vmcnt(0)
  s_branch .Lh2_done_g
.Lh2_loop_g:
  ds_read_b32 v12, v10 offset:1024
  s_getreg_b32 s3, hwreg(HW_REG_IB_STS)
  s_bfe_u32 s79, s3, 131094
  s_and_b32 s3, s3, 15
  s_lshl4_add_u32 s3, s79, s3
  s_sub_u32 s3, s66, s3
  s_cmp_eq_u32 s3, s68
  s_cbranch_scc1 .Lh2_np_g
  s_mov_b32 s68, s3
  v_mov_b32 v13, s3
  ds_write_b32 v11, v13
.Lh2_np_g:
  s_waitcnt lgkmcnt(0)
  v_cmp_gt_u32 vcc, s67, v12
  s_cbranch_vccz .Lh2_go_g
  s_cmp_eq_u32 s74, 0
  s_cbranch_scc1 .Lh2_go_g
  s_sub_u32 s74, s74, 1
  s_sleep 1
  s_branch .Lh2_loop_g
.Lh2_go_g:
  s_add_u32 m0, s49, s63
  s_add_u32 s3, s50, s51
  buffer_load_dwordx4 v200, s[24:27], s3 offen lds
  buffer_load_dwordx4 v201, s[24:27], s3 offen offset:1024 lds
  buffer_load_dwordx4 v202, s[24:27], s3 offen offset:2048 lds
  buffer_load_dwordx4 v203, s[24:27], s3 offen offset:3072 lds
  s_add_u32 s51, s51, 128
  s_and_b32 s51, s51, 4095
  s_add_u32 s63, s63, 16384
  s_and_b32 s63, s63, 131071
  s_add_u32 s66, s66, 4
  s_add_u32 s67, s67, 1
  s_cmp_lt_u32 s67, 41
  s_cbranch_scc1 .Lh2_loop_g
.Lh2_done_g:
  s_lshr_b32 s3, s2, 3
  s_lshl2_add_u32 s3, s3, s75
  s_min_u32 s3, s3, 111
  s_lshl_b32 s3, s3, 13
  ds_read_b32 v12, v10 offset:1024
  s_waitcnt lgkmcnt(0)
  v_cmp_gt_u32 vcc, 16, v12
  s_cbranch_vccnz .Lsp_289
.Lrt_290:
  s_add_u32 m0, s48, 131072
  s_add_u32 s3, s69, 0
  buffer_load_dwordx4 v204, s[28:31], s3 offen lds
  buffer_load_dwordx4 v205, s[28:31], s3 offen offset:1024 lds
  s_add_u32 m0, s48, 139264
  s_add_u32 s3, s69, 458752
  buffer_load_dwordx4 v204, s[28:31], s3 offen lds
  buffer_load_dwordx4 v205, s[28:31], s3 offen offset:1024 lds
  s_getreg_b32 s3, hwreg(HW_REG_IB_STS)
  s_bfe_u32 s79, s3, 131094
  s_and_b32 s3, s3, 15
  s_lshl4_add_u32 s3, s79, s3
  s_sub_u32 s3, 220, s3
  v_mov_b32 v13, s3
  ds_write_b32 v11, v13
  ds_read_b32 v12, v10 offset:1024
  s_waitcnt lgkmcnt(0)
  v_cmp_gt_u32 vcc, 41, v12
  s_cbranch_vccnz .Lsp_291
.Lrt_292:
  s_add_u32 m0, s48, 0
  s_add_u32 s3, s69, 65536
  buffer_load_dwordx4 v204, s[28:31], s3 offen lds
  buffer_load_dwordx4 v205, s[28:31], s3 offen offset:1024 lds
  s_add_u32 m0, s48, 8192
  s_add_u32 s3, s69, 524288
  buffer_load_dwordx4 v204, s[28:31], s3 offen lds
  buffer_load_dwordx4 v205, s[28:31], s3 offen offset:1024 lds
  s_getreg_b32 s3, hwreg(HW_REG_IB_STS)
  s_bfe_u32 s79, s3, 131094
  s_and_b32 s3, s3, 15
  s_lshl4_add_u32 s3, s79, s3
  s_sub_u32 s3, 224, s3
  v_mov_b32 v13, s3
  ds_write_b32 v11, v13
  ds_read_b32 v12, v10 offset:1024
  s_waitcnt lgkmcnt(0)
  v_cmp_gt_u32 vcc, 42, v12
  s_cbranch_vccnz .Lsp_293
.Lrt_294:
  s_add_u32 m0, s48, 16384
  s_add_u32 s3, s69, 131072
  buffer_load_dwordx4 v204, s[28:31], s3 offen lds
  buffer_load_dwordx4 v205, s[28:31], s3 offen offset:1024 lds
  s_add_u32 m0, s48, 24576
  s_add_u32 s3, s69, 589824
  buffer_load_dwordx4 v204, s[28:31], s3 offen lds
  buffer_load_dwordx4 v205, s[28:31], s3 offen offset:1024 lds
  s_getreg_b32 s3, hwreg(HW_REG_IB_STS)
  s_bfe_u32 s79, s3, 131094
  s_and_b32 s3, s3, 15
  s_lshl4_add_u32 s3, s79, s3
  s_sub_u32 s3, 228, s3
  v_mov_b32 v13, s3
  ds_write_b32 v11, v13
  ds_read_b32 v12, v10 offset:1024
  s_waitcnt lgkmcnt(0)
  v_cmp_gt_u32 vcc, 43, v12
  s_cbranch_vccnz .Lsp_295
.Lrt_296:
  s_add_u32 m0, s48, 32768
  s_add_u32 s3, s69, 196608
  buffer_load_dwordx4 v204, s[28:31], s3 offen lds
  buffer_load_dwordx4 v205, s[28:31], s3 offen offset:1024 lds
  s_add_u32 m0, s48, 40960
  s_add_u32 s3, s69, 655360
  buffer_load_dwordx4 v204, s[28:31], s3 offen lds
  buffer_load_dwordx4 v205, s[28:31], s3 offen offset:1024 lds
  s_getreg_b32 s3, hwreg(HW_REG_IB_STS)
  s_bfe_u32 s79, s3, 131094
  s_and_b32 s3, s3, 15
  s_lshl4_add_u32 s3, s79, s3
  s_sub_u32 s3, 232, s3
  v_mov_b32 v13, s3
  ds_write_b32 v11, v13
  ds_read_b32 v12, v10 offset:1024
  s_waitcnt lgkmcnt(0)
  v_cmp_gt_u32 vcc, 44, v12
  s_cbranch_vccnz .Lsp_297
.Lrt_298:
  s_add_u32 m0, s48, 49152
  s_add_u32 s3, s69, 262144
  buffer_load_dwordx4 v204, s[28:31], s3 offen lds
  buffer_load_dwordx4 v205, s[28:31], s3 offen offset:1024 lds
  s_add_u32 m0, s48, 57344
  s_add_u32 s3, s69, 720896
  buffer_load_dwordx4 v204, s[28:31], s3 offen lds
  buffer_load_dwordx4 v205, s[28:31], s3 offen offset:1024 lds
  s_getreg_b32 s3, hwreg(HW_REG_IB_STS)
  s_bfe_u32 s79, s3, 131094
  s_and_b32 s3, s3, 15
  s_lshl4_add_u32 s3, s79, s3
  s_sub_u32 s3, 236, s3
  v_mov_b32 v13, s3
  ds_write_b32 v11, v13
  ds_read_b32 v12, v10 offset:1024
  s_waitcnt lgkmcnt(0)
  v_cmp_gt_u32 vcc, 45, v12
  s_cbranch_vccnz .Lsp_299
.Lrt_300:
  s_add_u32 m0, s48, 65536
  s_add_u32 s3, s69, 327680
  buffer_load_dwordx4 v204, s[28:31], s3 offen lds
  buffer_load_dwordx4 v205, s[28:31], s3 offen offset:1024 lds
  s_add_u32 m0, s48, 73728
  s_add_u32 s3, s69, 786432
  buffer_load_dwordx4 v204, s[28:31], s3 offen lds
  buffer_load_dwordx4 v205, s[28:31], s3 offen offset:1024 lds
  s_getreg_b32 s3, hwreg(HW_REG_IB_STS)
  s_bfe_u32 s79, s3, 131094
  s_and_b32 s3, s3, 15
  s_lshl4_add_u32 s3, s79, s3
  s_sub_u32 s3, 240, s3
  v_mov_b32 v13, s3
  ds_write_b32 v11, v13
  ds_read_b32 v12, v10 offset:1024
  s_waitcnt lgkmcnt(0)
  v_cmp_gt_u32 vcc, 46, v12
  s_cbranch_vccnz .Lsp_301
.Lrt_302:
  s_add_u32 m0, s48, 81920
  s_add_u32 s3, s69, 393216
  buffer_load_dwordx4 v204, s[28:31], s3 offen lds
  buffer_load_dwordx4 v205, s[28:31], s3 offen offset:1024 lds
  s_add_u32 m0, s48, 90112
  s_add_u32 s3, s69, 851968
  buffer_load_dwordx4 v204, s[28:31], s3 offen lds
  buffer_load_dwordx4 v205, s[28:31], s3 offen offset:1024 lds
  s_getreg_b32 s3, hwreg(HW_REG_IB_STS)
  s_bfe_u32 s79, s3, 131094
  s_and_b32 s3, s3, 15
  s_lshl4_add_u32 s3, s79, s3
  s_sub_u32 s3, 244, s3
  v_mov_b32 v13, s3
  ds_write_b32 v11, v13
.Lh2_dr_g:
  s_getreg_b32 s3, hwreg(HW_REG_IB_STS)
  s_bfe_u32 s79, s3, 131094
  s_and_b32 s3, s3, 15
  s_lshl4_add_u32 s3, s79, s3
  s_sub_u32 s3, 244, s3
  v_mov_b32 v13, s3
  ds_write_b32 v11, v13
  s_cmp_eq_u32 s3, 244
  s_cbranch_scc1 .Lh2_end_g
  s_sleep 1
  s_branch .Lh2_dr_g
.Lh2_end_g:
  s_waitcnt vmcnt(0) lgkmcnt(0)
.Lh_p2end_g:
  s_endpgm
.Lc_tail_g:
.Lc_s27_g:
  v_mfma_f32_16x16x32_bf16 v[28:31], v[32:35], v[24:27], v[28:31]
  v_mfma_f32_16x16x32_bf16 v[96:99], v[32:35], v[240:243], v[96:99]
  v_mfma_f32_16x16x32_bf16 v[100:103], v[32:35], v[244:247], v[100:103]
  s_waitcnt lgkmcnt(12)
  v_mfma_f32_16x16x32_bf16 v[28:31], v[36:39], v[24:27], v[28:31]
  v_mfma_f32_16x16x32_bf16 v[96:99], v[36:39], v[248:251], v[96:99]
  v_mfma_f32_16x16x32_bf16 v[100:103], v[36:39], v[252:255], v[100:103]
  s_nop 5
  ds_write_b128 v8, v[28:31] offset:512
  s_waitcnt lgkmcnt(11)
  v_mfma_f32_16x16x32_bf16 v[104:107], v[40:43], v[240:243], v[104:107]
  v_mov_b32 v15, 16
  ds_write_b32 v11, v15
  v_mfma_f32_16x16x32_bf16 v[108:111], v[40:43], v[244:247], v[108:111]
  s_mov_b32 s76, s71
  s_add_u32 s77, s72, 8
  s_waitcnt lgkmcnt(10)
  v_mfma_f32_16x16x32_bf16 v[104:107], v[44:47], v[248:251], v[104:107]
  s_lshl_b32 s60, s72, 2
  s_lshl_b32 s60, s77, 1
  v_mfma_f32_16x16x32_bf16 v[108:111], v[44:47], v[252:255], v[108:111]
  s_lshr_b32 s3, s75, 1
  s_add_u32 s60, s60, s3
  s_waitcnt lgkmcnt(8)
  v_mfma_f32_16x16x32_bf16 v[112:115], v[48:51], v[240:243], v[112:115]
  s_lshl_b32 s60, s60, 8
  s_add_u32 s60, s60, 17301504
  ds_read_b32 v13, v10 offset:1024
  v_mfma_f32_16x16x32_bf16 v[116:119], v[48:51], v[244:247], v[116:119]
  v_lshlrev_b32 v184, 2, v0
  v_and_b32 v1, 15, v0
  s_waitcnt lgkmcnt(7)
  v_mfma_f32_16x16x32_bf16 v[112:115], v[52:55], v[248:251], v[112:115]
  v_lshlrev_b32 v1, 1, v1
  s_lshl_b32 s3, s76, 8
  v_mfma_f32_16x16x32_bf16 v[116:119], v[52:55], v[252:255], v[116:119]
  buffer_load_ushort v176, v1, s[36:39], s3 offen offset:0
  buffer_load_ushort v177, v1, s[36:39], s3 offen offset:32
  s_waitcnt lgkmcnt(0)
  v_cmp_gt_u32 vcc, 16, v13
  s_cbranch_vccnz .Lsp_273
.Lrt_274:
.Lc_KC2_g:
  v_mfma_f32_16x16x32_bf16 v[120:123], v[56:59], v[240:243], v[120:123]
  buffer_load_ushort v178, v1, s[36:39], s3 offen offset:64
  buffer_load_ushort v179, v1, s[36:39], s3 offen offset:96
  v_mfma_f32_16x16x32_bf16 v[124:127], v[56:59], v[244:247], v[124:127]
  buffer_load_ushort v180, v1, s[36:39], s3 offen offset:128
  buffer_load_ushort v181, v1, s[36:39], s3 offen offset:160
  v_mfma_f32_16x16x32_bf16 v[120:123], v[60:63], v[248:251], v[120:123]
  buffer_load_ushort v182, v1, s[36:39], s3 offen offset:192
  buffer_load_ushort v183, v1, s[36:39], s3 offen offset:224
  v_mfma_f32_16x16x32_bf16 v[124:127], v[60:63], v[252:255], v[124:127]
  v_xor_b32 v3, 64, v8
  ds_read_b128 v[148:151], v3 offset:512
.Lc_U3E_g:
  v_xor_b32 v2, 128, v8
  ds_read_b128 v[152:155], v2 offset:512
  v_xor_b32 v3, 192, v8
  ds_read_b128 v[156:159], v3 offset:512
  v_fma_f32 v96, v160, v28, v96
  v_fma_f32 v97, v160, v29, v97
  v_fma_f32 v98, v160, v30, v98
  v_fma_f32 v99, v160, v31, v99
  v_mul_f32 v168, v96, v96
  v_mul_f32 v169, v97, v97
  v_mul_f32 v170, v98, v98
  v_mul_f32 v171, v99, v99
  v_fma_f32 v168, v166, v168, v162
  v_fma_f32 v169, v166, v169, v162
  v_fma_f32 v170, v166, v170, v162
  v_fma_f32 v171, v166, v171, v162
  v_mul_f32 v168, v96, v168
  v_mul_f32 v169, v97, v169
  v_mul_f32 v170, v98, v170
  v_mul_f32 v171, v99, v171
  v_exp_f32 v168, v168
  v_exp_f32 v169, v169
  v_exp_f32 v170, v170
  v_exp_f32 v171, v171
  v_fma_f32 v168, v168, v164, v164
  v_fma_f32 v169, v169, v164, v164
  v_fma_f32 v170, v170, v164, v164
  v_fma_f32 v171, v171, v164, v164
  v_rcp_f32 v168, v168
  v_rcp_f32 v169, v169
  v_rcp_f32 v170, v170
  v_rcp_f32 v171, v171
  v_mul_f32 v96, v96, v168
  v_mul_f32 v97, v97, v169
  v_mul_f32 v98, v98, v170
  v_mul_f32 v99, v99, v171
  v_cvt_pk_bf16_f32 v192, v96, v97
  v_cvt_pk_bf16_f32 v193, v98, v99
  v_fma_f32 v100, v161, v28, v100
  v_fma_f32 v101, v161, v29, v101
  v_fma_f32 v102, v161, v30, v102
  v_fma_f32 v103, v161, v31, v103
  v_mul_f32 v172, v100, v100
  v_mul_f32 v173, v101, v101
  v_mul_f32 v174, v102, v102
  v_mul_f32 v175, v103, v103
  v_fma_f32 v172, v167, v172, v163
  v_fma_f32 v173, v167, v173, v163
  v_fma_f32 v174, v167, v174, v163
  v_fma_f32 v175, v167, v175, v163
  v_mul_f32 v172, v100, v172
  v_mul_f32 v173, v101, v173
  v_mul_f32 v174, v102, v174
  v_mul_f32 v175, v103, v175
  v_exp_f32 v172, v172
  v_exp_f32 v173, v173
  v_exp_f32 v174, v174
  v_exp_f32 v175, v175
  v_fma_f32 v172, v172, v165, v165
  v_fma_f32 v173, v173, v165, v165
  v_fma_f32 v174, v174, v165, v165
  v_fma_f32 v175, v175, v165, v165
  v_rcp_f32 v172, v172
  v_rcp_f32 v173, v173
  v_rcp_f32 v174, v174
  v_rcp_f32 v175, v175
  v_mul_f32 v100, v100, v172
  v_mul_f32 v101, v101, v173
  v_mul_f32 v102, v102, v174
  v_mul_f32 v103, v103, v175
  v_cvt_pk_bf16_f32 v194, v100, v101
  v_cvt_pk_bf16_f32 v195, v102, v103
  s_nop 0
  v_permlane16_swap_b32 v192, v194
  v_permlane16_swap_b32 v193, v195
  s_waitcnt lgkmcnt(2)
  v_fma_f32 v104, v160, v148, v104
  v_fma_f32 v105, v160, v149, v105
  v_fma_f32 v106, v160, v150, v106
  v_fma_f32 v107, v160, v151, v107
  v_mul_f32 v168, v104, v104
  v_mul_f32 v169, v105, v105
  v_mul_f32 v170, v106, v106
  v_mul_f32 v171, v107, v107
  v_fma_f32 v168, v166, v168, v162
  v_fma_f32 v169, v166, v169, v162
  v_fma_f32 v170, v166, v170, v162
  v_fma_f32 v171, v166, v171, v162
  v_mul_f32 v168, v104, v168
  v_mul_f32 v169, v105, v169
  v_mul_f32 v170, v106, v170
  v_mul_f32 v171, v107, v171
  v_exp_f32 v168, v168
  v_exp_f32 v169, v169
  v_exp_f32 v170, v170
  v_exp_f32 v171, v171
  v_fma_f32 v168, v168, v164, v164
  v_fma_f32 v169, v169, v164, v164
  v_fma_f32 v170, v170, v164, v164
  v_fma_f32 v171, v171, v164, v164
  v_rcp_f32 v168, v168
  v_rcp_f32 v169, v169
  v_rcp_f32 v170, v170
  v_rcp_f32 v171, v171
  v_mul_f32 v104, v104, v168
  v_mul_f32 v105, v105, v169
  v_mul_f32 v106, v106, v170
  v_mul_f32 v107, v107, v171
  v_cvt_pk_bf16_f32 v196, v104, v105
  v_cvt_pk_bf16_f32 v197, v106, v107
  v_fma_f32 v108, v161, v148, v108
  v_fma_f32 v109, v161, v149, v109
  v_fma_f32 v110, v161, v150, v110
  v_fma_f32 v111, v161, v151, v111
  v_mul_f32 v172, v108, v108
  v_mul_f32 v173, v109, v109
  v_mul_f32 v174, v110, v110
  v_mul_f32 v175, v111, v111
  v_fma_f32 v172, v167, v172, v163
  v_fma_f32 v173, v167, v173, v163
  v_fma_f32 v174, v167, v174, v163
  v_fma_f32 v175, v167, v175, v163
  v_mul_f32 v172, v108, v172
  v_mul_f32 v173, v109, v173
  v_mul_f32 v174, v110, v174
  v_mul_f32 v175, v111, v175
  v_exp_f32 v172, v172
  v_exp_f32 v173, v173
  v_exp_f32 v174, v174
  v_exp_f32 v175, v175
  v_fma_f32 v172, v172, v165, v165
  v_fma_f32 v173, v173, v165, v165
  v_fma_f32 v174, v174, v165, v165
  v_fma_f32 v175, v175, v165, v165
  v_rcp_f32 v172, v172
  v_rcp_f32 v173, v173
  v_rcp_f32 v174, v174
  v_rcp_f32 v175, v175
  v_mul_f32 v108, v108, v172
  v_mul_f32 v109, v109, v173
  v_mul_f32 v110, v110, v174
  v_mul_f32 v111, v111, v175
  v_cvt_pk_bf16_f32 v198, v108, v109
  v_cvt_pk_bf16_f32 v199, v110, v111
  s_nop 0
  v_permlane16_swap_b32 v196, v198
  v_permlane16_swap_b32 v197, v199
  buffer_load_dword v184, v184, s[16:19], s60 offen sc1
  s_waitcnt lgkmcnt(1)
  v_fma_f32 v112, v160, v152, v112
  v_fma_f32 v113, v160, v153, v113
  v_fma_f32 v114, v160, v154, v114
  v_fma_f32 v115, v160, v155, v115
  v_mul_f32 v168, v112, v112
  v_mul_f32 v169, v113, v113
  v_mul_f32 v170, v114, v114
  v_mul_f32 v171, v115, v115
  v_fma_f32 v168, v166, v168, v162
  v_fma_f32 v169, v166, v169, v162
  v_fma_f32 v170, v166, v170, v162
  v_fma_f32 v171, v166, v171, v162
  v_mul_f32 v168, v112, v168
  v_mul_f32 v169, v113, v169
  v_mul_f32 v170, v114, v170
  v_mul_f32 v171, v115, v171
  v_exp_f32 v168, v168
  v_exp_f32 v169, v169
  v_exp_f32 v170, v170
  v_exp_f32 v171, v171
  v_fma_f32 v168, v168, v164, v164
  v_fma_f32 v169, v169, v164, v164
  v_fma_f32 v170, v170, v164, v164
  v_fma_f32 v171, v171, v164, v164
  v_rcp_f32 v168, v168
  v_rcp_f32 v169, v169
  v_rcp_f32 v170, v170
  v_rcp_f32 v171, v171
  v_mul_f32 v112, v112, v168
  v_mul_f32 v113, v113, v169
  v_mul_f32 v114, v114, v170
  v_mul_f32 v115, v115, v171
  v_cvt_pk_bf16_f32 v200, v112, v113
  v_cvt_pk_bf16_f32 v201, v114, v115
  v_fma_f32 v116, v161, v152, v116
  v_fma_f32 v117, v161, v153, v117
  v_fma_f32 v118, v161, v154, v118
  v_fma_f32 v119, v161, v155, v119
  v_mul_f32 v172, v116, v116
  v_mul_f32 v173, v117, v117
  v_mul_f32 v174, v118, v118
  v_mul_f32 v175, v119, v119
  v_fma_f32 v172, v167, v172, v163
  v_fma_f32 v173, v167, v173, v163
  v_fma_f32 v174, v167, v174, v163
  v_fma_f32 v175, v167, v175, v163
  v_mul_f32 v172, v116, v172
  v_mul_f32 v173, v117, v173
  v_mul_f32 v174, v118, v174
  v_mul_f32 v175, v119, v175
  v_exp_f32 v172, v172
  v_exp_f32 v173, v173
  v_exp_f32 v174, v174
  v_exp_f32 v175, v175
  v_fma_f32 v172, v172, v165, v165
  v_fma_f32 v173, v173, v165, v165
  v_fma_f32 v174, v174, v165, v165
  v_fma_f32 v175, v175, v165, v165
  v_rcp_f32 v172, v172
  v_rcp_f32 v173, v173
  v_rcp_f32 v174, v174
  v_rcp_f32 v175, v175
  v_mul_f32 v116, v116, v172
  v_mul_f32 v117, v117, v173
  v_mul_f32 v118, v118, v174
  v_mul_f32 v119, v119, v175
  v_cvt_pk_bf16_f32 v202, v116, v117
  v_cvt_pk_bf16_f32 v203, v118, v119
  s_nop 0
  v_permlane16_swap_b32 v200, v202
  v_permlane16_swap_b32 v201, v203
  s_waitcnt lgkmcnt(0)
  v_fma_f32 v120, v160, v156, v120
  v_fma_f32 v121, v160, v157, v121
  v_fma_f32 v122, v160, v158, v122
  v_fma_f32 v123, v160, v159, v123
  v_mul_f32 v168, v120, v120
  v_mul_f32 v169, v121, v121
  v_mul_f32 v170, v122, v122
  v_mul_f32 v171, v123, v123
  v_fma_f32 v168, v166, v168, v162
  v_fma_f32 v169, v166, v169, v162
  v_fma_f32 v170, v166, v170, v162
  v_fma_f32 v171, v166, v171, v162
  v_mul_f32 v168, v120, v168
  v_mul_f32 v169, v121, v169
  v_mul_f32 v170, v122, v170
  v_mul_f32 v171, v123, v171
  v_exp_f32 v168, v168
  v_exp_f32 v169, v169
  v_exp_f32 v170, v170
  v_exp_f32 v171, v171
  v_fma_f32 v168, v168, v164, v164
  v_fma_f32 v169, v169, v164, v164
  v_fma_f32 v170, v170, v164, v164
  v_fma_f32 v171, v171, v164, v164
  v_rcp_f32 v168, v168
  v_rcp_f32 v169, v169
  v_rcp_f32 v170, v170
  v_rcp_f32 v171, v171
  v_mul_f32 v120, v120, v168
  v_mul_f32 v121, v121, v169
  v_mul_f32 v122, v122, v170
  v_mul_f32 v123, v123, v171
  v_cvt_pk_bf16_f32 v204, v120, v121
  v_cvt_pk_bf16_f32 v205, v122, v123
  v_fma_f32 v124, v161, v156, v124
  v_fma_f32 v125, v161, v157, v125
  v_fma_f32 v126, v161, v158, v126
  v_fma_f32 v127, v161, v159, v127
  v_mul_f32 v172, v124, v124
  v_mul_f32 v173, v125, v125
  v_mul_f32 v174, v126, v126
  v_mul_f32 v175, v127, v127
  v_fma_f32 v172, v167, v172, v163
  v_fma_f32 v173, v167, v173, v163
  v_fma_f32 v174, v167, v174, v163
  v_fma_f32 v175, v167, v175, v163
  v_mul_f32 v172, v124, v172
  v_mul_f32 v173, v125, v173
  v_mul_f32 v174, v126, v174
  v_mul_f32 v175, v127, v175
  v_exp_f32 v172, v172
  v_exp_f32 v173, v173
  v_exp_f32 v174, v174
  v_exp_f32 v175, v175
  v_fma_f32 v172, v172, v165, v165
  v_fma_f32 v173, v173, v165, v165
  v_fma_f32 v174, v174, v165, v165
  v_fma_f32 v175, v175, v165, v165
  v_rcp_f32 v172, v172
  v_rcp_f32 v173, v173
  v_rcp_f32 v174, v174
  v_rcp_f32 v175, v175
  v_mul_f32 v124, v124, v172
  v_mul_f32 v125, v125, v173
  v_mul_f32 v126, v126, v174
  v_mul_f32 v127, v127, v175
  v_cvt_pk_bf16_f32 v206, v124, v125
  v_cvt_pk_bf16_f32 v207, v126, v127
  s_nop 0
  v_permlane16_swap_b32 v204, v206
  v_permlane16_swap_b32 v205, v207
.Lc_p1end_g:
  s_mov_b32 s48, s71
  s_add_u32 s49, s72, 8
  s_lshl_b32 s50, s72, 2
  s_mov_b32 s50, 0
  v_lshlrev_b32 v25, 2, v0
  s_cmp_eq_u32 s72, 7
  s_cbranch_scc1 .Lc2_skip
  v_and_b32 v1, 15, v0
  v_lshrrev_b32 v2, 4, v0
  v_lshlrev_b32 v24, 15, v2
  v_lshl_add_u32 v24, v1, 4, v24
  v_mul_u32_u24 v20, 30720, v2
  v_lshl_add_u32 v20, v1, 4, v20
  v_add_u32 v21, 122880, v20
  v_lshrrev_b32 v3, 1, v1
  v_xor_b32 v3, v3, v2
  v_lshlrev_b32 v3, 4, v3
  v_lshl_add_u32 v4, v1, 7, v3
  v_xor_b32 v5, 64, v4
  v_add_u32 v6, 65536, v4
  v_add_u32 v7, 65536, v5
  s_lshl2_add_u32 s3, s49, s75
  s_lshl_b32 s51, s3, 9
  s_mul_i32 s50, s50, 245760
  s_lshl_b32 s58, s3, 17
  s_lshl_b32 s61, s3, 2
  s_lshl_b32 s3, s48, 11
  s_add_u32 s58, s58, s3
  s_add_u32 s58, s58, 8388608
  s_add_u32 s59, s58, 5242880
  s_lshl_b32 s3, s48, 8
  s_add_u32 s61, s61, s3
  s_add_u32 s61, s61, 17366912
  s_mov_b32 s52, 92
  s_mov_b32 s53, 3
  v_mov_b32 v30, 16
  s_waitcnt vmcnt(1)
  v_lshlrev_b32 v64, 16, v176
  v_lshlrev_b32 v65, 16, v176
  v_lshlrev_b32 v66, 16, v176
  v_lshlrev_b32 v67, 16, v176
  v_lshlrev_b32 v68, 16, v176
  v_lshlrev_b32 v69, 16, v176
  v_lshlrev_b32 v70, 16, v176
  v_lshlrev_b32 v71, 16, v176
  v_lshlrev_b32 v72, 16, v177
  v_lshlrev_b32 v73, 16, v177
  v_lshlrev_b32 v74, 16, v177
  v_lshlrev_b32 v75, 16, v177
  v_lshlrev_b32 v76, 16, v177
  v_lshlrev_b32 v77, 16, v177
  v_lshlrev_b32 v78, 16, v177
  v_lshlrev_b32 v79, 16, v177
  v_lshlrev_b32 v80, 16, v178
  v_lshlrev_b32 v81, 16, v178
  v_lshlrev_b32 v82, 16, v178
  v_lshlrev_b32 v83, 16, v178
  v_lshlrev_b32 v84, 16, v178
  v_lshlrev_b32 v85, 16, v178
  v_lshlrev_b32 v86, 16, v178
  v_lshlrev_b32 v87, 16, v178
  v_lshlrev_b32 v88, 16, v179
  v_lshlrev_b32 v89, 16, v179
  v_lshlrev_b32 v90, 16, v179
  v_lshlrev_b32 v91, 16, v179
  v_lshlrev_b32 v92, 16, v179
  v_lshlrev_b32 v93, 16, v179
  v_lshlrev_b32 v94, 16, v179
  v_lshlrev_b32 v95, 16, v179
  v_lshlrev_b32 v96, 16, v180
  v_lshlrev_b32 v97, 16, v180
  v_lshlrev_b32 v98, 16, v180
  v_lshlrev_b32 v99, 16, v180
  v_lshlrev_b32 v100, 16, v180
  v_lshlrev_b32 v101, 16, v180
  v_lshlrev_b32 v102, 16, v180
  v_lshlrev_b32 v103, 16, v180
  v_lshlrev_b32 v104, 16, v181
  v_lshlrev_b32 v105, 16, v181
  v_lshlrev_b32 v106, 16, v181
  v_lshlrev_b32 v107, 16, v181
  v_lshlrev_b32 v108, 16, v181
  v_lshlrev_b32 v109, 16, v181
  v_lshlrev_b32 v110, 16, v181
  v_lshlrev_b32 v111, 16, v181
  v_lshlrev_b32 v112, 16, v182
  v_lshlrev_b32 v113, 16, v182
  v_lshlrev_b32 v114, 16, v182
  v_lshlrev_b32 v115, 16, v182
  v_lshlrev_b32 v116, 16, v182
  v_lshlrev_b32 v117, 16, v182
  v_lshlrev_b32 v118, 16, v182
  v_lshlrev_b32 v119, 16, v182
  v_lshlrev_b32 v120, 16, v183
  v_lshlrev_b32 v121, 16, v183
  v_lshlrev_b32 v122, 16, v183
  v_lshlrev_b32 v123, 16, v183
  v_lshlrev_b32 v124, 16, v183
  v_lshlrev_b32 v125, 16, v183
  v_lshlrev_b32 v126, 16, v183
  v_lshlrev_b32 v127, 16, v183
  s_waitcnt vmcnt(0)
  v_cmp_ne_u32 vcc, s73, v184
  s_nop 1
  s_and_b32 s3, vcc_lo, 0xFFFF
  s_cbranch_scc1 .Lc2_fl_g
.Lc2_go_g:
.Lc_p2go_g:
  s_add_u32 s56, s51, s50
  s_add_u32 s50, s51, 7864320
  ds_read_b32 v13, v10 offset:0
  buffer_load_dwordx4 v[128:131], v20, s[16:19], s56 offen sc1
  buffer_load_dwordx4 v[132:135], v20, s[16:19], s56 offen offset:256 sc1
  buffer_load_dwordx4 v[136:139], v21, s[16:19], s56 offen sc1
  buffer_load_dwordx4 v[140:143], v21, s[16:19], s56 offen offset:256 sc1
  s_add_u32 s56, s56, 245760
  buffer_load_dwordx4 v[144:147], v20, s[16:19], s56 offen sc1
  buffer_load_dwordx4 v[148:151], v20, s[16:19], s56 offen offset:256 sc1
  buffer_load_dwordx4 v[152:155], v21, s[16:19], s56 offen sc1
  buffer_load_dwordx4 v[156:159], v21, s[16:19], s56 offen offset:256 sc1
  s_waitcnt lgkmcnt(0)
  v_cmp_gt_u32 vcc, s52, v13
  s_cbranch_vccnz .Lsp_303
.Lrt_304:
.Lc_p2full0_g:
  ds_read_b128 v[32:35], v4 offset:0
  ds_read_b128 v[36:39], v4 offset:2048
  ds_read_b128 v[40:43], v4 offset:4096
  ds_read_b128 v[44:47], v4 offset:6144
  ds_read_b128 v[48:51], v4 offset:8192
  ds_read_b128 v[52:55], v4 offset:10240
  ds_read_b128 v[56:59], v4 offset:12288
  ds_read_b128 v[60:63], v4 offset:14336
  s_add_u32 s56, s56, 245760
  buffer_load_dwordx4 v[160:163], v20, s[16:19], s56 offen sc1
  buffer_load_dwordx4 v[164:167], v20, s[16:19], s56 offen offset:256 sc1
  buffer_load_dwordx4 v[168:171], v21, s[16:19], s56 offen sc1
  buffer_load_dwordx4 v[172:175], v21, s[16:19], s56 offen offset:256 sc1
  s_add_u32 s56, s56, 245760
  buffer_load_dwordx4 v[176:179], v20, s[16:19], s56 offen sc1
  buffer_load_dwordx4 v[180:183], v20, s[16:19], s56 offen offset:256 sc1
  buffer_store_dwordx4 v[192:195], v23, s[16:19], s66 offen sc1
  buffer_store_dwordx4 v[196:199], v23, s[16:19], s67 offen sc1
  buffer_store_dwordx4 v[200:203], v23, s[16:19], s68 offen sc1
  buffer_store_dwordx4 v[204:207], v23, s[16:19], s69 offen sc1
.Lc2_loop_g:
  s_waitcnt vmcnt(13) lgkmcnt(6)
  v_mfma_f32_16x16x32_bf16 v[64:67], v[128:131], v[32:35], v[64:67]
  buffer_load_dwordx4 v[184:187], v21, s[16:19], s56 offen sc1
  v_mfma_f32_16x16x32_bf16 v[68:71], v[132:135], v[32:35], v[68:71]
  ds_read_b128 v[32:35], v5 offset:0
  v_mfma_f32_16x16x32_bf16 v[72:75], v[128:131], v[36:39], v[72:75]
  buffer_load_dwordx4 v[188:191], v21, s[16:19], s56 offen offset:256 sc1
  v_mfma_f32_16x16x32_bf16 v[76:79], v[132:135], v[36:39], v[76:79]
  ds_read_b128 v[36:39], v5 offset:2048
  s_waitcnt lgkmcnt(6)
  v_mfma_f32_16x16x32_bf16 v[80:83], v[128:131], v[40:43], v[80:83]
  v_mfma_f32_16x16x32_bf16 v[84:87], v[132:135], v[40:43], v[84:87]
  ds_read_b128 v[40:43], v5 offset:4096
  v_mfma_f32_16x16x32_bf16 v[88:91], v[128:131], v[44:47], v[88:91]
  ds_read_b32 v13, v10 offset:0
  v_mfma_f32_16x16x32_bf16 v[92:95], v[132:135], v[44:47], v[92:95]
  ds_read_b128 v[44:47], v5 offset:6144
  s_waitcnt lgkmcnt(7)
  v_mfma_f32_16x16x32_bf16 v[96:99], v[128:131], v[48:51], v[96:99]
  buffer_load_dword v31, v25, s[16:19], s60 offen sc1
  s_add_u32 s56, s56, 245760
  s_cmp_eq_u32 s56, s50
  s_cselect_b32 s56, s51, s56
  v_mfma_f32_16x16x32_bf16 v[100:103], v[132:135], v[48:51], v[100:103]
  ds_read_b128 v[48:51], v5 offset:8192
  v_mfma_f32_16x16x32_bf16 v[104:107], v[128:131], v[52:55], v[104:107]
  v_mfma_f32_16x16x32_bf16 v[108:111], v[132:135], v[52:55], v[108:111]
  ds_read_b128 v[52:55], v5 offset:10240
  s_waitcnt lgkmcnt(7)
  v_mfma_f32_16x16x32_bf16 v[112:115], v[128:131], v[56:59], v[112:115]
  v_add_u32 v30, 1, v30
  s_add_u32 s52, s52, 4
  v_mfma_f32_16x16x32_bf16 v[116:119], v[132:135], v[56:59], v[116:119]
  ds_read_b128 v[56:59], v5 offset:12288
  v_mfma_f32_16x16x32_bf16 v[120:123], v[128:131], v[60:63], v[120:123]
  v_mfma_f32_16x16x32_bf16 v[124:127], v[132:135], v[60:63], v[124:127]
  ds_read_b128 v[60:63], v5 offset:14336
  s_waitcnt vmcnt(14) lgkmcnt(5)
  v_mfma_f32_16x16x32_bf16 v[64:67], v[136:139], v[32:35], v[64:67]
  v_cmp_gt_u32 vcc, s52, v13
  s_cbranch_vccnz .Lsp_323
.Lrt_324:
  v_mfma_f32_16x16x32_bf16 v[68:71], v[140:143], v[32:35], v[68:71]
  ds_read_b128 v[32:35], v4 offset:16384
  v_mfma_f32_16x16x32_bf16 v[72:75], v[136:139], v[36:39], v[72:75]
  ds_write_b32 v11, v30
  v_mfma_f32_16x16x32_bf16 v[76:79], v[140:143], v[36:39], v[76:79]
  ds_read_b128 v[36:39], v4 offset:18432
  s_waitcnt lgkmcnt(7)
  v_mfma_f32_16x16x32_bf16 v[80:83], v[136:139], v[40:43], v[80:83]
  buffer_load_dwordx4 v[192:195], v20, s[16:19], s56 offen sc1
  v_mfma_f32_16x16x32_bf16 v[84:87], v[140:143], v[40:43], v[84:87]
  ds_read_b128 v[40:43], v4 offset:20480
  v_mfma_f32_16x16x32_bf16 v[88:91], v[136:139], v[44:47], v[88:91]
  buffer_load_dwordx4 v[196:199], v20, s[16:19], s56 offen offset:256 sc1
  v_mfma_f32_16x16x32_bf16 v[92:95], v[140:143], v[44:47], v[92:95]
  ds_read_b128 v[44:47], v4 offset:22528
  s_waitcnt lgkmcnt(7)
  v_mfma_f32_16x16x32_bf16 v[96:99], v[136:139], v[48:51], v[96:99]
  v_mfma_f32_16x16x32_bf16 v[100:103], v[140:143], v[48:51], v[100:103]
  ds_read_b128 v[48:51], v4 offset:24576
  v_mfma_f32_16x16x32_bf16 v[104:107], v[136:139], v[52:55], v[104:107]
  v_mfma_f32_16x16x32_bf16 v[108:111], v[140:143], v[52:55], v[108:111]
  ds_read_b128 v[52:55], v4 offset:26624
  s_waitcnt lgkmcnt(7)
  v_mfma_f32_16x16x32_bf16 v[112:115], v[136:139], v[56:59], v[112:115]
  v_mfma_f32_16x16x32_bf16 v[116:119], v[140:143], v[56:59], v[116:119]
  ds_read_b128 v[56:59], v4 offset:28672
  v_mfma_f32_16x16x32_bf16 v[120:123], v[136:139], v[60:63], v[120:123]
  v_mfma_f32_16x16x32_bf16 v[124:127], v[140:143], v[60:63], v[124:127]
  ds_read_b128 v[60:63], v4 offset:30720
  s_waitcnt vmcnt(13) lgkmcnt(6)
  v_mfma_f32_16x16x32_bf16 v[64:67], v[144:147], v[32:35], v[64:67]
  buffer_load_dwordx4 v[200:203], v21, s[16:19], s56 offen sc1
  v_mfma_f32_16x16x32_bf16 v[68:71], v[148:151], v[32:35], v[68:71]
  ds_read_b128 v[32:35], v5 offset:16384
  v_mfma_f32_16x16x32_bf16 v[72:75], v[144:147], v[36:39], v[72:75]
  buffer_load_dwordx4 v[204:207], v21, s[16:19], s56 offen offset:256 sc1
  v_mfma_f32_16x16x32_bf16 v[76:79], v[148:151], v[36:39], v[76:79]
  ds_read_b128 v[36:39], v5 offset:18432
  s_waitcnt lgkmcnt(6)
  v_mfma_f32_16x16x32_bf16 v[80:83], v[144:147], v[40:43], v[80:83]
  v_mfma_f32_16x16x32_bf16 v[84:87], v[148:151], v[40:43], v[84:87]
  ds_read_b128 v[40:43], v5 offset:20480
  v_mfma_f32_16x16x32_bf16 v[88:91], v[144:147], v[44:47], v[88:91]
  ds_read_b32 v13, v10 offset:0
  v_mfma_f32_16x16x32_bf16 v[92:95], v[148:151], v[44:47], v[92:95]
  ds_read_b128 v[44:47], v5 offset:22528
  s_waitcnt lgkmcnt(7)
  v_mfma_f32_16x16x32_bf16 v[96:99], v[144:147], v[48:51], v[96:99]
  s_add_u32 s56, s56, 245760
  v_mfma_f32_16x16x32_bf16 v[100:103], v[148:151], v[48:51], v[100:103]
  ds_read_b128 v[48:51], v5 offset:24576
  v_mfma_f32_16x16x32_bf16 v[104:107], v[144:147], v[52:55], v[104:107]
  v_mfma_f32_16x16x32_bf16 v[108:111], v[148:151], v[52:55], v[108:111]
  ds_read_b128 v[52:55], v5 offset:26624
  s_waitcnt lgkmcnt(7)
  v_mfma_f32_16x16x32_bf16 v[112:115], v[144:147], v[56:59], v[112:115]
  v_add_u32 v30, 1, v30
  s_add_u32 s52, s52, 4
  v_mfma_f32_16x16x32_bf16 v[116:119], v[148:151], v[56:59], v[116:119]
  ds_read_b128 v[56:59], v5 offset:28672
  v_mfma_f32_16x16x32_bf16 v[120:123], v[144:147], v[60:63], v[120:123]
  v_mfma_f32_16x16x32_bf16 v[124:127], v[148:151], v[60:63], v[124:127]
  ds_read_b128 v[60:63], v5 offset:30720
  s_waitcnt vmcnt(13) lgkmcnt(5)
  v_mfma_f32_16x16x32_bf16 v[64:67], v[152:155], v[32:35], v[64:67]
  v_cmp_gt_u32 vcc, s52, v13
  s_cbranch_vccnz .Lsp_325
.Lrt_326:
  v_mfma_f32_16x16x32_bf16 v[68:71], v[156:159], v[32:35], v[68:71]
  ds_read_b128 v[32:35], v4 offset:32768
  v_mfma_f32_16x16x32_bf16 v[72:75], v[152:155], v[36:39], v[72:75]
  ds_write_b32 v11, v30
  v_mfma_f32_16x16x32_bf16 v[76:79], v[156:159], v[36:39], v[76:79]
  ds_read_b128 v[36:39], v4 offset:34816
  s_waitcnt lgkmcnt(7)
  v_mfma_f32_16x16x32_bf16 v[80:83], v[152:155], v[40:43], v[80:83]
  buffer_load_dwordx4 v[208:211], v20, s[16:19], s56 offen sc1
  v_mfma_f32_16x16x32_bf16 v[84:87], v[156:159], v[40:43], v[84:87]
  ds_read_b128 v[40:43], v4 offset:36864
  v_mfma_f32_16x16x32_bf16 v[88:91], v[152:155], v[44:47], v[88:91]
  buffer_load_dwordx4 v[212:215], v20, s[16:19], s56 offen offset:256 sc1
  v_mfma_f32_16x16x32_bf16 v[92:95], v[156:159], v[44:47], v[92:95]
  ds_read_b128 v[44:47], v4 offset:38912
  s_waitcnt lgkmcnt(7)
  v_mfma_f32_16x16x32_bf16 v[96:99], v[152:155], v[48:51], v[96:99]
  v_mfma_f32_16x16x32_bf16 v[100:103], v[156:159], v[48:51], v[100:103]
  ds_read_b128 v[48:51], v4 offset:40960
  v_mfma_f32_16x16x32_bf16 v[104:107], v[152:155], v[52:55], v[104:107]
  v_mfma_f32_16x16x32_bf16 v[108:111], v[156:159], v[52:55], v[108:111]
  ds_read_b128 v[52:55], v4 offset:43008
  s_waitcnt lgkmcnt(7)
  v_mfma_f32_16x16x32_bf16 v[112:115], v[152:155], v[56:59], v[112:115]
  v_mfma_f32_16x16x32_bf16 v[116:119], v[156:159], v[56:59], v[116:119]
  ds_read_b128 v[56:59], v4 offset:45056
  v_mfma_f32_16x16x32_bf16 v[120:123], v[152:155], v[60:63], v[120:123]
  v_mfma_f32_16x16x32_bf16 v[124:127], v[156:159], v[60:63], v[124:127]
  ds_read_b128 v[60:63], v4 offset:47104
  s_waitcnt vmcnt(13) lgkmcnt(6)
  v_mfma_f32_16x16x32_bf16 v[64:67], v[160:163], v[32:35], v[64:67]
  buffer_load_dwordx4 v[216:219], v21, s[16:19], s56 offen sc1
  v_mfma_f32_16x16x32_bf16 v[68:71], v[164:167], v[32:35], v[68:71]
  ds_read_b128 v[32:35], v5 offset:32768
  v_mfma_f32_16x16x32_bf16 v[72:75], v[160:163], v[36:39], v[72:75]
  buffer_load_dwordx4 v[220:223], v21, s[16:19], s56 offen offset:256 sc1
  v_mfma_f32_16x16x32_bf16 v[76:79], v[164:167], v[36:39], v[76:79]
  ds_read_b128 v[36:39], v5 offset:34816
  s_waitcnt lgkmcnt(6)
  v_mfma_f32_16x16x32_bf16 v[80:83], v[160:163], v[40:43], v[80:83]
  v_mfma_f32_16x16x32_bf16 v[84:87], v[164:167], v[40:43], v[84:87]
  ds_read_b128 v[40:43], v5 offset:36864
  v_mfma_f32_16x16x32_bf16 v[88:91], v[160:163], v[44:47], v[88:91]
  ds_read_b32 v13, v10 offset:0
  v_mfma_f32_16x16x32_bf16 v[92:95], v[164:167], v[44:47], v[92:95]
  ds_read_b128 v[44:47], v5 offset:38912
  s_waitcnt lgkmcnt(7)
  v_mfma_f32_16x16x32_bf16 v[96:99], v[160:163], v[48:51], v[96:99]
  s_add_u32 s56, s56, 245760
  v_mfma_f32_16x16x32_bf16 v[100:103], v[164:167], v[48:51], v[100:103]
  ds_read_b128 v[48:51], v5 offset:40960
  v_mfma_f32_16x16x32_bf16 v[104:107], v[160:163], v[52:55], v[104:107]
  v_mfma_f32_16x16x32_bf16 v[108:111], v[164:167], v[52:55], v[108:111]
  ds_read_b128 v[52:55], v5 offset:43008
  s_waitcnt lgkmcnt(7)
  v_mfma_f32_16x16x32_bf16 v[112:115], v[160:163], v[56:59], v[112:115]
  v_add_u32 v30, 1, v30
  s_add_u32 s52, s52, 4
  v_mfma_f32_16x16x32_bf16 v[116:119], v[164:167], v[56:59], v[116:119]
  ds_read_b128 v[56:59], v5 offset:45056
  v_mfma_f32_16x16x32_bf16 v[120:123], v[160:163], v[60:63], v[120:123]
  v_mfma_f32_16x16x32_bf16 v[124:127], v[164:167], v[60:63], v[124:127]
  ds_read_b128 v[60:63], v5 offset:47104
  s_waitcnt vmcnt(13) lgkmcnt(5)
  v_mfma_f32_16x16x32_bf16 v[64:67], v[168:171], v[32:35], v[64:67]
  v_cmp_gt_u32 vcc, s52, v13
  s_cbranch_vccnz .Lsp_327
.Lrt_328:
  v_mfma_f32_16x16x32_bf16 v[68:71], v[172:175], v[32:35], v[68:71]
  ds_read_b128 v[32:35], v4 offset:49152
  v_mfma_f32_16x16x32_bf16 v[72:75], v[168:171], v[36:39], v[72:75]
  ds_write_b32 v11, v30
  v_mfma_f32_16x16x32_bf16 v[76:79], v[172:175], v[36:39], v[76:79]
  ds_read_b128 v[36:39], v4 offset:51200
  s_waitcnt lgkmcnt(7)
  v_mfma_f32_16x16x32_bf16 v[80:83], v[168:171], v[40:43], v[80:83]
  buffer_load_dwordx4 v[224:227], v20, s[16:19], s56 offen sc1
  v_mfma_f32_16x16x32_bf16 v[84:87], v[172:175], v[40:43], v[84:87]
  ds_read_b128 v[40:43], v4 offset:53248
  v_mfma_f32_16x16x32_bf16 v[88:91], v[168:171], v[44:47], v[88:91]
  buffer_load_dwordx4 v[228:231], v20, s[16:19], s56 offen offset:256 sc1
  v_mfma_f32_16x16x32_bf16 v[92:95], v[172:175], v[44:47], v[92:95]
  ds_read_b128 v[44:47], v4 offset:55296
  s_waitcnt lgkmcnt(7)
  v_mfma_f32_16x16x32_bf16 v[96:99], v[168:171], v[48:51], v[96:99]
  v_mfma_f32_16x16x32_bf16 v[100:103], v[172:175], v[48:51], v[100:103]
  ds_read_b128 v[48:51], v4 offset:57344
  v_mfma_f32_16x16x32_bf16 v[104:107], v[168:171], v[52:55], v[104:107]
  v_mfma_f32_16x16x32_bf16 v[108:111], v[172:175], v[52:55], v[108:111]
  ds_read_b128 v[52:55], v4 offset:59392
  s_waitcnt lgkmcnt(7)
  v_mfma_f32_16x16x32_bf16 v[112:115], v[168:171], v[56:59], v[112:115]
  v_mfma_f32_16x16x32_bf16 v[116:119], v[172:175], v[56:59], v[116:119]
  ds_read_b128 v[56:59], v4 offset:61440
  v_mfma_f32_16x16x32_bf16 v[120:123], v[168:171], v[60:63], v[120:123]
  v_mfma_f32_16x16x32_bf16 v[124:127], v[172:175], v[60:63], v[124:127]
  ds_read_b128 v[60:63], v4 offset:63488
  s_waitcnt vmcnt(13) lgkmcnt(6)
  v_mfma_f32_16x16x32_bf16 v[64:67], v[176:179], v[32:35], v[64:67]
  buffer_load_dwordx4 v[232:235], v21, s[16:19], s56 offen sc1
  v_mfma_f32_16x16x32_bf16 v[68:71], v[180:183], v[32:35], v[68:71]
  ds_read_b128 v[32:35], v5 offset:49152
  v_mfma_f32_16x16x32_bf16 v[72:75], v[176:179], v[36:39], v[72:75]
  buffer_load_dwordx4 v[236:239], v21, s[16:19], s56 offen offset:256 sc1
  v_mfma_f32_16x16x32_bf16 v[76:79], v[180:183], v[36:39], v[76:79]
  ds_read_b128 v[36:39], v5 offset:51200
  s_waitcnt lgkmcnt(6)
  v_mfma_f32_16x16x32_bf16 v[80:83], v[176:179], v[40:43], v[80:83]
  v_mfma_f32_16x16x32_bf16 v[84:87], v[180:183], v[40:43], v[84:87]
  ds_read_b128 v[40:43], v5 offset:53248
  v_mfma_f32_16x16x32_bf16 v[88:91], v[176:179], v[44:47], v[88:91]
  ds_read_b32 v13, v10 offset:0
  v_mfma_f32_16x16x32_bf16 v[92:95], v[180:183], v[44:47], v[92:95]
  ds_read_b128 v[44:47], v5 offset:55296
  s_waitcnt lgkmcnt(7)
  v_mfma_f32_16x16x32_bf16 v[96:99], v[176:179], v[48:51], v[96:99]
  s_add_u32 s56, s56, 245760
  v_mfma_f32_16x16x32_bf16 v[100:103], v[180:183], v[48:51], v[100:103]
  ds_read_b128 v[48:51], v5 offset:57344
  v_mfma_f32_16x16x32_bf16 v[104:107], v[176:179], v[52:55], v[104:107]
  v_mfma_f32_16x16x32_bf16 v[108:111], v[180:183], v[52:55], v[108:111]
  ds_read_b128 v[52:55], v5 offset:59392
  s_waitcnt lgkmcnt(7)
  v_mfma_f32_16x16x32_bf16 v[112:115], v[176:179], v[56:59], v[112:115]
  v_add_u32 v30, 1, v30
  s_add_u32 s52, s52, 4
  v_mfma_f32_16x16x32_bf16 v[116:119], v[180:183], v[56:59], v[116:119]
  ds_read_b128 v[56:59], v5 offset:61440
  v_mfma_f32_16x16x32_bf16 v[120:123], v[176:179], v[60:63], v[120:123]
  v_mfma_f32_16x16x32_bf16 v[124:127], v[180:183], v[60:63], v[124:127]
  ds_read_b128 v[60:63], v5 offset:63488
  s_waitcnt vmcnt(13) lgkmcnt(5)
  v_mfma_f32_16x16x32_bf16 v[64:67], v[184:187], v[32:35], v[64:67]
  v_cmp_gt_u32 vcc, s52, v13
  s_cbranch_vccnz .Lsp_329
.Lrt_330:
  v_mfma_f32_16x16x32_bf16 v[68:71], v[188:191], v[32:35], v[68:71]
  ds_read_b128 v[32:35], v6 offset:0
  v_mfma_f32_16x16x32_bf16 v[72:75], v[184:187], v[36:39], v[72:75]
  ds_write_b32 v11, v30
  v_mfma_f32_16x16x32_bf16 v[76:79], v[188:191], v[36:39], v[76:79]
  ds_read_b128 v[36:39], v6 offset:2048
  s_waitcnt lgkmcnt(7)
  v_mfma_f32_16x16x32_bf16 v[80:83], v[184:187], v[40:43], v[80:83]
  buffer_load_dwordx4 v[240:243], v20, s[16:19], s56 offen sc1
  v_mfma_f32_16x16x32_bf16 v[84:87], v[188:191], v[40:43], v[84:87]
  ds_read_b128 v[40:43], v6 offset:4096
  v_mfma_f32_16x16x32_bf16 v[88:91], v[184:187], v[44:47], v[88:91]
  buffer_load_dwordx4 v[244:247], v20, s[16:19], s56 offen offset:256 sc1
  v_mfma_f32_16x16x32_bf16 v[92:95], v[188:191], v[44:47], v[92:95]
  ds_read_b128 v[44:47], v6 offset:6144
  s_waitcnt lgkmcnt(7)
  v_mfma_f32_16x16x32_bf16 v[96:99], v[184:187], v[48:51], v[96:99]
  v_mfma_f32_16x16x32_bf16 v[100:103], v[188:191], v[48:51], v[100:103]
  ds_read_b128 v[48:51], v6 offset:8192
  v_mfma_f32_16x16x32_bf16 v[104:107], v[184:187], v[52:55], v[104:107]
  v_mfma_f32_16x16x32_bf16 v[108:111], v[188:191], v[52:55], v[108:111]
  ds_read_b128 v[52:55], v6 offset:10240
  s_waitcnt lgkmcnt(7)
  v_mfma_f32_16x16x32_bf16 v[112:115], v[184:187], v[56:59], v[112:115]
  v_mfma_f32_16x16x32_bf16 v[116:119], v[188:191], v[56:59], v[116:119]
  ds_read_b128 v[56:59], v6 offset:12288
  v_mfma_f32_16x16x32_bf16 v[120:123], v[184:187], v[60:63], v[120:123]
  v_mfma_f32_16x16x32_bf16 v[124:127], v[188:191], v[60:63], v[124:127]
  ds_read_b128 v[60:63], v6 offset:14336
  s_waitcnt vmcnt(12) lgkmcnt(6)
  v_mfma_f32_16x16x32_bf16 v[64:67], v[192:195], v[32:35], v[64:67]
  buffer_load_dwordx4 v[248:251], v21, s[16:19], s56 offen sc1
  v_mfma_f32_16x16x32_bf16 v[68:71], v[196:199], v[32:35], v[68:71]
  ds_read_b128 v[32:35], v7 offset:0
  v_mfma_f32_16x16x32_bf16 v[72:75], v[192:195], v[36:39], v[72:75]
  buffer_load_dwordx4 v[252:255], v21, s[16:19], s56 offen offset:256 sc1
  v_mfma_f32_16x16x32_bf16 v[76:79], v[196:199], v[36:39], v[76:79]
  ds_read_b128 v[36:39], v7 offset:2048
  s_waitcnt lgkmcnt(6)
  v_mfma_f32_16x16x32_bf16 v[80:83], v[192:195], v[40:43], v[80:83]
  v_mfma_f32_16x16x32_bf16 v[84:87], v[196:199], v[40:43], v[84:87]
  ds_read_b128 v[40:43], v7 offset:4096
  v_mfma_f32_16x16x32_bf16 v[88:91], v[192:195], v[44:47], v[88:91]
  ds_read_b32 v13, v10 offset:0
  v_mfma_f32_16x16x32_bf16 v[92:95], v[196:199], v[44:47], v[92:95]
  ds_read_b128 v[44:47], v7 offset:6144
  s_waitcnt lgkmcnt(7)
  v_mfma_f32_16x16x32_bf16 v[96:99], v[192:195], v[48:51], v[96:99]
  s_add_u32 s56, s56, 245760
  s_cmp_eq_u32 s56, s50
  s_cselect_b32 s56, s51, s56
  v_mfma_f32_16x16x32_bf16 v[100:103], v[196:199], v[48:51], v[100:103]
  ds_read_b128 v[48:51], v7 offset:8192
  v_mfma_f32_16x16x32_bf16 v[104:107], v[192:195], v[52:55], v[104:107]
  s_waitcnt vmcnt(16)
  v_cmp_ne_u32 vcc, s73, v31
  s_cbranch_vccnz .Lsp_331
.Lrt_332:
  v_mfma_f32_16x16x32_bf16 v[108:111], v[196:199], v[52:55], v[108:111]
  ds_read_b128 v[52:55], v7 offset:10240
  s_waitcnt lgkmcnt(7)
  v_mfma_f32_16x16x32_bf16 v[112:115], v[192:195], v[56:59], v[112:115]
  v_add_u32 v30, 1, v30
  s_add_u32 s52, s52, 4
  v_mfma_f32_16x16x32_bf16 v[116:119], v[196:199], v[56:59], v[116:119]
  ds_read_b128 v[56:59], v7 offset:12288
  v_mfma_f32_16x16x32_bf16 v[120:123], v[192:195], v[60:63], v[120:123]
  v_mfma_f32_16x16x32_bf16 v[124:127], v[196:199], v[60:63], v[124:127]
  ds_read_b128 v[60:63], v7 offset:14336
  s_waitcnt vmcnt(12) lgkmcnt(5)
  v_mfma_f32_16x16x32_bf16 v[64:67], v[200:203], v[32:35], v[64:67]
  v_cmp_gt_u32 vcc, s52, v13
  s_cbranch_vccnz .Lsp_333
.Lrt_334:
  v_mfma_f32_16x16x32_bf16 v[68:71], v[204:207], v[32:35], v[68:71]
  ds_read_b128 v[32:35], v6 offset:16384
  v_mfma_f32_16x16x32_bf16 v[72:75], v[200:203], v[36:39], v[72:75]
  ds_write_b32 v11, v30
  v_mfma_f32_16x16x32_bf16 v[76:79], v[204:207], v[36:39], v[76:79]
  ds_read_b128 v[36:39], v6 offset:18432
  s_waitcnt lgkmcnt(7)
  v_mfma_f32_16x16x32_bf16 v[80:83], v[200:203], v[40:43], v[80:83]
  buffer_load_dwordx4 v[128:131], v20, s[16:19], s56 offen sc1
  v_mfma_f32_16x16x32_bf16 v[84:87], v[204:207], v[40:43], v[84:87]
  ds_read_b128 v[40:43], v6 offset:20480
  v_mfma_f32_16x16x32_bf16 v[88:91], v[200:203], v[44:47], v[88:91]
  buffer_load_dwordx4 v[132:135], v20, s[16:19], s56 offen offset:256 sc1
  v_mfma_f32_16x16x32_bf16 v[92:95], v[204:207], v[44:47], v[92:95]
  ds_read_b128 v[44:47], v6 offset:22528
  s_waitcnt lgkmcnt(7)
  v_mfma_f32_16x16x32_bf16 v[96:99], v[200:203], v[48:51], v[96:99]
  v_mfma_f32_16x16x32_bf16 v[100:103], v[204:207], v[48:51], v[100:103]
  ds_read_b128 v[48:51], v6 offset:24576
  v_mfma_f32_16x16x32_bf16 v[104:107], v[200:203], v[52:55], v[104:107]
  v_mfma_f32_16x16x32_bf16 v[108:111], v[204:207], v[52:55], v[108:111]
  ds_read_b128 v[52:55], v6 offset:26624
  s_waitcnt lgkmcnt(7)
  v_mfma_f32_16x16x32_bf16 v[112:115], v[200:203], v[56:59], v[112:115]
  v_mfma_f32_16x16x32_bf16 v[116:119], v[204:207], v[56:59], v[116:119]
  ds_read_b128 v[56:59], v6 offset:28672
  v_mfma_f32_16x16x32_bf16 v[120:123], v[200:203], v[60:63], v[120:123]
  v_mfma_f32_16x16x32_bf16 v[124:127], v[204:207], v[60:63], v[124:127]
  ds_read_b128 v[60:63], v6 offset:30720
  s_waitcnt vmcnt(12) lgkmcnt(6)
  v_mfma_f32_16x16x32_bf16 v[64:67], v[208:211], v[32:35], v[64:67]
  buffer_load_dwordx4 v[136:139], v21, s[16:19], s56 offen sc1
  v_mfma_f32_16x16x32_bf16 v[68:71], v[212:215], v[32:35], v[68:71]
  ds_read_b128 v[32:35], v7 offset:16384
  v_mfma_f32_16x16x32_bf16 v[72:75], v[208:211], v[36:39], v[72:75]
  buffer_load_dwordx4 v[140:143], v21, s[16:19], s56 offen offset:256 sc1
  v_mfma_f32_16x16x32_bf16 v[76:79], v[212:215], v[36:39], v[76:79]
  ds_read_b128 v[36:39], v7 offset:18432
  s_waitcnt lgkmcnt(6)
  v_mfma_f32_16x16x32_bf16 v[80:83], v[208:211], v[40:43], v[80:83]
  v_mfma_f32_16x16x32_bf16 v[84:87], v[212:215], v[40:43], v[84:87]
  ds_read_b128 v[40:43], v7 offset:20480
  v_mfma_f32_16x16x32_bf16 v[88:91], v[208:211], v[44:47], v[88:91]
  ds_read_b32 v13, v10 offset:0
  v_mfma_f32_16x16x32_bf16 v[92:95], v[212:215], v[44:47], v[92:95]
  ds_read_b128 v[44:47], v7 offset:22528
  s_waitcnt lgkmcnt(7)
  v_mfma_f32_16x16x32_bf16 v[96:99], v[208:211], v[48:51], v[96:99]
  s_add_u32 s56, s56, 245760
  v_mfma_f32_16x16x32_bf16 v[100:103], v[212:215], v[48:51], v[100:103]
  ds_read_b128 v[48:51], v7 offset:24576
  v_mfma_f32_16x16x32_bf16 v[104:107], v[208:211], v[52:55], v[104:107]
  v_mfma_f32_16x16x32_bf16 v[108:111], v[212:215], v[52:55], v[108:111]
  ds_read_b128 v[52:55], v7 offset:26624
  s_waitcnt lgkmcnt(7)
  v_mfma_f32_16x16x32_bf16 v[112:115], v[208:211], v[56:59], v[112:115]
  s_mov_b64 exec, 1
  buffer_store_dword v12, off, s[16:19], s57 sc1
  s_mov_b64 exec, -1
  v_add_u32 v30, 1, v30
  s_add_u32 s52, s52, 4
  v_mfma_f32_16x16x32_bf16 v[116:119], v[212:215], v[56:59], v[116:119]
  ds_read_b128 v[56:59], v7 offset:28672
  v_mfma_f32_16x16x32_bf16 v[120:123], v[208:211], v[60:63], v[120:123]
  v_mfma_f32_16x16x32_bf16 v[124:127], v[212:215], v[60:63], v[124:127]
  ds_read_b128 v[60:63], v7 offset:30720
  s_waitcnt vmcnt(13) lgkmcnt(5)
  v_mfma_f32_16x16x32_bf16 v[64:67], v[216:219], v[32:35], v[64:67]
  v_cmp_gt_u32 vcc, s52, v13
  s_cbranch_vccnz .Lsp_335
.Lrt_336:
  v_mfma_f32_16x16x32_bf16 v[68:71], v[220:223], v[32:35], v[68:71]
  ds_read_b128 v[32:35], v6 offset:32768
  v_mfma_f32_16x16x32_bf16 v[72:75], v[216:219], v[36:39], v[72:75]
  ds_write_b32 v11, v30
  v_mfma_f32_16x16x32_bf16 v[76:79], v[220:223], v[36:39], v[76:79]
  ds_read_b128 v[36:39], v6 offset:34816
  s_waitcnt lgkmcnt(7)
  v_mfma_f32_16x16x32_bf16 v[80:83], v[216:219], v[40:43], v[80:83]
  buffer_load_dwordx4 v[144:147], v20, s[16:19], s56 offen sc1
  v_mfma_f32_16x16x32_bf16 v[84:87], v[220:223], v[40:43], v[84:87]
  ds_read_b128 v[40:43], v6 offset:36864
  v_mfma_f32_16x16x32_bf16 v[88:91], v[216:219], v[44:47], v[88:91]
  buffer_load_dwordx4 v[148:151], v20, s[16:19], s56 offen offset:256 sc1
  v_mfma_f32_16x16x32_bf16 v[92:95], v[220:223], v[44:47], v[92:95]
  ds_read_b128 v[44:47], v6 offset:38912
  s_waitcnt lgkmcnt(7)
  v_mfma_f32_16x16x32_bf16 v[96:99], v[216:219], v[48:51], v[96:99]
  v_mfma_f32_16x16x32_bf16 v[100:103], v[220:223], v[48:51], v[100:103]
  ds_read_b128 v[48:51], v6 offset:40960
  v_mfma_f32_16x16x32_bf16 v[104:107], v[216:219], v[52:55], v[104:107]
  v_mfma_f32_16x16x32_bf16 v[108:111], v[220:223], v[52:55], v[108:111]
  ds_read_b128 v[52:55], v6 offset:43008
  s_waitcnt lgkmcnt(7)
  v_mfma_f32_16x16x32_bf16 v[112:115], v[216:219], v[56:59], v[112:115]
  v_mfma_f32_16x16x32_bf16 v[116:119], v[220:223], v[56:59], v[116:119]
  ds_read_b128 v[56:59], v6 offset:45056
  v_mfma_f32_16x16x32_bf16 v[120:123], v[216:219], v[60:63], v[120:123]
  v_mfma_f32_16x16x32_bf16 v[124:127], v[220:223], v[60:63], v[124:127]
  ds_read_b128 v[60:63], v6 offset:47104
  s_waitcnt vmcnt(13) lgkmcnt(6)
  v_mfma_f32_16x16x32_bf16 v[64:67], v[224:227], v[32:35], v[64:67]
  buffer_load_dwordx4 v[152:155], v21, s[16:19], s56 offen sc1
  v_mfma_f32_16x16x32_bf16 v[68:71], v[228:231], v[32:35], v[68:71]
  ds_read_b128 v[32:35], v7 offset:32768
  v_mfma_f32_16x16x32_bf16 v[72:75], v[224:227], v[36:39], v[72:75]
  buffer_load_dwordx4 v[156:159], v21, s[16:19], s56 offen offset:256 sc1
  v_mfma_f32_16x16x32_bf16 v[76:79], v[228:231], v[36:39], v[76:79]
  ds_read_b128 v[36:39], v7 offset:34816
  s_waitcnt lgkmcnt(6)
  v_mfma_f32_16x16x32_bf16 v[80:83], v[224:227], v[40:43], v[80:83]
  v_mfma_f32_16x16x32_bf16 v[84:87], v[228:231], v[40:43], v[84:87]
  ds_read_b128 v[40:43], v7 offset:36864
  v_mfma_f32_16x16x32_bf16 v[88:91], v[224:227], v[44:47], v[88:91]
  ds_read_b32 v13, v10 offset:0
  v_mfma_f32_16x16x32_bf16 v[92:95], v[228:231], v[44:47], v[92:95]
  ds_read_b128 v[44:47], v7 offset:38912
  s_waitcnt lgkmcnt(7)
  v_mfma_f32_16x16x32_bf16 v[96:99], v[224:227], v[48:51], v[96:99]
  s_add_u32 s56, s56, 245760
  v_mfma_f32_16x16x32_bf16 v[100:103], v[228:231], v[48:51], v[100:103]
  ds_read_b128 v[48:51], v7 offset:40960
  v_mfma_f32_16x16x32_bf16 v[104:107], v[224:227], v[52:55], v[104:107]
  v_mfma_f32_16x16x32_bf16 v[108:111], v[228:231], v[52:55], v[108:111]
  ds_read_b128 v[52:55], v7 offset:43008
  s_waitcnt lgkmcnt(7)
  v_mfma_f32_16x16x32_bf16 v[112:115], v[224:227], v[56:59], v[112:115]
  v_add_u32 v30, 1, v30
  s_add_u32 s52, s52, 4
  v_mfma_f32_16x16x32_bf16 v[116:119], v[228:231], v[56:59], v[116:119]
  ds_read_b128 v[56:59], v7 offset:45056
  v_mfma_f32_16x16x32_bf16 v[120:123], v[224:227], v[60:63], v[120:123]
  v_mfma_f32_16x16x32_bf16 v[124:127], v[228:231], v[60:63], v[124:127]
  ds_read_b128 v[60:63], v7 offset:47104
  s_waitcnt vmcnt(13) lgkmcnt(5)
  v_mfma_f32_16x16x32_bf16 v[64:67], v[232:235], v[32:35], v[64:67]
  v_cmp_gt_u32 vcc, s52, v13
  s_cbranch_vccnz .Lsp_337
.Lrt_338:
  v_mfma_f32_16x16x32_bf16 v[68:71], v[236:239], v[32:35], v[68:71]
  ds_read_b128 v[32:35], v6 offset:49152
  v_mfma_f32_16x16x32_bf16 v[72:75], v[232:235], v[36:39], v[72:75]
  ds_write_b32 v11, v30
  v_mfma_f32_16x16x32_bf16 v[76:79], v[236:239], v[36:39], v[76:79]
  ds_read_b128 v[36:39], v6 offset:51200
  s_waitcnt lgkmcnt(7)
  v_mfma_f32_16x16x32_bf16 v[80:83], v[232:235], v[40:43], v[80:83]
  buffer_load_dwordx4 v[160:163], v20, s[16:19], s56 offen sc1
  v_mfma_f32_16x16x32_bf16 v[84:87], v[236:239], v[40:43], v[84:87]
  ds_read_b128 v[40:43], v6 offset:53248
  v_mfma_f32_16x16x32_bf16 v[88:91], v[232:235], v[44:47], v[88:91]
  buffer_load_dwordx4 v[164:167], v20, s[16:19], s56 offen offset:256 sc1
  v_mfma_f32_16x16x32_bf16 v[92:95], v[236:239], v[44:47], v[92:95]
  ds_read_b128 v[44:47], v6 offset:55296
  s_waitcnt lgkmcnt(7)
  v_mfma_f32_16x16x32_bf16 v[96:99], v[232:235], v[48:51], v[96:99]
  v_mfma_f32_16x16x32_bf16 v[100:103], v[236:239], v[48:51], v[100:103]
  ds_read_b128 v[48:51], v6 offset:57344
  v_mfma_f32_16x16x32_bf16 v[104:107], v[232:235], v[52:55], v[104:107]
  v_mfma_f32_16x16x32_bf16 v[108:111], v[236:239], v[52:55], v[108:111]
  ds_read_b128 v[52:55], v6 offset:59392
  s_waitcnt lgkmcnt(7)
  v_mfma_f32_16x16x32_bf16 v[112:115], v[232:235], v[56:59], v[112:115]
  v_mfma_f32_16x16x32_bf16 v[116:119], v[236:239], v[56:59], v[116:119]
  ds_read_b128 v[56:59], v6 offset:61440
  v_mfma_f32_16x16x32_bf16 v[120:123], v[232:235], v[60:63], v[120:123]
  v_mfma_f32_16x16x32_bf16 v[124:127], v[236:239], v[60:63], v[124:127]
  ds_read_b128 v[60:63], v6 offset:63488
  s_waitcnt vmcnt(13) lgkmcnt(6)
  v_mfma_f32_16x16x32_bf16 v[64:67], v[240:243], v[32:35], v[64:67]
  buffer_load_dwordx4 v[168:171], v21, s[16:19], s56 offen sc1
  v_mfma_f32_16x16x32_bf16 v[68:71], v[244:247], v[32:35], v[68:71]
  ds_read_b128 v[32:35], v7 offset:49152
  v_mfma_f32_16x16x32_bf16 v[72:75], v[240:243], v[36:39], v[72:75]
  buffer_load_dwordx4 v[172:175], v21, s[16:19], s56 offen offset:256 sc1
  v_mfma_f32_16x16x32_bf16 v[76:79], v[244:247], v[36:39], v[76:79]
  ds_read_b128 v[36:39], v7 offset:51200
  s_waitcnt lgkmcnt(6)
  v_mfma_f32_16x16x32_bf16 v[80:83], v[240:243], v[40:43], v[80:83]
  v_mfma_f32_16x16x32_bf16 v[84:87], v[244:247], v[40:43], v[84:87]
  ds_read_b128 v[40:43], v7 offset:53248
  v_mfma_f32_16x16x32_bf16 v[88:91], v[240:243], v[44:47], v[88:91]
  ds_read_b32 v13, v10 offset:0
  v_mfma_f32_16x16x32_bf16 v[92:95], v[244:247], v[44:47], v[92:95]
  ds_read_b128 v[44:47], v7 offset:55296
  s_waitcnt lgkmcnt(7)
  v_mfma_f32_16x16x32_bf16 v[96:99], v[240:243], v[48:51], v[96:99]
  s_add_u32 s56, s56, 245760
  v_mfma_f32_16x16x32_bf16 v[100:103], v[244:247], v[48:51], v[100:103]
  ds_read_b128 v[48:51], v7 offset:57344
  v_mfma_f32_16x16x32_bf16 v[104:107], v[240:243], v[52:55], v[104:107]
  v_mfma_f32_16x16x32_bf16 v[108:111], v[244:247], v[52:55], v[108:111]
  ds_read_b128 v[52:55], v7 offset:59392
  s_waitcnt lgkmcnt(7)
  v_mfma_f32_16x16x32_bf16 v[112:115], v[240:243], v[56:59], v[112:115]
  v_add_u32 v30, 1, v30
  s_add_u32 s52, s52, 4
  v_mfma_f32_16x16x32_bf16 v[116:119], v[244:247], v[56:59], v[116:119]
  ds_read_b128 v[56:59], v7 offset:61440
  v_mfma_f32_16x16x32_bf16 v[120:123], v[240:243], v[60:63], v[120:123]
  v_mfma_f32_16x16x32_bf16 v[124:127], v[244:247], v[60:63], v[124:127]
  ds_read_b128 v[60:63], v7 offset:63488
  s_waitcnt vmcnt(13) lgkmcnt(5)
  v_mfma_f32_16x16x32_bf16 v[64:67], v[248:251], v[32:35], v[64:67]
  v_cmp_gt_u32 vcc, s52, v13
  s_cbranch_vccnz .Lsp_339
.Lrt_340:
  v_mfma_f32_16x16x32_bf16 v[68:71], v[252:255], v[32:35], v[68:71]
  ds_read_b128 v[32:35], v4 offset:0
  v_mfma_f32_16x16x32_bf16 v[72:75], v[248:251], v[36:39], v[72:75]
  ds_write_b32 v11, v30
  v_mfma_f32_16x16x32_bf16 v[76:79], v[252:255], v[36:39], v[76:79]
  ds_read_b128 v[36:39], v4 offset:2048
  s_waitcnt lgkmcnt(7)
  v_mfma_f32_16x16x32_bf16 v[80:83], v[248:251], v[40:43], v[80:83]
  buffer_load_dwordx4 v[176:179], v20, s[16:19], s56 offen sc1
  v_mfma_f32_16x16x32_bf16 v[84:87], v[252:255], v[40:43], v[84:87]
  ds_read_b128 v[40:43], v4 offset:4096
  v_mfma_f32_16x16x32_bf16 v[88:91], v[248:251], v[44:47], v[88:91]
  buffer_load_dwordx4 v[180:183], v20, s[16:19], s56 offen offset:256 sc1
  v_mfma_f32_16x16x32_bf16 v[92:95], v[252:255], v[44:47], v[92:95]
  ds_read_b128 v[44:47], v4 offset:6144
  s_waitcnt lgkmcnt(7)
  v_mfma_f32_16x16x32_bf16 v[96:99], v[248:251], v[48:51], v[96:99]
  v_mfma_f32_16x16x32_bf16 v[100:103], v[252:255], v[48:51], v[100:103]
  ds_read_b128 v[48:51], v4 offset:8192
  v_mfma_f32_16x16x32_bf16 v[104:107], v[248:251], v[52:55], v[104:107]
  v_mfma_f32_16x16x32_bf16 v[108:111], v[252:255], v[52:55], v[108:111]
  ds_read_b128 v[52:55], v4 offset:10240
  s_waitcnt lgkmcnt(7)
  v_mfma_f32_16x16x32_bf16 v[112:115], v[248:251], v[56:59], v[112:115]
  s_sub_u32 s53, s53, 1
  s_cmp_lg_u32 s53, 0
  v_mfma_f32_16x16x32_bf16 v[116:119], v[252:255], v[56:59], v[116:119]
  ds_read_b128 v[56:59], v4 offset:12288
  v_mfma_f32_16x16x32_bf16 v[120:123], v[248:251], v[60:63], v[120:123]
  v_mfma_f32_16x16x32_bf16 v[124:127], v[252:255], v[60:63], v[124:127]
  ds_read_b128 v[60:63], v4 offset:14336
  s_cbranch_scc1 .Lc2_loop_g
.Lc2_last_g:
.Lc2_n24_g:
  s_waitcnt vmcnt(13) lgkmcnt(6)
  v_mfma_f32_16x16x32_bf16 v[64:67], v[128:131], v[32:35], v[64:67]
  buffer_load_dwordx4 v[184:187], v21, s[16:19], s56 offen sc1
  v_mfma_f32_16x16x32_bf16 v[68:71], v[132:135], v[32:35], v[68:71]
  ds_read_b128 v[32:35], v5 offset:0
  v_mfma_f32_16x16x32_bf16 v[72:75], v[128:131], v[36:39], v[72:75]
  buffer_load_dwordx4 v[188:191], v21, s[16:19], s56 offen offset:256 sc1
  v_mfma_f32_16x16x32_bf16 v[76:79], v[132:135], v[36:39], v[76:79]
  ds_read_b128 v[36:39], v5 offset:2048
  s_waitcnt lgkmcnt(6)
  v_mfma_f32_16x16x32_bf16 v[80:83], v[128:131], v[40:43], v[80:83]
  v_mfma_f32_16x16x32_bf16 v[84:87], v[132:135], v[40:43], v[84:87]
  ds_read_b128 v[40:43], v5 offset:4096
  v_mfma_f32_16x16x32_bf16 v[88:91], v[128:131], v[44:47], v[88:91]
  ds_read_b32 v13, v10 offset:0
  v_mfma_f32_16x16x32_bf16 v[92:95], v[132:135], v[44:47], v[92:95]
  ds_read_b128 v[44:47], v5 offset:6144
  s_waitcnt lgkmcnt(7)
  v_mfma_f32_16x16x32_bf16 v[96:99], v[128:131], v[48:51], v[96:99]
  s_add_u32 s56, s56, 245760
  s_cmp_eq_u32 s56, s50
  s_cselect_b32 s56, s51, s56
  v_mfma_f32_16x16x32_bf16 v[100:103], v[132:135], v[48:51], v[100:103]
  ds_read_b128 v[48:51], v5 offset:8192
  v_mfma_f32_16x16x32_bf16 v[104:107], v[128:131], v[52:55], v[104:107]
  v_mfma_f32_16x16x32_bf16 v[108:111], v[132:135], v[52:55], v[108:111]
  ds_read_b128 v[52:55], v5 offset:10240
  s_waitcnt lgkmcnt(7)
  v_mfma_f32_16x16x32_bf16 v[112:115], v[128:131], v[56:59], v[112:115]
  s_lshl_b32 s3, s48, 4
  s_add_u32 s60, s60, s3
  v_and_b32 v25, 12, v25
  buffer_load_dword v31, v25, s[16:19], s60 offen offset:3584 sc1
  v_add_u32 v30, 1, v30
  s_add_u32 s52, s52, 4
  v_mfma_f32_16x16x32_bf16 v[116:119], v[132:135], v[56:59], v[116:119]
  ds_read_b128 v[56:59], v5 offset:12288
  v_mfma_f32_16x16x32_bf16 v[120:123], v[128:131], v[60:63], v[120:123]
  v_mfma_f32_16x16x32_bf16 v[124:127], v[132:135], v[60:63], v[124:127]
  ds_read_b128 v[60:63], v5 offset:14336
  s_waitcnt vmcnt(14) lgkmcnt(5)
  v_mfma_f32_16x16x32_bf16 v[64:67], v[136:139], v[32:35], v[64:67]
  v_cmp_gt_u32 vcc, s52, v13
  s_cbranch_vccnz .Lsp_359
.Lrt_360:
  v_mfma_f32_16x16x32_bf16 v[68:71], v[140:143], v[32:35], v[68:71]
  ds_read_b128 v[32:35], v4 offset:16384
  v_mfma_f32_16x16x32_bf16 v[72:75], v[136:139], v[36:39], v[72:75]
  ds_write_b32 v11, v30
  v_mfma_f32_16x16x32_bf16 v[76:79], v[140:143], v[36:39], v[76:79]
  ds_read_b128 v[36:39], v4 offset:18432
  s_waitcnt lgkmcnt(7)
  v_mfma_f32_16x16x32_bf16 v[80:83], v[136:139], v[40:43], v[80:83]
  buffer_load_dwordx4 v[192:195], v20, s[16:19], s56 offen sc1
  v_mfma_f32_16x16x32_bf16 v[84:87], v[140:143], v[40:43], v[84:87]
  ds_read_b128 v[40:43], v4 offset:20480
  v_mfma_f32_16x16x32_bf16 v[88:91], v[136:139], v[44:47], v[88:91]
  buffer_load_dwordx4 v[196:199], v20, s[16:19], s56 offen offset:256 sc1
  v_mfma_f32_16x16x32_bf16 v[92:95], v[140:143], v[44:47], v[92:95]
  ds_read_b128 v[44:47], v4 offset:22528
  s_waitcnt lgkmcnt(7)
  v_mfma_f32_16x16x32_bf16 v[96:99], v[136:139], v[48:51], v[96:99]
  v_mfma_f32_16x16x32_bf16 v[100:103], v[140:143], v[48:51], v[100:103]
  ds_read_b128 v[48:51], v4 offset:24576
  v_mfma_f32_16x16x32_bf16 v[104:107], v[136:139], v[52:55], v[104:107]
  v_mfma_f32_16x16x32_bf16 v[108:111], v[140:143], v[52:55], v[108:111]
  ds_read_b128 v[52:55], v4 offset:26624
  s_waitcnt lgkmcnt(7)
  v_mfma_f32_16x16x32_bf16 v[112:115], v[136:139], v[56:59], v[112:115]
  v_mfma_f32_16x16x32_bf16 v[116:119], v[140:143], v[56:59], v[116:119]
  ds_read_b128 v[56:59], v4 offset:28672
  v_mfma_f32_16x16x32_bf16 v[120:123], v[136:139], v[60:63], v[120:123]
  v_mfma_f32_16x16x32_bf16 v[124:127], v[140:143], v[60:63], v[124:127]
  ds_read_b128 v[60:63], v4 offset:30720
.Lc2_n25_g:
  s_waitcnt vmcnt(13) lgkmcnt(6)
  v_mfma_f32_16x16x32_bf16 v[64:67], v[144:147], v[32:35], v[64:67]
  buffer_load_dwordx4 v[200:203], v21, s[16:19], s56 offen sc1
  v_mfma_f32_16x16x32_bf16 v[68:71], v[148:151], v[32:35], v[68:71]
  ds_read_b128 v[32:35], v5 offset:16384
  v_mfma_f32_16x16x32_bf16 v[72:75], v[144:147], v[36:39], v[72:75]
  buffer_load_dwordx4 v[204:207], v21, s[16:19], s56 offen offset:256 sc1
  v_mfma_f32_16x16x32_bf16 v[76:79], v[148:151], v[36:39], v[76:79]
  ds_read_b128 v[36:39], v5 offset:18432
  s_waitcnt lgkmcnt(6)
  v_mfma_f32_16x16x32_bf16 v[80:83], v[144:147], v[40:43], v[80:83]
  v_mfma_f32_16x16x32_bf16 v[84:87], v[148:151], v[40:43], v[84:87]
  ds_read_b128 v[40:43], v5 offset:20480
  v_mfma_f32_16x16x32_bf16 v[88:91], v[144:147], v[44:47], v[88:91]
  ds_read_b32 v13, v10 offset:0
  v_mfma_f32_16x16x32_bf16 v[92:95], v[148:151], v[44:47], v[92:95]
  ds_read_b128 v[44:47], v5 offset:22528
  s_waitcnt lgkmcnt(7)
  v_mfma_f32_16x16x32_bf16 v[96:99], v[144:147], v[48:51], v[96:99]
  s_add_u32 s56, s56, 245760
  v_mfma_f32_16x16x32_bf16 v[100:103], v[148:151], v[48:51], v[100:103]
  ds_read_b128 v[48:51], v5 offset:24576
  v_mfma_f32_16x16x32_bf16 v[104:107], v[144:147], v[52:55], v[104:107]
  v_mfma_f32_16x16x32_bf16 v[108:111], v[148:151], v[52:55], v[108:111]
  ds_read_b128 v[52:55], v5 offset:26624
  s_waitcnt lgkmcnt(7)
  v_mfma_f32_16x16x32_bf16 v[112:115], v[144:147], v[56:59], v[112:115]
  v_add_u32 v30, 1, v30
  s_add_u32 s52, s52, 4
  v_mfma_f32_16x16x32_bf16 v[116:119], v[148:151], v[56:59], v[116:119]
  ds_read_b128 v[56:59], v5 offset:28672
  v_mfma_f32_16x16x32_bf16 v[120:123], v[144:147], v[60:63], v[120:123]
  v_mfma_f32_16x16x32_bf16 v[124:127], v[148:151], v[60:63], v[124:127]
  ds_read_b128 v[60:63], v5 offset:30720
  s_waitcnt vmcnt(13) lgkmcnt(5)
  v_mfma_f32_16x16x32_bf16 v[64:67], v[152:155], v[32:35], v[64:67]
  v_cmp_gt_u32 vcc, s52, v13
  s_cbranch_vccnz .Lsp_361
.Lrt_362:
  v_mfma_f32_16x16x32_bf16 v[68:71], v[156:159], v[32:35], v[68:71]
  ds_read_b128 v[32:35], v4 offset:32768
  v_mfma_f32_16x16x32_bf16 v[72:75], v[152:155], v[36:39], v[72:75]
  ds_write_b32 v11, v30
  v_mfma_f32_16x16x32_bf16 v[76:79], v[156:159], v[36:39], v[76:79]
  ds_read_b128 v[36:39], v4 offset:34816
  s_waitcnt lgkmcnt(7)
  v_mfma_f32_16x16x32_bf16 v[80:83], v[152:155], v[40:43], v[80:83]
  buffer_load_dwordx4 v[208:211], v20, s[16:19], s56 offen sc1
  v_mfma_f32_16x16x32_bf16 v[84:87], v[156:159], v[40:43], v[84:87]
  ds_read_b128 v[40:43], v4 offset:36864
  v_mfma_f32_16x16x32_bf16 v[88:91], v[152:155], v[44:47], v[88:91]
  buffer_load_dwordx4 v[212:215], v20, s[16:19], s56 offen offset:256 sc1
  v_mfma_f32_16x16x32_bf16 v[92:95], v[156:159], v[44:47], v[92:95]
  ds_read_b128 v[44:47], v4 offset:38912
  s_waitcnt lgkmcnt(7)
  v_mfma_f32_16x16x32_bf16 v[96:99], v[152:155], v[48:51], v[96:99]
  v_mfma_f32_16x16x32_bf16 v[100:103], v[156:159], v[48:51], v[100:103]
  ds_read_b128 v[48:51], v4 offset:40960
  v_mfma_f32_16x16x32_bf16 v[104:107], v[152:155], v[52:55], v[104:107]
  v_mfma_f32_16x16x32_bf16 v[108:111], v[156:159], v[52:55], v[108:111]
  ds_read_b128 v[52:55], v4 offset:43008
  s_waitcnt lgkmcnt(7)
  v_mfma_f32_16x16x32_bf16 v[112:115], v[152:155], v[56:59], v[112:115]
  v_mfma_f32_16x16x32_bf16 v[116:119], v[156:159], v[56:59], v[116:119]
  ds_read_b128 v[56:59], v4 offset:45056
  v_mfma_f32_16x16x32_bf16 v[120:123], v[152:155], v[60:63], v[120:123]
  v_mfma_f32_16x16x32_bf16 v[124:127], v[156:159], v[60:63], v[124:127]
  ds_read_b128 v[60:63], v4 offset:47104
.Lc2_n26_g:
  s_waitcnt vmcnt(13) lgkmcnt(6)
  v_mfma_f32_16x16x32_bf16 v[64:67], v[160:163], v[32:35], v[64:67]
  buffer_load_dwordx4 v[216:219], v21, s[16:19], s56 offen sc1
  v_mfma_f32_16x16x32_bf16 v[68:71], v[164:167], v[32:35], v[68:71]
  ds_read_b128 v[32:35], v5 offset:32768
  v_mfma_f32_16x16x32_bf16 v[72:75], v[160:163], v[36:39], v[72:75]
  buffer_load_dwordx4 v[220:223], v21, s[16:19], s56 offen offset:256 sc1
  v_mfma_f32_16x16x32_bf16 v[76:79], v[164:167], v[36:39], v[76:79]
  ds_read_b128 v[36:39], v5 offset:34816
  s_waitcnt lgkmcnt(6)
  v_mfma_f32_16x16x32_bf16 v[80:83], v[160:163], v[40:43], v[80:83]
  v_mfma_f32_16x16x32_bf16 v[84:87], v[164:167], v[40:43], v[84:87]
  ds_read_b128 v[40:43], v5 offset:36864
  v_mfma_f32_16x16x32_bf16 v[88:91], v[160:163], v[44:47], v[88:91]
  ds_read_b32 v13, v10 offset:0
  v_mfma_f32_16x16x32_bf16 v[92:95], v[164:167], v[44:47], v[92:95]
  ds_read_b128 v[44:47], v5 offset:38912
  s_waitcnt lgkmcnt(7)
  v_mfma_f32_16x16x32_bf16 v[96:99], v[160:163], v[48:51], v[96:99]
  s_add_u32 s56, s56, 245760
  v_mfma_f32_16x16x32_bf16 v[100:103], v[164:167], v[48:51], v[100:103]
  ds_read_b128 v[48:51], v5 offset:40960
  v_mfma_f32_16x16x32_bf16 v[104:107], v[160:163], v[52:55], v[104:107]
  v_mfma_f32_16x16x32_bf16 v[108:111], v[164:167], v[52:55], v[108:111]
  ds_read_b128 v[52:55], v5 offset:43008
  s_waitcnt lgkmcnt(7)
  v_mfma_f32_16x16x32_bf16 v[112:115], v[160:163], v[56:59], v[112:115]
  v_add_u32 v30, 1, v30
  s_add_u32 s52, s52, 4
  v_mfma_f32_16x16x32_bf16 v[116:119], v[164:167], v[56:59], v[116:119]
  ds_read_b128 v[56:59], v5 offset:45056
  v_mfma_f32_16x16x32_bf16 v[120:123], v[160:163], v[60:63], v[120:123]
  v_mfma_f32_16x16x32_bf16 v[124:127], v[164:167], v[60:63], v[124:127]
  ds_read_b128 v[60:63], v5 offset:47104
  s_waitcnt vmcnt(13) lgkmcnt(5)
  v_mfma_f32_16x16x32_bf16 v[64:67], v[168:171], v[32:35], v[64:67]
  v_cmp_gt_u32 vcc, s52, v13
  s_cbranch_vccnz .Lsp_363
.Lrt_364:
  v_mfma_f32_16x16x32_bf16 v[68:71], v[172:175], v[32:35], v[68:71]
  ds_read_b128 v[32:35], v4 offset:49152
  v_mfma_f32_16x16x32_bf16 v[72:75], v[168:171], v[36:39], v[72:75]
  ds_write_b32 v11, v30
  v_mfma_f32_16x16x32_bf16 v[76:79], v[172:175], v[36:39], v[76:79]
  ds_read_b128 v[36:39], v4 offset:51200
  s_waitcnt lgkmcnt(7)
  v_mfma_f32_16x16x32_bf16 v[80:83], v[168:171], v[40:43], v[80:83]
  buffer_load_dwordx4 v[224:227], v20, s[16:19], s56 offen sc1
  s_waitcnt vmcnt(9)
  v_cmp_ne_u32 vcc, s73, v31
  s_cbranch_vccnz .Lc2_zf
.Lc2_zgo:
.Lc2_zg_g:
  v_mfma_f32_16x16x32_bf16 v[84:87], v[172:175], v[40:43], v[84:87]
  ds_read_b128 v[40:43], v4 offset:53248
  v_mfma_f32_16x16x32_bf16 v[88:91], v[168:171], v[44:47], v[88:91]
  buffer_load_dwordx4 v[228:231], v20, s[16:19], s56 offen offset:256 sc1
  v_mfma_f32_16x16x32_bf16 v[92:95], v[172:175], v[44:47], v[92:95]
  ds_read_b128 v[44:47], v4 offset:55296
  s_waitcnt lgkmcnt(7)
  v_mfma_f32_16x16x32_bf16 v[96:99], v[168:171], v[48:51], v[96:99]
  buffer_load_dwordx4 v[128:131], v24, s[16:19], s59 offen offset:0 sc1
  v_mfma_f32_16x16x32_bf16 v[100:103], v[172:175], v[48:51], v[100:103]
  ds_read_b128 v[48:51], v4 offset:57344
  v_mfma_f32_16x16x32_bf16 v[104:107], v[168:171], v[52:55], v[104:107]
  buffer_load_dwordx4 v[132:135], v24, s[16:19], s59 offen offset:256 sc1
  v_mfma_f32_16x16x32_bf16 v[108:111], v[172:175], v[52:55], v[108:111]
  ds_read_b128 v[52:55], v4 offset:59392
  s_waitcnt lgkmcnt(7)
  v_mfma_f32_16x16x32_bf16 v[112:115], v[168:171], v[56:59], v[112:115]
  v_mfma_f32_16x16x32_bf16 v[116:119], v[172:175], v[56:59], v[116:119]
  ds_read_b128 v[56:59], v4 offset:61440
  v_mfma_f32_16x16x32_bf16 v[120:123], v[168:171], v[60:63], v[120:123]
  v_mfma_f32_16x16x32_bf16 v[124:127], v[172:175], v[60:63], v[124:127]
  ds_read_b128 v[60:63], v4 offset:63488
.Lc2_n27_g:
  s_waitcnt vmcnt(15) lgkmcnt(6)
  v_mfma_f32_16x16x32_bf16 v[64:67], v[176:179], v[32:35], v[64:67]
  buffer_load_dwordx4 v[232:235], v21, s[16:19], s56 offen sc1
  v_mfma_f32_16x16x32_bf16 v[68:71], v[180:183], v[32:35], v[68:71]
  ds_read_b128 v[32:35], v5 offset:49152
  v_mfma_f32_16x16x32_bf16 v[72:75], v[176:179], v[36:39], v[72:75]
  buffer_load_dwordx4 v[236:239], v21, s[16:19], s56 offen offset:256 sc1
  v_mfma_f32_16x16x32_bf16 v[76:79], v[180:183], v[36:39], v[76:79]
  ds_read_b128 v[36:39], v5 offset:51200
  s_waitcnt lgkmcnt(6)
  v_mfma_f32_16x16x32_bf16 v[80:83], v[176:179], v[40:43], v[80:83]
  buffer_load_dwordx4 v[136:139], v24, s[16:19], s59 offen offset:512 sc1
  v_mfma_f32_16x16x32_bf16 v[84:87], v[180:183], v[40:43], v[84:87]
  ds_read_b128 v[40:43], v5 offset:53248
  v_mfma_f32_16x16x32_bf16 v[88:91], v[176:179], v[44:47], v[88:91]
  buffer_load_dwordx4 v[140:143], v24, s[16:19], s59 offen offset:768 sc1
  ds_read_b32 v13, v10 offset:0
  v_mfma_f32_16x16x32_bf16 v[92:95], v[180:183], v[44:47], v[92:95]
  ds_read_b128 v[44:47], v5 offset:55296
  s_waitcnt lgkmcnt(7)
  v_mfma_f32_16x16x32_bf16 v[96:99], v[176:179], v[48:51], v[96:99]
  s_add_u32 s56, s56, 245760
  v_mfma_f32_16x16x32_bf16 v[100:103], v[180:183], v[48:51], v[100:103]
  ds_read_b128 v[48:51], v5 offset:57344
  v_mfma_f32_16x16x32_bf16 v[104:107], v[176:179], v[52:55], v[104:107]
  v_mfma_f32_16x16x32_bf16 v[108:111], v[180:183], v[52:55], v[108:111]
  ds_read_b128 v[52:55], v5 offset:59392
  s_waitcnt lgkmcnt(7)
  v_mfma_f32_16x16x32_bf16 v[112:115], v[176:179], v[56:59], v[112:115]
  v_add_u32 v30, 1, v30
  s_add_u32 s52, s52, 4
  v_mfma_f32_16x16x32_bf16 v[116:119], v[180:183], v[56:59], v[116:119]
  ds_read_b128 v[56:59], v5 offset:61440
  v_mfma_f32_16x16x32_bf16 v[120:123], v[176:179], v[60:63], v[120:123]
  v_mfma_f32_16x16x32_bf16 v[124:127], v[180:183], v[60:63], v[124:127]
  ds_read_b128 v[60:63], v5 offset:63488
  s_waitcnt vmcnt(17) lgkmcnt(5)
  v_mfma_f32_16x16x32_bf16 v[64:67], v[184:187], v[32:35], v[64:67]
  v_cmp_gt_u32 vcc, s52, v13
  s_cbranch_vccnz .Lsp_365
.Lrt_366:
  v_mfma_f32_16x16x32_bf16 v[68:71], v[188:191], v[32:35], v[68:71]
  ds_read_b128 v[32:35], v6 offset:0
  v_mfma_f32_16x16x32_bf16 v[72:75], v[184:187], v[36:39], v[72:75]
  ds_write_b32 v11, v30
  v_mfma_f32_16x16x32_bf16 v[76:79], v[188:191], v[36:39], v[76:79]
  ds_read_b128 v[36:39], v6 offset:2048
  s_waitcnt lgkmcnt(7)
  v_mfma_f32_16x16x32_bf16 v[80:83], v[184:187], v[40:43], v[80:83]
  buffer_load_dwordx4 v[240:243], v20, s[16:19], s56 offen sc1
  v_mfma_f32_16x16x32_bf16 v[84:87], v[188:191], v[40:43], v[84:87]
  ds_read_b128 v[40:43], v6 offset:4096
  v_mfma_f32_16x16x32_bf16 v[88:91], v[184:187], v[44:47], v[88:91]
  buffer_load_dwordx4 v[244:247], v20, s[16:19], s56 offen offset:256 sc1
  v_mfma_f32_16x16x32_bf16 v[92:95], v[188:191], v[44:47], v[92:95]
  ds_read_b128 v[44:47], v6 offset:6144
  s_waitcnt lgkmcnt(7)
  v_mfma_f32_16x16x32_bf16 v[96:99], v[184:187], v[48:51], v[96:99]
  buffer_load_dwordx4 v[144:147], v24, s[16:19], s59 offen offset:1024 sc1
  v_mfma_f32_16x16x32_bf16 v[100:103], v[188:191], v[48:51], v[100:103]
  ds_read_b128 v[48:51], v6 offset:8192
  v_mfma_f32_16x16x32_bf16 v[104:107], v[184:187], v[52:55], v[104:107]
  buffer_load_dwordx4 v[148:151], v24, s[16:19], s59 offen offset:1280 sc1
  v_mfma_f32_16x16x32_bf16 v[108:111], v[188:191], v[52:55], v[108:111]
  ds_read_b128 v[52:55], v6 offset:10240
  s_waitcnt lgkmcnt(7)
  v_mfma_f32_16x16x32_bf16 v[112:115], v[184:187], v[56:59], v[112:115]
  v_mfma_f32_16x16x32_bf16 v[116:119], v[188:191], v[56:59], v[116:119]
  ds_read_b128 v[56:59], v6 offset:12288
  v_mfma_f32_16x16x32_bf16 v[120:123], v[184:187], v[60:63], v[120:123]
  v_mfma_f32_16x16x32_bf16 v[124:127], v[188:191], v[60:63], v[124:127]
  ds_read_b128 v[60:63], v6 offset:14336
.Lc2_n28_g:
  s_waitcnt vmcnt(18) lgkmcnt(6)
  v_mfma_f32_16x16x32_bf16 v[64:67], v[192:195], v[32:35], v[64:67]
  buffer_load_dwordx4 v[248:251], v21, s[16:19], s56 offen sc1
  v_mfma_f32_16x16x32_bf16 v[68:71], v[196:199], v[32:35], v[68:71]
  ds_read_b128 v[32:35], v7 offset:0
  v_mfma_f32_16x16x32_bf16 v[72:75], v[192:195], v[36:39], v[72:75]
  buffer_load_dwordx4 v[252:255], v21, s[16:19], s56 offen offset:256 sc1
  v_mfma_f32_16x16x32_bf16 v[76:79], v[196:199], v[36:39], v[76:79]
  ds_read_b128 v[36:39], v7 offset:2048
  s_waitcnt lgkmcnt(6)
  v_mfma_f32_16x16x32_bf16 v[80:83], v[192:195], v[40:43], v[80:83]
  buffer_load_dwordx4 v[152:155], v24, s[16:19], s59 offen offset:1536 sc1
  v_mfma_f32_16x16x32_bf16 v[84:87], v[196:199], v[40:43], v[84:87]
  ds_read_b128 v[40:43], v7 offset:4096
  v_mfma_f32_16x16x32_bf16 v[88:91], v[192:195], v[44:47], v[88:91]
  buffer_load_dwordx4 v[156:159], v24, s[16:19], s59 offen offset:1792 sc1
  ds_read_b32 v13, v10 offset:0
  v_mfma_f32_16x16x32_bf16 v[92:95], v[196:199], v[44:47], v[92:95]
  ds_read_b128 v[44:47], v7 offset:6144
  s_waitcnt lgkmcnt(7)
  v_mfma_f32_16x16x32_bf16 v[96:99], v[192:195], v[48:51], v[96:99]
  v_mfma_f32_16x16x32_bf16 v[100:103], v[196:199], v[48:51], v[100:103]
  ds_read_b128 v[48:51], v7 offset:8192
  v_mfma_f32_16x16x32_bf16 v[104:107], v[192:195], v[52:55], v[104:107]
  v_mfma_f32_16x16x32_bf16 v[108:111], v[196:199], v[52:55], v[108:111]
  ds_read_b128 v[52:55], v7 offset:10240
  s_waitcnt lgkmcnt(7)
  v_mfma_f32_16x16x32_bf16 v[112:115], v[192:195], v[56:59], v[112:115]
  v_add_u32 v30, 1, v30
  s_add_u32 s52, s52, 4
  v_mfma_f32_16x16x32_bf16 v[116:119], v[196:199], v[56:59], v[116:119]
  ds_read_b128 v[56:59], v7 offset:12288
  v_mfma_f32_16x16x32_bf16 v[120:123], v[192:195], v[60:63], v[120:123]
  v_mfma_f32_16x16x32_bf16 v[124:127], v[196:199], v[60:63], v[124:127]
  ds_read_b128 v[60:63], v7 offset:14336
  s_waitcnt vmcnt(20) lgkmcnt(5)
  v_mfma_f32_16x16x32_bf16 v[64:67], v[200:203], v[32:35], v[64:67]
  v_cmp_gt_u32 vcc, s52, v13
  s_cbranch_vccnz .Lsp_367
.Lrt_368:
  v_mfma_f32_16x16x32_bf16 v[68:71], v[204:207], v[32:35], v[68:71]
  ds_read_b128 v[32:35], v6 offset:16384
  v_mfma_f32_16x16x32_bf16 v[72:75], v[200:203], v[36:39], v[72:75]
  ds_write_b32 v11, v30
  v_mfma_f32_16x16x32_bf16 v[76:79], v[204:207], v[36:39], v[76:79]
  ds_read_b128 v[36:39], v6 offset:18432
  s_waitcnt lgkmcnt(7)
  v_mfma_f32_16x16x32_bf16 v[80:83], v[200:203], v[40:43], v[80:83]
  v_mfma_f32_16x16x32_bf16 v[84:87], v[204:207], v[40:43], v[84:87]
  ds_read_b128 v[40:43], v6 offset:20480
  v_mfma_f32_16x16x32_bf16 v[88:91], v[200:203], v[44:47], v[88:91]
  v_mfma_f32_16x16x32_bf16 v[92:95], v[204:207], v[44:47], v[92:95]
  ds_read_b128 v[44:47], v6 offset:22528
  s_waitcnt lgkmcnt(7)
  v_mfma_f32_16x16x32_bf16 v[96:99], v[200:203], v[48:51], v[96:99]
  v_mfma_f32_16x16x32_bf16 v[100:103], v[204:207], v[48:51], v[100:103]
  ds_read_b128 v[48:51], v6 offset:24576
  v_mfma_f32_16x16x32_bf16 v[104:107], v[200:203], v[52:55], v[104:107]
  v_mfma_f32_16x16x32_bf16 v[108:111], v[204:207], v[52:55], v[108:111]
  ds_read_b128 v[52:55], v6 offset:26624
  s_waitcnt lgkmcnt(7)
  v_mfma_f32_16x16x32_bf16 v[112:115], v[200:203], v[56:59], v[112:115]
  v_mfma_f32_16x16x32_bf16 v[116:119], v[204:207], v[56:59], v[116:119]
  ds_read_b128 v[56:59], v6 offset:28672
  v_mfma_f32_16x16x32_bf16 v[120:123], v[200:203], v[60:63], v[120:123]
  v_mfma_f32_16x16x32_bf16 v[124:127], v[204:207], v[60:63], v[124:127]
  ds_read_b128 v[60:63], v6 offset:30720
.Lc2_n29_g:
  s_waitcnt vmcnt(18) lgkmcnt(6)
  v_mfma_f32_16x16x32_bf16 v[64:67], v[208:211], v[32:35], v[64:67]
  v_mfma_f32_16x16x32_bf16 v[68:71], v[212:215], v[32:35], v[68:71]
  ds_read_b128 v[32:35], v7 offset:16384
  v_mfma_f32_16x16x32_bf16 v[72:75], v[208:211], v[36:39], v[72:75]
  v_mfma_f32_16x16x32_bf16 v[76:79], v[212:215], v[36:39], v[76:79]
  ds_read_b128 v[36:39], v7 offset:18432
  s_waitcnt lgkmcnt(6)
  v_mfma_f32_16x16x32_bf16 v[80:83], v[208:211], v[40:43], v[80:83]
  v_mfma_f32_16x16x32_bf16 v[84:87], v[212:215], v[40:43], v[84:87]
  ds_read_b128 v[40:43], v7 offset:20480
  v_mfma_f32_16x16x32_bf16 v[88:91], v[208:211], v[44:47], v[88:91]
  ds_read_b32 v13, v10 offset:0
  v_mfma_f32_16x16x32_bf16 v[92:95], v[212:215], v[44:47], v[92:95]
  ds_read_b128 v[44:47], v7 offset:22528
  s_waitcnt lgkmcnt(7)
  v_mfma_f32_16x16x32_bf16 v[96:99], v[208:211], v[48:51], v[96:99]
  v_mfma_f32_16x16x32_bf16 v[100:103], v[212:215], v[48:51], v[100:103]
  ds_read_b128 v[48:51], v7 offset:24576
  v_mfma_f32_16x16x32_bf16 v[104:107], v[208:211], v[52:55], v[104:107]
  v_mfma_f32_16x16x32_bf16 v[108:111], v[212:215], v[52:55], v[108:111]
  ds_read_b128 v[52:55], v7 offset:26624
  s_waitcnt lgkmcnt(7)
  v_mfma_f32_16x16x32_bf16 v[112:115], v[208:211], v[56:59], v[112:115]
  v_add_u32 v30, 1, v30
  s_add_u32 s52, s52, 8
  v_mfma_f32_16x16x32_bf16 v[116:119], v[212:215], v[56:59], v[116:119]
  ds_read_b128 v[56:59], v7 offset:28672
  v_mfma_f32_16x16x32_bf16 v[120:123], v[208:211], v[60:63], v[120:123]
  v_mfma_f32_16x16x32_bf16 v[124:127], v[212:215], v[60:63], v[124:127]
  ds_read_b128 v[60:63], v7 offset:30720
  s_waitcnt vmcnt(16) lgkmcnt(5)
  v_mfma_f32_16x16x32_bf16 v[64:67], v[216:219], v[32:35], v[64:67]
  v_cmp_gt_u32 vcc, s52, v13
  s_cbranch_vccnz .Lsp_369
.Lrt_370:
  v_mfma_f32_16x16x32_bf16 v[68:71], v[220:223], v[32:35], v[68:71]
  ds_read_b128 v[32:35], v6 offset:32768
  v_mfma_f32_16x16x32_bf16 v[72:75], v[216:219], v[36:39], v[72:75]
  ds_write_b32 v11, v30
  v_mfma_f32_16x16x32_bf16 v[76:79], v[220:223], v[36:39], v[76:79]
  ds_read_b128 v[36:39], v7 offset:32768
  s_waitcnt lgkmcnt(7)
  v_mfma_f32_16x16x32_bf16 v[80:83], v[216:219], v[40:43], v[80:83]
  v_mfma_f32_16x16x32_bf16 v[84:87], v[220:223], v[40:43], v[84:87]
  ds_read_b128 v[40:43], v6 offset:49152
  v_mfma_f32_16x16x32_bf16 v[88:91], v[216:219], v[44:47], v[88:91]
  v_mfma_f32_16x16x32_bf16 v[92:95], v[220:223], v[44:47], v[92:95]
  ds_read_b128 v[44:47], v7 offset:49152
  s_waitcnt lgkmcnt(7)
  v_mfma_f32_16x16x32_bf16 v[96:99], v[216:219], v[48:51], v[96:99]
  v_mfma_f32_16x16x32_bf16 v[100:103], v[220:223], v[48:51], v[100:103]
  ds_read_b128 v[48:51], v6 offset:34816
  v_mfma_f32_16x16x32_bf16 v[104:107], v[216:219], v[52:55], v[104:107]
  v_mfma_f32_16x16x32_bf16 v[108:111], v[220:223], v[52:55], v[108:111]
  ds_read_b128 v[52:55], v7 offset:34816
  s_waitcnt lgkmcnt(7)
  v_mfma_f32_16x16x32_bf16 v[112:115], v[216:219], v[56:59], v[112:115]
  v_mfma_f32_16x16x32_bf16 v[116:119], v[220:223], v[56:59], v[116:119]
  ds_read_b128 v[56:59], v6 offset:51200
  v_mfma_f32_16x16x32_bf16 v[120:123], v[216:219], v[60:63], v[120:123]
  v_mfma_f32_16x16x32_bf16 v[124:127], v[220:223], v[60:63], v[124:127]
  ds_read_b128 v[60:63], v7 offset:51200
.Lc2_n30_g:
  s_waitcnt vmcnt(14) lgkmcnt(6)
  v_mfma_f32_16x16x32_bf16 v[64:67], v[224:227], v[32:35], v[64:67]
  v_mfma_f32_16x16x32_bf16 v[68:71], v[228:231], v[32:35], v[68:71]
  ds_read_b128 v[32:35], v6 offset:36864
  s_waitcnt vmcnt(10)
  v_mfma_f32_16x16x32_bf16 v[64:67], v[232:235], v[36:39], v[64:67]
  v_mfma_f32_16x16x32_bf16 v[68:71], v[236:239], v[36:39], v[68:71]
  ds_read_b128 v[36:39], v7 offset:36864
.Lc2_n31_g:
  s_waitcnt vmcnt(6) lgkmcnt(6)
  v_mfma_f32_16x16x32_bf16 v[64:67], v[240:243], v[40:43], v[64:67]
  v_mfma_f32_16x16x32_bf16 v[68:71], v[244:247], v[40:43], v[68:71]
  ds_read_b128 v[40:43], v6 offset:53248
  s_waitcnt vmcnt(2)
  v_mfma_f32_16x16x32_bf16 v[64:67], v[248:251], v[44:47], v[64:67]
  v_mfma_f32_16x16x32_bf16 v[68:71], v[252:255], v[44:47], v[68:71]
  ds_read_b128 v[44:47], v7 offset:53248
  s_waitcnt lgkmcnt(6)
  v_mfma_f32_16x16x32_bf16 v[72:75], v[224:227], v[48:51], v[72:75]
  v_mfma_f32_16x16x32_bf16 v[76:79], v[228:231], v[48:51], v[76:79]
  ds_read_b128 v[48:51], v6 offset:38912
  v_mfma_f32_16x16x32_bf16 v[72:75], v[232:235], v[52:55], v[72:75]
  s_waitcnt vmcnt(13)
  v_lshlrev_b32 v8, 16, v128
  v_and_b32 v9, 0xffff0000, v128
  v_mfma_f32_16x16x32_bf16 v[76:79], v[236:239], v[52:55], v[76:79]
  ds_read_b128 v[52:55], v7 offset:38912
  v_mul_f32 v64, v64, v8
  s_waitcnt lgkmcnt(6)
  v_mfma_f32_16x16x32_bf16 v[72:75], v[240:243], v[56:59], v[72:75]
  v_mul_f32 v65, v65, v9
  v_cvt_pk_bf16_f32 v64, v64, v65
  v_mfma_f32_16x16x32_bf16 v[76:79], v[244:247], v[56:59], v[76:79]
  ds_read_b128 v[56:59], v6 offset:55296
  v_lshlrev_b32 v2, 16, v129
  v_mfma_f32_16x16x32_bf16 v[72:75], v[248:251], v[60:63], v[72:75]
  v_and_b32 v3, 0xffff0000, v129
  v_mul_f32 v66, v66, v2
  v_mfma_f32_16x16x32_bf16 v[76:79], v[252:255], v[60:63], v[76:79]
  ds_read_b128 v[60:63], v7 offset:55296
  v_mul_f32 v67, v67, v3
  s_waitcnt lgkmcnt(6)
  v_mfma_f32_16x16x32_bf16 v[80:83], v[224:227], v[32:35], v[80:83]
  v_cvt_pk_bf16_f32 v65, v66, v67
  v_lshlrev_b32 v8, 16, v130
  v_mfma_f32_16x16x32_bf16 v[84:87], v[228:231], v[32:35], v[84:87]
  ds_read_b128 v[32:35], v6 offset:40960
  v_and_b32 v9, 0xffff0000, v130
  v_mfma_f32_16x16x32_bf16 v[80:83], v[232:235], v[36:39], v[80:83]
  v_mul_f32 v68, v68, v8
  v_mul_f32 v69, v69, v9
  v_mfma_f32_16x16x32_bf16 v[84:87], v[236:239], v[36:39], v[84:87]
  ds_read_b128 v[36:39], v7 offset:40960
  v_cvt_pk_bf16_f32 v66, v68, v69
  s_waitcnt lgkmcnt(6)
  v_mfma_f32_16x16x32_bf16 v[80:83], v[240:243], v[40:43], v[80:83]
  v_lshlrev_b32 v2, 16, v131
  v_and_b32 v3, 0xffff0000, v131
  v_mfma_f32_16x16x32_bf16 v[84:87], v[244:247], v[40:43], v[84:87]
  ds_read_b128 v[40:43], v6 offset:57344
  v_mul_f32 v70, v70, v2
  v_mfma_f32_16x16x32_bf16 v[80:83], v[248:251], v[44:47], v[80:83]
  v_mul_f32 v71, v71, v3
  v_cvt_pk_bf16_f32 v67, v70, v71
  v_mfma_f32_16x16x32_bf16 v[84:87], v[252:255], v[44:47], v[84:87]
  ds_read_b128 v[44:47], v7 offset:57344
  buffer_store_dwordx4 v[64:67], v24, s[16:19], s58 offen offset:0 sc1
  s_waitcnt vmcnt(13) lgkmcnt(6)
  v_mfma_f32_16x16x32_bf16 v[88:91], v[224:227], v[48:51], v[88:91]
  v_lshlrev_b32 v8, 16, v132
  v_and_b32 v9, 0xffff0000, v132
  v_mfma_f32_16x16x32_bf16 v[92:95], v[228:231], v[48:51], v[92:95]
  ds_read_b128 v[48:51], v6 offset:43008
  v_mul_f32 v72, v72, v8
  v_mfma_f32_16x16x32_bf16 v[88:91], v[232:235], v[52:55], v[88:91]
  v_mul_f32 v73, v73, v9
  v_cvt_pk_bf16_f32 v72, v72, v73
  v_mfma_f32_16x16x32_bf16 v[92:95], v[236:239], v[52:55], v[92:95]
  ds_read_b128 v[52:55], v7 offset:43008
  v_lshlrev_b32 v2, 16, v133
  s_waitcnt lgkmcnt(6)
  v_mfma_f32_16x16x32_bf16 v[88:91], v[240:243], v[56:59], v[88:91]
  v_and_b32 v3, 0xffff0000, v133
  v_mul_f32 v74, v74, v2
  v_mfma_f32_16x16x32_bf16 v[92:95], v[244:247], v[56:59], v[92:95]
  ds_read_b128 v[56:59], v6 offset:59392
  v_mul_f32 v75, v75, v3
  v_mfma_f32_16x16x32_bf16 v[88:91], v[248:251], v[60:63], v[88:91]
  v_cvt_pk_bf16_f32 v73, v74, v75
  v_lshlrev_b32 v8, 16, v134
  v_mfma_f32_16x16x32_bf16 v[92:95], v[252:255], v[60:63], v[92:95]
  ds_read_b128 v[60:63], v7 offset:59392
  v_and_b32 v9, 0xffff0000, v134
  s_waitcnt lgkmcnt(6)
  v_mfma_f32_16x16x32_bf16 v[96:99], v[224:227], v[32:35], v[96:99]
  v_mul_f32 v76, v76, v8
  v_mul_f32 v77, v77, v9
  v_mfma_f32_16x16x32_bf16 v[100:103], v[228:231], v[32:35], v[100:103]
  ds_read_b128 v[32:35], v6 offset:45056
  v_cvt_pk_bf16_f32 v74, v76, v77
  v_mfma_f32_16x16x32_bf16 v[96:99], v[232:235], v[36:39], v[96:99]
  v_lshlrev_b32 v2, 16, v135
  v_and_b32 v3, 0xffff0000, v135
  v_mfma_f32_16x16x32_bf16 v[100:103], v[236:239], v[36:39], v[100:103]
  ds_read_b128 v[36:39], v7 offset:45056
  v_mul_f32 v78, v78, v2
  s_waitcnt lgkmcnt(6)
  v_mfma_f32_16x16x32_bf16 v[96:99], v[240:243], v[40:43], v[96:99]
  v_mul_f32 v79, v79, v3
  v_cvt_pk_bf16_f32 v75, v78, v79
  v_mfma_f32_16x16x32_bf16 v[100:103], v[244:247], v[40:43], v[100:103]
  ds_read_b128 v[40:43], v6 offset:61440
  buffer_store_dwordx4 v[72:75], v24, s[16:19], s58 offen offset:256 sc1
  s_waitcnt vmcnt(11)
  v_mfma_f32_16x16x32_bf16 v[96:99], v[248:251], v[44:47], v[96:99]
  v_lshlrev_b32 v8, 16, v136
  v_and_b32 v9, 0xffff0000, v136
  v_mfma_f32_16x16x32_bf16 v[100:103], v[252:255], v[44:47], v[100:103]
  ds_read_b128 v[44:47], v7 offset:61440
  v_mul_f32 v80, v80, v8
  s_waitcnt lgkmcnt(6)
  v_mfma_f32_16x16x32_bf16 v[104:107], v[224:227], v[48:51], v[104:107]
  v_mul_f32 v81, v81, v9
  v_cvt_pk_bf16_f32 v80, v80, v81
  v_mfma_f32_16x16x32_bf16 v[108:111], v[228:231], v[48:51], v[108:111]
  ds_read_b128 v[48:51], v6 offset:47104
  v_lshlrev_b32 v2, 16, v137
  v_mfma_f32_16x16x32_bf16 v[104:107], v[232:235], v[52:55], v[104:107]
  v_and_b32 v3, 0xffff0000, v137
  v_mul_f32 v82, v82, v2
  v_mfma_f32_16x16x32_bf16 v[108:111], v[236:239], v[52:55], v[108:111]
  ds_read_b128 v[52:55], v7 offset:47104
  v_mul_f32 v83, v83, v3
  s_waitcnt lgkmcnt(6)
  v_mfma_f32_16x16x32_bf16 v[104:107], v[240:243], v[56:59], v[104:107]
  v_add_u32 v30, 2, v30
  v_cvt_pk_bf16_f32 v81, v82, v83
  v_lshlrev_b32 v8, 16, v138
  v_mfma_f32_16x16x32_bf16 v[108:111], v[244:247], v[56:59], v[108:111]
  ds_read_b128 v[56:59], v6 offset:63488
  v_and_b32 v9, 0xffff0000, v138
  v_mfma_f32_16x16x32_bf16 v[104:107], v[248:251], v[60:63], v[104:107]
  v_mul_f32 v84, v84, v8
  v_mul_f32 v85, v85, v9
  v_mfma_f32_16x16x32_bf16 v[108:111], v[252:255], v[60:63], v[108:111]
  ds_read_b128 v[60:63], v7 offset:63488
  v_cvt_pk_bf16_f32 v82, v84, v85
  s_waitcnt lgkmcnt(6)
  v_mfma_f32_16x16x32_bf16 v[112:115], v[224:227], v[32:35], v[112:115]
  v_lshlrev_b32 v2, 16, v139
  v_and_b32 v3, 0xffff0000, v139
  v_mfma_f32_16x16x32_bf16 v[116:119], v[228:231], v[32:35], v[116:119]
  v_mul_f32 v86, v86, v2
  v_mfma_f32_16x16x32_bf16 v[112:115], v[232:235], v[36:39], v[112:115]
  ds_write_b32 v11, v30
  v_mul_f32 v87, v87, v3
  v_cvt_pk_bf16_f32 v83, v86, v87
  v_mfma_f32_16x16x32_bf16 v[116:119], v[236:239], v[36:39], v[116:119]
  buffer_store_dwordx4 v[80:83], v24, s[16:19], s58 offen offset:512 sc1
  s_waitcnt vmcnt(11) lgkmcnt(5)
  v_mfma_f32_16x16x32_bf16 v[112:115], v[240:243], v[40:43], v[112:115]
  v_lshlrev_b32 v8, 16, v140
  v_and_b32 v9, 0xffff0000, v140
  v_mfma_f32_16x16x32_bf16 v[116:119], v[244:247], v[40:43], v[116:119]
  v_mul_f32 v88, v88, v8
  v_mfma_f32_16x16x32_bf16 v[112:115], v[248:251], v[44:47], v[112:115]
  v_mul_f32 v89, v89, v9
  v_cvt_pk_bf16_f32 v88, v88, v89
  v_mfma_f32_16x16x32_bf16 v[116:119], v[252:255], v[44:47], v[116:119]
  v_lshlrev_b32 v2, 16, v141
  s_waitcnt lgkmcnt(3)
  v_mfma_f32_16x16x32_bf16 v[120:123], v[224:227], v[48:51], v[120:123]
  v_and_b32 v3, 0xffff0000, v141
  v_mul_f32 v90, v90, v2
  v_mfma_f32_16x16x32_bf16 v[124:127], v[228:231], v[48:51], v[124:127]
  v_mul_f32 v91, v91, v3
  v_mfma_f32_16x16x32_bf16 v[120:123], v[232:235], v[52:55], v[120:123]
  v_cvt_pk_bf16_f32 v89, v90, v91
  v_lshlrev_b32 v8, 16, v142
  v_mfma_f32_16x16x32_bf16 v[124:127], v[236:239], v[52:55], v[124:127]
  v_and_b32 v9, 0xffff0000, v142
  s_waitcnt lgkmcnt(1)
  v_mfma_f32_16x16x32_bf16 v[120:123], v[240:243], v[56:59], v[120:123]
  v_mul_f32 v92, v92, v8
  v_mul_f32 v93, v93, v9
  v_mfma_f32_16x16x32_bf16 v[124:127], v[244:247], v[56:59], v[124:127]
  v_cvt_pk_bf16_f32 v90, v92, v93
  v_mfma_f32_16x16x32_bf16 v[120:123], v[248:251], v[60:63], v[120:123]
  v_lshlrev_b32 v2, 16, v143
  v_and_b32 v3, 0xffff0000, v143
  v_mfma_f32_16x16x32_bf16 v[124:127], v[252:255], v[60:63], v[124:127]
  v_mul_f32 v94, v94, v2
.Lc2_mmend_g:
  v_mul_f32 v95, v95, v3
  v_cvt_pk_bf16_f32 v91, v94, v95
  buffer_store_dwordx4 v[88:91], v24, s[16:19], s58 offen offset:768 sc1
  s_waitcnt vmcnt(9)
  v_lshlrev_b32 v8, 16, v144
  v_and_b32 v9, 0xffff0000, v144
  v_mul_f32 v96, v96, v8
  v_mul_f32 v97, v97, v9
  v_cvt_pk_bf16_f32 v96, v96, v97
  v_lshlrev_b32 v2, 16, v145
  v_and_b32 v3, 0xffff0000, v145
  v_mul_f32 v98, v98, v2
  v_mul_f32 v99, v99, v3
  v_cvt_pk_bf16_f32 v97, v98, v99
  v_lshlrev_b32 v8, 16, v146
  v_and_b32 v9, 0xffff0000, v146
  v_mul_f32 v100, v100, v8
  v_mul_f32 v101, v101, v9
  v_cvt_pk_bf16_f32 v98, v100, v101
  v_lshlrev_b32 v2, 16, v147
  v_and_b32 v3, 0xffff0000, v147
  v_mul_f32 v102, v102, v2
  v_mul_f32 v103, v103, v3
  v_cvt_pk_bf16_f32 v99, v102, v103
  buffer_store_dwordx4 v[96:99], v24, s[16:19], s58 offen offset:1024 sc1
  s_waitcnt vmcnt(9)
  v_lshlrev_b32 v8, 16, v148
  v_and_b32 v9, 0xffff0000, v148
  v_mul_f32 v104, v104, v8
  v_mul_f32 v105, v105, v9
  v_cvt_pk_bf16_f32 v104, v104, v105
  v_lshlrev_b32 v2, 16, v149
  v_and_b32 v3, 0xffff0000, v149
  v_mul_f32 v106, v106, v2
  v_mul_f32 v107, v107, v3
  v_cvt_pk_bf16_f32 v105, v106, v107
  v_lshlrev_b32 v8, 16, v150
  v_and_b32 v9, 0xffff0000, v150
  v_mul_f32 v108, v108, v8
  v_mul_f32 v109, v109, v9
  v_cvt_pk_bf16_f32 v106, v108, v109
  v_lshlrev_b32 v2, 16, v151
  v_and_b32 v3, 0xffff0000, v151
  v_mul_f32 v110, v110, v2
  v_mul_f32 v111, v111, v3
  v_cvt_pk_bf16_f32 v107, v110, v111
  buffer_store_dwordx4 v[104:107], v24, s[16:19], s58 offen offset:1280 sc1
  s_waitcnt vmcnt(7)
  v_lshlrev_b32 v8, 16, v152
  v_and_b32 v9, 0xffff0000, v152
  v_mul_f32 v112, v112, v8
  v_mul_f32 v113, v113, v9
  v_cvt_pk_bf16_f32 v112, v112, v113
  v_lshlrev_b32 v2, 16, v153
  v_and_b32 v3, 0xffff0000, v153
  v_mul_f32 v114, v114, v2
  v_mul_f32 v115, v115, v3
  v_cvt_pk_bf16_f32 v113, v114, v115
  v_lshlrev_b32 v8, 16, v154
  v_and_b32 v9, 0xffff0000, v154
  v_mul_f32 v116, v116, v8
  v_mul_f32 v117, v117, v9
  v_cvt_pk_bf16_f32 v114, v116, v117
  v_lshlrev_b32 v2, 16, v155
  v_and_b32 v3, 0xffff0000, v155
  v_mul_f32 v118, v118, v2
  v_mul_f32 v119, v119, v3
  v_cvt_pk_bf16_f32 v115, v118, v119
  buffer_store_dwordx4 v[112:115], v24, s[16:19], s58 offen offset:1536 sc1
  s_waitcnt vmcnt(7)
  v_lshlrev_b32 v8, 16, v156
  v_and_b32 v9, 0xffff0000, v156
  v_mul_f32 v120, v120, v8
  v_mul_f32 v121, v121, v9
  v_cvt_pk_bf16_f32 v120, v120, v121
  v_lshlrev_b32 v2, 16, v157
  v_and_b32 v3, 0xffff0000, v157
  v_mul_f32 v122, v122, v2
  v_mul_f32 v123, v123, v3
  v_cvt_pk_bf16_f32 v121, v122, v123
  v_lshlrev_b32 v8, 16, v158
  v_and_b32 v9, 0xffff0000, v158
  v_mul_f32 v124, v124, v8
  v_mul_f32 v125, v125, v9
  v_cvt_pk_bf16_f32 v122, v124, v125
  v_lshlrev_b32 v2, 16, v159
  v_and_b32 v3, 0xffff0000, v159
  v_mul_f32 v126, v126, v2
  v_mul_f32 v127, v127, v3
  v_cvt_pk_bf16_f32 v123, v126, v127
  buffer_store_dwordx4 v[120:123], v24, s[16:19], s58 offen offset:1792 sc1
  s_waitcnt vmcnt(0)
  s_mov_b64 exec, 1
  buffer_store_dword v12, off, s[16:19], s61 sc1
  s_mov_b64 exec, -1
  s_waitcnt lgkmcnt(0)
.Lc2_join:
.Lc_p2end_g:
  s_xor_b32 s72, s72, 4
  s_and_b32 s48, s2, 3
  s_lshl_b32 s48, s48, 2
  s_lshr_b32 s48, 12918, s48
  s_and_b32 s48, s48, 7
  s_lshr_b32 s3, s2, 6
  s_lshl2_add_u32 s48, s48, s3
  s_lshr_b32 s52, s48, 1
  s_lshl_b32 s52, s52, 8
  s_add_u32 s52, s52, 17367040
  v_lshlrev_b32 v25, 2, v0
  buffer_load_dword v31, v25, s[16:19], s52 offen sc1
  s_lshr_b32 s53, s75, 1
  s_and_b32 s3, s75, 1
  s_lshl1_add_u32 s48, s48, s3
  v_and_b32 v1, 31, v0
  v_lshrrev_b32 v2, 5, v0
  v_lshlrev_b32 v7, 4, v2
  v_lshl_add_u32 v7, v1, 10, v7
  s_lshl_b32 s50, s48, 15
  s_lshl1_add_u32 s3, s72, s53
  s_lshl_b32 s51, s3, 17
  s_lshl_b32 s3, s3, 6
  s_add_u32 s50, s50, s3
  buffer_load_dwordx4 v[96:99], v7, s[4:7], s50 offen offset:0
  buffer_load_dwordx4 v[100:103], v7, s[4:7], s50 offen offset:32
  v_lshlrev_b32 v6, 15, v2
  v_lshl_add_u32 v6, v1, 4, v6
  s_lshl_b32 s48, s48, 9
  s_mul_i32 s49, s53, 1835008
  s_add_u32 s49, s49, s48
  s_add_u32 s49, s49, 12582912
  s_add_u32 s51, s51, s48
  s_add_u32 s51, s51, 8388608
  v_bfe_u32 v3, v0, 2, 2
  v_lshl_add_u32 v3, v2, 3, v3
  v_lshlrev_b32 v3, 7, v3
  v_bfe_u32 v1, v0, 4, 1
  v_bfe_u32 v2, v0, 3, 1
  v_lshl_add_u32 v1, v2, 1, v1
  v_lshl_add_u32 v3, v1, 5, v3
  v_and_b32 v1, 1, v0
  v_lshl_add_u32 v3, v1, 4, v3
  v_bfe_u32 v1, v0, 1, 1
  v_lshl_add_u32 v3, v1, 3, v3
  s_mul_i32 s3, s53, 8256
  v_xor_b32 v4, s3, v3
  v_xor_b32 v5, 64, v4
  s_lshl_b32 s3, s75, 12
  s_add_u32 s3, s3, 98304
  v_lshl_add_u32 v16, v0, 4, s3
  s_xor_b32 s3, s75, 2
  s_lshl_b32 s3, s3, 8
  s_add_u32 s3, s3, 157696
  v_mov_b32 v17, s3
  s_lshl_b32 s3, s72, 1
  s_lshl_b32 s55, 0x30003, s3
  s_mov_b32 s54, 0x0FFFFFFF
  ds_read_b32 v13, v10 offset:0
.Lc3_pre_g:
  s_waitcnt vmcnt(2)
.Lc3_fl1_g:
  v_cmp_ne_u32 vcc, s73, v31
  s_and_b32 s3, vcc_lo, s54
  s_cbranch_scc1 .Lc3_fl_g
.Lc3_go_g:
.Lc_p3go_g:
  buffer_load_dwordx4 v[128:131], v6, s[16:19], s49 offen sc1
  s_add_u32 s49, s49, 65536
  buffer_load_dwordx4 v[132:135], v6, s[16:19], s49 offen sc1
  s_add_u32 s49, s49, 65536
  buffer_load_dwordx4 v[136:139], v6, s[16:19], s49 offen sc1
  s_add_u32 s49, s49, 65536
  buffer_load_dwordx4 v[140:143], v6, s[16:19], s49 offen sc1
  s_add_u32 s49, s49, 65536
  buffer_load_dwordx4 v[144:147], v6, s[16:19], s49 offen sc1
  s_add_u32 s49, s49, 65536
  buffer_load_dwordx4 v[148:151], v6, s[16:19], s49 offen sc1
  s_add_u32 s49, s49, 65536
  buffer_load_dwordx4 v[152:155], v6, s[16:19], s49 offen sc1
  s_add_u32 s49, s49, 65536
  buffer_load_dwordx4 v[156:159], v6, s[16:19], s49 offen sc1
  s_add_u32 s49, s49, 65536
  buffer_load_dwordx4 v[160:163], v6, s[16:19], s49 offen sc1
  s_add_u32 s49, s49, 65536
  buffer_load_dwordx4 v[164:167], v6, s[16:19], s49 offen sc1
  s_add_u32 s49, s49, 65536
  buffer_load_dwordx4 v[168:171], v6, s[16:19], s49 offen sc1
  s_add_u32 s49, s49, 65536
  buffer_load_dwordx4 v[172:175], v6, s[16:19], s49 offen sc1
  s_add_u32 s49, s49, 65536
  buffer_load_dwordx4 v[176:179], v6, s[16:19], s49 offen sc1
  s_add_u32 s49, s49, 65536
  buffer_load_dwordx4 v[180:183], v6, s[16:19], s49 offen sc1
  s_add_u32 s49, s49, 65536
  s_waitcnt lgkmcnt(0)
  v_cmp_gt_u32 vcc, 244, v13
  s_cbranch_vccnz .Lsp_371
.Lrt_372:
  ds_read_b32 v13, v10 offset:1024
  v_add_u32 v5, 131072, v5
  ds_read_b64_tr_b16 v[32:33], v5 offset:0
  ds_read_b64_tr_b16 v[34:35], v5 offset:512
  v_add_u32 v4, 131072, v4
  ds_read_b64_tr_b16 v[36:37], v4 offset:0
  ds_read_b64_tr_b16 v[38:39], v4 offset:512
  ds_read_b64_tr_b16 v[40:41], v5 offset:2048
  ds_read_b64_tr_b16 v[42:43], v5 offset:2560
  ds_read_b64_tr_b16 v[44:45], v4 offset:2048
  ds_read_b64_tr_b16 v[46:47], v4 offset:2560
  ds_read_b64_tr_b16 v[48:49], v5 offset:4096
  ds_read_b64_tr_b16 v[50:51], v5 offset:4608
  ds_read_b64_tr_b16 v[52:53], v4 offset:4096
  ds_read_b64_tr_b16 v[54:55], v4 offset:4608
  ds_read_b64_tr_b16 v[56:57], v5 offset:6144
  ds_read_b64_tr_b16 v[58:59], v5 offset:6656
  s_waitcnt vmcnt(13) lgkmcnt(12)
  v_mfma_f32_32x32x16_bf16 v[80:95], v[32:35], v[128:131], 0
.Lc3_m0_g:
  ds_read_b64_tr_b16 v[60:61], v4 offset:6144
  ds_read_b64_tr_b16 v[62:63], v4 offset:6656
  s_waitcnt lgkmcnt(12)
  v_mfma_f32_32x32x16_bf16 v[64:79], v[36:39], v[128:131], 0
  v_add_u32 v5, 4294836224, v5
  ds_read_b64_tr_b16 v[32:33], v5 offset:0
  ds_read_b64_tr_b16 v[34:35], v5 offset:512
  s_waitcnt vmcnt(12) lgkmcnt(12)
  v_mfma_f32_32x32x16_bf16 v[80:95], v[40:43], v[132:135], v[80:95]
  v_add_u32 v4, 4294836224, v4
  ds_read_b64_tr_b16 v[36:37], v4 offset:0
  ds_read_b64_tr_b16 v[38:39], v4 offset:512
  s_waitcnt lgkmcnt(12)
  v_mfma_f32_32x32x16_bf16 v[64:79], v[44:47], v[132:135], v[64:79]
  ds_read_b64_tr_b16 v[40:41], v5 offset:2048
  ds_read_b64_tr_b16 v[42:43], v5 offset:2560
  s_waitcnt vmcnt(11) lgkmcnt(12)
  v_mfma_f32_32x32x16_bf16 v[80:95], v[48:51], v[136:139], v[80:95]
  ds_read_b64_tr_b16 v[44:45], v4 offset:2048
  ds_read_b64_tr_b16 v[46:47], v4 offset:2560
  s_waitcnt lgkmcnt(12)
  v_mfma_f32_32x32x16_bf16 v[64:79], v[52:55], v[136:139], v[64:79]
  ds_read_b64_tr_b16 v[48:49], v5 offset:4096
  ds_read_b64_tr_b16 v[50:51], v5 offset:4608
  s_waitcnt vmcnt(10) lgkmcnt(12)
  v_mfma_f32_32x32x16_bf16 v[80:95], v[56:59], v[140:143], v[80:95]
  ds_read_b64_tr_b16 v[52:53], v4 offset:4096
  ds_read_b64_tr_b16 v[54:55], v4 offset:4608
  s_waitcnt lgkmcnt(12)
  v_mfma_f32_32x32x16_bf16 v[64:79], v[60:63], v[140:143], v[64:79]
  ds_read_b64_tr_b16 v[56:57], v5 offset:6144
  ds_read_b64_tr_b16 v[58:59], v5 offset:6656
  s_waitcnt vmcnt(9) lgkmcnt(12)
  v_mfma_f32_32x32x16_bf16 v[80:95], v[32:35], v[144:147], v[80:95]
  ds_read_b64_tr_b16 v[60:61], v4 offset:6144
  ds_read_b64_tr_b16 v[62:63], v4 offset:6656
  s_waitcnt lgkmcnt(12)
  v_mfma_f32_32x32x16_bf16 v[64:79], v[36:39], v[144:147], v[64:79]
  ds_read_b64_tr_b16 v[32:33], v5 offset:16384
  ds_read_b64_tr_b16 v[34:35], v5 offset:16896
  s_waitcnt vmcnt(8) lgkmcnt(12)
  v_mfma_f32_32x32x16_bf16 v[80:95], v[40:43], v[148:151], v[80:95]
  ds_read_b64_tr_b16 v[36:37], v4 offset:16384
  ds_read_b64_tr_b16 v[38:39], v4 offset:16896
  buffer_load_dword v30, v25, s[16:19], s52 offen sc1
  buffer_load_dwordx4 v[184:187], v6, s[16:19], s49 offen sc1
  s_add_u32 s49, s49, 65536
  buffer_load_dwordx4 v[188:191], v6, s[16:19], s49 offen sc1
  s_add_u32 s49, s49, 65536
  buffer_load_dwordx4 v[192:195], v6, s[16:19], s49 offen sc1
  s_add_u32 s49, s49, 65536
  buffer_load_dwordx4 v[196:199], v6, s[16:19], s49 offen sc1
  s_add_u32 s49, s49, 65536
  buffer_load_dwordx4 v[200:203], v6, s[16:19], s49 offen sc1
  s_add_u32 s49, s49, 65536
  buffer_load_dwordx4 v[204:207], v6, s[16:19], s49 offen sc1
  s_add_u32 s49, s49, 65536
  buffer_load_dwordx4 v[208:211], v6, s[16:19], s49 offen sc1
  s_add_u32 s49, s49, 65536
  buffer_load_dwordx4 v[212:215], v6, s[16:19], s49 offen sc1
  s_add_u32 s49, s49, 65536
  s_waitcnt lgkmcnt(12)
  v_mfma_f32_32x32x16_bf16 v[64:79], v[44:47], v[148:151], v[64:79]
  ds_read_b64_tr_b16 v[40:41], v5 offset:18432
  ds_read_b64_tr_b16 v[42:43], v5 offset:18944
  s_waitcnt vmcnt(16) lgkmcnt(12)
  v_mfma_f32_32x32x16_bf16 v[80:95], v[48:51], v[152:155], v[80:95]
  ds_read_b64_tr_b16 v[44:45], v4 offset:18432
  ds_read_b64_tr_b16 v[46:47], v4 offset:18944
  s_waitcnt lgkmcnt(12)
  v_mfma_f32_32x32x16_bf16 v[64:79], v[52:55], v[152:155], v[64:79]
  ds_read_b64_tr_b16 v[48:49], v5 offset:20480
  ds_read_b64_tr_b16 v[50:51], v5 offset:20992
  s_waitcnt vmcnt(15) lgkmcnt(12)
  v_mfma_f32_32x32x16_bf16 v[80:95], v[56:59], v[156:159], v[80:95]
  ds_read_b64_tr_b16 v[52:53], v4 offset:20480
  ds_read_b64_tr_b16 v[54:55], v4 offset:20992
  s_waitcnt lgkmcnt(12)
  v_mfma_f32_32x32x16_bf16 v[64:79], v[60:63], v[156:159], v[64:79]
  ds_read_b64_tr_b16 v[56:57], v5 offset:22528
  ds_read_b64_tr_b16 v[58:59], v5 offset:23040
  s_waitcnt vmcnt(14) lgkmcnt(12)
  v_mfma_f32_32x32x16_bf16 v[80:95], v[32:35], v[160:163], v[80:95]
  ds_read_b64_tr_b16 v[60:61], v4 offset:22528
  ds_read_b64_tr_b16 v[62:63], v4 offset:23040
  s_waitcnt lgkmcnt(12)
  v_mfma_f32_32x32x16_bf16 v[64:79], v[36:39], v[160:163], v[64:79]
  ds_read_b64_tr_b16 v[32:33], v5 offset:32768
  ds_read_b64_tr_b16 v[34:35], v5 offset:33280
  s_waitcnt vmcnt(13) lgkmcnt(12)
  v_mfma_f32_32x32x16_bf16 v[80:95], v[40:43], v[164:167], v[80:95]
  ds_read_b64_tr_b16 v[36:37], v4 offset:32768
  ds_read_b64_tr_b16 v[38:39], v4 offset:33280
  s_waitcnt lgkmcnt(12)
  v_mfma_f32_32x32x16_bf16 v[64:79], v[44:47], v[164:167], v[64:79]
  ds_read_b64_tr_b16 v[40:41], v5 offset:34816
  ds_read_b64_tr_b16 v[42:43], v5 offset:35328
  s_waitcnt vmcnt(12) lgkmcnt(12)
  v_mfma_f32_32x32x16_bf16 v[80:95], v[48:51], v[168:171], v[80:95]
  ds_read_b64_tr_b16 v[44:45], v4 offset:34816
  ds_read_b64_tr_b16 v[46:47], v4 offset:35328
  s_waitcnt lgkmcnt(12)
  v_mfma_f32_32x32x16_bf16 v[64:79], v[52:55], v[168:171], v[64:79]
  ds_read_b64_tr_b16 v[48:49], v5 offset:36864
  ds_read_b64_tr_b16 v[50:51], v5 offset:37376
  s_waitcnt vmcnt(11) lgkmcnt(12)
  v_mfma_f32_32x32x16_bf16 v[80:95], v[56:59], v[172:175], v[80:95]
  ds_read_b64_tr_b16 v[52:53], v4 offset:36864
  ds_read_b64_tr_b16 v[54:55], v4 offset:37376
  s_waitcnt lgkmcnt(12)
  v_mfma_f32_32x32x16_bf16 v[64:79], v[60:63], v[172:175], v[64:79]
  ds_read_b64_tr_b16 v[56:57], v5 offset:38912
  ds_read_b64_tr_b16 v[58:59], v5 offset:39424
  s_waitcnt vmcnt(10) lgkmcnt(12)
  v_mfma_f32_32x32x16_bf16 v[80:95], v[32:35], v[176:179], v[80:95]
  ds_read_b64_tr_b16 v[60:61], v4 offset:38912
  ds_read_b64_tr_b16 v[62:63], v4 offset:39424
  s_waitcnt lgkmcnt(12)
  v_mfma_f32_32x32x16_bf16 v[64:79], v[36:39], v[176:179], v[64:79]
  ds_read_b64_tr_b16 v[32:33], v5 offset:49152
  ds_read_b64_tr_b16 v[34:35], v5 offset:49664
  s_waitcnt vmcnt(9) lgkmcnt(12)
  v_mfma_f32_32x32x16_bf16 v[80:95], v[40:43], v[180:183], v[80:95]
  ds_read_b64_tr_b16 v[36:37], v4 offset:49152
  ds_read_b64_tr_b16 v[38:39], v4 offset:49664
  s_waitcnt lgkmcnt(12)
  v_mfma_f32_32x32x16_bf16 v[64:79], v[44:47], v[180:183], v[64:79]
  ds_read_b64_tr_b16 v[40:41], v5 offset:51200
  ds_read_b64_tr_b16 v[42:43], v5 offset:51712
  s_waitcnt vmcnt(8)
  v_cmp_ne_u32 vcc, s73, v30
  s_and_b32 s3, vcc_hi, s55
  s_cbranch_scc1 .Lc3_f2_g
.Lc3_g2_g:
  s_add_u32 s3, s51, 65536
  buffer_load_dwordx4 v[104:107], v6, s[16:19], s51 offen sc1
  buffer_load_dwordx4 v[108:111], v6, s[16:19], s3 offen sc1
  s_add_u32 s51, s51, 2097152
  s_add_u32 s3, s3, 2097152
  buffer_load_dwordx4 v[112:115], v6, s[16:19], s51 offen sc1
  buffer_load_dwordx4 v[116:119], v6, s[16:19], s3 offen sc1
  buffer_load_dwordx4 v[216:219], v6, s[16:19], s49 offen sc1
  s_add_u32 s49, s49, 65536
  buffer_load_dwordx4 v[220:223], v6, s[16:19], s49 offen sc1
  s_add_u32 s49, s49, 65536
  buffer_load_dwordx4 v[224:227], v6, s[16:19], s49 offen sc1
  s_add_u32 s49, s49, 65536
  buffer_load_dwordx4 v[228:231], v6, s[16:19], s49 offen sc1
  s_add_u32 s49, s49, 65536
  buffer_load_dwordx4 v[232:235], v6, s[16:19], s49 offen sc1
  s_add_u32 s49, s49, 65536
  buffer_load_dwordx4 v[236:239], v6, s[16:19], s49 offen sc1
  s_waitcnt vmcnt(17) lgkmcnt(12)
  v_mfma_f32_32x32x16_bf16 v[80:95], v[48:51], v[184:187], v[80:95]
  ds_read_b64_tr_b16 v[44:45], v4 offset:51200
  ds_read_b64_tr_b16 v[46:47], v4 offset:51712
  s_waitcnt lgkmcnt(12)
  v_mfma_f32_32x32x16_bf16 v[64:79], v[52:55], v[184:187], v[64:79]
  ds_read_b64_tr_b16 v[48:49], v5 offset:53248
  ds_read_b64_tr_b16 v[50:51], v5 offset:53760
  s_waitcnt vmcnt(16) lgkmcnt(12)
  v_mfma_f32_32x32x16_bf16 v[80:95], v[56:59], v[188:191], v[80:95]
  ds_read_b64_tr_b16 v[52:53], v4 offset:53248
  ds_read_b64_tr_b16 v[54:55], v4 offset:53760
  s_waitcnt lgkmcnt(12)
  v_mfma_f32_32x32x16_bf16 v[64:79], v[60:63], v[188:191], v[64:79]
  ds_read_b64_tr_b16 v[56:57], v5 offset:55296
  ds_read_b64_tr_b16 v[58:59], v5 offset:55808
  s_waitcnt vmcnt(15) lgkmcnt(12)
  v_mfma_f32_32x32x16_bf16 v[80:95], v[32:35], v[192:195], v[80:95]
  ds_read_b64_tr_b16 v[60:61], v4 offset:55296
  ds_read_b64_tr_b16 v[62:63], v4 offset:55808
  s_waitcnt lgkmcnt(12)
  v_mfma_f32_32x32x16_bf16 v[64:79], v[36:39], v[192:195], v[64:79]
  v_add_u32 v5, 65536, v5
  ds_read_b64_tr_b16 v[32:33], v5 offset:0
  ds_read_b64_tr_b16 v[34:35], v5 offset:512
  s_waitcnt vmcnt(14) lgkmcnt(12)
  v_mfma_f32_32x32x16_bf16 v[80:95], v[40:43], v[196:199], v[80:95]
  v_add_u32 v4, 65536, v4
  ds_read_b64_tr_b16 v[36:37], v4 offset:0
  ds_read_b64_tr_b16 v[38:39], v4 offset:512
  s_waitcnt lgkmcnt(12)
  v_mfma_f32_32x32x16_bf16 v[64:79], v[44:47], v[196:199], v[64:79]
  ds_read_b64_tr_b16 v[40:41], v5 offset:2048
  ds_read_b64_tr_b16 v[42:43], v5 offset:2560
  s_waitcnt vmcnt(13) lgkmcnt(12)
  v_mfma_f32_32x32x16_bf16 v[80:95], v[48:51], v[200:203], v[80:95]
  ds_read_b64_tr_b16 v[44:45], v4 offset:2048
  ds_read_b64_tr_b16 v[46:47], v4 offset:2560
  s_waitcnt lgkmcnt(12)
  v_mfma_f32_32x32x16_bf16 v[64:79], v[52:55], v[200:203], v[64:79]
  ds_read_b64_tr_b16 v[48:49], v5 offset:4096
  ds_read_b64_tr_b16 v[50:51], v5 offset:4608
  s_waitcnt vmcnt(12) lgkmcnt(12)
  v_mfma_f32_32x32x16_bf16 v[80:95], v[56:59], v[204:207], v[80:95]
  ds_read_b64_tr_b16 v[52:53], v4 offset:4096
  ds_read_b64_tr_b16 v[54:55], v4 offset:4608
  s_waitcnt lgkmcnt(12)
  v_mfma_f32_32x32x16_bf16 v[64:79], v[60:63], v[204:207], v[64:79]
  ds_read_b64_tr_b16 v[56:57], v5 offset:6144
  ds_read_b64_tr_b16 v[58:59], v5 offset:6656
  s_waitcnt vmcnt(11) lgkmcnt(12)
  v_mfma_f32_32x32x16_bf16 v[80:95], v[32:35], v[208:211], v[80:95]
  ds_read_b64_tr_b16 v[60:61], v4 offset:6144
  ds_read_b64_tr_b16 v[62:63], v4 offset:6656
  s_waitcnt lgkmcnt(12)
  v_mfma_f32_32x32x16_bf16 v[64:79], v[36:39], v[208:211], v[64:79]
  ds_read_b64_tr_b16 v[32:33], v5 offset:16384
  ds_read_b64_tr_b16 v[34:35], v5 offset:16896
  s_waitcnt vmcnt(10) lgkmcnt(12)
  v_mfma_f32_32x32x16_bf16 v[80:95], v[40:43], v[212:215], v[80:95]
  ds_read_b64_tr_b16 v[36:37], v5 offset:18432
  ds_read_b64_tr_b16 v[38:39], v5 offset:18944
  s_waitcnt lgkmcnt(12)
  v_mfma_f32_32x32x16_bf16 v[64:79], v[44:47], v[212:215], v[64:79]
  ds_read_b64_tr_b16 v[40:41], v5 offset:20480
  ds_read_b64_tr_b16 v[42:43], v5 offset:20992
  s_waitcnt vmcnt(5) lgkmcnt(12)
  v_mfma_f32_32x32x16_bf16 v[80:95], v[48:51], v[216:219], v[80:95]
  ds_read_b64_tr_b16 v[44:45], v5 offset:22528
  ds_read_b64_tr_b16 v[46:47], v5 offset:23040
  s_waitcnt vmcnt(6)
  v_lshlrev_b32 v240, 16, v104
  v_and_b32 v241, 0xffff0000, v104
  v_lshlrev_b32 v8, 16, v112
  v_and_b32 v9, 0xffff0000, v112
  v_sub_f32 v240, v240, v8
  v_sub_f32 v241, v241, v9
  v_cvt_pk_bf16_f32 v241, v240, v241
  v_lshlrev_b32 v8, 16, v96
  s_waitcnt lgkmcnt(12)
  v_mfma_f32_32x32x16_bf16 v[64:79], v[52:55], v[216:219], v[64:79]
  ds_read_b64_tr_b16 v[48:49], v4 offset:16384
  ds_read_b64_tr_b16 v[50:51], v4 offset:16896
  v_and_b32 v9, 0xffff0000, v96
  v_lshlrev_b32 v240, 16, v241
  v_and_b32 v241, 0xffff0000, v241
  v_add_f32 v240, v240, v8
  v_add_f32 v241, v241, v9
  v_cvt_pk_bf16_f32 v241, v240, v241
  v_lshlrev_b32 v240, 16, v241
  v_and_b32 v241, 0xffff0000, v241
  s_waitcnt vmcnt(4) lgkmcnt(12)
  v_mfma_f32_32x32x16_bf16 v[80:95], v[56:59], v[220:223], v[80:95]
  ds_read_b64_tr_b16 v[52:53], v4 offset:18432
  ds_read_b64_tr_b16 v[54:55], v4 offset:18944
  v_lshlrev_b32 v242, 16, v105
  v_and_b32 v243, 0xffff0000, v105
  v_lshlrev_b32 v2, 16, v113
  v_and_b32 v3, 0xffff0000, v113
  v_sub_f32 v242, v242, v2
  v_sub_f32 v243, v243, v3
  v_cvt_pk_bf16_f32 v243, v242, v243
  v_lshlrev_b32 v2, 16, v97
  s_waitcnt lgkmcnt(12)
  v_mfma_f32_32x32x16_bf16 v[64:79], v[60:63], v[220:223], v[64:79]
  ds_read_b64_tr_b16 v[56:57], v4 offset:20480
  ds_read_b64_tr_b16 v[58:59], v4 offset:20992
  v_and_b32 v3, 0xffff0000, v97
  v_lshlrev_b32 v242, 16, v243
  v_and_b32 v243, 0xffff0000, v243
  v_add_f32 v242, v242, v2
  v_add_f32 v243, v243, v3
  v_cvt_pk_bf16_f32 v243, v242, v243
  v_lshlrev_b32 v242, 16, v243
  v_and_b32 v243, 0xffff0000, v243
  s_waitcnt vmcnt(3) lgkmcnt(12)
  v_mfma_f32_32x32x16_bf16 v[80:95], v[32:35], v[224:227], v[80:95]
  ds_read_b64_tr_b16 v[60:61], v4 offset:22528
  ds_read_b64_tr_b16 v[62:63], v4 offset:23040
  v_lshlrev_b32 v244, 16, v106
  v_and_b32 v245, 0xffff0000, v106
  v_lshlrev_b32 v8, 16, v114
  v_and_b32 v9, 0xffff0000, v114
  v_sub_f32 v244, v244, v8
  v_sub_f32 v245, v245, v9
  v_cvt_pk_bf16_f32 v245, v244, v245
  v_lshlrev_b32 v8, 16, v98
  s_waitcnt vmcnt(2) lgkmcnt(12)
  v_mfma_f32_32x32x16_bf16 v[80:95], v[36:39], v[228:231], v[80:95]
  v_and_b32 v9, 0xffff0000, v98
  v_lshlrev_b32 v244, 16, v245
  v_and_b32 v245, 0xffff0000, v245
  v_add_f32 v244, v244, v8
  v_add_f32 v245, v245, v9
  v_cvt_pk_bf16_f32 v245, v244, v245
  v_lshlrev_b32 v244, 16, v245
  v_and_b32 v245, 0xffff0000, v245
  s_waitcnt vmcnt(1) lgkmcnt(10)
  v_mfma_f32_32x32x16_bf16 v[80:95], v[40:43], v[232:235], v[80:95]
  v_lshlrev_b32 v246, 16, v107
  v_and_b32 v247, 0xffff0000, v107
  v_lshlrev_b32 v2, 16, v115
  v_and_b32 v3, 0xffff0000, v115
  v_sub_f32 v246, v246, v2
  v_sub_f32 v247, v247, v3
  v_cvt_pk_bf16_f32 v247, v246, v247
  v_lshlrev_b32 v2, 16, v99
  s_waitcnt vmcnt(0) lgkmcnt(8)
  v_mfma_f32_32x32x16_bf16 v[80:95], v[44:47], v[236:239], v[80:95]
  v_and_b32 v3, 0xffff0000, v99
  v_lshlrev_b32 v246, 16, v247
  v_and_b32 v247, 0xffff0000, v247
  v_add_f32 v246, v246, v2
  v_add_f32 v247, v247, v3
  v_cvt_pk_bf16_f32 v247, v246, v247
  v_lshlrev_b32 v246, 16, v247
  v_and_b32 v247, 0xffff0000, v247
  s_waitcnt lgkmcnt(6)
  v_mfma_f32_32x32x16_bf16 v[64:79], v[48:51], v[224:227], v[64:79]
  v_lshlrev_b32 v248, 16, v108
  v_and_b32 v249, 0xffff0000, v108
  v_lshlrev_b32 v8, 16, v116
  v_and_b32 v9, 0xffff0000, v116
  v_sub_f32 v248, v248, v8
  v_sub_f32 v249, v249, v9
  v_cvt_pk_bf16_f32 v249, v248, v249
  v_lshlrev_b32 v8, 16, v100
  s_waitcnt lgkmcnt(4)
  v_mfma_f32_32x32x16_bf16 v[64:79], v[52:55], v[228:231], v[64:79]
  v_and_b32 v9, 0xffff0000, v100
  v_lshlrev_b32 v248, 16, v249
  v_and_b32 v249, 0xffff0000, v249
  v_add_f32 v248, v248, v8
  v_add_f32 v249, v249, v9
  v_cvt_pk_bf16_f32 v249, v248, v249
  v_lshlrev_b32 v248, 16, v249
  v_and_b32 v249, 0xffff0000, v249
  s_waitcnt lgkmcnt(2)
  v_mfma_f32_32x32x16_bf16 v[64:79], v[56:59], v[232:235], v[64:79]
  v_lshlrev_b32 v250, 16, v109
  v_and_b32 v251, 0xffff0000, v109
  v_lshlrev_b32 v2, 16, v117
  v_and_b32 v3, 0xffff0000, v117
  v_sub_f32 v250, v250, v2
  v_sub_f32 v251, v251, v3
  v_cvt_pk_bf16_f32 v251, v250, v251
  v_lshlrev_b32 v2, 16, v101
  s_waitcnt lgkmcnt(0)
  v_mfma_f32_32x32x16_bf16 v[64:79], v[60:63], v[236:239], v[64:79]
  v_and_b32 v3, 0xffff0000, v101
  v_lshlrev_b32 v250, 16, v251
  v_and_b32 v251, 0xffff0000, v251
  v_add_f32 v250, v250, v2
  v_add_f32 v251, v251, v3
  v_cvt_pk_bf16_f32 v251, v250, v251
  v_lshlrev_b32 v250, 16, v251
  v_and_b32 v251, 0xffff0000, v251
  v_lshlrev_b32 v252, 16, v110
  v_and_b32 v253, 0xffff0000, v110
  v_lshlrev_b32 v8, 16, v118
  v_and_b32 v9, 0xffff0000, v118
  v_sub_f32 v252, v252, v8
  v_sub_f32 v253, v253, v9
  v_cvt_pk_bf16_f32 v253, v252, v253
  v_lshlrev_b32 v8, 16, v102
  v_and_b32 v9, 0xffff0000, v102
  v_lshlrev_b32 v252, 16, v253
  v_and_b32 v253, 0xffff0000, v253
  v_add_f32 v252, v252, v8
  v_add_f32 v253, v253, v9
  v_cvt_pk_bf16_f32 v253, v252, v253
  v_lshlrev_b32 v252, 16, v253
  v_and_b32 v253, 0xffff0000, v253
  v_lshlrev_b32 v254, 16, v111
  v_and_b32 v255, 0xffff0000, v111
  v_lshlrev_b32 v2, 16, v119
  v_and_b32 v3, 0xffff0000, v119
  v_sub_f32 v254, v254, v2
  v_sub_f32 v255, v255, v3
  v_cvt_pk_bf16_f32 v255, v254, v255
  v_lshlrev_b32 v2, 16, v103
  v_and_b32 v3, 0xffff0000, v103
  v_lshlrev_b32 v254, 16, v255
  v_and_b32 v255, 0xffff0000, v255
  v_add_f32 v254, v254, v2
  v_add_f32 v255, v255, v3
  v_cvt_pk_bf16_f32 v255, v254, v255
  v_lshlrev_b32 v254, 16, v255
  v_and_b32 v255, 0xffff0000, v255
  v_cmp_gt_u32 vcc, 48, v13
  s_cbranch_vccnz .Lsp_373
.Lrt_374:
  ds_write_b128 v16, v[80:83] offset:0
  ds_write_b128 v16, v[84:87] offset:1024
  ds_write_b128 v16, v[88:91] offset:2048
  ds_write_b128 v16, v[92:95] offset:3072
  v_mov_b32 v15, 4
  ds_write_b32 v11, v15 offset:9216
  v_xor_b32 v16, 8192, v16
.Lc_p3mm_g:
  ds_read_b32 v13, v17
  s_waitcnt lgkmcnt(0)
  v_cmp_gt_u32 vcc, 4, v13
  s_cbranch_vccnz .Lsp_375
.Lrt_376:
  ds_read_b128 v[80:83], v16 offset:0
  ds_read_b128 v[84:87], v16 offset:1024
  ds_read_b128 v[88:91], v16 offset:2048
  ds_read_b128 v[92:95], v16 offset:3072
  s_waitcnt lgkmcnt(3)
  v_pk_add_f32 v[64:65], v[64:65], v[80:81]
  v_cvt_pk_bf16_f32 v65, v64, v65
  v_lshlrev_b32 v64, 16, v65
  v_and_b32 v65, 0xffff0000, v65
  v_pk_add_f32 v[64:65], v[64:65], v[240:241]
  v_cvt_pk_bf16_f32 v96, v64, v65
  v_pk_add_f32 v[66:67], v[66:67], v[82:83]
  v_cvt_pk_bf16_f32 v67, v66, v67
  v_lshlrev_b32 v66, 16, v67
  v_and_b32 v67, 0xffff0000, v67
  v_pk_add_f32 v[66:67], v[66:67], v[242:243]
  v_cvt_pk_bf16_f32 v97, v66, v67
  s_waitcnt lgkmcnt(2)
  v_pk_add_f32 v[68:69], v[68:69], v[84:85]
  v_cvt_pk_bf16_f32 v69, v68, v69
  v_lshlrev_b32 v68, 16, v69
  v_and_b32 v69, 0xffff0000, v69
  v_pk_add_f32 v[68:69], v[68:69], v[244:245]
  v_cvt_pk_bf16_f32 v98, v68, v69
  v_pk_add_f32 v[70:71], v[70:71], v[86:87]
  v_cvt_pk_bf16_f32 v71, v70, v71
  v_lshlrev_b32 v70, 16, v71
  v_and_b32 v71, 0xffff0000, v71
  v_pk_add_f32 v[70:71], v[70:71], v[246:247]
  v_cvt_pk_bf16_f32 v99, v70, v71
  buffer_store_dwordx4 v[96:99], v7, s[32:35], s50 offen offset:0
  s_waitcnt lgkmcnt(1)
  v_pk_add_f32 v[72:73], v[72:73], v[88:89]
  v_cvt_pk_bf16_f32 v73, v72, v73
  v_lshlrev_b32 v72, 16, v73
  v_and_b32 v73, 0xffff0000, v73
  v_pk_add_f32 v[72:73], v[72:73], v[248:249]
  v_cvt_pk_bf16_f32 v100, v72, v73
  v_pk_add_f32 v[74:75], v[74:75], v[90:91]
  v_cvt_pk_bf16_f32 v75, v74, v75
  v_lshlrev_b32 v74, 16, v75
  v_and_b32 v75, 0xffff0000, v75
  v_pk_add_f32 v[74:75], v[74:75], v[250:251]
  v_cvt_pk_bf16_f32 v101, v74, v75
  s_waitcnt lgkmcnt(0)
  v_pk_add_f32 v[76:77], v[76:77], v[92:93]
  v_cvt_pk_bf16_f32 v77, v76, v77
  v_lshlrev_b32 v76, 16, v77
  v_and_b32 v77, 0xffff0000, v77
  v_pk_add_f32 v[76:77], v[76:77], v[252:253]
  v_cvt_pk_bf16_f32 v102, v76, v77
  v_pk_add_f32 v[78:79], v[78:79], v[94:95]
  v_cvt_pk_bf16_f32 v79, v78, v79
  v_lshlrev_b32 v78, 16, v79
  v_and_b32 v79, 0xffff0000, v79
  v_pk_add_f32 v[78:79], v[78:79], v[254:255]
  v_cvt_pk_bf16_f32 v103, v78, v79
  buffer_store_dwordx4 v[100:103], v7, s[32:35], s50 offen offset:32
.Lc_p3end_g:
  s_endpgm
.Lh_dt4:
  s_and_b32 s64, s2, 3
  s_lshl_b32 s64, s64, 5
  s_add_u32 s3, s3, s64
  s_sub_u32 s3, s3, 80
  s_min_u32 s3, s3, 111
  s_and_b32 s64, s3, 3
  s_lshr_b32 s3, s3, 2
  s_lshl_b32 s3, s3, 5
  s_add_u32 s3, s3, s64
  s_lshl_b32 s3, s3, 10
  buffer_load_dword v127, v126, s[28:31], s3 offen
  s_branch .Lh_dt3
.Lh_dt2:
  s_cmp_ge_u32 s3, 80
  s_cbranch_scc1 .Lh_dt4
  s_and_b32 s64, s2, 1
  s_lshl_b32 s64, s64, 7
  s_add_u32 s3, s3, s64
  s_add_u32 s3, s3, 48
  s_lshl_b32 s3, s3, 15
  buffer_load_dword v127, v126, s[40:43], s3 offen offset:3072
  s_branch .Lh_dt3
.Lsp_229:
  s_getreg_b32 s3, hwreg(HW_REG_IB_STS)
  s_bfe_u32 s79, s3, 131094
  s_and_b32 s3, s3, 15
  s_lshl4_add_u32 s3, s79, s3
  s_sub_u32 s3, 78, s3
  v_mov_b32 v13, s3
  ds_write_b32 v11, v13
  ds_read_b32 v12, v10 offset:10240
  s_cmp_eq_u32 s74, 0
  s_waitcnt lgkmcnt(0)
  s_cbranch_scc1 .Lrt_230
  s_sub_u32 s74, s74, 1
  v_cmp_gt_u32 vcc, 2, v12
  s_cbranch_vccnz .Lsp_229
  s_branch .Lrt_230
.Lno_231:
  buffer_load_dword v52, off, s[20:23], 0 sc1
  s_cmp_eq_u32 s74, 0
  s_waitcnt vmcnt(0)
  s_cbranch_scc1 .Lnk_232
  s_sub_u32 s74, s74, 1
  v_readfirstlane_b32 s73, v52
  s_cmp_lg_u32 s73, 0
  s_cbranch_scc0 .Lno_231
  s_branch .Lnk_232
.Lsp_233:
  s_getreg_b32 s3, hwreg(HW_REG_IB_STS)
  s_bfe_u32 s79, s3, 131094
  s_and_b32 s3, s3, 15
  s_lshl4_add_u32 s3, s79, s3
  s_sub_u32 s3, 78, s3
  v_mov_b32 v13, s3
  ds_write_b32 v11, v13
  ds_read_b32 v12, v52 offset:0
  s_cmp_eq_u32 s74, 0
  s_waitcnt lgkmcnt(0)
  s_cbranch_scc1 .Lrt_234
  s_sub_u32 s74, s74, 1
  v_cmp_gt_u32 vcc, 3, v12
  s_cbranch_vccnz .Lsp_233
  s_branch .Lrt_234
.Lsp_235:
  s_getreg_b32 s3, hwreg(HW_REG_IB_STS)
  s_bfe_u32 s79, s3, 131094
  s_and_b32 s3, s3, 15
  s_lshl4_add_u32 s3, s79, s3
  s_sub_u32 s3, 79, s3
  v_mov_b32 v13, s3
  ds_write_b32 v11, v13
  ds_read_b32 v12, v10 offset:1024
  s_cmp_eq_u32 s74, 0
  s_waitcnt lgkmcnt(0)
  s_cbranch_scc1 .Lrt_236
  s_sub_u32 s74, s74, 1
  v_cmp_gt_u32 vcc, 9, v12
  s_cbranch_vccnz .Lsp_235
  s_branch .Lrt_236
.Lsp_273:
  ds_read_b32 v13, v10 offset:1024
  s_cmp_eq_u32 s74, 0
  s_waitcnt lgkmcnt(0)
  s_cbranch_scc1 .Lrt_274
  s_sub_u32 s74, s74, 1
  v_cmp_gt_u32 vcc, 16, v13
  s_cbranch_vccnz .Lsp_273
  s_branch .Lrt_274
.Lsp_275:
  s_getreg_b32 s3, hwreg(HW_REG_IB_STS)
  s_bfe_u32 s79, s3, 131094
  s_and_b32 s3, s3, 15
  s_lshl4_add_u32 s3, s79, s3
  s_sub_u32 s3, 88, s3
  v_mov_b32 v13, s3
  ds_write_b32 v11, v13
  ds_read_b32 v12, v10 offset:1024
  s_cmp_eq_u32 s74, 0
  s_waitcnt lgkmcnt(0)
  s_cbranch_scc1 .Lrt_276
  s_sub_u32 s74, s74, 1
  v_cmp_gt_u32 vcc, 10, v12
  s_cbranch_vccnz .Lsp_275
  s_branch .Lrt_276
.Lsp_277:
  s_getreg_b32 s3, hwreg(HW_REG_IB_STS)
  s_bfe_u32 s79, s3, 131094
  s_and_b32 s3, s3, 15
  s_lshl4_add_u32 s3, s79, s3
  s_sub_u32 s3, 92, s3
  v_mov_b32 v13, s3
  ds_write_b32 v11, v13
  ds_read_b32 v12, v10 offset:1024
  s_cmp_eq_u32 s74, 0
  s_waitcnt lgkmcnt(0)
  s_cbranch_scc1 .Lrt_278
  s_sub_u32 s74, s74, 1
  v_cmp_gt_u32 vcc, 11, v12
  s_cbranch_vccnz .Lsp_277
  s_branch .Lrt_278
.Lsp_279:
  s_getreg_b32 s3, hwreg(HW_REG_IB_STS)
  s_bfe_u32 s79, s3, 131094
  s_and_b32 s3, s3, 15
  s_lshl4_add_u32 s3, s79, s3
  s_sub_u32 s3, 96, s3
  v_mov_b32 v13, s3
  ds_write_b32 v11, v13
  ds_read_b32 v12, v10 offset:1024
  s_cmp_eq_u32 s74, 0
  s_waitcnt lgkmcnt(0)
  s_cbranch_scc1 .Lrt_280
  s_sub_u32 s74, s74, 1
  v_cmp_gt_u32 vcc, 12, v12
  s_cbranch_vccnz .Lsp_279
  s_branch .Lrt_280
.Lsp_281:
  s_getreg_b32 s3, hwreg(HW_REG_IB_STS)
  s_bfe_u32 s79, s3, 131094
  s_and_b32 s3, s3, 15
  s_lshl4_add_u32 s3, s79, s3
  s_sub_u32 s3, 100, s3
  v_mov_b32 v13, s3
  ds_write_b32 v11, v13
  ds_read_b32 v12, v10 offset:1024
  s_cmp_eq_u32 s74, 0
  s_waitcnt lgkmcnt(0)
  s_cbranch_scc1 .Lrt_282
  s_sub_u32 s74, s74, 1
  v_cmp_gt_u32 vcc, 13, v12
  s_cbranch_vccnz .Lsp_281
  s_branch .Lrt_282
.Lsp_283:
  s_getreg_b32 s3, hwreg(HW_REG_IB_STS)
  s_bfe_u32 s79, s3, 131094
  s_and_b32 s3, s3, 15
  s_lshl4_add_u32 s3, s79, s3
  s_sub_u32 s3, 104, s3
  v_mov_b32 v13, s3
  ds_write_b32 v11, v13
  ds_read_b32 v12, v10 offset:1024
  s_cmp_eq_u32 s74, 0
  s_waitcnt lgkmcnt(0)
  s_cbranch_scc1 .Lrt_284
  s_sub_u32 s74, s74, 1
  v_cmp_gt_u32 vcc, 14, v12
  s_cbranch_vccnz .Lsp_283
  s_branch .Lrt_284
.Lsp_285:
  s_getreg_b32 s3, hwreg(HW_REG_IB_STS)
  s_bfe_u32 s79, s3, 131094
  s_and_b32 s3, s3, 15
  s_lshl4_add_u32 s3, s79, s3
  s_sub_u32 s3, 108, s3
  v_mov_b32 v13, s3
  ds_write_b32 v11, v13
  ds_read_b32 v12, v10 offset:1024
  s_cmp_eq_u32 s74, 0
  s_waitcnt lgkmcnt(0)
  s_cbranch_scc1 .Lrt_286
  s_sub_u32 s74, s74, 1
  v_cmp_gt_u32 vcc, 15, v12
  s_cbranch_vccnz .Lsp_285
  s_branch .Lrt_286
.Lsp_287:
  s_getreg_b32 s3, hwreg(HW_REG_IB_STS)
  s_bfe_u32 s79, s3, 131094
  s_and_b32 s3, s3, 15
  s_lshl4_add_u32 s3, s79, s3
  s_sub_u32 s3, 112, s3
  v_mov_b32 v13, s3
  ds_write_b32 v11, v13
  ds_read_b32 v12, v10 offset:2048
  s_cmp_eq_u32 s74, 0
  s_waitcnt lgkmcnt(0)
  s_cbranch_scc1 .Lrt_288
  s_sub_u32 s74, s74, 1
  v_cmp_gt_u32 vcc, 4, v12
  s_cbranch_vccnz .Lsp_287
  s_branch .Lrt_288
.Lh_tch_g:
  s_getreg_b32 s3, hwreg(HW_REG_IB_STS)
  s_bfe_u32 s79, s3, 131094
  s_and_b32 s3, s3, 15
  s_lshl4_add_u32 s3, s79, s3
  s_sub_u32 s3, 12, s3
  v_mov_b32 v13, s3
  ds_write_b32 v11, v13
  s_cmp_eq_u32 s3, 12
  s_cbranch_scc0 .Lh_tch_g
  v_mov_b32 v13, 0
  ds_write_b32 v11, v13
  v_mov_b32 v13, 4
  ds_write_b32 v11, v13 offset:2048
  v_lshrrev_b32 v1, 2, v0
  v_and_b32 v2, 3, v0
  v_lshlrev_b32 v2, 7, v2
  v_lshl_add_u32 v1, v1, 12, v2
  s_lshr_b32 s3, s2, 6
  s_lshl2_add_u32 s3, s3, s75
  s_and_b32 s64, s2, 1
  s_lshl_b32 s64, s64, 4
  s_add_u32 s64, s64, s3
  s_lshl_b32 s64, s64, 18
  s_and_b32 s65, s2, 3
  s_lshl_b32 s65, s65, 4
  s_add_u32 s65, s65, s3
  s_lshl_b32 s65, s65, 17
  s_add_u32 s3, s64, 0
  buffer_load_dword v127, v1, s[40:43], s3 offen offset:1024
  s_add_u32 s3, s64, 65536
  buffer_load_dword v127, v1, s[40:43], s3 offen offset:1024
  s_add_u32 s3, s64, 131072
  buffer_load_dword v127, v1, s[40:43], s3 offen offset:1024
  s_add_u32 s3, s64, 196608
  buffer_load_dword v127, v1, s[40:43], s3 offen offset:1024
  s_add_u32 s3, s65, 0
  buffer_load_dword v127, v1, s[24:27], s3 offen offset:1024
  s_add_u32 s3, s65, 65536
  buffer_load_dword v127, v1, s[24:27], s3 offen offset:1024
  s_add_u32 s3, s64, 0
  buffer_load_dword v127, v1, s[40:43], s3 offen offset:1536
  s_add_u32 s3, s64, 65536
  buffer_load_dword v127, v1, s[40:43], s3 offen offset:1536
  s_add_u32 s3, s64, 131072
  buffer_load_dword v127, v1, s[40:43], s3 offen offset:1536
  s_add_u32 s3, s64, 196608
  buffer_load_dword v127, v1, s[40:43], s3 offen offset:1536
  s_add_u32 s3, s65, 0
  buffer_load_dword v127, v1, s[24:27], s3 offen offset:1536
  s_add_u32 s3, s65, 65536
  buffer_load_dword v127, v1, s[24:27], s3 offen offset:1536
  s_add_u32 s3, s64, 0
  buffer_load_dword v127, v1, s[40:43], s3 offen offset:2048
  s_add_u32 s3, s64, 65536
  buffer_load_dword v127, v1, s[40:43], s3 offen offset:2048
  s_add_u32 s3, s64, 131072
  buffer_load_dword v127, v1, s[40:43], s3 offen offset:2048
  s_add_u32 s3, s64, 196608
  buffer_load_dword v127, v1, s[40:43], s3 offen offset:2048
  s_add_u32 s3, s65, 0
  buffer_load_dword v127, v1, s[24:27], s3 offen offset:2048
  s_add_u32 s3, s65, 65536
  buffer_load_dword v127, v1, s[24:27], s3 offen offset:2048
  s_add_u32 s3, s64, 0
  buffer_load_dword v127, v1, s[40:43], s3 offen offset:2560
  s_add_u32 s3, s64, 65536
  buffer_load_dword v127, v1, s[40:43], s3 offen offset:2560
  s_add_u32 s3, s64, 131072
  buffer_load_dword v127, v1, s[40:43], s3 offen offset:2560
  s_add_u32 s3, s64, 196608
  buffer_load_dword v127, v1, s[40:43], s3 offen offset:2560
  s_add_u32 s3, s65, 0
  buffer_load_dword v127, v1, s[24:27], s3 offen offset:2560
  s_add_u32 s3, s65, 65536
  buffer_load_dword v127, v1, s[24:27], s3 offen offset:2560
.Lh_tchi_g:
  s_waitcnt vmcnt(0) lgkmcnt(0)
.Lh_tche_g:
  s_branch .Lh2_done_g
.Lsp_289:
  s_getreg_b32 s3, hwreg(HW_REG_IB_STS)
  s_bfe_u32 s79, s3, 131094
  s_and_b32 s3, s3, 15
  s_lshl4_add_u32 s3, s79, s3
  s_sub_u32 s3, 216, s3
  v_mov_b32 v13, s3
  ds_write_b32 v11, v13
  ds_read_b32 v12, v10 offset:1024
  s_cmp_eq_u32 s74, 0
  s_waitcnt lgkmcnt(0)
  s_cbranch_scc1 .Lrt_290
  s_sub_u32 s74, s74, 1
  v_cmp_gt_u32 vcc, 16, v12
  s_cbranch_vccnz .Lsp_289
  s_branch .Lrt_290
.Lsp_291:
  s_getreg_b32 s3, hwreg(HW_REG_IB_STS)
  s_bfe_u32 s79, s3, 131094
  s_and_b32 s3, s3, 15
  s_lshl4_add_u32 s3, s79, s3
  s_sub_u32 s3, 220, s3
  v_mov_b32 v13, s3
  ds_write_b32 v11, v13
  ds_read_b32 v12, v10 offset:1024
  s_cmp_eq_u32 s74, 0
  s_waitcnt lgkmcnt(0)
  s_cbranch_scc1 .Lrt_292
  s_sub_u32 s74, s74, 1
  v_cmp_gt_u32 vcc, 41, v12
  s_cbranch_vccnz .Lsp_291
  s_branch .Lrt_292
.Lsp_293:
  s_getreg_b32 s3, hwreg(HW_REG_IB_STS)
  s_bfe_u32 s79, s3, 131094
  s_and_b32 s3, s3, 15
  s_lshl4_add_u32 s3, s79, s3
  s_sub_u32 s3, 224, s3
  v_mov_b32 v13, s3
  ds_write_b32 v11, v13
  ds_read_b32 v12, v10 offset:1024
  s_cmp_eq_u32 s74, 0
  s_waitcnt lgkmcnt(0)
  s_cbranch_scc1 .Lrt_294
  s_sub_u32 s74, s74, 1
  v_cmp_gt_u32 vcc, 42, v12
  s_cbranch_vccnz .Lsp_293
  s_branch .Lrt_294
.Lsp_295:
  s_getreg_b32 s3, hwreg(HW_REG_IB_STS)
  s_bfe_u32 s79, s3, 131094
  s_and_b32 s3, s3, 15
  s_lshl4_add_u32 s3, s79, s3
  s_sub_u32 s3, 228, s3
  v_mov_b32 v13, s3
  ds_write_b32 v11, v13
  ds_read_b32 v12, v10 offset:1024
  s_cmp_eq_u32 s74, 0
  s_waitcnt lgkmcnt(0)
  s_cbranch_scc1 .Lrt_296
  s_sub_u32 s74, s74, 1
  v_cmp_gt_u32 vcc, 43, v12
  s_cbranch_vccnz .Lsp_295
  s_branch .Lrt_296
.Lsp_297:
  s_getreg_b32 s3, hwreg(HW_REG_IB_STS)
  s_bfe_u32 s79, s3, 131094
  s_and_b32 s3, s3, 15
  s_lshl4_add_u32 s3, s79, s3
  s_sub_u32 s3, 232, s3
  v_mov_b32 v13, s3
  ds_write_b32 v11, v13
  ds_read_b32 v12, v10 offset:1024
  s_cmp_eq_u32 s74, 0
  s_waitcnt lgkmcnt(0)
  s_cbranch_scc1 .Lrt_298
  s_sub_u32 s74, s74, 1
  v_cmp_gt_u32 vcc, 44, v12
  s_cbranch_vccnz .Lsp_297
  s_branch .Lrt_298
.Lsp_299:
  s_getreg_b32 s3, hwreg(HW_REG_IB_STS)
  s_bfe_u32 s79, s3, 131094
  s_and_b32 s3, s3, 15
  s_lshl4_add_u32 s3, s79, s3
  s_sub_u32 s3, 236, s3
  v_mov_b32 v13, s3
  ds_write_b32 v11, v13
  ds_read_b32 v12, v10 offset:1024
  s_cmp_eq_u32 s74, 0
  s_waitcnt lgkmcnt(0)
  s_cbranch_scc1 .Lrt_300
  s_sub_u32 s74, s74, 1
  v_cmp_gt_u32 vcc, 45, v12
  s_cbranch_vccnz .Lsp_299
  s_branch .Lrt_300
.Lsp_301:
  s_getreg_b32 s3, hwreg(HW_REG_IB_STS)
  s_bfe_u32 s79, s3, 131094
  s_and_b32 s3, s3, 15
  s_lshl4_add_u32 s3, s79, s3
  s_sub_u32 s3, 240, s3
  v_mov_b32 v13, s3
  ds_write_b32 v11, v13
  ds_read_b32 v12, v10 offset:1024
  s_cmp_eq_u32 s74, 0
  s_waitcnt lgkmcnt(0)
  s_cbranch_scc1 .Lrt_302
  s_sub_u32 s74, s74, 1
  v_cmp_gt_u32 vcc, 46, v12
  s_cbranch_vccnz .Lsp_301
  s_branch .Lrt_302
.Lc2_fl_g:
  s_sleep 0
  buffer_load_dword v31, v25, s[16:19], s60 offen sc1
  s_cmp_eq_u32 s74, 0
  s_waitcnt vmcnt(0)
  s_cbranch_scc1 .Lc2_go_g
  s_sub_u32 s74, s74, 16
  s_max_i32 s74, s74, 0
  v_cmp_ne_u32 vcc, s73, v31
  s_nop 1
  s_and_b32 s3, vcc_lo, 0xFFFF
  s_cbranch_scc1 .Lc2_fl_g
  s_branch .Lc2_go_g
.Lsp_303:
  ds_read_b32 v13, v10 offset:0
  s_cmp_eq_u32 s74, 0
  s_waitcnt lgkmcnt(0)
  s_cbranch_scc1 .Lrt_304
  s_sub_u32 s74, s74, 1
  v_cmp_gt_u32 vcc, s52, v13
  s_cbranch_vccnz .Lsp_303
  s_branch .Lrt_304
.Lsp_323:
  ds_read_b32 v13, v10 offset:0
  s_cmp_eq_u32 s74, 0
  s_waitcnt lgkmcnt(0)
  s_cbranch_scc1 .Lrt_324
  s_sub_u32 s74, s74, 1
  v_cmp_gt_u32 vcc, s52, v13
  s_cbranch_vccnz .Lsp_323
  s_branch .Lrt_324
.Lsp_325:
  ds_read_b32 v13, v10 offset:0
  s_cmp_eq_u32 s74, 0
  s_waitcnt lgkmcnt(0)
  s_cbranch_scc1 .Lrt_326
  s_sub_u32 s74, s74, 1
  v_cmp_gt_u32 vcc, s52, v13
  s_cbranch_vccnz .Lsp_325
  s_branch .Lrt_326
.Lsp_327:
  ds_read_b32 v13, v10 offset:0
  s_cmp_eq_u32 s74, 0
  s_waitcnt lgkmcnt(0)
  s_cbranch_scc1 .Lrt_328
  s_sub_u32 s74, s74, 1
  v_cmp_gt_u32 vcc, s52, v13
  s_cbranch_vccnz .Lsp_327
  s_branch .Lrt_328
.Lsp_329:
  ds_read_b32 v13, v10 offset:0
  s_cmp_eq_u32 s74, 0
  s_waitcnt lgkmcnt(0)
  s_cbranch_scc1 .Lrt_330
  s_sub_u32 s74, s74, 1
  v_cmp_gt_u32 vcc, s52, v13
  s_cbranch_vccnz .Lsp_329
  s_branch .Lrt_330
.Lsp_331:
  buffer_load_dword v31, v25, s[16:19], s60 offen sc1
  s_cmp_eq_u32 s74, 0
  s_waitcnt vmcnt(0)
  s_cbranch_scc1 .Lrt_332
  s_sub_u32 s74, s74, 16
  s_max_i32 s74, s74, 0
  v_cmp_ne_u32 vcc, s73, v31
  s_cbranch_vccnz .Lsp_331
  s_branch .Lrt_332
.Lsp_333:
  ds_read_b32 v13, v10 offset:0
  s_cmp_eq_u32 s74, 0
  s_waitcnt lgkmcnt(0)
  s_cbranch_scc1 .Lrt_334
  s_sub_u32 s74, s74, 1
  v_cmp_gt_u32 vcc, s52, v13
  s_cbranch_vccnz .Lsp_333
  s_branch .Lrt_334
.Lsp_335:
  ds_read_b32 v13, v10 offset:0
  s_cmp_eq_u32 s74, 0
  s_waitcnt lgkmcnt(0)
  s_cbranch_scc1 .Lrt_336
  s_sub_u32 s74, s74, 1
  v_cmp_gt_u32 vcc, s52, v13
  s_cbranch_vccnz .Lsp_335
  s_branch .Lrt_336
.Lsp_337:
  ds_read_b32 v13, v10 offset:0
  s_cmp_eq_u32 s74, 0
  s_waitcnt lgkmcnt(0)
  s_cbranch_scc1 .Lrt_338
  s_sub_u32 s74, s74, 1
  v_cmp_gt_u32 vcc, s52, v13
  s_cbranch_vccnz .Lsp_337
  s_branch .Lrt_338
.Lsp_339:
  ds_read_b32 v13, v10 offset:0
  s_cmp_eq_u32 s74, 0
  s_waitcnt lgkmcnt(0)
  s_cbranch_scc1 .Lrt_340
  s_sub_u32 s74, s74, 1
  v_cmp_gt_u32 vcc, s52, v13
  s_cbranch_vccnz .Lsp_339
  s_branch .Lrt_340
.Lsp_359:
  ds_read_b32 v13, v10 offset:0
  s_cmp_eq_u32 s74, 0
  s_waitcnt lgkmcnt(0)
  s_cbranch_scc1 .Lrt_360
  s_sub_u32 s74, s74, 1
  v_cmp_gt_u32 vcc, s52, v13
  s_cbranch_vccnz .Lsp_359
  s_branch .Lrt_360
.Lsp_361:
  ds_read_b32 v13, v10 offset:0
  s_cmp_eq_u32 s74, 0
  s_waitcnt lgkmcnt(0)
  s_cbranch_scc1 .Lrt_362
  s_sub_u32 s74, s74, 1
  v_cmp_gt_u32 vcc, s52, v13
  s_cbranch_vccnz .Lsp_361
  s_branch .Lrt_362
.Lsp_363:
  ds_read_b32 v13, v10 offset:0
  s_cmp_eq_u32 s74, 0
  s_waitcnt lgkmcnt(0)
  s_cbranch_scc1 .Lrt_364
  s_sub_u32 s74, s74, 1
  v_cmp_gt_u32 vcc, s52, v13
  s_cbranch_vccnz .Lsp_363
  s_branch .Lrt_364
.Lc2_zf:
  buffer_load_dword v31, v25, s[16:19], s60 offen offset:3584 sc1
  s_cmp_eq_u32 s74, 0
  s_waitcnt vmcnt(0)
  s_cbranch_scc1 .Lc2_zgo
  s_sub_u32 s74, s74, 16
  s_max_i32 s74, s74, 0
  v_cmp_ne_u32 vcc, s73, v31
  s_cbranch_vccnz .Lc2_zf
  s_branch .Lc2_zgo
.Lsp_365:
  ds_read_b32 v13, v10 offset:0
  s_cmp_eq_u32 s74, 0
  s_waitcnt lgkmcnt(0)
  s_cbranch_scc1 .Lrt_366
  s_sub_u32 s74, s74, 1
  v_cmp_gt_u32 vcc, s52, v13
  s_cbranch_vccnz .Lsp_365
  s_branch .Lrt_366
.Lsp_367:
  ds_read_b32 v13, v10 offset:0
  s_cmp_eq_u32 s74, 0
  s_waitcnt lgkmcnt(0)
  s_cbranch_scc1 .Lrt_368
  s_sub_u32 s74, s74, 1
  v_cmp_gt_u32 vcc, s52, v13
  s_cbranch_vccnz .Lsp_367
  s_branch .Lrt_368
.Lsp_369:
  ds_read_b32 v13, v10 offset:0
  s_cmp_eq_u32 s74, 0
  s_waitcnt lgkmcnt(0)
  s_cbranch_scc1 .Lrt_370
  s_sub_u32 s74, s74, 1
  v_cmp_gt_u32 vcc, s52, v13
  s_cbranch_vccnz .Lsp_369
  s_branch .Lrt_370
.Lc2_skip:
  ds_read_b32 v13, v10 offset:0
  s_cmp_eq_u32 s74, 0
  s_waitcnt lgkmcnt(0)
  s_cbranch_scc1 .Lc2_skip2
  s_sub_u32 s74, s74, 1
  v_cmp_gt_u32 vcc, 120, v13
  s_sleep 2
  s_cbranch_vccnz .Lc2_skip
.Lc2_skip2:
  v_mov_b32 v30, 48
  s_mov_b32 s62, 1
  ds_write_b32 v11, v30
.Lc2_skip3:
  buffer_load_dword v12, off, s[20:23], 0 sc1
  s_cmp_eq_u32 s74, 0
  s_waitcnt vmcnt(0) lgkmcnt(0)
  s_cbranch_scc1 .Lc2_join
  s_sub_u32 s74, s74, 1
  v_readfirstlane_b32 s73, v12
  s_cmp_lg_u32 s73, 0
  s_cbranch_scc0 .Lc2_skip3
  s_branch .Lc2_join
.Lc3_fl_g:
  s_sleep 8
  buffer_load_dword v31, v25, s[16:19], s52 offen sc1
  s_cmp_eq_u32 s74, 0
  s_waitcnt vmcnt(0)
  s_cbranch_scc1 .Lc3_go_g
  s_sub_u32 s74, s74, 16
  s_max_i32 s74, s74, 0
  v_cmp_ne_u32 vcc, s73, v31
  s_nop 1
  s_and_b32 s3, vcc_lo, s54
  s_cbranch_scc1 .Lc3_fl_g
  s_branch .Lc3_go_g
.Lsp_371:
  ds_read_b32 v13, v10 offset:0
  s_cmp_eq_u32 s74, 0
  s_waitcnt lgkmcnt(0)
  s_cbranch_scc1 .Lrt_372
  s_sub_u32 s74, s74, 1
  v_cmp_gt_u32 vcc, 244, v13
  s_cbranch_vccnz .Lsp_371
  s_branch .Lrt_372
.Lc3_f2_g:
  buffer_load_dword v30, v25, s[16:19], s52 offen sc1
  s_cmp_eq_u32 s74, 0
  s_waitcnt vmcnt(0)
  s_cbranch_scc1 .Lc3_g2_g
  s_sub_u32 s74, s74, 16
  s_max_i32 s74, s74, 0
  v_cmp_ne_u32 vcc, s73, v30
  s_nop 1
  s_and_b32 s3, vcc_hi, s55
  s_cbranch_scc0 .Lc3_g2_g
  s_sleep 4
  s_branch .Lc3_f2_g
.Lsp_373:
  ds_read_b32 v13, v10 offset:1024
  s_cmp_eq_u32 s74, 0
  s_waitcnt lgkmcnt(0)
  s_cbranch_scc1 .Lrt_374
  s_sub_u32 s74, s74, 1
  v_cmp_gt_u32 vcc, 48, v13
  s_cbranch_vccnz .Lsp_373
  s_branch .Lrt_374
.Lsp_375:
  ds_read_b32 v13, v17 offset:0
  s_cmp_eq_u32 s74, 0
  s_waitcnt lgkmcnt(0)
  s_cbranch_scc1 .Lrt_376
  s_sub_u32 s74, s74, 1
  v_cmp_gt_u32 vcc, 4, v13
  s_cbranch_vccnz .Lsp_375
  s_branch .Lrt_376
.Lend_g:
.section .rodata,"a"
.p2align 6
.amdhsa_kernel gz_kernel
  .amdhsa_next_free_vgpr 256
  .amdhsa_next_free_sgpr 102
  .amdhsa_accum_offset 256
  .amdhsa_group_segment_fixed_size 0
  .amdhsa_kernarg_size 104
  .amdhsa_user_sgpr_count 2
  .amdhsa_user_sgpr_kernarg_segment_ptr 1
  .amdhsa_system_sgpr_workgroup_id_x 1
.end_amdhsa_kernel
```
